```python
import torch

def _softmax(x, axis=-1):
    return torch.softmax(x, dim=axis)
def _gelu(x):
    return torch.nn.functional.gelu(x, approximate="tanh")
def _silu(x):
    return torch.nn.functional.silu(x)
def _sigmoid(x):
    return torch.sigmoid(x)
def _layernorm(x, axis=-1, eps=1e-5):
    m = x.mean(dim=axis, keepdim=True)
    v = x.var(dim=axis, keepdim=True, unbiased=False)
    return (x - m) / torch.sqrt(v + eps)
def _scatter_add(tgt, idx, src, axis=0):
    return tgt.clone().index_add_(axis, idx, src)
def _segment_sum(src, seg, n):
    out = torch.zeros((n,) + src.shape[1:], dtype=src.dtype)
    return out.index_add_(0, seg, src)
def _pad(x, pw):
    flat = tuple(v for pair in reversed(pw) for v in pair)
    return torch.nn.functional.pad(x, flat)

kernel_name = 'gated_mix__spectral_gfnet__glu_gated_reglu__prompt'

def setup_inputs():

    _w = (lambda a: (lambda t: t.to(torch.bfloat16) if t.is_floating_point() else t)(torch.as_tensor(a)))
    def _A_setup():
        B, S, D = 1, 2048, 576
        Df = D // 2 + 1
        return {
            "x": _w((lambda *s: torch.randn(*s, dtype=torch.bfloat16) * 0.05)(B, S, D)),
            "w_r": _w((lambda *s: torch.randn(*s, dtype=torch.bfloat16) * 0.05)(S, Df) * 0.02),
            "w_i": _w((lambda *s: torch.randn(*s, dtype=torch.bfloat16) * 0.05)(S, Df) * 0.02),
        }
    _A_in = _A_setup()

    def _B_setup():
        B, S, D, F = 1, 2048, 576, 4608
        return {
            "x": _w((lambda *s: torch.randn(*s, dtype=torch.bfloat16) * 0.05)(B, S, D)),
            "W_gate": _w((lambda *s: torch.randn(*s, dtype=torch.bfloat16) * 0.2)(D, F) * (2.0 / D) ** 0.5),
            "W_up": _w((lambda *s: torch.randn(*s, dtype=torch.bfloat16) * 0.2)(D, F) * (2.0 / D) ** 0.5),
            "W_down": _w((lambda *s: torch.randn(*s, dtype=torch.bfloat16) * 0.2)(F, D) * (1.0 / F) ** 0.5),
        }
    _B_in = _B_setup()

    return {
        "A_x": _A_in["x"],
        "A_w_r": _A_in["w_r"],
        "A_w_i": _A_in["w_i"],
        "B_x": _B_in["x"],
        "B_W_gate": _B_in["W_gate"],
        "B_W_up": _B_in["W_up"],
        "B_W_down": _B_in["W_down"],
        "gate_w": _w((lambda *s: torch.randn(*s, dtype=torch.bfloat16) * 0.05)(576) * 16.0),
    }

def reference(A_x, A_w_r, A_w_i, B_x, B_W_gate, B_W_up, B_W_down, gate_w):
    def _A_ref(x, w_r, w_i):
        B, S, D = x.shape
        X = (lambda x, axes=(-2,-1): torch.fft.rfft2(x.float(), dim=axes))(x, axes=(-2, -1))
        W = w_r + 1j * w_i
        X = X * W
        y = (lambda x, s, axes=(-2,-1): torch.fft.irfft2(x, s=s, dim=axes).to(torch.bfloat16))(X, (S, D), axes=(-2, -1))
        return y

    def _B_ref(x, W_gate, W_up, W_down):
        gate = torch.einsum("bsd,df->bsf", x, W_gate)
        up = torch.einsum("bsd,df->bsf", x, W_up)
        gate = gate * (lambda x, dt: x.to(dt))(gate > 0, gate.dtype)
        h = gate * up
        return torch.einsum("bsf,fd->bsd", h, W_down)

    x = A_x
    g = _sigmoid((x * gate_w).sum(-1, keepdims=True))
    a = _A_ref(x, A_w_r, A_w_i)
    b = _B_ref(x, B_W_gate, B_W_up, B_W_down)
    return g * a + (1 - g) * b
```

```asm
; @launch grid=(256,1,1) block=(256,1,1) lds=160512
.amdgcn_target "amdgcn-amd-amdhsa--gfx950"
.text
.globl gated_mix__spectral_gfnet__glu_gated_reglu__prompt_kernel
.p2align 8
.type gated_mix__spectral_gfnet__glu_gated_reglu__prompt_kernel,@function
gated_mix__spectral_gfnet__glu_gated_reglu__prompt_kernel:
    s_cmp_ge_u32 s2, 256
    s_cbranch_scc1 L_end
    s_load_dwordx2 s[8:9], s[0:1], 0
    s_load_dwordx2 s[12:13], s[0:1], 32
    s_load_dwordx2 s[20:21], s[0:1], 40
    s_load_dwordx2 s[16:17], s[0:1], 80
    s_load_dwordx4 s[64:67], s[0:1], 8
    s_load_dwordx4 s[76:79], s[0:1], 48
    s_load_dwordx4 s[80:83], s[0:1], 64
    v_lshrrev_b32 v2, 6, v0
    v_and_b32 v0, 63, v0
    s_and_b32 s39, s2, 7
    s_lshr_b32 s38, s2, 3
    v_readfirstlane_b32 s36, v2
    s_and_b32 s40, s38, 3
    s_lshr_b32 s38, s38, 2
    s_lshl_b32 s37, s39, 2
    s_add_u32 s37, s37, s40
    s_getpc_b64 s[4:5]
L_pc:
    s_lshr_b32 s6, s2, 3
    s_lshl_b32 s6, s6, 2
    s_add_u32 s6, s6, s36
    s_lshl_b32 s6, s6, 10
    v_and_b32 v250, 7, v0
    v_lshlrev_b32 v250, 7, v250
    v_add_u32 v250, s6, v250
    v_min_u32 v250, L_code_end-L_pc-4, v250
    v_mov_b32 v251, s5
    v_add_co_u32 v250, vcc, s4, v250
    s_nop 1
    v_addc_co_u32 v251, vcc, 0, v251, vcc
    global_load_dword a220, v[250:251], off
    s_lshl_b32 s41, s40, 3
    s_add_u32 s41, s41, s39
    s_sub_u32 s3, s39, s38
    s_and_b32 s3, s3, 7
    s_lshr_b32 s4, s3, 2
    s_add_u32 s4, s4, 16
    s_and_b32 s3, s3, 3
    s_cmp_eq_u32 s3, 0
    s_cselect_b32 s4, s4, 31
    s_cmp_eq_u32 s40, 2
    s_cselect_b32 s41, s4, s41
    s_lshl_b32 s42, s2, 2
    s_add_u32 s42, s42, s36
    s_lshl_b32 s43, s38, 2
    s_add_u32 s43, s43, s36
    s_mul_i32 s43, s43, 1152
    v_lshrrev_b32 v3, 3, v0
    s_mov_b32 s44, 73728
    v_mul_lo_u32 v3, v3, s44
    v_add_u32 v3, s43, v3
    v_and_b32 v4, 7, v0
    v_lshrrev_b32 v5, 4, v0
    v_xor_b32 v6, v5, v4
    v_lshl_add_u32 v8, v6, 4, v3
    v_xor_b32 v6, 4, v6
    v_lshl_add_u32 v9, v6, 4, v3
    s_mul_i32 s45, s36, 73728
    s_mul_i32 s44, s37, 288
    s_add_u32 s45, s45, s44
    s_mov_b32 s46, 26843546
    s_sub_u32 s48, 4, s40
    s_and_b32 s48, s48, 3
    s_lshl_b32 s47, s48, 5
    v_lshrrev_b32 v22, 3, v0
    v_mul_u32_u24 v22, 9216, v22
    v_add3_u32 v22, v22, s45, 0
    v_add_u32 v22, s47, v22
    v_bfe_u32 v23, v0, 4, 1
    v_lshlrev_b32 v23, 1, v23
    v_and_b32 v6, 7, v0
    v_xor_b32 v23, v23, v6
    v_lshl_add_u32 v6, v23, 4, v22
    v_xor_b32 v23, 4, v23
    v_lshl_add_u32 v7, v23, 4, v22
    s_lshr_b32 s49, s42, 1
    s_and_b32 s50, s49, 31
    s_bfe_u32 s51, s49, 0x30005
    s_lshl_b32 s51, s51, 8
    s_add_u32 s50, s50, s51
    s_lshr_b32 s51, s49, 8
    s_lshl_b32 s51, s51, 5
    s_add_u32 s50, s50, s51
    s_mul_i32 s50, s50, 578
    s_and_b32 s63, s50, 2
    s_sub_u32 s50, s50, s63
    s_lshl_b32 s63, s63, 3
    s_and_b32 s51, s42, 1
    s_mul_i32 s51, s51, 40
    v_add_u32 v10, s51, v0
    v_lshlrev_b32 v11, 3, v10
    s_and_b32 s52, s42, 15
    s_lshl_b32 s52, s52, 1
    v_lshrrev_b32 v12, 5, v0
    v_add_u32 v12, s52, v12
    v_and_b32 v13, 3, v12
    v_bfe_u32 v14, v12, 2, 2
    v_lshl_add_u32 v13, v14, 3, v13
    v_lshrrev_b32 v14, 4, v12
    v_lshl_add_u32 v13, v14, 2, v13
    s_mov_b32 s44, 73728
    v_mul_lo_u32 v13, v13, s44
    v_and_b32 v14, 31, v0
    v_lshlrev_b32 v14, 4, v14
    v_add_u32 v13, v13, v14
    s_lshr_b32 s53, s42, 4
    s_lshr_b32 s54, s53, 1
    s_and_b32 s55, s53, 1
    s_lshl_b32 s55, s55, 5
    s_add_u32 s54, s54, s55
    s_mul_i32 s54, s54, 1152
    s_mov_b32 s10, 2359296
    s_mov_b32 s11, 0x20000
    s_mov_b32 s14, 5308416
    s_mov_b32 s15, 0x20000
    s_mov_b32 s22, 5308416
    s_mov_b32 s23, 0x20000
    s_mov_b32 s18, 45877248
    s_mov_b32 s19, 0x20000
    s_mov_b32 s26, 1183744
    s_mov_b32 s27, 0x20000
    s_mov_b32 s30, 1183744
    s_mov_b32 s31, 0x20000
    s_mov_b32 s34, 1152
    s_mov_b32 s35, 0x20000
    s_lshl_b32 s55, s36, 10
    s_mul_i32 s56, s36, 1280
    s_mul_i32 s57, s36, 24576
    s_add_u32 s57, s57, 62208
    s_mul_i32 s4, s40, 0
    s_mul_i32 s3, s38, 1
    s_add_u32 s3, s3, s4
    s_mul_i32 s4, s3, 57
    s_lshr_b32 s4, s4, 9
    s_mul_i32 s4, s4, 9
    s_sub_u32 s68, s3, s4
    s_lshl_b32 s72, s68, 7
    s_mul_i32 s74, s68, 589824
    v_min_u32 v250, 17, v0
    v_lshlrev_b32 v250, 7, v250
    s_mul_i32 s70, s42, 2304
    s_lshr_b32 s71, s2, 3
    s_lshl_b32 s71, s71, 1
    s_lshr_b32 s3, s36, 1
    s_add_u32 s71, s71, s3
    s_add_u32 s71, s71, 512
    s_mul_i32 s71, s71, 9216
    s_mul_i32 s3, s39, 1152
    s_add_u32 s71, s71, s3
    s_bitcmp1_b32 s36, 0
    s_cselect_b32 s73, 0x1e0, 0x1f
    s_waitcnt lgkmcnt(0)
    s_add_u32 m0, s57, 0
    s_add_u32 s58, s72, 0
    buffer_load_dwordx4 v8, s[8:11], s58 offen lds
    s_add_u32 m0, s57, 1024
    s_add_u32 s58, s72, 589824
    buffer_load_dwordx4 v9, s[8:11], s58 offen lds
    s_add_u32 m0, s57, 2048
    s_add_u32 s58, s72, 1179648
    buffer_load_dwordx4 v8, s[8:11], s58 offen lds
    s_add_u32 m0, s57, 3072
    s_add_u32 s58, s72, 1769472
    buffer_load_dwordx4 v9, s[8:11], s58 offen lds
    s_add_u32 m0, s57, 4096
    s_add_u32 s58, s72, 36864
    buffer_load_dwordx4 v8, s[8:11], s58 offen lds
    s_add_u32 m0, s57, 5120
    s_add_u32 s58, s72, 626688
    buffer_load_dwordx4 v9, s[8:11], s58 offen lds
    s_add_u32 m0, s57, 6144
    s_add_u32 s58, s72, 1216512
    buffer_load_dwordx4 v8, s[8:11], s58 offen lds
    s_add_u32 m0, s57, 7168
    s_add_u32 s58, s72, 1806336
    buffer_load_dwordx4 v9, s[8:11], s58 offen lds
    s_add_u32 m0, s55, 0
    s_nop 0
    buffer_load_dwordx4 v6, s[12:15], s74 offen lds
    s_add_u32 m0, s55, 4096
    s_nop 0
    buffer_load_dwordx4 v7, s[20:23], s74 offen lds
    s_add_u32 s74, s74, 294912
    s_cmp_ge_u32 s74, 5308416
    s_cselect_b32 s74, 0, s74
    s_add_u32 m0, s55, 10368
    s_nop 0
    buffer_load_dwordx4 v6, s[12:15], s74 offen lds
    s_add_u32 m0, s55, 14464
    s_nop 0
    buffer_load_dwordx4 v7, s[20:23], s74 offen lds
    s_mov_b64 s[24:25], s[64:65]
    s_mov_b64 s[28:29], s[66:67]
    s_mov_b64 s[32:33], s[78:79]
    v_mov_b32 v252, v13
    v_mov_b32 v253, v14
    v_mov_b32 v254, v11
    s_mov_b32 s52, s50
    s_lshl_b32 s3, s38, 3
    s_add_u32 s3, s3, s39
    s_lshl_b32 s60, s3, 5
    s_add_u32 s60, s60, s40
    s_lshl_b32 s60, s60, 2
    s_mul_i32 s84, s38, 3
    s_add_u32 s84, s84, s40
    s_lshl_b32 s84, s84, 5
    s_add_u32 s84, s84, s39
    s_add_u32 s84, s84, 2048
    s_add_u32 s3, s3, 3072
    s_cmp_eq_u32 s40, 3
    s_cselect_b32 s84, s3, s84
    s_cselect_b32 s85, 256, 0
    s_lshl_b32 s84, s84, 2
    v_mul_u32_u24 v14, s85, v0
    v_add_u32 v14, s84, v14
    v_writelane_b32 v14, s60, 16
    v_mov_b32 v15, 0
    s_add_u32 s60, s60, 26970112
    s_add_u32 s84, s84, 26970112
    s_add_u32 s85, s84, 2048
    s_mov_b32 s3, 26970112
    s_and_b32 s61, s2, 3
    s_lshl_b32 s61, s61, 6
    s_cmp_eq_u32 s36, 0
    s_cselect_b32 s60, s60, 0x80000000
    s_cselect_b32 s84, s84, 0x80000000
    s_cselect_b32 s61, s61, 0x80000000
    s_cselect_b32 s3, s3, 0x80000000
    s_mov_b64 exec, 0x1ffff
    buffer_store_dword v15, v14, s[16:19], s3 offen sc0 sc1
    s_mov_b64 exec, -1
    v_and_b32 v16, 31, v0
    v_lshrrev_b32 v17, 5, v0
    v_lshlrev_b32 v18, 7, v16
    v_add_u32 v18, s57, v18
    v_lshrrev_b32 v19, 1, v16
    v_and_b32 v19, 7, v19
    v_xor_b32 v19, v19, v17
    v_lshlrev_b32 v19, 4, v19
    v_xor_b32 v20, 0, v19
    v_add_u32 v2, v18, v20
    v_xor_b32 v20, 32, v19
    v_add_u32 v3, v18, v20
    v_xor_b32 v20, 64, v19
    v_add_u32 v4, v18, v20
    v_xor_b32 v20, 96, v19
    v_add_u32 v5, v18, v20
    v_lshlrev_b32 v22, 2, v12
    s_lshl_b32 s53, s53, 7
    s_add_u32 s53, s53, 26961920
    s_mov_b32 s6, 0xffff0000
    v_lshrrev_b32 v18, 3, v10
    v_lshlrev_b32 v18, 18, v18
    v_and_b32 v19, 3, v10
    v_lshl_add_u32 v18, v19, 4, v18
    v_bfe_u32 v19, v10, 2, 1
    v_lshl_add_u32 v18, v19, 15, v18
    v_mov_b32 v20, 0x80000000
    v_cmp_gt_u32 vcc, 40, v0
    s_nop 1
    v_cndmask_b32 v18, v20, v18, vcc
    v_cmp_gt_u32 vcc, 73, v10
    s_nop 1
    v_cndmask_b32 v23, v20, v18, vcc
    v_cmp_gt_u32 vcc, 72, v10
    s_nop 1
    v_cndmask_b32 v255, v20, v18, vcc
    s_lshl_b32 s49, s49, 6
    s_add_u32 s49, s49, 23855104
    s_mov_b32 s50, 0x05040100
    s_mov_b32 s51, 0x07060302
    s_lshl_b32 s44, s41, 5
    v_add_u32 v18, s44, v16
    v_subrev_u32 v19, 288, v18
    v_cmp_gt_u32 vcc, 289, v18
    v_mov_b32 v20, 0x3e800000
    s_nop 0
    v_cndmask_b32 v18, v19, v18, vcc
    v_cndmask_b32 v21, v20, 0, vcc
    v_mul_u32_u24 v19, s68, v18
    s_mov_b32 s44, 477218589
    v_mul_hi_u32 v20, v19, s44
    v_mul_u32_u24 v20, 9, v20
    v_sub_u32 v19, v19, v20
    v_cvt_f32_u32 v19, v19
    v_fmamk_f32 v21, v19, 0x3de38e39, v21
    v_cvt_f32_u32 v18, v18
    v_mul_f32 v18, 0x3ae38e39, v18
    v_cvt_f32_u32 v19, v17
    v_mul_f32 v19, 0x41000000, v19
    v_fma_f32 v21, v19, v18, v21
    v_cos_f32 v11, v21
    v_add_f32 v20, v21, v18
    v_cos_f32 v13, v20
    v_fmamk_f32 v21, v18, 0xc1800000, v21
    v_cos_f32 v10, v21
    v_add_f32 v20, v21, v18
    v_cos_f32 v12, v20
    v_mul_f32 v20, 0x41800000, v18
    v_cos_f32 v14, v20
    v_cos_f32 v15, v18
    v_add_f32 v14, v14, v14
    v_add_f32 v15, v15, v15
    v_bfe_u32 v18, v0, 4, 1
    v_mul_u32_u24 v1, 4160, v18
    v_lshrrev_b32 v18, 5, v0
    v_lshl_add_u32 v1, v18, 10, v1
    v_bfe_u32 v18, v0, 2, 2
    v_lshl_add_u32 v1, v18, 7, v1
    v_and_b32 v18, 3, v0
    v_lshl_add_u32 v1, v18, 3, v1
    v_bfe_u32 v18, v0, 3, 1
    v_lshl_add_u32 v1, v18, 5, v1
    v_xor_b32 v19, 32, v1
    v_xor_b32 v20, 64, v1
    v_xor_b32 v21, 96, v1
    buffer_load_dword a220, v250, s[8:11], s70 offen
    s_waitcnt vmcnt(4)
    s_barrier
    s_cmp_lt_u32 s41, 18
    s_cbranch_scc0 L_r1_nodft
    ds_read_b128 a[0:3], v2 offset:0
    ds_read_b64_tr_b16 v[24:25], v1 offset:0
    ds_read_b64_tr_b16 v[26:27], v1 offset:512
    ds_read_b128 a[4:7], v2 offset:4096
    ds_read_b64_tr_b16 v[28:29], v19 offset:0
    ds_read_b64_tr_b16 v[30:31], v19 offset:512
    ds_read_b64_tr_b16 v[32:33], v20 offset:0
    ds_read_b64_tr_b16 v[34:35], v20 offset:512
    ds_read_b64_tr_b16 v[36:37], v21 offset:0
    ds_read_b64_tr_b16 v[38:39], v21 offset:512
    v_fma_f32 v16, v15, v13, -v11
    v_cvt_pk_bf16_f32 v40, v11, v13
    v_fma_f32 v17, v15, v16, -v13
    v_fma_f32 v10, v14, v11, -v10
    v_fma_f32 v18, v15, v17, -v16
    v_cvt_pk_bf16_f32 v41, v16, v17
    v_fma_f32 v16, v15, v18, -v17
    v_fma_f32 v12, v14, v13, -v12
    v_fma_f32 v17, v15, v16, -v18
    v_cvt_pk_bf16_f32 v42, v18, v16
    v_fma_f32 v18, v15, v17, -v16
    v_cvt_pk_bf16_f32 v43, v17, v18
    s_waitcnt lgkmcnt(0)
    v_mfma_f32_32x32x16_bf16 v[64:79], v[24:27], a[0:3], 0
    ds_read_b128 a[8:11], v3 offset:0
    ds_read_b64_tr_b16 v[44:45], v1 offset:2048
    v_fma_f32 v16, v15, v12, -v10
    v_cvt_pk_bf16_f32 v60, v10, v12
    v_fma_f32 v17, v15, v16, -v12
    v_mfma_f32_32x32x16_bf16 v[80:95], v[24:27], a[4:7], 0
    ds_read_b64_tr_b16 v[46:47], v1 offset:2560
    ds_read_b128 a[12:15], v3 offset:4096
    v_fma_f32 v11, v14, v10, -v11
    v_fma_f32 v18, v15, v17, -v16
    v_cvt_pk_bf16_f32 v61, v16, v17
    v_mfma_f32_32x32x16_bf16 v[96:111], v[28:31], a[0:3], 0
    ds_read_b64_tr_b16 v[48:49], v19 offset:2048
    ds_read_b64_tr_b16 v[50:51], v19 offset:2560
    v_fma_f32 v16, v15, v18, -v17
    v_fma_f32 v13, v14, v12, -v13
    v_fma_f32 v17, v15, v16, -v18
    v_mfma_f32_32x32x16_bf16 v[112:127], v[28:31], a[4:7], 0
    ds_read_b64_tr_b16 v[52:53], v20 offset:2048
    ds_read_b64_tr_b16 v[54:55], v20 offset:2560
    v_cvt_pk_bf16_f32 v62, v18, v16
    v_fma_f32 v18, v15, v17, -v16
    v_cvt_pk_bf16_f32 v63, v17, v18
    v_mfma_f32_32x32x16_bf16 v[128:143], v[32:35], a[0:3], 0
    ds_read_b64_tr_b16 v[56:57], v21 offset:2048
    ds_read_b64_tr_b16 v[58:59], v21 offset:2560
    s_add_u32 s74, s74, 294912
    s_cmp_ge_u32 s74, 5308416
    s_cselect_b32 s74, 0, s74
    s_add_u32 m0, s55, 20736
    s_nop 0
    buffer_load_dwordx4 v6, s[12:15], s74 offen lds
    v_mfma_f32_32x32x16_bf16 v[144:159], v[32:35], a[4:7], 0
    s_add_u32 m0, s55, 24832
    s_nop 0
    buffer_load_dwordx4 v7, s[20:23], s74 offen lds
    v_mfma_f32_32x32x16_bf16 v[160:175], v[36:39], a[0:3], 0
    s_add_u32 s72, s72, 128
    s_cmp_ge_u32 s72, 1152
    s_cselect_b32 s72, 0, s72
    s_add_u32 m0, s57, 8192
    s_add_u32 s58, s72, 0
    buffer_load_dwordx4 v8, s[8:11], s58 offen lds
    v_mfma_f32_32x32x16_bf16 v[176:191], v[36:39], a[4:7], 0
    s_add_u32 m0, s57, 9216
    s_add_u32 s58, s72, 589824
    buffer_load_dwordx4 v9, s[8:11], s58 offen lds
    v_mfma_f32_32x32x16_bf16 v[192:207], a[0:3], v[40:43], 0
    s_add_u32 m0, s57, 10240
    s_add_u32 s58, s72, 1179648
    buffer_load_dwordx4 v8, s[8:11], s58 offen lds
    v_mfma_f32_32x32x16_bf16 v[208:223], a[4:7], v[40:43], 0
    s_add_u32 m0, s57, 11264
    s_add_u32 s58, s72, 1769472
    buffer_load_dwordx4 v9, s[8:11], s58 offen lds
    s_waitcnt vmcnt(8) lgkmcnt(0)
    s_barrier
    v_mfma_f32_32x32x16_bf16 v[64:79], v[44:47], a[8:11], v[64:79]
    ds_read_b128 a[16:19], v4 offset:0
    ds_read_b64_tr_b16 v[24:25], v1 offset:10368
    v_fma_f32 v16, v15, v13, -v11
    v_cvt_pk_bf16_f32 v40, v11, v13
    v_fma_f32 v17, v15, v16, -v13
    v_mfma_f32_32x32x16_bf16 v[80:95], v[44:47], a[12:15], v[80:95]
    ds_read_b64_tr_b16 v[26:27], v1 offset:10880
    ds_read_b128 a[20:23], v4 offset:4096
    v_fma_f32 v10, v14, v11, -v10
    v_fma_f32 v18, v15, v17, -v16
    v_cvt_pk_bf16_f32 v41, v16, v17
    v_mfma_f32_32x32x16_bf16 v[96:111], v[48:51], a[8:11], v[96:111]
    ds_read_b64_tr_b16 v[28:29], v19 offset:10368
    ds_read_b64_tr_b16 v[30:31], v19 offset:10880
    v_fma_f32 v16, v15, v18, -v17
    v_fma_f32 v12, v14, v13, -v12
    v_fma_f32 v17, v15, v16, -v18
    v_mfma_f32_32x32x16_bf16 v[112:127], v[48:51], a[12:15], v[112:127]
    ds_read_b64_tr_b16 v[32:33], v20 offset:10368
    ds_read_b64_tr_b16 v[34:35], v20 offset:10880
    v_cvt_pk_bf16_f32 v42, v18, v16
    v_fma_f32 v18, v15, v17, -v16
    v_cvt_pk_bf16_f32 v43, v17, v18
    v_mfma_f32_32x32x16_bf16 v[128:143], v[52:55], a[8:11], v[128:143]
    ds_read_b64_tr_b16 v[36:37], v21 offset:10368
    ds_read_b64_tr_b16 v[38:39], v21 offset:10880
    s_add_u32 m0, s57, 12288
    s_add_u32 s58, s72, 36864
    buffer_load_dwordx4 v8, s[8:11], s58 offen lds
    v_mfma_f32_32x32x16_bf16 v[144:159], v[52:55], a[12:15], v[144:159]
    s_add_u32 m0, s57, 13312
    s_add_u32 s58, s72, 626688
    buffer_load_dwordx4 v9, s[8:11], s58 offen lds
    v_mfma_f32_32x32x16_bf16 v[160:175], v[56:59], a[8:11], v[160:175]
    s_add_u32 m0, s57, 14336
    s_add_u32 s58, s72, 1216512
    buffer_load_dwordx4 v8, s[8:11], s58 offen lds
    v_mfma_f32_32x32x16_bf16 v[176:191], v[56:59], a[12:15], v[176:191]
    s_add_u32 m0, s57, 15360
    s_add_u32 s58, s72, 1806336
    buffer_load_dwordx4 v9, s[8:11], s58 offen lds
    v_mfma_f32_32x32x16_bf16 v[192:207], a[8:11], v[60:63], v[192:207]
    s_mov_b32 exec_lo, s73
    s_mov_b32 exec_hi, 0
    buffer_load_dword a220, v250, s[12:15], s71 offen
    s_mov_b64 exec, -1
    v_mfma_f32_32x32x16_bf16 v[208:223], a[12:15], v[60:63], v[208:223]
    s_mov_b32 exec_lo, s73
    s_mov_b32 exec_hi, 0
    buffer_load_dword a220, v250, s[20:23], s71 offen
    s_mov_b64 exec, -1
    s_waitcnt lgkmcnt(0)
    v_mfma_f32_32x32x16_bf16 v[64:79], v[24:27], a[16:19], v[64:79]
    ds_read_b128 a[24:27], v5 offset:0
    ds_read_b64_tr_b16 v[44:45], v1 offset:12416
    v_fma_f32 v16, v15, v12, -v10
    v_cvt_pk_bf16_f32 v60, v10, v12
    v_fma_f32 v17, v15, v16, -v12
    v_mfma_f32_32x32x16_bf16 v[80:95], v[24:27], a[20:23], v[80:95]
    ds_read_b64_tr_b16 v[46:47], v1 offset:12928
    ds_read_b128 a[28:31], v5 offset:4096
    v_fma_f32 v11, v14, v10, -v11
    v_fma_f32 v18, v15, v17, -v16
    v_cvt_pk_bf16_f32 v61, v16, v17
    v_mfma_f32_32x32x16_bf16 v[96:111], v[28:31], a[16:19], v[96:111]
    ds_read_b64_tr_b16 v[48:49], v19 offset:12416
    ds_read_b64_tr_b16 v[50:51], v19 offset:12928
    v_fma_f32 v16, v15, v18, -v17
    v_fma_f32 v13, v14, v12, -v13
    v_fma_f32 v17, v15, v16, -v18
    v_mfma_f32_32x32x16_bf16 v[112:127], v[28:31], a[20:23], v[112:127]
    ds_read_b64_tr_b16 v[52:53], v20 offset:12416
    ds_read_b64_tr_b16 v[54:55], v20 offset:12928
    v_cvt_pk_bf16_f32 v62, v18, v16
    v_fma_f32 v18, v15, v17, -v16
    v_cvt_pk_bf16_f32 v63, v17, v18
    v_mfma_f32_32x32x16_bf16 v[128:143], v[32:35], a[16:19], v[128:143]
    ds_read_b64_tr_b16 v[56:57], v21 offset:12416
    ds_read_b64_tr_b16 v[58:59], v21 offset:12928
    s_add_u32 s74, s74, 294912
    s_cmp_ge_u32 s74, 5308416
    s_cselect_b32 s74, 0, s74
    s_add_u32 m0, s55, 31104
    s_nop 0
    buffer_load_dwordx4 v6, s[12:15], s74 offen lds
    v_mfma_f32_32x32x16_bf16 v[144:159], v[32:35], a[20:23], v[144:159]
    s_add_u32 m0, s55, 35200
    s_nop 0
    buffer_load_dwordx4 v7, s[20:23], s74 offen lds
    v_mfma_f32_32x32x16_bf16 v[160:175], v[36:39], a[16:19], v[160:175]
    s_add_u32 s74, s74, 294912
    s_cmp_ge_u32 s74, 5308416
    s_cselect_b32 s74, 0, s74
    s_add_u32 m0, s55, 41472
    s_nop 0
    buffer_load_dwordx4 v6, s[12:15], s74 offen lds
    v_mfma_f32_32x32x16_bf16 v[176:191], v[36:39], a[20:23], v[176:191]
    s_add_u32 m0, s55, 45568
    s_nop 0
    buffer_load_dwordx4 v7, s[20:23], s74 offen lds
    v_mfma_f32_32x32x16_bf16 v[192:207], a[16:19], v[40:43], v[192:207]
    s_add_u32 s72, s72, 128
    s_cmp_ge_u32 s72, 1152
    s_cselect_b32 s72, 0, s72
    s_add_u32 m0, s57, 16384
    s_add_u32 s58, s72, 0
    buffer_load_dwordx4 v8, s[8:11], s58 offen lds
    v_mfma_f32_32x32x16_bf16 v[208:223], a[20:23], v[40:43], v[208:223]
    s_add_u32 m0, s57, 17408
    s_add_u32 s58, s72, 589824
    buffer_load_dwordx4 v9, s[8:11], s58 offen lds
    s_waitcnt vmcnt(8) lgkmcnt(0)
    s_barrier
    v_mfma_f32_32x32x16_bf16 v[64:79], v[44:47], a[24:27], v[64:79]
    ds_read_b128 a[32:35], v2 offset:8192
    ds_read_b64_tr_b16 v[24:25], v1 offset:20736
    v_fma_f32 v16, v15, v13, -v11
    v_cvt_pk_bf16_f32 v40, v11, v13
    v_fma_f32 v17, v15, v16, -v13
    v_mfma_f32_32x32x16_bf16 v[80:95], v[44:47], a[28:31], v[80:95]
    ds_read_b64_tr_b16 v[26:27], v1 offset:21248
    ds_read_b128 a[36:39], v2 offset:12288
    v_fma_f32 v10, v14, v11, -v10
    v_fma_f32 v18, v15, v17, -v16
    v_cvt_pk_bf16_f32 v41, v16, v17
    v_mfma_f32_32x32x16_bf16 v[96:111], v[48:51], a[24:27], v[96:111]
    ds_read_b64_tr_b16 v[28:29], v19 offset:20736
    ds_read_b64_tr_b16 v[30:31], v19 offset:21248
    v_fma_f32 v16, v15, v18, -v17
    v_fma_f32 v12, v14, v13, -v12
    v_fma_f32 v17, v15, v16, -v18
    v_mfma_f32_32x32x16_bf16 v[112:127], v[48:51], a[28:31], v[112:127]
    ds_read_b64_tr_b16 v[32:33], v20 offset:20736
    ds_read_b64_tr_b16 v[34:35], v20 offset:21248
    v_cvt_pk_bf16_f32 v42, v18, v16
    v_fma_f32 v18, v15, v17, -v16
    v_cvt_pk_bf16_f32 v43, v17, v18
    v_mfma_f32_32x32x16_bf16 v[128:143], v[52:55], a[24:27], v[128:143]
    ds_read_b64_tr_b16 v[36:37], v21 offset:20736
    ds_read_b64_tr_b16 v[38:39], v21 offset:21248
    s_add_u32 m0, s57, 18432
    s_add_u32 s58, s72, 1179648
    buffer_load_dwordx4 v8, s[8:11], s58 offen lds
    v_mfma_f32_32x32x16_bf16 v[144:159], v[52:55], a[28:31], v[144:159]
    s_add_u32 m0, s57, 19456
    s_add_u32 s58, s72, 1769472
    buffer_load_dwordx4 v9, s[8:11], s58 offen lds
    v_mfma_f32_32x32x16_bf16 v[160:175], v[56:59], a[24:27], v[160:175]
    s_add_u32 m0, s57, 20480
    s_add_u32 s58, s72, 36864
    buffer_load_dwordx4 v8, s[8:11], s58 offen lds
    v_mfma_f32_32x32x16_bf16 v[176:191], v[56:59], a[28:31], v[176:191]
    s_add_u32 m0, s57, 21504
    s_add_u32 s58, s72, 626688
    buffer_load_dwordx4 v9, s[8:11], s58 offen lds
    v_mfma_f32_32x32x16_bf16 v[192:207], a[24:27], v[60:63], v[192:207]
    s_add_u32 m0, s57, 22528
    s_add_u32 s58, s72, 1216512
    buffer_load_dwordx4 v8, s[8:11], s58 offen lds
    v_mfma_f32_32x32x16_bf16 v[208:223], a[28:31], v[60:63], v[208:223]
    s_add_u32 m0, s57, 23552
    s_add_u32 s58, s72, 1806336
    buffer_load_dwordx4 v9, s[8:11], s58 offen lds
    s_waitcnt lgkmcnt(0)
    v_mfma_f32_32x32x16_bf16 v[64:79], v[24:27], a[32:35], v[64:79]
    ds_read_b128 a[40:43], v3 offset:8192
    ds_read_b64_tr_b16 v[44:45], v1 offset:22784
    v_fma_f32 v16, v15, v12, -v10
    v_cvt_pk_bf16_f32 v60, v10, v12
    v_fma_f32 v17, v15, v16, -v12
    v_mfma_f32_32x32x16_bf16 v[80:95], v[24:27], a[36:39], v[80:95]
    ds_read_b64_tr_b16 v[46:47], v1 offset:23296
    ds_read_b128 a[44:47], v3 offset:12288
    v_fma_f32 v11, v14, v10, -v11
    v_fma_f32 v18, v15, v17, -v16
    v_cvt_pk_bf16_f32 v61, v16, v17
    v_mfma_f32_32x32x16_bf16 v[96:111], v[28:31], a[32:35], v[96:111]
    ds_read_b64_tr_b16 v[48:49], v19 offset:22784
    ds_read_b64_tr_b16 v[50:51], v19 offset:23296
    v_fma_f32 v16, v15, v18, -v17
    v_fma_f32 v13, v14, v12, -v13
    v_fma_f32 v17, v15, v16, -v18
    v_mfma_f32_32x32x16_bf16 v[112:127], v[28:31], a[36:39], v[112:127]
    ds_read_b64_tr_b16 v[52:53], v20 offset:22784
    ds_read_b64_tr_b16 v[54:55], v20 offset:23296
    v_cvt_pk_bf16_f32 v62, v18, v16
    v_fma_f32 v18, v15, v17, -v16
    v_cvt_pk_bf16_f32 v63, v17, v18
    v_mfma_f32_32x32x16_bf16 v[128:143], v[32:35], a[32:35], v[128:143]
    ds_read_b64_tr_b16 v[56:57], v21 offset:22784
    ds_read_b64_tr_b16 v[58:59], v21 offset:23296
    s_add_u32 s74, s74, 294912
    s_cmp_ge_u32 s74, 5308416
    s_cselect_b32 s74, 0, s74
    s_add_u32 m0, s55, 51840
    s_nop 0
    buffer_load_dwordx4 v6, s[12:15], s74 offen lds
    v_mfma_f32_32x32x16_bf16 v[144:159], v[32:35], a[36:39], v[144:159]
    s_add_u32 m0, s55, 55936
    s_nop 0
    buffer_load_dwordx4 v7, s[20:23], s74 offen lds
    v_mfma_f32_32x32x16_bf16 v[160:175], v[36:39], a[32:35], v[160:175]
    s_add_u32 s74, s74, 294912
    s_cmp_ge_u32 s74, 5308416
    s_cselect_b32 s74, 0, s74
    s_add_u32 m0, s55, 0
    s_nop 0
    buffer_load_dwordx4 v6, s[12:15], s74 offen lds
    v_mfma_f32_32x32x16_bf16 v[176:191], v[36:39], a[36:39], v[176:191]
    s_add_u32 m0, s55, 4096
    s_nop 0
    buffer_load_dwordx4 v7, s[20:23], s74 offen lds
    v_mfma_f32_32x32x16_bf16 v[192:207], a[32:35], v[40:43], v[192:207]
    s_add_u32 s72, s72, 128
    s_cmp_ge_u32 s72, 1152
    s_cselect_b32 s72, 0, s72
    s_add_u32 m0, s57, 0
    s_add_u32 s58, s72, 0
    buffer_load_dwordx4 v8, s[8:11], s58 offen lds
    v_mfma_f32_32x32x16_bf16 v[208:223], a[36:39], v[40:43], v[208:223]
    s_add_u32 m0, s57, 1024
    s_add_u32 s58, s72, 589824
    buffer_load_dwordx4 v9, s[8:11], s58 offen lds
    s_waitcnt vmcnt(16) lgkmcnt(0)
    s_barrier
    v_mfma_f32_32x32x16_bf16 v[64:79], v[44:47], a[40:43], v[64:79]
    ds_read_b128 a[48:51], v4 offset:8192
    ds_read_b64_tr_b16 v[24:25], v1 offset:31104
    v_fma_f32 v16, v15, v13, -v11
    v_cvt_pk_bf16_f32 v40, v11, v13
    v_fma_f32 v17, v15, v16, -v13
    v_mfma_f32_32x32x16_bf16 v[80:95], v[44:47], a[44:47], v[80:95]
    ds_read_b64_tr_b16 v[26:27], v1 offset:31616
    ds_read_b128 a[52:55], v4 offset:12288
    v_fma_f32 v10, v14, v11, -v10
    v_fma_f32 v18, v15, v17, -v16
    v_cvt_pk_bf16_f32 v41, v16, v17
    v_mfma_f32_32x32x16_bf16 v[96:111], v[48:51], a[40:43], v[96:111]
    ds_read_b64_tr_b16 v[28:29], v19 offset:31104
    ds_read_b64_tr_b16 v[30:31], v19 offset:31616
    v_fma_f32 v16, v15, v18, -v17
    v_fma_f32 v12, v14, v13, -v12
    v_fma_f32 v17, v15, v16, -v18
    v_mfma_f32_32x32x16_bf16 v[112:127], v[48:51], a[44:47], v[112:127]
    ds_read_b64_tr_b16 v[32:33], v20 offset:31104
    ds_read_b64_tr_b16 v[34:35], v20 offset:31616
    v_cvt_pk_bf16_f32 v42, v18, v16
    v_fma_f32 v18, v15, v17, -v16
    v_cvt_pk_bf16_f32 v43, v17, v18
    v_mfma_f32_32x32x16_bf16 v[128:143], v[52:55], a[40:43], v[128:143]
    ds_read_b64_tr_b16 v[36:37], v21 offset:31104
    ds_read_b64_tr_b16 v[38:39], v21 offset:31616
    s_add_u32 m0, s57, 2048
    s_add_u32 s58, s72, 1179648
    buffer_load_dwordx4 v8, s[8:11], s58 offen lds
    v_mfma_f32_32x32x16_bf16 v[144:159], v[52:55], a[44:47], v[144:159]
    s_add_u32 m0, s57, 3072
    s_add_u32 s58, s72, 1769472
    buffer_load_dwordx4 v9, s[8:11], s58 offen lds
    v_mfma_f32_32x32x16_bf16 v[160:175], v[56:59], a[40:43], v[160:175]
    s_add_u32 m0, s57, 4096
    s_add_u32 s58, s72, 36864
    buffer_load_dwordx4 v8, s[8:11], s58 offen lds
    v_mfma_f32_32x32x16_bf16 v[176:191], v[56:59], a[44:47], v[176:191]
    s_add_u32 m0, s57, 5120
    s_add_u32 s58, s72, 626688
    buffer_load_dwordx4 v9, s[8:11], s58 offen lds
    v_mfma_f32_32x32x16_bf16 v[192:207], a[40:43], v[60:63], v[192:207]
    s_add_u32 m0, s57, 6144
    s_add_u32 s58, s72, 1216512
    buffer_load_dwordx4 v8, s[8:11], s58 offen lds
    v_mfma_f32_32x32x16_bf16 v[208:223], a[44:47], v[60:63], v[208:223]
    s_add_u32 m0, s57, 7168
    s_add_u32 s58, s72, 1806336
    buffer_load_dwordx4 v9, s[8:11], s58 offen lds
    s_waitcnt lgkmcnt(0)
    v_mfma_f32_32x32x16_bf16 v[64:79], v[24:27], a[48:51], v[64:79]
    ds_read_b128 a[56:59], v5 offset:8192
    ds_read_b64_tr_b16 v[44:45], v1 offset:33152
    v_fma_f32 v16, v15, v12, -v10
    v_cvt_pk_bf16_f32 v60, v10, v12
    v_mfma_f32_32x32x16_bf16 v[80:95], v[24:27], a[52:55], v[80:95]
    ds_read_b64_tr_b16 v[46:47], v1 offset:33664
    ds_read_b128 a[60:63], v5 offset:12288
    v_fma_f32 v17, v15, v16, -v12
    v_fma_f32 v11, v14, v10, -v11
    v_mfma_f32_32x32x16_bf16 v[96:111], v[28:31], a[48:51], v[96:111]
    ds_read_b64_tr_b16 v[48:49], v19 offset:33152
    ds_read_b64_tr_b16 v[50:51], v19 offset:33664
    v_fma_f32 v18, v15, v17, -v16
    v_cvt_pk_bf16_f32 v61, v16, v17
    v_mfma_f32_32x32x16_bf16 v[112:127], v[28:31], a[52:55], v[112:127]
    ds_read_b64_tr_b16 v[52:53], v20 offset:33152
    ds_read_b64_tr_b16 v[54:55], v20 offset:33664
    v_fma_f32 v16, v15, v18, -v17
    v_fma_f32 v13, v14, v12, -v13
    v_mfma_f32_32x32x16_bf16 v[128:143], v[32:35], a[48:51], v[128:143]
    ds_read_b64_tr_b16 v[56:57], v21 offset:33152
    ds_read_b64_tr_b16 v[58:59], v21 offset:33664
    v_fma_f32 v17, v15, v16, -v18
    v_cvt_pk_bf16_f32 v62, v18, v16
    v_mfma_f32_32x32x16_bf16 v[144:159], v[32:35], a[52:55], v[144:159]
    v_fma_f32 v18, v15, v17, -v16
    v_cvt_pk_bf16_f32 v63, v17, v18
    v_mfma_f32_32x32x16_bf16 v[160:175], v[36:39], a[48:51], v[160:175]
    s_add_u32 s74, s74, 294912
    s_cmp_ge_u32 s74, 5308416
    s_cselect_b32 s74, 0, s74
    s_add_u32 m0, s55, 10368
    s_nop 0
    buffer_load_dwordx4 v6, s[12:15], s74 offen lds
    v_mfma_f32_32x32x16_bf16 v[176:191], v[36:39], a[52:55], v[176:191]
    s_add_u32 m0, s55, 14464
    s_nop 0
    buffer_load_dwordx4 v7, s[20:23], s74 offen lds
    v_mfma_f32_32x32x16_bf16 v[192:207], a[48:51], v[40:43], v[192:207]
    s_add_u32 s74, s74, 294912
    s_cmp_ge_u32 s74, 5308416
    s_cselect_b32 s74, 0, s74
    s_add_u32 m0, s55, 20736
    s_nop 0
    buffer_load_dwordx4 v6, s[12:15], s74 offen lds
    v_mfma_f32_32x32x16_bf16 v[208:223], a[52:55], v[40:43], v[208:223]
    s_add_u32 m0, s55, 24832
    s_nop 0
    buffer_load_dwordx4 v7, s[20:23], s74 offen lds
    s_waitcnt vmcnt(16) lgkmcnt(0)
    s_barrier
    v_mfma_f32_32x32x16_bf16 v[64:79], v[44:47], a[56:59], v[64:79]
    ds_read_b128 a[64:67], v2 offset:16384
    ds_read_b64_tr_b16 v[24:25], v1 offset:41472
    v_fma_f32 v16, v15, v13, -v11
    v_cvt_pk_bf16_f32 v40, v11, v13
    v_mfma_f32_32x32x16_bf16 v[80:95], v[44:47], a[60:63], v[80:95]
    ds_read_b64_tr_b16 v[26:27], v1 offset:41984
    ds_read_b128 a[68:71], v2 offset:20480
    v_fma_f32 v17, v15, v16, -v13
    v_fma_f32 v10, v14, v11, -v10
    v_mfma_f32_32x32x16_bf16 v[96:111], v[48:51], a[56:59], v[96:111]
    ds_read_b64_tr_b16 v[28:29], v19 offset:41472
    ds_read_b64_tr_b16 v[30:31], v19 offset:41984
    v_fma_f32 v18, v15, v17, -v16
    v_cvt_pk_bf16_f32 v41, v16, v17
    v_mfma_f32_32x32x16_bf16 v[112:127], v[48:51], a[60:63], v[112:127]
    ds_read_b64_tr_b16 v[32:33], v20 offset:41472
    ds_read_b64_tr_b16 v[34:35], v20 offset:41984
    v_fma_f32 v16, v15, v18, -v17
    v_fma_f32 v12, v14, v13, -v12
    v_mfma_f32_32x32x16_bf16 v[128:143], v[52:55], a[56:59], v[128:143]
    ds_read_b64_tr_b16 v[36:37], v21 offset:41472
    ds_read_b64_tr_b16 v[38:39], v21 offset:41984
    v_fma_f32 v17, v15, v16, -v18
    v_cvt_pk_bf16_f32 v42, v18, v16
    v_mfma_f32_32x32x16_bf16 v[144:159], v[52:55], a[60:63], v[144:159]
    buffer_load_dwordx4 v[224:227], v252, s[8:11], s54 offen offset:0
    v_fma_f32 v18, v15, v17, -v16
    v_mfma_f32_32x32x16_bf16 v[160:175], v[56:59], a[56:59], v[160:175]
    buffer_load_dwordx4 v[236:239], v253, s[32:35], 0 offen offset:0
    v_cvt_pk_bf16_f32 v43, v17, v18
    v_mfma_f32_32x32x16_bf16 v[176:191], v[56:59], a[60:63], v[176:191]
    buffer_load_dwordx4 v[228:231], v252, s[8:11], s54 offen offset:512
    v_mfma_f32_32x32x16_bf16 v[192:207], a[56:59], v[60:63], v[192:207]
    buffer_load_dwordx4 v[240:243], v253, s[32:35], 0 offen offset:512
    v_mfma_f32_32x32x16_bf16 v[208:223], a[60:63], v[60:63], v[208:223]
    buffer_load_dwordx4 v[232:235], v252, s[8:11], s54 offen offset:1024
    s_waitcnt lgkmcnt(0)
    v_mfma_f32_32x32x16_bf16 v[64:79], v[24:27], a[64:67], v[64:79]
    ds_read_b128 a[72:75], v3 offset:16384
    ds_read_b64_tr_b16 v[44:45], v1 offset:43520
    v_fma_f32 v16, v15, v12, -v10
    v_cvt_pk_bf16_f32 v60, v10, v12
    v_mfma_f32_32x32x16_bf16 v[80:95], v[24:27], a[68:71], v[80:95]
    ds_read_b64_tr_b16 v[46:47], v1 offset:44032
    ds_read_b128 a[76:79], v3 offset:20480
    v_fma_f32 v17, v15, v16, -v12
    v_fma_f32 v11, v14, v10, -v11
    v_mfma_f32_32x32x16_bf16 v[96:111], v[28:31], a[64:67], v[96:111]
    ds_read_b64_tr_b16 v[48:49], v19 offset:43520
    ds_read_b64_tr_b16 v[50:51], v19 offset:44032
    v_fma_f32 v18, v15, v17, -v16
    v_cvt_pk_bf16_f32 v61, v16, v17
    v_mfma_f32_32x32x16_bf16 v[112:127], v[28:31], a[68:71], v[112:127]
    ds_read_b64_tr_b16 v[52:53], v20 offset:43520
    ds_read_b64_tr_b16 v[54:55], v20 offset:44032
    v_fma_f32 v16, v15, v18, -v17
    v_fma_f32 v13, v14, v12, -v13
    v_mfma_f32_32x32x16_bf16 v[128:143], v[32:35], a[64:67], v[128:143]
    ds_read_b64_tr_b16 v[56:57], v21 offset:43520
    ds_read_b64_tr_b16 v[58:59], v21 offset:44032
    v_fma_f32 v17, v15, v16, -v18
    v_cvt_pk_bf16_f32 v62, v18, v16
    v_mfma_f32_32x32x16_bf16 v[144:159], v[32:35], a[68:71], v[144:159]
    buffer_load_dwordx4 v[244:247], v253, s[32:35], 0 offen offset:1024
    v_fma_f32 v18, v15, v17, -v16
    v_mfma_f32_32x32x16_bf16 v[160:175], v[36:39], a[64:67], v[160:175]
    s_add_u32 s7, s52, 0
    buffer_load_dwordx3 a[224:226], v254, s[24:27], s7 offen
    v_mfma_f32_32x32x16_bf16 v[176:191], v[36:39], a[68:71], v[176:191]
    buffer_load_dwordx3 a[240:242], v254, s[28:31], s7 offen
    v_cvt_pk_bf16_f32 v63, v17, v18
    v_mfma_f32_32x32x16_bf16 v[192:207], a[64:67], v[40:43], v[192:207]
    s_add_u32 s7, s52, 36992
    buffer_load_dwordx3 a[228:230], v254, s[24:27], s7 offen
    v_mfma_f32_32x32x16_bf16 v[208:223], a[68:71], v[40:43], v[208:223]
    buffer_load_dwordx3 a[244:246], v254, s[28:31], s7 offen
    s_waitcnt vmcnt(24) lgkmcnt(0)
    s_barrier
    v_mfma_f32_32x32x16_bf16 v[64:79], v[44:47], a[72:75], v[64:79]
    ds_read_b128 a[80:83], v4 offset:16384
    ds_read_b64_tr_b16 v[24:25], v1 offset:51840
    v_fma_f32 v16, v15, v13, -v11
    v_cvt_pk_bf16_f32 v40, v11, v13
    v_mfma_f32_32x32x16_bf16 v[80:95], v[44:47], a[76:79], v[80:95]
    ds_read_b64_tr_b16 v[26:27], v1 offset:52352
    ds_read_b128 a[84:87], v4 offset:20480
    v_fma_f32 v17, v15, v16, -v13
    v_fma_f32 v10, v14, v11, -v10
    v_mfma_f32_32x32x16_bf16 v[96:111], v[48:51], a[72:75], v[96:111]
    ds_read_b64_tr_b16 v[28:29], v19 offset:51840
    ds_read_b64_tr_b16 v[30:31], v19 offset:52352
    v_fma_f32 v18, v15, v17, -v16
    v_cvt_pk_bf16_f32 v41, v16, v17
    v_mfma_f32_32x32x16_bf16 v[112:127], v[48:51], a[76:79], v[112:127]
    ds_read_b64_tr_b16 v[32:33], v20 offset:51840
    ds_read_b64_tr_b16 v[34:35], v20 offset:52352
    v_fma_f32 v16, v15, v18, -v17
    v_fma_f32 v12, v14, v13, -v12
    v_mfma_f32_32x32x16_bf16 v[128:143], v[52:55], a[72:75], v[128:143]
    ds_read_b64_tr_b16 v[36:37], v21 offset:51840
    ds_read_b64_tr_b16 v[38:39], v21 offset:52352
    v_fma_f32 v17, v15, v16, -v18
    v_cvt_pk_bf16_f32 v42, v18, v16
    v_mfma_f32_32x32x16_bf16 v[144:159], v[52:55], a[76:79], v[144:159]
    s_add_u32 s7, s52, 73984
    buffer_load_dwordx3 a[232:234], v254, s[24:27], s7 offen
    v_mfma_f32_32x32x16_bf16 v[160:175], v[56:59], a[72:75], v[160:175]
    buffer_load_dwordx3 a[248:250], v254, s[28:31], s7 offen
    v_fma_f32 v18, v15, v17, -v16
    v_mfma_f32_32x32x16_bf16 v[176:191], v[56:59], a[76:79], v[176:191]
    s_add_u32 s7, s52, 110976
    buffer_load_dwordx3 a[236:238], v254, s[24:27], s7 offen
    v_mfma_f32_32x32x16_bf16 v[192:207], a[72:75], v[60:63], v[192:207]
    buffer_load_dwordx3 a[252:254], v254, s[28:31], s7 offen
    v_cvt_pk_bf16_f32 v43, v17, v18
    v_mfma_f32_32x32x16_bf16 v[208:223], a[76:79], v[60:63], v[208:223]
    s_add_u32 s72, s72, 128
    s_cmp_ge_u32 s72, 1152
    s_cselect_b32 s72, 0, s72
    s_add_u32 m0, s57, 8192
    s_add_u32 s58, s72, 0
    buffer_load_dwordx4 v8, s[8:11], s58 offen lds
    s_waitcnt lgkmcnt(0)
    v_mfma_f32_32x32x16_bf16 v[64:79], v[24:27], a[80:83], v[64:79]
    ds_read_b128 a[88:91], v5 offset:16384
    ds_read_b64_tr_b16 v[44:45], v1 offset:53888
    v_fma_f32 v16, v15, v12, -v10
    v_cvt_pk_bf16_f32 v60, v10, v12
    v_fma_f32 v17, v15, v16, -v12
    v_mfma_f32_32x32x16_bf16 v[80:95], v[24:27], a[84:87], v[80:95]
    ds_read_b64_tr_b16 v[46:47], v1 offset:54400
    ds_read_b128 a[92:95], v5 offset:20480
    v_fma_f32 v11, v14, v10, -v11
    v_fma_f32 v18, v15, v17, -v16
    v_cvt_pk_bf16_f32 v61, v16, v17
    v_mfma_f32_32x32x16_bf16 v[96:111], v[28:31], a[80:83], v[96:111]
    ds_read_b64_tr_b16 v[48:49], v19 offset:53888
    ds_read_b64_tr_b16 v[50:51], v19 offset:54400
    v_fma_f32 v16, v15, v18, -v17
    v_fma_f32 v13, v14, v12, -v13
    v_fma_f32 v17, v15, v16, -v18
    v_mfma_f32_32x32x16_bf16 v[112:127], v[28:31], a[84:87], v[112:127]
    ds_read_b64_tr_b16 v[52:53], v20 offset:53888
    ds_read_b64_tr_b16 v[54:55], v20 offset:54400
    v_cvt_pk_bf16_f32 v62, v18, v16
    v_fma_f32 v18, v15, v17, -v16
    v_cvt_pk_bf16_f32 v63, v17, v18
    v_mfma_f32_32x32x16_bf16 v[128:143], v[32:35], a[80:83], v[128:143]
    ds_read_b64_tr_b16 v[56:57], v21 offset:53888
    ds_read_b64_tr_b16 v[58:59], v21 offset:54400
    v_mfma_f32_32x32x16_bf16 v[144:159], v[32:35], a[84:87], v[144:159]
    s_add_u32 m0, s57, 9216
    s_add_u32 s58, s72, 589824
    buffer_load_dwordx4 v9, s[8:11], s58 offen lds
    v_mfma_f32_32x32x16_bf16 v[160:175], v[36:39], a[80:83], v[160:175]
    s_add_u32 m0, s57, 10240
    s_add_u32 s58, s72, 1179648
    buffer_load_dwordx4 v8, s[8:11], s58 offen lds
    v_mfma_f32_32x32x16_bf16 v[176:191], v[36:39], a[84:87], v[176:191]
    s_add_u32 m0, s57, 11264
    s_add_u32 s58, s72, 1769472
    buffer_load_dwordx4 v9, s[8:11], s58 offen lds
    v_mfma_f32_32x32x16_bf16 v[192:207], a[80:83], v[40:43], v[192:207]
    s_add_u32 m0, s57, 12288
    s_add_u32 s58, s72, 36864
    buffer_load_dwordx4 v8, s[8:11], s58 offen lds
    v_mfma_f32_32x32x16_bf16 v[208:223], a[84:87], v[40:43], v[208:223]
    s_add_u32 m0, s57, 13312
    s_add_u32 s58, s72, 626688
    buffer_load_dwordx4 v9, s[8:11], s58 offen lds
    s_waitcnt vmcnt(24) lgkmcnt(0)
    s_barrier
    v_mfma_f32_32x32x16_bf16 v[64:79], v[44:47], a[88:91], v[64:79]
    ds_read_b128 a[96:99], v2 offset:0
    ds_read_b64_tr_b16 v[24:25], v1 offset:0
    v_fma_f32 v16, v15, v13, -v11
    v_cvt_pk_bf16_f32 v40, v11, v13
    v_fma_f32 v17, v15, v16, -v13
    v_mfma_f32_32x32x16_bf16 v[80:95], v[44:47], a[92:95], v[80:95]
    ds_read_b64_tr_b16 v[26:27], v1 offset:512
    ds_read_b128 a[100:103], v2 offset:4096
    v_fma_f32 v10, v14, v11, -v10
    v_fma_f32 v18, v15, v17, -v16
    v_cvt_pk_bf16_f32 v41, v16, v17
    v_mfma_f32_32x32x16_bf16 v[96:111], v[48:51], a[88:91], v[96:111]
    ds_read_b64_tr_b16 v[28:29], v19 offset:0
    ds_read_b64_tr_b16 v[30:31], v19 offset:512
    v_fma_f32 v16, v15, v18, -v17
    v_fma_f32 v12, v14, v13, -v12
    v_fma_f32 v17, v15, v16, -v18
    v_mfma_f32_32x32x16_bf16 v[112:127], v[48:51], a[92:95], v[112:127]
    ds_read_b64_tr_b16 v[32:33], v20 offset:0
    ds_read_b64_tr_b16 v[34:35], v20 offset:512
    v_cvt_pk_bf16_f32 v42, v18, v16
    v_fma_f32 v18, v15, v17, -v16
    v_cvt_pk_bf16_f32 v43, v17, v18
    v_mfma_f32_32x32x16_bf16 v[128:143], v[52:55], a[88:91], v[128:143]
    ds_read_b64_tr_b16 v[36:37], v21 offset:0
    ds_read_b64_tr_b16 v[38:39], v21 offset:512
    v_mfma_f32_32x32x16_bf16 v[144:159], v[52:55], a[92:95], v[144:159]
    s_add_u32 m0, s57, 14336
    s_add_u32 s58, s72, 1216512
    buffer_load_dwordx4 v8, s[8:11], s58 offen lds
    v_mfma_f32_32x32x16_bf16 v[160:175], v[56:59], a[88:91], v[160:175]
    s_add_u32 m0, s57, 15360
    s_add_u32 s58, s72, 1806336
    buffer_load_dwordx4 v9, s[8:11], s58 offen lds
    v_mfma_f32_32x32x16_bf16 v[176:191], v[56:59], a[92:95], v[176:191]
    s_add_u32 s74, s74, 294912
    s_cmp_ge_u32 s74, 5308416
    s_cselect_b32 s74, 0, s74
    s_add_u32 m0, s55, 31104
    s_nop 0
    buffer_load_dwordx4 v6, s[12:15], s74 offen lds
    v_mfma_f32_32x32x16_bf16 v[192:207], a[88:91], v[60:63], v[192:207]
    s_add_u32 m0, s55, 35200
    s_nop 0
    buffer_load_dwordx4 v7, s[20:23], s74 offen lds
    v_mfma_f32_32x32x16_bf16 v[208:223], a[92:95], v[60:63], v[208:223]
    s_add_u32 s74, s74, 294912
    s_cmp_ge_u32 s74, 5308416
    s_cselect_b32 s74, 0, s74
    s_add_u32 m0, s55, 41472
    s_nop 0
    buffer_load_dwordx4 v6, s[12:15], s74 offen lds
    s_waitcnt lgkmcnt(0)
    v_mfma_f32_32x32x16_bf16 v[64:79], v[24:27], a[96:99], v[64:79]
    ds_read_b128 a[104:107], v3 offset:0
    ds_read_b64_tr_b16 v[44:45], v1 offset:2048
    v_fma_f32 v16, v15, v12, -v10
    v_cvt_pk_bf16_f32 v60, v10, v12
    v_fma_f32 v17, v15, v16, -v12
    v_mfma_f32_32x32x16_bf16 v[80:95], v[24:27], a[100:103], v[80:95]
    ds_read_b64_tr_b16 v[46:47], v1 offset:2560
    ds_read_b128 a[108:111], v3 offset:4096
    v_fma_f32 v11, v14, v10, -v11
    v_fma_f32 v18, v15, v17, -v16
    v_cvt_pk_bf16_f32 v61, v16, v17
    v_mfma_f32_32x32x16_bf16 v[96:111], v[28:31], a[96:99], v[96:111]
    ds_read_b64_tr_b16 v[48:49], v19 offset:2048
    ds_read_b64_tr_b16 v[50:51], v19 offset:2560
    v_fma_f32 v16, v15, v18, -v17
    v_fma_f32 v13, v14, v12, -v13
    v_fma_f32 v17, v15, v16, -v18
    v_mfma_f32_32x32x16_bf16 v[112:127], v[28:31], a[100:103], v[112:127]
    ds_read_b64_tr_b16 v[52:53], v20 offset:2048
    ds_read_b64_tr_b16 v[54:55], v20 offset:2560
    v_cvt_pk_bf16_f32 v62, v18, v16
    v_fma_f32 v18, v15, v17, -v16
    v_cvt_pk_bf16_f32 v63, v17, v18
    v_mfma_f32_32x32x16_bf16 v[128:143], v[32:35], a[96:99], v[128:143]
    ds_read_b64_tr_b16 v[56:57], v21 offset:2048
    ds_read_b64_tr_b16 v[58:59], v21 offset:2560
    v_mfma_f32_32x32x16_bf16 v[144:159], v[32:35], a[100:103], v[144:159]
    s_add_u32 m0, s55, 45568
    s_nop 0
    buffer_load_dwordx4 v7, s[20:23], s74 offen lds
    v_mfma_f32_32x32x16_bf16 v[160:175], v[36:39], a[96:99], v[160:175]
    s_add_u32 s72, s72, 128
    s_cmp_ge_u32 s72, 1152
    s_cselect_b32 s72, 0, s72
    s_add_u32 m0, s57, 16384
    s_add_u32 s58, s72, 0
    buffer_load_dwordx4 v8, s[8:11], s58 offen lds
    v_mfma_f32_32x32x16_bf16 v[176:191], v[36:39], a[100:103], v[176:191]
    s_add_u32 m0, s57, 17408
    s_add_u32 s58, s72, 589824
    buffer_load_dwordx4 v9, s[8:11], s58 offen lds
    v_mfma_f32_32x32x16_bf16 v[192:207], a[96:99], v[40:43], v[192:207]
    s_add_u32 m0, s57, 18432
    s_add_u32 s58, s72, 1179648
    buffer_load_dwordx4 v8, s[8:11], s58 offen lds
    v_mfma_f32_32x32x16_bf16 v[208:223], a[100:103], v[40:43], v[208:223]
    s_add_u32 m0, s57, 19456
    s_add_u32 s58, s72, 1769472
    buffer_load_dwordx4 v9, s[8:11], s58 offen lds
    s_mov_b32 s24, s76
    s_mov_b32 s25, s77
    s_mov_b32 s26, 5308416
    s_mov_b32 s27, 0x20000
    s_mov_b32 s28, s80
    s_mov_b32 s29, s81
    s_mov_b32 s30, 2359296
    s_mov_b32 s31, 0x20000
    s_mov_b32 s32, s82
    s_mov_b32 s33, s83
    s_mov_b32 s34, 256
    s_mov_b32 s35, 0x20000
    s_waitcnt vmcnt(16) lgkmcnt(0)
    s_barrier
    v_mfma_f32_32x32x16_bf16 v[64:79], v[44:47], a[104:107], v[64:79]
    ds_read_b128 a[112:115], v4 offset:0
    ds_read_b64_tr_b16 v[24:25], v1 offset:10368
    v_fma_f32 v16, v15, v13, -v11
    v_cvt_pk_bf16_f32 v40, v11, v13
    v_fma_f32 v17, v15, v16, -v13
    v_fma_f32 v10, v14, v11, -v10
    v_fma_f32 v18, v15, v17, -v16
    v_mfma_f32_32x32x16_bf16 v[80:95], v[44:47], a[108:111], v[80:95]
    ds_read_b64_tr_b16 v[26:27], v1 offset:10880
    ds_read_b128 a[116:119], v4 offset:4096
    v_cvt_pk_bf16_f32 v41, v16, v17
    v_fma_f32 v16, v15, v18, -v17
    v_fma_f32 v12, v14, v13, -v12
    v_fma_f32 v17, v15, v16, -v18
    v_cvt_pk_bf16_f32 v42, v18, v16
    v_mfma_f32_32x32x16_bf16 v[96:111], v[48:51], a[104:107], v[96:111]
    ds_read_b64_tr_b16 v[28:29], v19 offset:10368
    ds_read_b64_tr_b16 v[30:31], v19 offset:10880
    v_fma_f32 v18, v15, v17, -v16
    v_cvt_pk_bf16_f32 v43, v17, v18
    v_mov_b32 v248, 0
    v_mov_b32 v249, 0
    v_lshlrev_b32 v250, 16, v224
    v_mfma_f32_32x32x16_bf16 v[112:127], v[48:51], a[108:111], v[112:127]
    ds_read_b64_tr_b16 v[32:33], v20 offset:10368
    ds_read_b64_tr_b16 v[34:35], v20 offset:10880
    v_and_b32 v251, s6, v224
    v_lshlrev_b32 v252, 16, v236
    v_and_b32 v253, s6, v236
    v_mul_f32 v250, v250, v252
    v_mul_f32 v251, v251, v253
    v_mfma_f32_32x32x16_bf16 v[128:143], v[52:55], a[104:107], v[128:143]
    ds_read_b64_tr_b16 v[36:37], v21 offset:10368
    ds_read_b64_tr_b16 v[38:39], v21 offset:10880
    v_cvt_pk_bf16_f32 v252, v250, v251
    v_lshlrev_b32 v250, 16, v252
    v_and_b32 v251, s6, v252
    v_add_f32 v248, v248, v250
    v_add_f32 v249, v249, v251
    v_mfma_f32_32x32x16_bf16 v[144:159], v[52:55], a[108:111], v[144:159]
    s_add_u32 m0, s57, 20480
    s_add_u32 s58, s72, 36864
    buffer_load_dwordx4 v8, s[8:11], s58 offen lds
    v_lshlrev_b32 v250, 16, v225
    v_and_b32 v251, s6, v225
    v_mfma_f32_32x32x16_bf16 v[160:175], v[56:59], a[104:107], v[160:175]
    s_add_u32 m0, s57, 21504
    s_add_u32 s58, s72, 626688
    buffer_load_dwordx4 v9, s[8:11], s58 offen lds
    v_lshlrev_b32 v252, 16, v237
    v_and_b32 v253, s6, v237
    v_mfma_f32_32x32x16_bf16 v[176:191], v[56:59], a[108:111], v[176:191]
    s_add_u32 m0, s57, 22528
    s_add_u32 s58, s72, 1216512
    buffer_load_dwordx4 v8, s[8:11], s58 offen lds
    v_mfma_f32_32x32x16_bf16 v[192:207], a[104:107], v[60:63], v[192:207]
    s_add_u32 m0, s57, 23552
    s_add_u32 s58, s72, 1806336
    buffer_load_dwordx4 v9, s[8:11], s58 offen lds
    v_mfma_f32_32x32x16_bf16 v[208:223], a[108:111], v[60:63], v[208:223]
    s_add_u32 s74, s74, 294912
    s_cmp_ge_u32 s74, 5308416
    s_cselect_b32 s74, 0, s74
    s_add_u32 m0, s55, 51840
    s_nop 0
    buffer_load_dwordx4 v6, s[12:15], s74 offen lds
    s_waitcnt lgkmcnt(0)
    v_mfma_f32_32x32x16_bf16 v[64:79], v[24:27], a[112:115], v[64:79]
    ds_read_b128 a[120:123], v5 offset:0
    ds_read_b64_tr_b16 v[44:45], v1 offset:12416
    v_fma_f32 v16, v15, v12, -v10
    v_cvt_pk_bf16_f32 v60, v10, v12
    v_fma_f32 v17, v15, v16, -v12
    v_fma_f32 v11, v14, v10, -v11
    v_mfma_f32_32x32x16_bf16 v[80:95], v[24:27], a[116:119], v[80:95]
    ds_read_b64_tr_b16 v[46:47], v1 offset:12928
    ds_read_b128 a[124:127], v5 offset:4096
    v_fma_f32 v18, v15, v17, -v16
    v_cvt_pk_bf16_f32 v61, v16, v17
    v_fma_f32 v16, v15, v18, -v17
    v_fma_f32 v13, v14, v12, -v13
    v_mfma_f32_32x32x16_bf16 v[96:111], v[28:31], a[112:115], v[96:111]
    ds_read_b64_tr_b16 v[48:49], v19 offset:12416
    ds_read_b64_tr_b16 v[50:51], v19 offset:12928
    v_fma_f32 v17, v15, v16, -v18
    v_cvt_pk_bf16_f32 v62, v18, v16
    v_fma_f32 v18, v15, v17, -v16
    v_cvt_pk_bf16_f32 v63, v17, v18
    v_mfma_f32_32x32x16_bf16 v[112:127], v[28:31], a[116:119], v[112:127]
    ds_read_b64_tr_b16 v[52:53], v20 offset:12416
    ds_read_b64_tr_b16 v[54:55], v20 offset:12928
    v_mul_f32 v250, v250, v252
    v_mul_f32 v251, v251, v253
    v_cvt_pk_bf16_f32 v252, v250, v251
    v_lshlrev_b32 v250, 16, v252
    v_mfma_f32_32x32x16_bf16 v[128:143], v[32:35], a[112:115], v[128:143]
    ds_read_b64_tr_b16 v[56:57], v21 offset:12416
    ds_read_b64_tr_b16 v[58:59], v21 offset:12928
    v_and_b32 v251, s6, v252
    v_add_f32 v248, v248, v250
    v_add_f32 v249, v249, v251
    v_lshlrev_b32 v250, 16, v226
    v_mfma_f32_32x32x16_bf16 v[144:159], v[32:35], a[116:119], v[144:159]
    v_and_b32 v251, s6, v226
    v_lshlrev_b32 v252, 16, v238
    v_and_b32 v253, s6, v238
    v_mul_f32 v250, v250, v252
    v_mul_f32 v251, v251, v253
    v_cvt_pk_bf16_f32 v252, v250, v251
    v_mfma_f32_32x32x16_bf16 v[160:175], v[36:39], a[112:115], v[160:175]
    s_add_u32 m0, s55, 55936
    s_nop 0
    buffer_load_dwordx4 v7, s[20:23], s74 offen lds
    v_lshlrev_b32 v250, 16, v252
    v_and_b32 v251, s6, v252
    v_mfma_f32_32x32x16_bf16 v[176:191], v[36:39], a[116:119], v[176:191]
    s_add_u32 s74, s74, 294912
    s_cmp_ge_u32 s74, 5308416
    s_cselect_b32 s74, 0, s74
    s_add_u32 m0, s55, 0
    s_nop 0
    buffer_load_dwordx4 v6, s[12:15], s74 offen lds
    v_add_f32 v248, v248, v250
    v_mfma_f32_32x32x16_bf16 v[192:207], a[112:115], v[40:43], v[192:207]
    s_add_u32 m0, s55, 4096
    s_nop 0
    buffer_load_dwordx4 v7, s[20:23], s74 offen lds
    v_mfma_f32_32x32x16_bf16 v[208:223], a[116:119], v[40:43], v[208:223]
    s_waitcnt vmcnt(16) lgkmcnt(0)
    s_barrier
    v_mfma_f32_32x32x16_bf16 v[64:79], v[44:47], a[120:123], v[64:79]
    ds_read_b128 a[128:131], v2 offset:8192
    ds_read_b64_tr_b16 v[24:25], v1 offset:20736
    v_fma_f32 v16, v15, v13, -v11
    v_cvt_pk_bf16_f32 v40, v11, v13
    v_fma_f32 v17, v15, v16, -v13
    v_fma_f32 v10, v14, v11, -v10
    v_fma_f32 v18, v15, v17, -v16
    v_mfma_f32_32x32x16_bf16 v[80:95], v[44:47], a[124:127], v[80:95]
    ds_read_b64_tr_b16 v[26:27], v1 offset:21248
    ds_read_b128 a[132:135], v2 offset:12288
    v_cvt_pk_bf16_f32 v41, v16, v17
    v_fma_f32 v16, v15, v18, -v17
    v_fma_f32 v12, v14, v13, -v12
    v_fma_f32 v17, v15, v16, -v18
    v_cvt_pk_bf16_f32 v42, v18, v16
    v_mfma_f32_32x32x16_bf16 v[96:111], v[48:51], a[120:123], v[96:111]
    ds_read_b64_tr_b16 v[28:29], v19 offset:20736
    ds_read_b64_tr_b16 v[30:31], v19 offset:21248
    v_fma_f32 v18, v15, v17, -v16
    v_cvt_pk_bf16_f32 v43, v17, v18
    v_add_f32 v249, v249, v251
    v_lshlrev_b32 v250, 16, v227
    v_and_b32 v251, s6, v227
    v_mfma_f32_32x32x16_bf16 v[112:127], v[48:51], a[124:127], v[112:127]
    ds_read_b64_tr_b16 v[32:33], v20 offset:20736
    ds_read_b64_tr_b16 v[34:35], v20 offset:21248
    v_lshlrev_b32 v252, 16, v239
    v_and_b32 v253, s6, v239
    v_mul_f32 v250, v250, v252
    v_mul_f32 v251, v251, v253
    v_cvt_pk_bf16_f32 v252, v250, v251
    v_mfma_f32_32x32x16_bf16 v[128:143], v[52:55], a[120:123], v[128:143]
    ds_read_b64_tr_b16 v[36:37], v21 offset:20736
    ds_read_b64_tr_b16 v[38:39], v21 offset:21248
    v_lshlrev_b32 v250, 16, v252
    v_and_b32 v251, s6, v252
    v_add_f32 v248, v248, v250
    v_add_f32 v249, v249, v251
    v_lshlrev_b32 v250, 16, v228
    v_mfma_f32_32x32x16_bf16 v[144:159], v[52:55], a[124:127], v[144:159]
    s_add_u32 s72, s72, 128
    s_cmp_ge_u32 s72, 1152
    s_cselect_b32 s72, 0, s72
    s_add_u32 m0, s57, 0
    s_add_u32 s58, s72, 0
    buffer_load_dwordx4 v8, s[8:11], s58 offen lds
    v_and_b32 v251, s6, v228
    v_mfma_f32_32x32x16_bf16 v[160:175], v[56:59], a[120:123], v[160:175]
    s_add_u32 m0, s57, 1024
    s_add_u32 s58, s72, 589824
    buffer_load_dwordx4 v9, s[8:11], s58 offen lds
    v_lshlrev_b32 v252, 16, v240
    v_and_b32 v253, s6, v240
    v_mfma_f32_32x32x16_bf16 v[176:191], v[56:59], a[124:127], v[176:191]
    s_add_u32 m0, s57, 2048
    s_add_u32 s58, s72, 1179648
    buffer_load_dwordx4 v8, s[8:11], s58 offen lds
    v_mul_f32 v250, v250, v252
    v_mfma_f32_32x32x16_bf16 v[192:207], a[120:123], v[60:63], v[192:207]
    s_add_u32 m0, s57, 3072
    s_add_u32 s58, s72, 1769472
    buffer_load_dwordx4 v9, s[8:11], s58 offen lds
    v_mfma_f32_32x32x16_bf16 v[208:223], a[124:127], v[60:63], v[208:223]
    s_add_u32 m0, s57, 4096
    s_add_u32 s58, s72, 36864
    buffer_load_dwordx4 v8, s[8:11], s58 offen lds
    s_waitcnt lgkmcnt(0)
    v_mfma_f32_32x32x16_bf16 v[64:79], v[24:27], a[128:131], v[64:79]
    ds_read_b128 a[136:139], v3 offset:8192
    ds_read_b64_tr_b16 v[44:45], v1 offset:22784
    v_fma_f32 v16, v15, v12, -v10
    v_cvt_pk_bf16_f32 v60, v10, v12
    v_fma_f32 v17, v15, v16, -v12
    v_fma_f32 v11, v14, v10, -v11
    v_mfma_f32_32x32x16_bf16 v[80:95], v[24:27], a[132:135], v[80:95]
    ds_read_b64_tr_b16 v[46:47], v1 offset:23296
    ds_read_b128 a[140:143], v3 offset:12288
    v_fma_f32 v18, v15, v17, -v16
    v_cvt_pk_bf16_f32 v61, v16, v17
    v_fma_f32 v16, v15, v18, -v17
    v_fma_f32 v13, v14, v12, -v13
    v_mfma_f32_32x32x16_bf16 v[96:111], v[28:31], a[128:131], v[96:111]
    ds_read_b64_tr_b16 v[48:49], v19 offset:22784
    ds_read_b64_tr_b16 v[50:51], v19 offset:23296
    v_fma_f32 v17, v15, v16, -v18
    v_cvt_pk_bf16_f32 v62, v18, v16
    v_fma_f32 v18, v15, v17, -v16
    v_cvt_pk_bf16_f32 v63, v17, v18
    v_mfma_f32_32x32x16_bf16 v[112:127], v[28:31], a[132:135], v[112:127]
    ds_read_b64_tr_b16 v[52:53], v20 offset:22784
    ds_read_b64_tr_b16 v[54:55], v20 offset:23296
    v_mul_f32 v251, v251, v253
    v_cvt_pk_bf16_f32 v252, v250, v251
    v_lshlrev_b32 v250, 16, v252
    v_and_b32 v251, s6, v252
    v_mfma_f32_32x32x16_bf16 v[128:143], v[32:35], a[128:131], v[128:143]
    ds_read_b64_tr_b16 v[56:57], v21 offset:22784
    ds_read_b64_tr_b16 v[58:59], v21 offset:23296
    v_add_f32 v248, v248, v250
    v_add_f32 v249, v249, v251
    v_lshlrev_b32 v250, 16, v229
    v_and_b32 v251, s6, v229
    v_mfma_f32_32x32x16_bf16 v[144:159], v[32:35], a[132:135], v[144:159]
    v_lshlrev_b32 v252, 16, v241
    v_and_b32 v253, s6, v241
    v_mul_f32 v250, v250, v252
    v_mul_f32 v251, v251, v253
    v_cvt_pk_bf16_f32 v252, v250, v251
    v_lshlrev_b32 v250, 16, v252
    v_mfma_f32_32x32x16_bf16 v[160:175], v[36:39], a[128:131], v[160:175]
    s_add_u32 m0, s57, 5120
    s_add_u32 s58, s72, 626688
    buffer_load_dwordx4 v9, s[8:11], s58 offen lds
    v_and_b32 v251, s6, v252
    v_mfma_f32_32x32x16_bf16 v[176:191], v[36:39], a[132:135], v[176:191]
    s_add_u32 m0, s57, 6144
    s_add_u32 s58, s72, 1216512
    buffer_load_dwordx4 v8, s[8:11], s58 offen lds
    v_add_f32 v248, v248, v250
    v_mfma_f32_32x32x16_bf16 v[192:207], a[128:131], v[40:43], v[192:207]
    s_add_u32 m0, s57, 7168
    s_add_u32 s58, s72, 1806336
    buffer_load_dwordx4 v9, s[8:11], s58 offen lds
    v_add_f32 v249, v249, v251
    v_mfma_f32_32x32x16_bf16 v[208:223], a[132:135], v[40:43], v[208:223]
    s_add_u32 s74, s74, 294912
    s_cmp_ge_u32 s74, 5308416
    s_cselect_b32 s74, 0, s74
    s_add_u32 m0, s55, 10368
    s_nop 0
    buffer_load_dwordx4 v6, s[12:15], s74 offen lds
    s_waitcnt vmcnt(23) lgkmcnt(0)
    s_barrier
    v_mfma_f32_32x32x16_bf16 v[64:79], v[44:47], a[136:139], v[64:79]
    ds_read_b128 a[144:147], v4 offset:8192
    ds_read_b64_tr_b16 v[24:25], v1 offset:31104
    v_fma_f32 v16, v15, v13, -v11
    v_cvt_pk_bf16_f32 v40, v11, v13
    v_fma_f32 v17, v15, v16, -v13
    v_fma_f32 v10, v14, v11, -v10
    v_mfma_f32_32x32x16_bf16 v[80:95], v[44:47], a[140:143], v[80:95]
    ds_read_b64_tr_b16 v[26:27], v1 offset:31616
    ds_read_b128 a[148:151], v4 offset:12288
    v_fma_f32 v18, v15, v17, -v16
    v_cvt_pk_bf16_f32 v41, v16, v17
    v_fma_f32 v16, v15, v18, -v17
    v_fma_f32 v12, v14, v13, -v12
    v_mfma_f32_32x32x16_bf16 v[96:111], v[48:51], a[136:139], v[96:111]
    ds_read_b64_tr_b16 v[28:29], v19 offset:31104
    ds_read_b64_tr_b16 v[30:31], v19 offset:31616
    v_fma_f32 v17, v15, v16, -v18
    v_cvt_pk_bf16_f32 v42, v18, v16
    v_fma_f32 v18, v15, v17, -v16
    v_cvt_pk_bf16_f32 v43, v17, v18
    v_mfma_f32_32x32x16_bf16 v[112:127], v[48:51], a[140:143], v[112:127]
    ds_read_b64_tr_b16 v[32:33], v20 offset:31104
    ds_read_b64_tr_b16 v[34:35], v20 offset:31616
    v_lshlrev_b32 v250, 16, v230
    v_and_b32 v251, s6, v230
    v_lshlrev_b32 v252, 16, v242
    v_and_b32 v253, s6, v242
    v_mfma_f32_32x32x16_bf16 v[128:143], v[52:55], a[136:139], v[128:143]
    ds_read_b64_tr_b16 v[36:37], v21 offset:31104
    ds_read_b64_tr_b16 v[38:39], v21 offset:31616
    v_mul_f32 v250, v250, v252
    v_mul_f32 v251, v251, v253
    v_cvt_pk_bf16_f32 v252, v250, v251
    v_lshlrev_b32 v250, 16, v252
    v_mfma_f32_32x32x16_bf16 v[144:159], v[52:55], a[140:143], v[144:159]
    v_and_b32 v251, s6, v252
    v_add_f32 v248, v248, v250
    v_add_f32 v249, v249, v251
    v_lshlrev_b32 v250, 16, v231
    v_and_b32 v251, s6, v231
    v_lshlrev_b32 v252, 16, v243
    v_mfma_f32_32x32x16_bf16 v[160:175], v[56:59], a[136:139], v[160:175]
    s_add_u32 m0, s55, 14464
    s_nop 0
    buffer_load_dwordx4 v7, s[20:23], s74 offen lds
    v_and_b32 v253, s6, v243
    v_mul_f32 v250, v250, v252
    v_mfma_f32_32x32x16_bf16 v[176:191], v[56:59], a[140:143], v[176:191]
    s_add_u32 s74, s74, 294912
    s_cmp_ge_u32 s74, 5308416
    s_cselect_b32 s74, 0, s74
    s_add_u32 m0, s55, 20736
    s_nop 0
    buffer_load_dwordx4 v6, s[12:15], s74 offen lds
    v_mul_f32 v251, v251, v253
    v_mfma_f32_32x32x16_bf16 v[192:207], a[136:139], v[60:63], v[192:207]
    s_add_u32 m0, s55, 24832
    s_nop 0
    buffer_load_dwordx4 v7, s[20:23], s74 offen lds
    v_mfma_f32_32x32x16_bf16 v[208:223], a[140:143], v[60:63], v[208:223]
    s_waitcnt lgkmcnt(0)
    v_mfma_f32_32x32x16_bf16 v[64:79], v[24:27], a[144:147], v[64:79]
    ds_read_b128 a[152:155], v5 offset:8192
    ds_read_b64_tr_b16 v[44:45], v1 offset:33152
    v_fma_f32 v16, v15, v12, -v10
    v_cvt_pk_bf16_f32 v60, v10, v12
    v_mfma_f32_32x32x16_bf16 v[80:95], v[24:27], a[148:151], v[80:95]
    ds_read_b64_tr_b16 v[46:47], v1 offset:33664
    ds_read_b128 a[156:159], v5 offset:12288
    v_fma_f32 v17, v15, v16, -v12
    v_fma_f32 v11, v14, v10, -v11
    v_mfma_f32_32x32x16_bf16 v[96:111], v[28:31], a[144:147], v[96:111]
    ds_read_b64_tr_b16 v[48:49], v19 offset:33152
    ds_read_b64_tr_b16 v[50:51], v19 offset:33664
    v_fma_f32 v18, v15, v17, -v16
    v_cvt_pk_bf16_f32 v61, v16, v17
    v_mfma_f32_32x32x16_bf16 v[112:127], v[28:31], a[148:151], v[112:127]
    ds_read_b64_tr_b16 v[52:53], v20 offset:33152
    ds_read_b64_tr_b16 v[54:55], v20 offset:33664
    v_fma_f32 v16, v15, v18, -v17
    v_fma_f32 v13, v14, v12, -v13
    v_mfma_f32_32x32x16_bf16 v[128:143], v[32:35], a[144:147], v[128:143]
    ds_read_b64_tr_b16 v[56:57], v21 offset:33152
    ds_read_b64_tr_b16 v[58:59], v21 offset:33664
    v_fma_f32 v17, v15, v16, -v18
    v_cvt_pk_bf16_f32 v62, v18, v16
    v_mfma_f32_32x32x16_bf16 v[144:159], v[32:35], a[148:151], v[144:159]
    v_fma_f32 v18, v15, v17, -v16
    v_cvt_pk_bf16_f32 v63, v17, v18
    v_cvt_pk_bf16_f32 v252, v250, v251
    v_lshlrev_b32 v250, 16, v252
    v_mfma_f32_32x32x16_bf16 v[160:175], v[36:39], a[144:147], v[160:175]
    v_and_b32 v251, s6, v252
    v_add_f32 v248, v248, v250
    v_add_f32 v249, v249, v251
    v_lshlrev_b32 v250, 16, v232
    v_mfma_f32_32x32x16_bf16 v[176:191], v[36:39], a[148:151], v[176:191]
    v_and_b32 v251, s6, v232
    v_lshlrev_b32 v252, 16, v244
    v_and_b32 v253, s6, v244
    v_mul_f32 v250, v250, v252
    v_mfma_f32_32x32x16_bf16 v[192:207], a[144:147], v[40:43], v[192:207]
    v_mul_f32 v251, v251, v253
    v_cvt_pk_bf16_f32 v252, v250, v251
    v_lshlrev_b32 v250, 16, v252
    v_and_b32 v251, s6, v252
    v_mfma_f32_32x32x16_bf16 v[208:223], a[148:151], v[40:43], v[208:223]
    v_add_f32 v248, v248, v250
    v_add_f32 v249, v249, v251
    v_lshlrev_b32 v250, 16, v233
    s_waitcnt vmcnt(16) lgkmcnt(0)
    s_barrier
    v_mfma_f32_32x32x16_bf16 v[64:79], v[44:47], a[152:155], v[64:79]
    ds_read_b128 a[160:163], v2 offset:16384
    ds_read_b64_tr_b16 v[24:25], v1 offset:41472
    v_fma_f32 v16, v15, v13, -v11
    v_cvt_pk_bf16_f32 v40, v11, v13
    v_fma_f32 v17, v15, v16, -v13
    v_fma_f32 v10, v14, v11, -v10
    v_mfma_f32_32x32x16_bf16 v[80:95], v[44:47], a[156:159], v[80:95]
    ds_read_b64_tr_b16 v[26:27], v1 offset:41984
    ds_read_b128 a[164:167], v2 offset:20480
    v_fma_f32 v18, v15, v17, -v16
    v_cvt_pk_bf16_f32 v41, v16, v17
    v_fma_f32 v16, v15, v18, -v17
    v_fma_f32 v12, v14, v13, -v12
    v_mfma_f32_32x32x16_bf16 v[96:111], v[48:51], a[152:155], v[96:111]
    ds_read_b64_tr_b16 v[28:29], v19 offset:41472
    ds_read_b64_tr_b16 v[30:31], v19 offset:41984
    v_fma_f32 v17, v15, v16, -v18
    v_cvt_pk_bf16_f32 v42, v18, v16
    v_fma_f32 v18, v15, v17, -v16
    v_cvt_pk_bf16_f32 v43, v17, v18
    v_mfma_f32_32x32x16_bf16 v[112:127], v[48:51], a[156:159], v[112:127]
    ds_read_b64_tr_b16 v[32:33], v20 offset:41472
    ds_read_b64_tr_b16 v[34:35], v20 offset:41984
    v_and_b32 v251, s6, v233
    v_lshlrev_b32 v252, 16, v245
    v_and_b32 v253, s6, v245
    v_mul_f32 v250, v250, v252
    v_mfma_f32_32x32x16_bf16 v[128:143], v[52:55], a[152:155], v[128:143]
    ds_read_b64_tr_b16 v[36:37], v21 offset:41472
    ds_read_b64_tr_b16 v[38:39], v21 offset:41984
    v_mul_f32 v251, v251, v253
    v_cvt_pk_bf16_f32 v252, v250, v251
    v_lshlrev_b32 v250, 16, v252
    v_and_b32 v251, s6, v252
    v_mfma_f32_32x32x16_bf16 v[144:159], v[52:55], a[156:159], v[144:159]
    v_add_f32 v248, v248, v250
    v_add_f32 v249, v249, v251
    v_lshlrev_b32 v250, 16, v234
    v_and_b32 v251, s6, v234
    v_lshlrev_b32 v252, 16, v246
    v_and_b32 v253, s6, v246
    v_mfma_f32_32x32x16_bf16 v[160:175], v[56:59], a[152:155], v[160:175]
    s_add_u32 s72, s72, 128
    s_cmp_ge_u32 s72, 1152
    s_cselect_b32 s72, 0, s72
    s_add_u32 m0, s57, 8192
    s_add_u32 s58, s72, 0
    buffer_load_dwordx4 v8, s[8:11], s58 offen lds
    v_mfma_f32_32x32x16_bf16 v[176:191], v[56:59], a[156:159], v[176:191]
    s_add_u32 m0, s57, 9216
    s_add_u32 s58, s72, 589824
    buffer_load_dwordx4 v9, s[8:11], s58 offen lds
    v_mul_f32 v250, v250, v252
    v_mfma_f32_32x32x16_bf16 v[192:207], a[152:155], v[60:63], v[192:207]
    s_add_u32 m0, s57, 10240
    s_add_u32 s58, s72, 1179648
    buffer_load_dwordx4 v8, s[8:11], s58 offen lds
    v_mul_f32 v251, v251, v253
    v_mfma_f32_32x32x16_bf16 v[208:223], a[156:159], v[60:63], v[208:223]
    s_add_u32 m0, s57, 11264
    s_add_u32 s58, s72, 1769472
    buffer_load_dwordx4 v9, s[8:11], s58 offen lds
    v_cvt_pk_bf16_f32 v252, v250, v251
    s_waitcnt lgkmcnt(0)
    v_mfma_f32_32x32x16_bf16 v[64:79], v[24:27], a[160:163], v[64:79]
    ds_read_b128 a[168:171], v3 offset:16384
    ds_read_b64_tr_b16 v[44:45], v1 offset:43520
    v_fma_f32 v16, v15, v12, -v10
    v_cvt_pk_bf16_f32 v60, v10, v12
    v_fma_f32 v17, v15, v16, -v12
    v_fma_f32 v11, v14, v10, -v11
    v_mfma_f32_32x32x16_bf16 v[80:95], v[24:27], a[164:167], v[80:95]
    ds_read_b64_tr_b16 v[46:47], v1 offset:44032
    ds_read_b128 a[172:175], v3 offset:20480
    v_fma_f32 v18, v15, v17, -v16
    v_cvt_pk_bf16_f32 v61, v16, v17
    v_fma_f32 v16, v15, v18, -v17
    v_fma_f32 v13, v14, v12, -v13
    v_mfma_f32_32x32x16_bf16 v[96:111], v[28:31], a[160:163], v[96:111]
    ds_read_b64_tr_b16 v[48:49], v19 offset:43520
    ds_read_b64_tr_b16 v[50:51], v19 offset:44032
    v_fma_f32 v17, v15, v16, -v18
    v_cvt_pk_bf16_f32 v62, v18, v16
    v_fma_f32 v18, v15, v17, -v16
    v_cvt_pk_bf16_f32 v63, v17, v18
    v_mfma_f32_32x32x16_bf16 v[112:127], v[28:31], a[164:167], v[112:127]
    ds_read_b64_tr_b16 v[52:53], v20 offset:43520
    ds_read_b64_tr_b16 v[54:55], v20 offset:44032
    v_lshlrev_b32 v250, 16, v252
    v_and_b32 v251, s6, v252
    v_add_f32 v248, v248, v250
    v_add_f32 v249, v249, v251
    v_mfma_f32_32x32x16_bf16 v[128:143], v[32:35], a[160:163], v[128:143]
    ds_read_b64_tr_b16 v[56:57], v21 offset:43520
    ds_read_b64_tr_b16 v[58:59], v21 offset:44032
    v_lshlrev_b32 v250, 16, v235
    v_and_b32 v251, s6, v235
    v_lshlrev_b32 v252, 16, v247
    v_and_b32 v253, s6, v247
    v_mfma_f32_32x32x16_bf16 v[144:159], v[32:35], a[164:167], v[144:159]
    v_mul_f32 v250, v250, v252
    v_mul_f32 v251, v251, v253
    v_cvt_pk_bf16_f32 v252, v250, v251
    v_lshlrev_b32 v250, 16, v252
    v_and_b32 v251, s6, v252
    v_add_f32 v248, v248, v250
    v_mfma_f32_32x32x16_bf16 v[160:175], v[36:39], a[160:163], v[160:175]
    s_add_u32 m0, s57, 12288
    s_add_u32 s58, s72, 36864
    buffer_load_dwordx4 v8, s[8:11], s58 offen lds
    v_add_f32 v249, v249, v251
    v_mfma_f32_32x32x16_bf16 v[176:191], v[36:39], a[164:167], v[176:191]
    s_add_u32 m0, s57, 13312
    s_add_u32 s58, s72, 626688
    buffer_load_dwordx4 v9, s[8:11], s58 offen lds
    v_add_f32 v248, v248, v249
    v_mfma_f32_32x32x16_bf16 v[192:207], a[160:163], v[40:43], v[192:207]
    s_add_u32 m0, s57, 14336
    s_add_u32 s58, s72, 1216512
    buffer_load_dwordx4 v8, s[8:11], s58 offen lds
    v_add_f32_dpp v248, v248, v248 quad_perm:[1,0,3,2] row_mask:0xf bank_mask:0xf
    v_mfma_f32_32x32x16_bf16 v[208:223], a[164:167], v[40:43], v[208:223]
    s_add_u32 m0, s57, 15360
    s_add_u32 s58, s72, 1806336
    buffer_load_dwordx4 v9, s[8:11], s58 offen lds
    s_waitcnt vmcnt(22) lgkmcnt(0)
    s_barrier
    v_mfma_f32_32x32x16_bf16 v[64:79], v[44:47], a[168:171], v[64:79]
    ds_read_b128 a[176:179], v4 offset:16384
    ds_read_b64_tr_b16 v[24:25], v1 offset:51840
    v_fma_f32 v16, v15, v13, -v11
    v_cvt_pk_bf16_f32 v40, v11, v13
    v_fma_f32 v17, v15, v16, -v13
    v_fma_f32 v10, v14, v11, -v10
    v_fma_f32 v18, v15, v17, -v16
    v_mfma_f32_32x32x16_bf16 v[80:95], v[44:47], a[172:175], v[80:95]
    ds_read_b64_tr_b16 v[26:27], v1 offset:52352
    ds_read_b128 a[180:183], v4 offset:20480
    v_cvt_pk_bf16_f32 v41, v16, v17
    v_fma_f32 v16, v15, v18, -v17
    v_fma_f32 v12, v14, v13, -v12
    v_fma_f32 v17, v15, v16, -v18
    v_cvt_pk_bf16_f32 v42, v18, v16
    v_mfma_f32_32x32x16_bf16 v[96:111], v[48:51], a[168:171], v[96:111]
    ds_read_b64_tr_b16 v[28:29], v19 offset:51840
    ds_read_b64_tr_b16 v[30:31], v19 offset:52352
    v_fma_f32 v18, v15, v17, -v16
    v_cvt_pk_bf16_f32 v43, v17, v18
    v_add_f32_dpp v248, v248, v248 quad_perm:[2,3,0,1] row_mask:0xf bank_mask:0xf
    s_nop 1
    v_add_f32_dpp v248, v248, v248 row_half_mirror row_mask:0xf bank_mask:0xf
    s_nop 1
    v_add_f32_dpp v248, v248, v248 row_mirror row_mask:0xf bank_mask:0xf
    v_mfma_f32_32x32x16_bf16 v[112:127], v[48:51], a[172:175], v[112:127]
    ds_read_b64_tr_b16 v[32:33], v20 offset:51840
    ds_read_b64_tr_b16 v[34:35], v20 offset:52352
    v_mov_b32 v249, v248
    s_nop 1
    v_permlane16_swap_b32 v248, v249
    v_add_f32 v248, v248, v249
    v_cvt_pk_bf16_f32 v248, v248, v248
    v_lshlrev_b32 v248, 16, v248
    v_mfma_f32_32x32x16_bf16 v[128:143], v[52:55], a[168:171], v[128:143]
    ds_read_b64_tr_b16 v[36:37], v21 offset:51840
    ds_read_b64_tr_b16 v[38:39], v21 offset:52352
    v_mul_f32 v248, 0xbfb8aa3b, v248
    v_exp_f32 v248, v248
    s_nop 0
    v_add_f32 v248, 1.0, v248
    v_mfma_f32_32x32x16_bf16 v[144:159], v[52:55], a[172:175], v[144:159]
    v_rcp_f32 v248, v248
    s_nop 0
    v_cvt_pk_bf16_f32 v248, v248, v248
    v_lshlrev_b32 v248, 16, v248
    buffer_store_dword v248, v22, s[16:19], s53 offen sc0 sc1
    v_mfma_f32_32x32x16_bf16 v[160:175], v[56:59], a[168:171], v[160:175]
    s_add_u32 s74, s74, 294912
    s_cmp_ge_u32 s74, 5308416
    s_cselect_b32 s74, 0, s74
    s_add_u32 m0, s55, 31104
    s_nop 0
    buffer_load_dwordx4 v6, s[12:15], s74 offen lds
    v_accvgpr_read_b32 v250, a224
    v_accvgpr_read_b32 v251, a225
    v_mfma_f32_32x32x16_bf16 v[176:191], v[56:59], a[172:175], v[176:191]
    s_add_u32 m0, s55, 35200
    s_nop 0
    buffer_load_dwordx4 v7, s[20:23], s74 offen lds
    v_mfma_f32_32x32x16_bf16 v[192:207], a[168:171], v[60:63], v[192:207]
    s_add_u32 s74, s74, 294912
    s_cmp_ge_u32 s74, 5308416
    s_cselect_b32 s74, 0, s74
    s_add_u32 m0, s55, 41472
    s_nop 0
    buffer_load_dwordx4 v6, s[12:15], s74 offen lds
    v_mfma_f32_32x32x16_bf16 v[208:223], a[172:175], v[60:63], v[208:223]
    s_add_u32 m0, s55, 45568
    s_nop 0
    buffer_load_dwordx4 v7, s[20:23], s74 offen lds
    s_waitcnt lgkmcnt(0)
    v_mfma_f32_32x32x16_bf16 v[64:79], v[24:27], a[176:179], v[64:79]
    ds_read_b128 a[184:187], v5 offset:16384
    ds_read_b64_tr_b16 v[44:45], v1 offset:53888
    v_fma_f32 v16, v15, v12, -v10
    v_cvt_pk_bf16_f32 v60, v10, v12
    v_mfma_f32_32x32x16_bf16 v[80:95], v[24:27], a[180:183], v[80:95]
    ds_read_b64_tr_b16 v[46:47], v1 offset:54400
    ds_read_b128 a[188:191], v5 offset:20480
    v_fma_f32 v17, v15, v16, -v12
    v_fma_f32 v11, v14, v10, -v11
    v_mfma_f32_32x32x16_bf16 v[96:111], v[28:31], a[176:179], v[96:111]
    ds_read_b64_tr_b16 v[48:49], v19 offset:53888
    ds_read_b64_tr_b16 v[50:51], v19 offset:54400
    v_fma_f32 v18, v15, v17, -v16
    v_cvt_pk_bf16_f32 v61, v16, v17
    v_mfma_f32_32x32x16_bf16 v[112:127], v[28:31], a[180:183], v[112:127]
    ds_read_b64_tr_b16 v[52:53], v20 offset:53888
    ds_read_b64_tr_b16 v[54:55], v20 offset:54400
    v_fma_f32 v16, v15, v18, -v17
    v_fma_f32 v13, v14, v12, -v13
    v_mfma_f32_32x32x16_bf16 v[128:143], v[32:35], a[176:179], v[128:143]
    ds_read_b64_tr_b16 v[56:57], v21 offset:53888
    ds_read_b64_tr_b16 v[58:59], v21 offset:54400
    v_fma_f32 v17, v15, v16, -v18
    v_cvt_pk_bf16_f32 v62, v18, v16
    v_mfma_f32_32x32x16_bf16 v[144:159], v[32:35], a[180:183], v[144:159]
    v_fma_f32 v18, v15, v17, -v16
    v_cvt_pk_bf16_f32 v63, v17, v18
    v_accvgpr_read_b32 v252, a226
    v_alignbit_b32 v224, v251, v250, s63
    v_mfma_f32_32x32x16_bf16 v[160:175], v[36:39], a[176:179], v[160:175]
    v_alignbit_b32 v225, v252, v251, s63
    v_accvgpr_read_b32 v250, a240
    v_accvgpr_read_b32 v251, a241
    v_accvgpr_read_b32 v252, a242
    v_mfma_f32_32x32x16_bf16 v[176:191], v[36:39], a[180:183], v[176:191]
    v_alignbit_b32 v232, v251, v250, s63
    v_alignbit_b32 v233, v252, v251, s63
    v_accvgpr_read_b32 v250, a228
    v_accvgpr_read_b32 v251, a229
    v_mfma_f32_32x32x16_bf16 v[192:207], a[176:179], v[40:43], v[192:207]
    v_accvgpr_read_b32 v252, a230
    v_alignbit_b32 v226, v251, v250, s63
    v_alignbit_b32 v227, v252, v251, s63
    v_accvgpr_read_b32 v250, a244
    v_mfma_f32_32x32x16_bf16 v[208:223], a[180:183], v[40:43], v[208:223]
    v_accvgpr_read_b32 v251, a245
    v_accvgpr_read_b32 v252, a246
    v_alignbit_b32 v234, v251, v250, s63
    s_waitcnt vmcnt(17) lgkmcnt(0)
    s_barrier
    v_mfma_f32_32x32x16_bf16 v[64:79], v[44:47], a[184:187], v[64:79]
    ds_read_b128 a[192:195], v2 offset:0
    ds_read_b64_tr_b16 v[24:25], v1 offset:0
    v_fma_f32 v16, v15, v13, -v11
    v_cvt_pk_bf16_f32 v40, v11, v13
    v_fma_f32 v17, v15, v16, -v13
    v_fma_f32 v10, v14, v11, -v10
    v_mfma_f32_32x32x16_bf16 v[80:95], v[44:47], a[188:191], v[80:95]
    ds_read_b64_tr_b16 v[26:27], v1 offset:512
    ds_read_b128 a[196:199], v2 offset:4096
    v_fma_f32 v18, v15, v17, -v16
    v_cvt_pk_bf16_f32 v41, v16, v17
    v_fma_f32 v16, v15, v18, -v17
    v_fma_f32 v12, v14, v13, -v12
    v_mfma_f32_32x32x16_bf16 v[96:111], v[48:51], a[184:187], v[96:111]
    ds_read_b64_tr_b16 v[28:29], v19 offset:0
    ds_read_b64_tr_b16 v[30:31], v19 offset:512
    v_fma_f32 v17, v15, v16, -v18
    v_cvt_pk_bf16_f32 v42, v18, v16
    v_fma_f32 v18, v15, v17, -v16
    v_cvt_pk_bf16_f32 v43, v17, v18
    v_mfma_f32_32x32x16_bf16 v[112:127], v[48:51], a[188:191], v[112:127]
    ds_read_b64_tr_b16 v[32:33], v20 offset:0
    ds_read_b64_tr_b16 v[34:35], v20 offset:512
    v_alignbit_b32 v235, v252, v251, s63
    v_accvgpr_read_b32 v250, a232
    v_accvgpr_read_b32 v251, a233
    v_accvgpr_read_b32 v252, a234
    v_mfma_f32_32x32x16_bf16 v[128:143], v[52:55], a[184:187], v[128:143]
    ds_read_b64_tr_b16 v[36:37], v21 offset:0
    ds_read_b64_tr_b16 v[38:39], v21 offset:512
    v_alignbit_b32 v228, v251, v250, s63
    v_alignbit_b32 v229, v252, v251, s63
    v_accvgpr_read_b32 v250, a248
    v_accvgpr_read_b32 v251, a249
    v_mfma_f32_32x32x16_bf16 v[144:159], v[52:55], a[188:191], v[144:159]
    v_accvgpr_read_b32 v252, a250
    v_alignbit_b32 v236, v251, v250, s63
    v_alignbit_b32 v237, v252, v251, s63
    v_accvgpr_read_b32 v250, a236
    v_accvgpr_read_b32 v251, a237
    v_accvgpr_read_b32 v252, a238
    v_mfma_f32_32x32x16_bf16 v[160:175], v[56:59], a[184:187], v[160:175]
    s_add_u32 s72, s72, 128
    s_cmp_ge_u32 s72, 1152
    s_cselect_b32 s72, 0, s72
    s_add_u32 m0, s57, 16384
    s_add_u32 s58, s72, 0
    buffer_load_dwordx4 v8, s[8:11], s58 offen lds
    v_mfma_f32_32x32x16_bf16 v[176:191], v[56:59], a[188:191], v[176:191]
    s_add_u32 m0, s57, 17408
    s_add_u32 s58, s72, 589824
    buffer_load_dwordx4 v9, s[8:11], s58 offen lds
    v_alignbit_b32 v230, v251, v250, s63
    v_mfma_f32_32x32x16_bf16 v[192:207], a[184:187], v[60:63], v[192:207]
    s_add_u32 m0, s57, 18432
    s_add_u32 s58, s72, 1179648
    buffer_load_dwordx4 v8, s[8:11], s58 offen lds
    v_alignbit_b32 v231, v252, v251, s63
    v_mfma_f32_32x32x16_bf16 v[208:223], a[188:191], v[60:63], v[208:223]
    s_add_u32 m0, s57, 19456
    s_add_u32 s58, s72, 1769472
    buffer_load_dwordx4 v9, s[8:11], s58 offen lds
    v_accvgpr_read_b32 v250, a252
    s_waitcnt lgkmcnt(0)
    v_mfma_f32_32x32x16_bf16 v[64:79], v[24:27], a[192:195], v[64:79]
    ds_read_b128 a[200:203], v3 offset:0
    ds_read_b64_tr_b16 v[44:45], v1 offset:2048
    v_fma_f32 v16, v15, v12, -v10
    v_cvt_pk_bf16_f32 v60, v10, v12
    v_fma_f32 v17, v15, v16, -v12
    v_fma_f32 v11, v14, v10, -v11
    v_fma_f32 v18, v15, v17, -v16
    v_mfma_f32_32x32x16_bf16 v[80:95], v[24:27], a[196:199], v[80:95]
    ds_read_b64_tr_b16 v[46:47], v1 offset:2560
    ds_read_b128 a[204:207], v3 offset:4096
    v_cvt_pk_bf16_f32 v61, v16, v17
    v_fma_f32 v16, v15, v18, -v17
    v_fma_f32 v13, v14, v12, -v13
    v_fma_f32 v17, v15, v16, -v18
    v_cvt_pk_bf16_f32 v62, v18, v16
    v_mfma_f32_32x32x16_bf16 v[96:111], v[28:31], a[192:195], v[96:111]
    ds_read_b64_tr_b16 v[48:49], v19 offset:2048
    ds_read_b64_tr_b16 v[50:51], v19 offset:2560
    v_fma_f32 v18, v15, v17, -v16
    v_cvt_pk_bf16_f32 v63, v17, v18
    v_accvgpr_read_b32 v251, a253
    v_accvgpr_read_b32 v252, a254
    v_alignbit_b32 v238, v251, v250, s63
    v_mfma_f32_32x32x16_bf16 v[112:127], v[28:31], a[196:199], v[112:127]
    ds_read_b64_tr_b16 v[52:53], v20 offset:2048
    ds_read_b64_tr_b16 v[54:55], v20 offset:2560
    v_alignbit_b32 v239, v252, v251, s63
    v_perm_b32 v240, v232, v224, s50
    v_perm_b32 v241, v234, v226, s50
    v_perm_b32 v242, v236, v228, s50
    v_perm_b32 v243, v238, v230, s50
    v_mfma_f32_32x32x16_bf16 v[128:143], v[32:35], a[192:195], v[128:143]
    ds_read_b64_tr_b16 v[56:57], v21 offset:2048
    ds_read_b64_tr_b16 v[58:59], v21 offset:2560
    s_add_u32 s7, s49, 0
    buffer_store_dwordx4 v[240:243], v23, s[16:19], s7 offen sc0 sc1
    v_perm_b32 v244, v232, v224, s51
    v_mfma_f32_32x32x16_bf16 v[144:159], v[32:35], a[196:199], v[144:159]
    v_perm_b32 v245, v234, v226, s51
    v_perm_b32 v246, v236, v228, s51
    v_perm_b32 v247, v238, v230, s51
    s_add_u32 s7, s49, 65536
    buffer_store_dwordx4 v[244:247], v255, s[16:19], s7 offen sc0 sc1
    v_mfma_f32_32x32x16_bf16 v[160:175], v[36:39], a[192:195], v[160:175]
    s_add_u32 m0, s57, 20480
    s_add_u32 s58, s72, 36864
    buffer_load_dwordx4 v8, s[8:11], s58 offen lds
    v_perm_b32 v240, v233, v225, s50
    v_perm_b32 v241, v235, v227, s50
    v_mfma_f32_32x32x16_bf16 v[176:191], v[36:39], a[196:199], v[176:191]
    s_add_u32 m0, s57, 21504
    s_add_u32 s58, s72, 626688
    buffer_load_dwordx4 v9, s[8:11], s58 offen lds
    v_perm_b32 v242, v237, v229, s50
    v_mfma_f32_32x32x16_bf16 v[192:207], a[192:195], v[40:43], v[192:207]
    s_add_u32 m0, s57, 22528
    s_add_u32 s58, s72, 1216512
    buffer_load_dwordx4 v8, s[8:11], s58 offen lds
    v_mfma_f32_32x32x16_bf16 v[208:223], a[196:199], v[40:43], v[208:223]
    s_add_u32 m0, s57, 23552
    s_add_u32 s58, s72, 1806336
    buffer_load_dwordx4 v9, s[8:11], s58 offen lds
    s_waitcnt vmcnt(25) lgkmcnt(0)
    s_barrier
    v_mfma_f32_32x32x16_bf16 v[64:79], v[44:47], a[200:203], v[64:79]
    ds_read_b128 a[208:211], v4 offset:0
    ds_read_b64_tr_b16 v[24:25], v1 offset:10368
    v_fma_f32 v16, v15, v13, -v11
    v_cvt_pk_bf16_f32 v40, v11, v13
    v_fma_f32 v17, v15, v16, -v13
    v_mfma_f32_32x32x16_bf16 v[80:95], v[44:47], a[204:207], v[80:95]
    ds_read_b64_tr_b16 v[26:27], v1 offset:10880
    ds_read_b128 a[212:215], v4 offset:4096
    v_fma_f32 v10, v14, v11, -v10
    v_fma_f32 v18, v15, v17, -v16
    v_cvt_pk_bf16_f32 v41, v16, v17
    v_mfma_f32_32x32x16_bf16 v[96:111], v[48:51], a[200:203], v[96:111]
    ds_read_b64_tr_b16 v[28:29], v19 offset:10368
    ds_read_b64_tr_b16 v[30:31], v19 offset:10880
    v_fma_f32 v16, v15, v18, -v17
    v_fma_f32 v12, v14, v13, -v12
    v_fma_f32 v17, v15, v16, -v18
    v_mfma_f32_32x32x16_bf16 v[112:127], v[48:51], a[204:207], v[112:127]
    ds_read_b64_tr_b16 v[32:33], v20 offset:10368
    ds_read_b64_tr_b16 v[34:35], v20 offset:10880
    v_cvt_pk_bf16_f32 v42, v18, v16
    v_fma_f32 v18, v15, v17, -v16
    v_cvt_pk_bf16_f32 v43, v17, v18
    v_mfma_f32_32x32x16_bf16 v[128:143], v[52:55], a[200:203], v[128:143]
    ds_read_b64_tr_b16 v[36:37], v21 offset:10368
    ds_read_b64_tr_b16 v[38:39], v21 offset:10880
    v_perm_b32 v243, v239, v231, s50
    v_mfma_f32_32x32x16_bf16 v[144:159], v[52:55], a[204:207], v[144:159]
    s_add_u32 s7, s49, 131072
    buffer_store_dwordx4 v[240:243], v255, s[16:19], s7 offen sc0 sc1
    v_perm_b32 v244, v233, v225, s51
    v_mfma_f32_32x32x16_bf16 v[160:175], v[56:59], a[200:203], v[160:175]
    s_add_u32 s74, s74, 294912
    s_cmp_ge_u32 s74, 5308416
    s_cselect_b32 s74, 0, s74
    s_add_u32 m0, s55, 51840
    s_nop 0
    buffer_load_dwordx4 v6, s[12:15], s74 offen lds
    v_mfma_f32_32x32x16_bf16 v[176:191], v[56:59], a[204:207], v[176:191]
    s_add_u32 m0, s55, 55936
    s_nop 0
    buffer_load_dwordx4 v7, s[20:23], s74 offen lds
    v_perm_b32 v245, v235, v227, s51
    v_mfma_f32_32x32x16_bf16 v[192:207], a[200:203], v[60:63], v[192:207]
    v_perm_b32 v246, v237, v229, s51
    v_perm_b32 v247, v239, v231, s51
    v_mfma_f32_32x32x16_bf16 v[208:223], a[204:207], v[60:63], v[208:223]
    s_add_u32 s7, s49, 196608
    buffer_store_dwordx4 v[244:247], v255, s[16:19], s7 offen sc0 sc1
    v_lshlrev_b32 v8, 4, v0
    v_mul_hi_u32 v9, v8, s46
    v_mul_u32_u24 v6, 160, v9
    v_sub_u32 v8, v8, v6
    v_mul_u32_u24 v6, 9216, v9
    v_add3_u32 v6, v6, v8, s45
    v_cmp_le_u32 vcc, s47, v8
    v_add_u32 v9, 128, v6
    s_nop 0
    v_cndmask_b32 v6, v6, v9, vcc
    v_lshlrev_b32 v8, 2, v0
    v_add_u32 v8, 1024, v8
    v_mul_hi_u32 v9, v8, s46
    v_mul_u32_u24 v7, 160, v9
    v_sub_u32 v8, v8, v7
    v_mul_u32_u24 v7, 9216, v9
    v_add3_u32 v7, v7, v8, s45
    v_cmp_le_u32 vcc, s47, v8
    v_add_u32 v9, 128, v7
    s_nop 0
    v_cndmask_b32 v7, v7, v9, vcc
    v_subrev_u32 v7, 1024, v7
    s_waitcnt lgkmcnt(0)
    v_mfma_f32_32x32x16_bf16 v[64:79], v[24:27], a[208:211], v[64:79]
    ds_read_b128 a[216:219], v5 offset:0
    ds_read_b64_tr_b16 v[44:45], v1 offset:12416
    v_fma_f32 v16, v15, v12, -v10
    v_cvt_pk_bf16_f32 v60, v10, v12
    v_mfma_f32_32x32x16_bf16 v[80:95], v[24:27], a[212:215], v[80:95]
    ds_read_b64_tr_b16 v[46:47], v1 offset:12928
    ds_read_b128 a[220:223], v5 offset:4096
    v_fma_f32 v17, v15, v16, -v12
    v_fma_f32 v11, v14, v10, -v11
    v_mfma_f32_32x32x16_bf16 v[96:111], v[28:31], a[208:211], v[96:111]
    ds_read_b64_tr_b16 v[48:49], v19 offset:12416
    ds_read_b64_tr_b16 v[50:51], v19 offset:12928
    v_fma_f32 v18, v15, v17, -v16
    v_cvt_pk_bf16_f32 v61, v16, v17
    v_mfma_f32_32x32x16_bf16 v[112:127], v[28:31], a[212:215], v[112:127]
    ds_read_b64_tr_b16 v[52:53], v20 offset:12416
    ds_read_b64_tr_b16 v[54:55], v20 offset:12928
    v_fma_f32 v16, v15, v18, -v17
    v_fma_f32 v13, v14, v12, -v13
    v_mfma_f32_32x32x16_bf16 v[128:143], v[32:35], a[208:211], v[128:143]
    ds_read_b64_tr_b16 v[56:57], v21 offset:12416
    ds_read_b64_tr_b16 v[58:59], v21 offset:12928
    v_fma_f32 v17, v15, v16, -v18
    v_cvt_pk_bf16_f32 v62, v18, v16
    v_mfma_f32_32x32x16_bf16 v[144:159], v[32:35], a[212:215], v[144:159]
    v_fma_f32 v18, v15, v17, -v16
    v_cvt_pk_bf16_f32 v63, v17, v18
    v_mfma_f32_32x32x16_bf16 v[160:175], v[36:39], a[208:211], v[160:175]
    s_add_u32 s74, s74, 294912
    s_cmp_ge_u32 s74, 5308416
    s_cselect_b32 s74, 0, s74
    s_add_u32 m0, s56, 0
    s_nop 0
    buffer_load_dwordx4 v6, s[12:15], s74 offen lds
    v_mfma_f32_32x32x16_bf16 v[176:191], v[36:39], a[212:215], v[176:191]
    s_add_u32 m0, s56, 0
    s_nop 0
    buffer_load_dword v7, s[12:15], s74 offen offset:1024 lds
    v_mfma_f32_32x32x16_bf16 v[192:207], a[208:211], v[40:43], v[192:207]
    s_add_u32 m0, s56, 5248
    s_nop 0
    buffer_load_dwordx4 v6, s[20:23], s74 offen lds
    v_mfma_f32_32x32x16_bf16 v[208:223], a[212:215], v[40:43], v[208:223]
    s_add_u32 m0, s56, 5248
    s_nop 0
    buffer_load_dword v7, s[20:23], s74 offen offset:1024 lds
    s_waitcnt vmcnt(23) lgkmcnt(0)
    s_barrier
    v_mfma_f32_32x32x16_bf16 v[64:79], v[44:47], a[216:219], v[64:79]
    ds_read_b128 a[224:227], v2 offset:8192
    ds_read_b64_tr_b16 v[24:25], v1 offset:20736
    v_fma_f32 v16, v15, v13, -v11
    v_cvt_pk_bf16_f32 v40, v11, v13
    v_mfma_f32_32x32x16_bf16 v[80:95], v[44:47], a[220:223], v[80:95]
    ds_read_b64_tr_b16 v[26:27], v1 offset:21248
    ds_read_b128 a[228:231], v2 offset:12288
    v_fma_f32 v17, v15, v16, -v13
    v_fma_f32 v10, v14, v11, -v10
    v_mfma_f32_32x32x16_bf16 v[96:111], v[48:51], a[216:219], v[96:111]
    ds_read_b64_tr_b16 v[28:29], v19 offset:20736
    ds_read_b64_tr_b16 v[30:31], v19 offset:21248
    v_fma_f32 v18, v15, v17, -v16
    v_cvt_pk_bf16_f32 v41, v16, v17
    v_mfma_f32_32x32x16_bf16 v[112:127], v[48:51], a[220:223], v[112:127]
    ds_read_b64_tr_b16 v[32:33], v20 offset:20736
    ds_read_b64_tr_b16 v[34:35], v20 offset:21248
    v_fma_f32 v16, v15, v18, -v17
    v_fma_f32 v12, v14, v13, -v12
    v_mfma_f32_32x32x16_bf16 v[128:143], v[52:55], a[216:219], v[128:143]
    ds_read_b64_tr_b16 v[36:37], v21 offset:20736
    ds_read_b64_tr_b16 v[38:39], v21 offset:21248
    v_fma_f32 v17, v15, v16, -v18
    v_cvt_pk_bf16_f32 v42, v18, v16
    v_mfma_f32_32x32x16_bf16 v[144:159], v[52:55], a[220:223], v[144:159]
    v_fma_f32 v18, v15, v17, -v16
    v_cvt_pk_bf16_f32 v43, v17, v18
    v_mfma_f32_32x32x16_bf16 v[160:175], v[56:59], a[216:219], v[160:175]
    s_add_u32 s74, s74, 294912
    s_cmp_ge_u32 s74, 5308416
    s_cselect_b32 s74, 0, s74
    s_add_u32 m0, s56, 10368
    s_nop 0
    buffer_load_dwordx4 v6, s[12:15], s74 offen lds
    v_mfma_f32_32x32x16_bf16 v[176:191], v[56:59], a[220:223], v[176:191]
    s_add_u32 m0, s56, 10368
    s_nop 0
    buffer_load_dword v7, s[12:15], s74 offen offset:1024 lds
    v_mfma_f32_32x32x16_bf16 v[192:207], a[216:219], v[60:63], v[192:207]
    s_add_u32 m0, s56, 15616
    s_nop 0
    buffer_load_dwordx4 v6, s[20:23], s74 offen lds
    v_mfma_f32_32x32x16_bf16 v[208:223], a[220:223], v[60:63], v[208:223]
    s_add_u32 m0, s56, 15616
    s_nop 0
    buffer_load_dword v7, s[20:23], s74 offen offset:1024 lds
    s_waitcnt lgkmcnt(0)
    v_mfma_f32_32x32x16_bf16 v[64:79], v[24:27], a[224:227], v[64:79]
    ds_read_b128 a[232:235], v3 offset:8192
    ds_read_b64_tr_b16 v[44:45], v1 offset:22784
    v_fma_f32 v16, v15, v12, -v10
    v_mfma_f32_32x32x16_bf16 v[80:95], v[24:27], a[228:231], v[80:95]
    ds_read_b64_tr_b16 v[46:47], v1 offset:23296
    ds_read_b128 a[236:239], v3 offset:12288
    v_cvt_pk_bf16_f32 v60, v10, v12
    v_mfma_f32_32x32x16_bf16 v[96:111], v[28:31], a[224:227], v[96:111]
    ds_read_b64_tr_b16 v[48:49], v19 offset:22784
    ds_read_b64_tr_b16 v[50:51], v19 offset:23296
    v_fma_f32 v17, v15, v16, -v12
    v_mfma_f32_32x32x16_bf16 v[112:127], v[28:31], a[228:231], v[112:127]
    ds_read_b64_tr_b16 v[52:53], v20 offset:22784
    ds_read_b64_tr_b16 v[54:55], v20 offset:23296
    v_fma_f32 v11, v14, v10, -v11
    v_mfma_f32_32x32x16_bf16 v[128:143], v[32:35], a[224:227], v[128:143]
    ds_read_b64_tr_b16 v[56:57], v21 offset:22784
    ds_read_b64_tr_b16 v[58:59], v21 offset:23296
    v_fma_f32 v18, v15, v17, -v16
    v_mfma_f32_32x32x16_bf16 v[144:159], v[32:35], a[228:231], v[144:159]
    v_cvt_pk_bf16_f32 v61, v16, v17
    v_fma_f32 v16, v15, v18, -v17
    v_fma_f32 v13, v14, v12, -v13
    v_mfma_f32_32x32x16_bf16 v[160:175], v[36:39], a[224:227], v[160:175]
    v_fma_f32 v17, v15, v16, -v18
    v_cvt_pk_bf16_f32 v62, v18, v16
    v_fma_f32 v18, v15, v17, -v16
    v_mfma_f32_32x32x16_bf16 v[176:191], v[36:39], a[228:231], v[176:191]
    v_cvt_pk_bf16_f32 v63, v17, v18
    v_mfma_f32_32x32x16_bf16 v[192:207], a[224:227], v[40:43], v[192:207]
    v_mfma_f32_32x32x16_bf16 v[208:223], a[228:231], v[40:43], v[208:223]
    s_waitcnt vmcnt(24) lgkmcnt(0)
    s_barrier
    v_mfma_f32_32x32x16_bf16 v[64:79], v[44:47], a[232:235], v[64:79]
    ds_read_b128 a[240:243], v4 offset:8192
    ds_read_b64_tr_b16 v[24:25], v1 offset:31104
    v_fma_f32 v16, v15, v13, -v11
    v_cvt_pk_bf16_f32 v40, v11, v13
    v_mfma_f32_32x32x16_bf16 v[80:95], v[44:47], a[236:239], v[80:95]
    ds_read_b64_tr_b16 v[26:27], v1 offset:31616
    ds_read_b128 a[244:247], v4 offset:12288
    v_fma_f32 v17, v15, v16, -v13
    v_fma_f32 v10, v14, v11, -v10
    v_mfma_f32_32x32x16_bf16 v[96:111], v[48:51], a[232:235], v[96:111]
    ds_read_b64_tr_b16 v[28:29], v19 offset:31104
    ds_read_b64_tr_b16 v[30:31], v19 offset:31616
    v_fma_f32 v18, v15, v17, -v16
    v_cvt_pk_bf16_f32 v41, v16, v17
    v_mfma_f32_32x32x16_bf16 v[112:127], v[48:51], a[236:239], v[112:127]
    ds_read_b64_tr_b16 v[32:33], v20 offset:31104
    ds_read_b64_tr_b16 v[34:35], v20 offset:31616
    v_fma_f32 v16, v15, v18, -v17
    v_fma_f32 v12, v14, v13, -v12
    v_mfma_f32_32x32x16_bf16 v[128:143], v[52:55], a[232:235], v[128:143]
    ds_read_b64_tr_b16 v[36:37], v21 offset:31104
    ds_read_b64_tr_b16 v[38:39], v21 offset:31616
    v_fma_f32 v17, v15, v16, -v18
    v_cvt_pk_bf16_f32 v42, v18, v16
    v_mfma_f32_32x32x16_bf16 v[144:159], v[52:55], a[236:239], v[144:159]
    v_fma_f32 v18, v15, v17, -v16
    v_cvt_pk_bf16_f32 v43, v17, v18
    v_mfma_f32_32x32x16_bf16 v[160:175], v[56:59], a[232:235], v[160:175]
    s_add_u32 s74, s74, 294912
    s_cmp_ge_u32 s74, 5308416
    s_cselect_b32 s74, 0, s74
    s_add_u32 m0, s56, 20736
    s_nop 0
    buffer_load_dwordx4 v6, s[12:15], s74 offen lds
    v_mfma_f32_32x32x16_bf16 v[176:191], v[56:59], a[236:239], v[176:191]
    s_add_u32 m0, s56, 20736
    s_nop 0
    buffer_load_dword v7, s[12:15], s74 offen offset:1024 lds
    v_mfma_f32_32x32x16_bf16 v[192:207], a[232:235], v[60:63], v[192:207]
    s_add_u32 m0, s56, 25984
    s_nop 0
    buffer_load_dwordx4 v6, s[20:23], s74 offen lds
    v_mfma_f32_32x32x16_bf16 v[208:223], a[236:239], v[60:63], v[208:223]
    s_add_u32 m0, s56, 25984
    s_nop 0
    buffer_load_dword v7, s[20:23], s74 offen offset:1024 lds
    s_waitcnt lgkmcnt(0)
    v_mfma_f32_32x32x16_bf16 v[64:79], v[24:27], a[240:243], v[64:79]
    ds_read_b128 a[248:251], v5 offset:8192
    ds_read_b64_tr_b16 v[44:45], v1 offset:33152
    v_fma_f32 v16, v15, v12, -v10
    v_mfma_f32_32x32x16_bf16 v[80:95], v[24:27], a[244:247], v[80:95]
    ds_read_b64_tr_b16 v[46:47], v1 offset:33664
    ds_read_b128 a[252:255], v5 offset:12288
    v_cvt_pk_bf16_f32 v60, v10, v12
    v_mfma_f32_32x32x16_bf16 v[96:111], v[28:31], a[240:243], v[96:111]
    ds_read_b64_tr_b16 v[48:49], v19 offset:33152
    ds_read_b64_tr_b16 v[50:51], v19 offset:33664
    v_fma_f32 v17, v15, v16, -v12
    v_mfma_f32_32x32x16_bf16 v[112:127], v[28:31], a[244:247], v[112:127]
    ds_read_b64_tr_b16 v[52:53], v20 offset:33152
    ds_read_b64_tr_b16 v[54:55], v20 offset:33664
    v_fma_f32 v11, v14, v10, -v11
    v_mfma_f32_32x32x16_bf16 v[128:143], v[32:35], a[240:243], v[128:143]
    ds_read_b64_tr_b16 v[56:57], v21 offset:33152
    ds_read_b64_tr_b16 v[58:59], v21 offset:33664
    v_fma_f32 v18, v15, v17, -v16
    v_mfma_f32_32x32x16_bf16 v[144:159], v[32:35], a[244:247], v[144:159]
    v_cvt_pk_bf16_f32 v61, v16, v17
    v_fma_f32 v16, v15, v18, -v17
    v_fma_f32 v13, v14, v12, -v13
    v_mfma_f32_32x32x16_bf16 v[160:175], v[36:39], a[240:243], v[160:175]
    v_fma_f32 v17, v15, v16, -v18
    v_cvt_pk_bf16_f32 v62, v18, v16
    v_fma_f32 v18, v15, v17, -v16
    v_mfma_f32_32x32x16_bf16 v[176:191], v[36:39], a[244:247], v[176:191]
    v_cvt_pk_bf16_f32 v63, v17, v18
    v_mfma_f32_32x32x16_bf16 v[192:207], a[240:243], v[40:43], v[192:207]
    v_mfma_f32_32x32x16_bf16 v[208:223], a[244:247], v[40:43], v[208:223]
    s_waitcnt vmcnt(12) lgkmcnt(0)
    s_barrier
    v_mfma_f32_32x32x16_bf16 v[64:79], v[44:47], a[248:251], v[64:79]
    ds_read_b128 v[224:227], v2 offset:16384
    ds_read_b64_tr_b16 v[24:25], v1 offset:41472
    v_fma_f32 v16, v15, v13, -v11
    v_cvt_pk_bf16_f32 v40, v11, v13
    v_mfma_f32_32x32x16_bf16 v[80:95], v[44:47], a[252:255], v[80:95]
    ds_read_b64_tr_b16 v[26:27], v1 offset:41984
    ds_read_b128 v[228:231], v2 offset:20480
    v_fma_f32 v17, v15, v16, -v13
    v_fma_f32 v10, v14, v11, -v10
    v_mfma_f32_32x32x16_bf16 v[96:111], v[48:51], a[248:251], v[96:111]
    ds_read_b64_tr_b16 v[28:29], v19 offset:41472
    ds_read_b64_tr_b16 v[30:31], v19 offset:41984
    v_fma_f32 v18, v15, v17, -v16
    v_cvt_pk_bf16_f32 v41, v16, v17
    v_mfma_f32_32x32x16_bf16 v[112:127], v[48:51], a[252:255], v[112:127]
    ds_read_b64_tr_b16 v[32:33], v20 offset:41472
    ds_read_b64_tr_b16 v[34:35], v20 offset:41984
    v_fma_f32 v16, v15, v18, -v17
    v_fma_f32 v12, v14, v13, -v12
    v_mfma_f32_32x32x16_bf16 v[128:143], v[52:55], a[248:251], v[128:143]
    ds_read_b64_tr_b16 v[36:37], v21 offset:41472
    ds_read_b64_tr_b16 v[38:39], v21 offset:41984
    v_fma_f32 v17, v15, v16, -v18
    v_cvt_pk_bf16_f32 v42, v18, v16
    v_mfma_f32_32x32x16_bf16 v[144:159], v[52:55], a[252:255], v[144:159]
    v_fma_f32 v18, v15, v17, -v16
    v_cvt_pk_bf16_f32 v43, v17, v18
    v_mfma_f32_32x32x16_bf16 v[160:175], v[56:59], a[248:251], v[160:175]
    s_add_u32 s74, s74, 294912
    s_cmp_ge_u32 s74, 5308416
    s_cselect_b32 s74, 0, s74
    s_add_u32 m0, s56, 31104
    s_nop 0
    buffer_load_dwordx4 v6, s[12:15], s74 offen lds
    v_mfma_f32_32x32x16_bf16 v[176:191], v[56:59], a[252:255], v[176:191]
    s_add_u32 m0, s56, 31104
    s_nop 0
    buffer_load_dword v7, s[12:15], s74 offen offset:1024 lds
    v_mfma_f32_32x32x16_bf16 v[192:207], a[248:251], v[60:63], v[192:207]
    s_add_u32 m0, s56, 36352
    s_nop 0
    buffer_load_dwordx4 v6, s[20:23], s74 offen lds
    v_mfma_f32_32x32x16_bf16 v[208:223], a[252:255], v[60:63], v[208:223]
    s_add_u32 m0, s56, 36352
    s_nop 0
    buffer_load_dword v7, s[20:23], s74 offen offset:1024 lds
    s_waitcnt lgkmcnt(0)
    v_mfma_f32_32x32x16_bf16 v[64:79], v[24:27], v[224:227], v[64:79]
    ds_read_b128 v[232:235], v3 offset:16384
    ds_read_b64_tr_b16 v[44:45], v1 offset:43520
    v_fma_f32 v16, v15, v12, -v10
    v_mfma_f32_32x32x16_bf16 v[80:95], v[24:27], v[228:231], v[80:95]
    ds_read_b64_tr_b16 v[46:47], v1 offset:44032
    ds_read_b128 v[236:239], v3 offset:20480
    v_cvt_pk_bf16_f32 v60, v10, v12
    v_mfma_f32_32x32x16_bf16 v[96:111], v[28:31], v[224:227], v[96:111]
    ds_read_b64_tr_b16 v[48:49], v19 offset:43520
    ds_read_b64_tr_b16 v[50:51], v19 offset:44032
    v_fma_f32 v17, v15, v16, -v12
    v_mfma_f32_32x32x16_bf16 v[112:127], v[28:31], v[228:231], v[112:127]
    ds_read_b64_tr_b16 v[52:53], v20 offset:43520
    ds_read_b64_tr_b16 v[54:55], v20 offset:44032
    v_fma_f32 v11, v14, v10, -v11
    v_mfma_f32_32x32x16_bf16 v[128:143], v[32:35], v[224:227], v[128:143]
    ds_read_b64_tr_b16 v[56:57], v21 offset:43520
    ds_read_b64_tr_b16 v[58:59], v21 offset:44032
    v_fma_f32 v18, v15, v17, -v16
    v_mfma_f32_32x32x16_bf16 v[144:159], v[32:35], v[228:231], v[144:159]
    v_cvt_pk_bf16_f32 v61, v16, v17
    v_fma_f32 v16, v15, v18, -v17
    v_fma_f32 v13, v14, v12, -v13
    v_mfma_f32_32x32x16_bf16 v[160:175], v[36:39], v[224:227], v[160:175]
    v_mov_b32 v22, 1
    v_min_u32 v23, 1, v0
    v_lshlrev_b32 v23, 30, v23
    buffer_atomic_add v22, v23, s[32:35], s61 offen sc1
    v_mfma_f32_32x32x16_bf16 v[176:191], v[36:39], v[228:231], v[176:191]
    v_fma_f32 v17, v15, v16, -v18
    v_cvt_pk_bf16_f32 v62, v18, v16
    v_fma_f32 v18, v15, v17, -v16
    v_mfma_f32_32x32x16_bf16 v[192:207], v[224:227], v[40:43], v[192:207]
    v_cvt_pk_bf16_f32 v63, v17, v18
    v_mfma_f32_32x32x16_bf16 v[208:223], v[228:231], v[40:43], v[208:223]
    s_waitcnt lgkmcnt(0)
    s_barrier
    v_mfma_f32_32x32x16_bf16 v[64:79], v[44:47], v[232:235], v[64:79]
    ds_read_b128 v[240:243], v4 offset:16384
    ds_read_b64_tr_b16 v[24:25], v1 offset:51840
    v_fma_f32 v16, v15, v13, -v11
    v_cvt_pk_bf16_f32 v40, v11, v13
    v_mfma_f32_32x32x16_bf16 v[80:95], v[44:47], v[236:239], v[80:95]
    ds_read_b64_tr_b16 v[26:27], v1 offset:52352
    ds_read_b128 v[244:247], v4 offset:20480
    v_fma_f32 v17, v15, v16, -v13
    v_fma_f32 v10, v14, v11, -v10
    v_mfma_f32_32x32x16_bf16 v[96:111], v[48:51], v[232:235], v[96:111]
    ds_read_b64_tr_b16 v[28:29], v19 offset:51840
    ds_read_b64_tr_b16 v[30:31], v19 offset:52352
    v_fma_f32 v18, v15, v17, -v16
    v_cvt_pk_bf16_f32 v41, v16, v17
    v_mfma_f32_32x32x16_bf16 v[112:127], v[48:51], v[236:239], v[112:127]
    ds_read_b64_tr_b16 v[32:33], v20 offset:51840
    ds_read_b64_tr_b16 v[34:35], v20 offset:52352
    v_fma_f32 v16, v15, v18, -v17
    v_fma_f32 v12, v14, v13, -v12
    v_mfma_f32_32x32x16_bf16 v[128:143], v[52:55], v[232:235], v[128:143]
    ds_read_b64_tr_b16 v[36:37], v21 offset:51840
    ds_read_b64_tr_b16 v[38:39], v21 offset:52352
    v_fma_f32 v17, v15, v16, -v18
    v_cvt_pk_bf16_f32 v42, v18, v16
    v_mfma_f32_32x32x16_bf16 v[144:159], v[52:55], v[236:239], v[144:159]
    v_fma_f32 v18, v15, v17, -v16
    v_cvt_pk_bf16_f32 v43, v17, v18
    v_mfma_f32_32x32x16_bf16 v[160:175], v[56:59], v[232:235], v[160:175]
    s_add_u32 s74, s74, 294912
    s_cmp_ge_u32 s74, 5308416
    s_cselect_b32 s74, 0, s74
    s_add_u32 m0, s56, 41472
    s_nop 0
    buffer_load_dwordx4 v6, s[12:15], s74 offen lds
    v_mfma_f32_32x32x16_bf16 v[176:191], v[56:59], v[236:239], v[176:191]
    s_add_u32 m0, s56, 41472
    s_nop 0
    buffer_load_dword v7, s[12:15], s74 offen offset:1024 lds
    v_mfma_f32_32x32x16_bf16 v[192:207], v[232:235], v[60:63], v[192:207]
    s_add_u32 m0, s56, 46720
    s_nop 0
    buffer_load_dwordx4 v6, s[20:23], s74 offen lds
    v_mfma_f32_32x32x16_bf16 v[208:223], v[236:239], v[60:63], v[208:223]
    s_add_u32 m0, s56, 46720
    s_nop 0
    buffer_load_dword v7, s[20:23], s74 offen offset:1024 lds
    s_waitcnt lgkmcnt(0)
    v_mfma_f32_32x32x16_bf16 v[64:79], v[24:27], v[240:243], v[64:79]
    ds_read_b128 v[248:251], v5 offset:16384
    ds_read_b64_tr_b16 v[44:45], v1 offset:53888
    v_fma_f32 v16, v15, v12, -v10
    v_mfma_f32_32x32x16_bf16 v[80:95], v[24:27], v[244:247], v[80:95]
    ds_read_b64_tr_b16 v[46:47], v1 offset:54400
    ds_read_b128 v[252:255], v5 offset:20480
    v_cvt_pk_bf16_f32 v60, v10, v12
    v_mfma_f32_32x32x16_bf16 v[96:111], v[28:31], v[240:243], v[96:111]
    ds_read_b64_tr_b16 v[48:49], v19 offset:53888
    ds_read_b64_tr_b16 v[50:51], v19 offset:54400
    v_fma_f32 v17, v15, v16, -v12
    v_mfma_f32_32x32x16_bf16 v[112:127], v[28:31], v[244:247], v[112:127]
    ds_read_b64_tr_b16 v[52:53], v20 offset:53888
    ds_read_b64_tr_b16 v[54:55], v20 offset:54400
    v_fma_f32 v11, v14, v10, -v11
    v_mfma_f32_32x32x16_bf16 v[128:143], v[32:35], v[240:243], v[128:143]
    ds_read_b64_tr_b16 v[56:57], v21 offset:53888
    ds_read_b64_tr_b16 v[58:59], v21 offset:54400
    v_fma_f32 v18, v15, v17, -v16
    v_mfma_f32_32x32x16_bf16 v[144:159], v[32:35], v[244:247], v[144:159]
    v_cvt_pk_bf16_f32 v61, v16, v17
    v_fma_f32 v16, v15, v18, -v17
    v_fma_f32 v13, v14, v12, -v13
    v_mfma_f32_32x32x16_bf16 v[160:175], v[36:39], v[240:243], v[160:175]
    v_fma_f32 v17, v15, v16, -v18
    v_cvt_pk_bf16_f32 v62, v18, v16
    v_fma_f32 v18, v15, v17, -v16
    v_mfma_f32_32x32x16_bf16 v[176:191], v[36:39], v[244:247], v[176:191]
    v_cvt_pk_bf16_f32 v63, v17, v18
    v_mfma_f32_32x32x16_bf16 v[192:207], v[240:243], v[40:43], v[192:207]
    v_mfma_f32_32x32x16_bf16 v[208:223], v[244:247], v[40:43], v[208:223]
    v_bfe_u32 v8, v0, 4, 1
    v_mul_u32_u24 v1, 5248, v8
    v_lshrrev_b32 v8, 5, v0
    v_mul_u32_u24 v8, 1280, v8
    v_add_u32 v1, v1, v8
    v_bfe_u32 v8, v0, 2, 2
    v_mul_u32_u24 v8, 160, v8
    v_add_u32 v1, v1, v8
    v_and_b32 v8, 3, v0
    v_lshl_add_u32 v1, v8, 3, v1
    v_and_b32 v9, 3, v0
    v_lshlrev_b32 v9, 15, v9
    v_bfe_u32 v8, v0, 2, 3
    v_lshl_add_u32 v9, v8, 5, v9
    v_lshrrev_b32 v8, 5, v0
    v_lshl_add_u32 v9, v8, 4, v9
    s_lshl_b32 s44, s41, 17
    s_lshl_b32 s49, s38, 2
    s_add_u32 s49, s49, s36
    s_lshl_b32 s50, s49, 11
    s_lshl_b32 s49, s49, 10
    s_add_u32 s44, s44, s49
    s_add_u32 s44, s44, 21495808
    v_lshlrev_b32 v11, 4, v0
    v_add_u32 v11, s50, v11
    s_mul_i32 s49, s37, 9
    s_waitcnt vmcnt(17) lgkmcnt(0)
    s_barrier
    v_mfma_f32_32x32x16_bf16 v[64:79], v[44:47], v[248:251], v[64:79]
    ds_read_b64_tr_b16 v[24:25], v1 offset:0
    ds_read_b64_tr_b16 v[26:27], v1 offset:640
    v_mfma_f32_32x32x16_bf16 v[80:95], v[44:47], v[252:255], v[80:95]
    ds_read_b64_tr_b16 v[28:29], v1 offset:32
    ds_read_b64_tr_b16 v[30:31], v1 offset:672
    v_mfma_f32_32x32x16_bf16 v[96:111], v[48:51], v[248:251], v[96:111]
    ds_read_b64_tr_b16 v[32:33], v1 offset:64
    ds_read_b64_tr_b16 v[34:35], v1 offset:704
    v_mfma_f32_32x32x16_bf16 v[112:127], v[48:51], v[252:255], v[112:127]
    ds_read_b64_tr_b16 v[36:37], v1 offset:96
    ds_read_b64_tr_b16 v[38:39], v1 offset:736
    v_mfma_f32_32x32x16_bf16 v[128:143], v[52:55], v[248:251], v[128:143]
    ds_read_b64_tr_b16 v[40:41], v1 offset:128
    ds_read_b64_tr_b16 v[42:43], v1 offset:768
    v_mfma_f32_32x32x16_bf16 v[144:159], v[52:55], v[252:255], v[144:159]
    v_mfma_f32_32x32x16_bf16 v[160:175], v[56:59], v[248:251], v[160:175]
    s_add_u32 s74, s74, 294912
    s_cmp_ge_u32 s74, 5308416
    s_cselect_b32 s74, 0, s74
    s_add_u32 m0, s56, 51840
    s_nop 0
    buffer_load_dwordx4 v6, s[12:15], s74 offen lds
    v_mfma_f32_32x32x16_bf16 v[176:191], v[56:59], v[252:255], v[176:191]
    s_add_u32 m0, s56, 51840
    s_nop 0
    buffer_load_dword v7, s[12:15], s74 offen offset:1024 lds
    v_mfma_f32_32x32x16_bf16 v[192:207], v[248:251], v[60:63], v[192:207]
    s_add_u32 m0, s56, 57088
    s_nop 0
    buffer_load_dwordx4 v6, s[20:23], s74 offen lds
    v_mfma_f32_32x32x16_bf16 v[208:223], v[252:255], v[60:63], v[208:223]
    s_add_u32 m0, s56, 57088
    s_nop 0
    buffer_load_dword v7, s[20:23], s74 offen offset:1024 lds
    s_waitcnt lgkmcnt(0)
    s_add_u32 s50, s49, s48
    s_lshl_b32 s50, s50, 16
    v_max_f32 v64, 0, v64
    v_max_f32 v65, 0, v65
    v_max_f32 v66, 0, v66
    v_max_f32 v67, 0, v67
    v_max_f32 v68, 0, v68
    v_max_f32 v69, 0, v69
    v_max_f32 v70, 0, v70
    v_max_f32 v71, 0, v71
    v_mul_f32 v64, v64, v72
    v_mul_f32 v65, v65, v73
    v_mul_f32 v66, v66, v74
    v_mul_f32 v67, v67, v75
    v_mul_f32 v68, v68, v76
    v_mul_f32 v69, v69, v77
    v_mul_f32 v70, v70, v78
    v_mul_f32 v71, v71, v79
    v_cvt_pk_bf16_f32 v72, v64, v65
    v_cvt_pk_bf16_f32 v73, v66, v67
    v_cvt_pk_bf16_f32 v74, v68, v69
    v_cvt_pk_bf16_f32 v75, v70, v71
    buffer_store_dwordx4 v[72:75], v11, s[16:19], s50 offen offset:0 sc0 sc1
    s_nop 0
    v_mfma_f32_32x32x16_bf16 v[64:79], v[24:27], a[0:3], 0
    ds_read_b64_tr_b16 v[44:45], v1 offset:2560
    ds_read_b64_tr_b16 v[46:47], v1 offset:3200
    v_max_f32 v80, 0, v80
    v_max_f32 v81, 0, v81
    v_max_f32 v82, 0, v82
    v_max_f32 v83, 0, v83
    v_max_f32 v84, 0, v84
    v_max_f32 v85, 0, v85
    v_max_f32 v86, 0, v86
    v_max_f32 v87, 0, v87
    v_mul_f32 v80, v80, v88
    v_mul_f32 v81, v81, v89
    v_mul_f32 v82, v82, v90
    v_mul_f32 v83, v83, v91
    v_mul_f32 v84, v84, v92
    v_mul_f32 v85, v85, v93
    v_mul_f32 v86, v86, v94
    v_mul_f32 v87, v87, v95
    v_cvt_pk_bf16_f32 v88, v80, v81
    v_cvt_pk_bf16_f32 v89, v82, v83
    v_cvt_pk_bf16_f32 v90, v84, v85
    v_cvt_pk_bf16_f32 v91, v86, v87
    buffer_store_dwordx4 v[88:91], v11, s[16:19], s50 offen offset:1024 sc0 sc1
    s_nop 0
    v_mfma_f32_32x32x16_bf16 v[80:95], v[24:27], a[4:7], 0
    ds_read_b64_tr_b16 v[48:49], v1 offset:2592
    ds_read_b64_tr_b16 v[50:51], v1 offset:3232
    s_add_u32 s50, s49, s48
    s_add_u32 s50, s50, 1
    s_lshl_b32 s50, s50, 16
    v_max_f32 v96, 0, v96
    v_max_f32 v97, 0, v97
    v_max_f32 v98, 0, v98
    v_max_f32 v99, 0, v99
    v_max_f32 v100, 0, v100
    v_max_f32 v101, 0, v101
    v_max_f32 v102, 0, v102
    v_max_f32 v103, 0, v103
    v_mul_f32 v96, v96, v104
    v_mul_f32 v97, v97, v105
    v_mul_f32 v98, v98, v106
    v_mul_f32 v99, v99, v107
    v_mul_f32 v100, v100, v108
    v_mul_f32 v101, v101, v109
    v_mul_f32 v102, v102, v110
    v_mul_f32 v103, v103, v111
    v_cvt_pk_bf16_f32 v104, v96, v97
    v_cvt_pk_bf16_f32 v105, v98, v99
    v_cvt_pk_bf16_f32 v106, v100, v101
    v_cvt_pk_bf16_f32 v107, v102, v103
    buffer_store_dwordx4 v[104:107], v11, s[16:19], s50 offen offset:0 sc0 sc1
    s_nop 0
    v_mfma_f32_32x32x16_bf16 v[96:111], v[28:31], a[0:3], 0
    ds_read_b64_tr_b16 v[52:53], v1 offset:2624
    ds_read_b64_tr_b16 v[54:55], v1 offset:3264
    v_max_f32 v112, 0, v112
    v_max_f32 v113, 0, v113
    v_max_f32 v114, 0, v114
    v_max_f32 v115, 0, v115
    v_max_f32 v116, 0, v116
    v_max_f32 v117, 0, v117
    v_max_f32 v118, 0, v118
    v_max_f32 v119, 0, v119
    v_mul_f32 v112, v112, v120
    v_mul_f32 v113, v113, v121
    v_mul_f32 v114, v114, v122
    v_mul_f32 v115, v115, v123
    v_mul_f32 v116, v116, v124
    v_mul_f32 v117, v117, v125
    v_mul_f32 v118, v118, v126
    v_mul_f32 v119, v119, v127
    v_cvt_pk_bf16_f32 v120, v112, v113
    v_cvt_pk_bf16_f32 v121, v114, v115
    v_cvt_pk_bf16_f32 v122, v116, v117
    v_cvt_pk_bf16_f32 v123, v118, v119
    buffer_store_dwordx4 v[120:123], v11, s[16:19], s50 offen offset:1024 sc0 sc1
    s_nop 0
    v_mfma_f32_32x32x16_bf16 v[112:127], v[28:31], a[4:7], 0
    ds_read_b64_tr_b16 v[56:57], v1 offset:2656
    ds_read_b64_tr_b16 v[58:59], v1 offset:3296
    s_add_u32 s50, s49, s48
    s_add_u32 s50, s50, 2
    s_lshl_b32 s50, s50, 16
    v_max_f32 v128, 0, v128
    v_max_f32 v129, 0, v129
    v_max_f32 v130, 0, v130
    v_max_f32 v131, 0, v131
    v_max_f32 v132, 0, v132
    v_max_f32 v133, 0, v133
    v_max_f32 v134, 0, v134
    v_max_f32 v135, 0, v135
    v_mul_f32 v128, v128, v136
    v_mul_f32 v129, v129, v137
    v_mul_f32 v130, v130, v138
    v_mul_f32 v131, v131, v139
    v_mul_f32 v132, v132, v140
    v_mul_f32 v133, v133, v141
    v_mul_f32 v134, v134, v142
    v_mul_f32 v135, v135, v143
    v_cvt_pk_bf16_f32 v136, v128, v129
    v_cvt_pk_bf16_f32 v137, v130, v131
    v_cvt_pk_bf16_f32 v138, v132, v133
    v_cvt_pk_bf16_f32 v139, v134, v135
    buffer_store_dwordx4 v[136:139], v11, s[16:19], s50 offen offset:0 sc0 sc1
    s_nop 0
    v_mfma_f32_32x32x16_bf16 v[128:143], v[32:35], a[0:3], 0
    ds_read_b64_tr_b16 v[60:61], v1 offset:2688
    ds_read_b64_tr_b16 v[62:63], v1 offset:3328
    v_max_f32 v144, 0, v144
    v_max_f32 v145, 0, v145
    v_max_f32 v146, 0, v146
    v_max_f32 v147, 0, v147
    v_max_f32 v148, 0, v148
    v_max_f32 v149, 0, v149
    v_max_f32 v150, 0, v150
    v_max_f32 v151, 0, v151
    v_mul_f32 v144, v144, v152
    v_mul_f32 v145, v145, v153
    v_mul_f32 v146, v146, v154
    v_mul_f32 v147, v147, v155
    v_mul_f32 v148, v148, v156
    v_mul_f32 v149, v149, v157
    v_mul_f32 v150, v150, v158
    v_mul_f32 v151, v151, v159
    v_cvt_pk_bf16_f32 v152, v144, v145
    v_cvt_pk_bf16_f32 v153, v146, v147
    v_cvt_pk_bf16_f32 v154, v148, v149
    v_cvt_pk_bf16_f32 v155, v150, v151
    buffer_store_dwordx4 v[152:155], v11, s[16:19], s50 offen offset:1024 sc0 sc1
    s_nop 0
    v_mfma_f32_32x32x16_bf16 v[144:159], v[32:35], a[4:7], 0
    s_add_u32 s50, s49, s48
    s_add_u32 s50, s50, 3
    s_lshl_b32 s50, s50, 16
    v_max_f32 v160, 0, v160
    v_max_f32 v161, 0, v161
    v_max_f32 v162, 0, v162
    v_max_f32 v163, 0, v163
    v_max_f32 v164, 0, v164
    v_max_f32 v165, 0, v165
    v_max_f32 v166, 0, v166
    v_max_f32 v167, 0, v167
    v_mul_f32 v160, v160, v168
    v_mul_f32 v161, v161, v169
    v_mul_f32 v162, v162, v170
    v_mul_f32 v163, v163, v171
    v_mul_f32 v164, v164, v172
    v_mul_f32 v165, v165, v173
    v_mul_f32 v166, v166, v174
    v_mul_f32 v167, v167, v175
    v_cvt_pk_bf16_f32 v168, v160, v161
    v_cvt_pk_bf16_f32 v169, v162, v163
    v_cvt_pk_bf16_f32 v170, v164, v165
    v_cvt_pk_bf16_f32 v171, v166, v167
    buffer_store_dwordx4 v[168:171], v11, s[16:19], s50 offen offset:0 sc0 sc1
    s_nop 0
    v_mfma_f32_32x32x16_bf16 v[160:175], v[36:39], a[0:3], 0
    v_max_f32 v176, 0, v176
    v_max_f32 v177, 0, v177
    v_max_f32 v178, 0, v178
    v_max_f32 v179, 0, v179
    v_max_f32 v180, 0, v180
    v_max_f32 v181, 0, v181
    v_max_f32 v182, 0, v182
    v_max_f32 v183, 0, v183
    v_mul_f32 v176, v176, v184
    v_mul_f32 v177, v177, v185
    v_mul_f32 v178, v178, v186
    v_mul_f32 v179, v179, v187
    v_mul_f32 v180, v180, v188
    v_mul_f32 v181, v181, v189
    v_mul_f32 v182, v182, v190
    v_mul_f32 v183, v183, v191
    v_cvt_pk_bf16_f32 v184, v176, v177
    v_cvt_pk_bf16_f32 v185, v178, v179
    v_cvt_pk_bf16_f32 v186, v180, v181
    v_cvt_pk_bf16_f32 v187, v182, v183
    buffer_store_dwordx4 v[184:187], v11, s[16:19], s50 offen offset:1024 sc0 sc1
    s_nop 0
    v_mfma_f32_32x32x16_bf16 v[176:191], v[36:39], a[4:7], 0
    v_cvt_pk_bf16_f32 v192, v192, v193
    v_cvt_pk_bf16_f32 v193, v194, v195
    v_cvt_pk_bf16_f32 v194, v196, v197
    v_cvt_pk_bf16_f32 v195, v198, v199
    v_cvt_pk_bf16_f32 v196, v200, v201
    v_cvt_pk_bf16_f32 v197, v202, v203
    v_cvt_pk_bf16_f32 v198, v204, v205
    v_cvt_pk_bf16_f32 v199, v206, v207
    buffer_store_dwordx4 v[192:195], v9, s[16:19], s44 offen offset:0 sc0 sc1
    buffer_store_dwordx4 v[196:199], v9, s[16:19], s44 offen offset:256 sc0 sc1
    s_nop 0
    v_mfma_f32_32x32x16_bf16 v[192:207], v[40:43], a[0:3], 0
    v_cvt_pk_bf16_f32 v208, v208, v209
    v_cvt_pk_bf16_f32 v209, v210, v211
    v_cvt_pk_bf16_f32 v210, v212, v213
    v_cvt_pk_bf16_f32 v211, v214, v215
    v_cvt_pk_bf16_f32 v212, v216, v217
    v_cvt_pk_bf16_f32 v213, v218, v219
    v_cvt_pk_bf16_f32 v214, v220, v221
    v_cvt_pk_bf16_f32 v215, v222, v223
    buffer_store_dwordx4 v[208:211], v9, s[16:19], s44 offen offset:512 sc0 sc1
    buffer_store_dwordx4 v[212:215], v9, s[16:19], s44 offen offset:768 sc0 sc1
    s_nop 0
    v_mfma_f32_32x32x16_bf16 v[208:223], v[40:43], a[4:7], 0
    s_branch L_r2
L_r1_nodft:
    ds_read_b128 a[0:3], v2 offset:0
    ds_read_b64_tr_b16 v[24:25], v1 offset:0
    ds_read_b64_tr_b16 v[26:27], v1 offset:512
    ds_read_b128 a[4:7], v2 offset:4096
    ds_read_b64_tr_b16 v[28:29], v19 offset:0
    ds_read_b64_tr_b16 v[30:31], v19 offset:512
    ds_read_b64_tr_b16 v[32:33], v20 offset:0
    ds_read_b64_tr_b16 v[34:35], v20 offset:512
    ds_read_b64_tr_b16 v[36:37], v21 offset:0
    ds_read_b64_tr_b16 v[38:39], v21 offset:512
    s_waitcnt lgkmcnt(0)
    v_mfma_f32_32x32x16_bf16 v[64:79], v[24:27], a[0:3], 0
    ds_read_b128 a[8:11], v3 offset:0
    ds_read_b64_tr_b16 v[44:45], v1 offset:2048
    v_mfma_f32_32x32x16_bf16 v[80:95], v[24:27], a[4:7], 0
    ds_read_b64_tr_b16 v[46:47], v1 offset:2560
    ds_read_b128 a[12:15], v3 offset:4096
    v_mfma_f32_32x32x16_bf16 v[96:111], v[28:31], a[0:3], 0
    ds_read_b64_tr_b16 v[48:49], v19 offset:2048
    ds_read_b64_tr_b16 v[50:51], v19 offset:2560
    s_add_u32 s74, s74, 294912
    s_cmp_ge_u32 s74, 5308416
    s_cselect_b32 s74, 0, s74
    s_add_u32 m0, s55, 20736
    s_nop 0
    buffer_load_dwordx4 v6, s[12:15], s74 offen lds
    v_mfma_f32_32x32x16_bf16 v[112:127], v[28:31], a[4:7], 0
    ds_read_b64_tr_b16 v[52:53], v20 offset:2048
    ds_read_b64_tr_b16 v[54:55], v20 offset:2560
    s_add_u32 m0, s55, 24832
    s_nop 0
    buffer_load_dwordx4 v7, s[20:23], s74 offen lds
    v_mfma_f32_32x32x16_bf16 v[128:143], v[32:35], a[0:3], 0
    ds_read_b64_tr_b16 v[56:57], v21 offset:2048
    ds_read_b64_tr_b16 v[58:59], v21 offset:2560
    s_add_u32 s72, s72, 128
    s_cmp_ge_u32 s72, 1152
    s_cselect_b32 s72, 0, s72
    s_add_u32 m0, s57, 8192
    s_add_u32 s58, s72, 0
    buffer_load_dwordx4 v8, s[8:11], s58 offen lds
    v_mfma_f32_32x32x16_bf16 v[144:159], v[32:35], a[4:7], 0
    s_add_u32 m0, s57, 9216
    s_add_u32 s58, s72, 589824
    buffer_load_dwordx4 v9, s[8:11], s58 offen lds
    v_mfma_f32_32x32x16_bf16 v[160:175], v[36:39], a[0:3], 0
    s_add_u32 m0, s57, 10240
    s_add_u32 s58, s72, 1179648
    buffer_load_dwordx4 v8, s[8:11], s58 offen lds
    v_mfma_f32_32x32x16_bf16 v[176:191], v[36:39], a[4:7], 0
    s_add_u32 m0, s57, 11264
    s_add_u32 s58, s72, 1769472
    buffer_load_dwordx4 v9, s[8:11], s58 offen lds
    s_waitcnt vmcnt(8) lgkmcnt(0)
    s_barrier
    v_mfma_f32_32x32x16_bf16 v[64:79], v[44:47], a[8:11], v[64:79]
    ds_read_b128 a[16:19], v4 offset:0
    ds_read_b64_tr_b16 v[24:25], v1 offset:10368
    v_mfma_f32_32x32x16_bf16 v[80:95], v[44:47], a[12:15], v[80:95]
    ds_read_b64_tr_b16 v[26:27], v1 offset:10880
    ds_read_b128 a[20:23], v4 offset:4096
    v_mfma_f32_32x32x16_bf16 v[96:111], v[48:51], a[8:11], v[96:111]
    ds_read_b64_tr_b16 v[28:29], v19 offset:10368
    ds_read_b64_tr_b16 v[30:31], v19 offset:10880
    s_add_u32 m0, s57, 12288
    s_add_u32 s58, s72, 36864
    buffer_load_dwordx4 v8, s[8:11], s58 offen lds
    v_mfma_f32_32x32x16_bf16 v[112:127], v[48:51], a[12:15], v[112:127]
    ds_read_b64_tr_b16 v[32:33], v20 offset:10368
    ds_read_b64_tr_b16 v[34:35], v20 offset:10880
    s_add_u32 m0, s57, 13312
    s_add_u32 s58, s72, 626688
    buffer_load_dwordx4 v9, s[8:11], s58 offen lds
    v_mfma_f32_32x32x16_bf16 v[128:143], v[52:55], a[8:11], v[128:143]
    ds_read_b64_tr_b16 v[36:37], v21 offset:10368
    ds_read_b64_tr_b16 v[38:39], v21 offset:10880
    s_add_u32 m0, s57, 14336
    s_add_u32 s58, s72, 1216512
    buffer_load_dwordx4 v8, s[8:11], s58 offen lds
    v_mfma_f32_32x32x16_bf16 v[144:159], v[52:55], a[12:15], v[144:159]
    s_add_u32 m0, s57, 15360
    s_add_u32 s58, s72, 1806336
    buffer_load_dwordx4 v9, s[8:11], s58 offen lds
    v_mfma_f32_32x32x16_bf16 v[160:175], v[56:59], a[8:11], v[160:175]
    s_mov_b32 exec_lo, s73
    s_mov_b32 exec_hi, 0
    buffer_load_dword a220, v250, s[12:15], s71 offen
    s_mov_b64 exec, -1
    v_mfma_f32_32x32x16_bf16 v[176:191], v[56:59], a[12:15], v[176:191]
    s_mov_b32 exec_lo, s73
    s_mov_b32 exec_hi, 0
    buffer_load_dword a220, v250, s[20:23], s71 offen
    s_mov_b64 exec, -1
    s_waitcnt lgkmcnt(0)
    v_mfma_f32_32x32x16_bf16 v[64:79], v[24:27], a[16:19], v[64:79]
    ds_read_b128 a[24:27], v5 offset:0
    ds_read_b64_tr_b16 v[44:45], v1 offset:12416
    v_mfma_f32_32x32x16_bf16 v[80:95], v[24:27], a[20:23], v[80:95]
    ds_read_b64_tr_b16 v[46:47], v1 offset:12928
    ds_read_b128 a[28:31], v5 offset:4096
    v_mfma_f32_32x32x16_bf16 v[96:111], v[28:31], a[16:19], v[96:111]
    ds_read_b64_tr_b16 v[48:49], v19 offset:12416
    ds_read_b64_tr_b16 v[50:51], v19 offset:12928
    s_add_u32 s74, s74, 294912
    s_cmp_ge_u32 s74, 5308416
    s_cselect_b32 s74, 0, s74
    s_add_u32 m0, s55, 31104
    s_nop 0
    buffer_load_dwordx4 v6, s[12:15], s74 offen lds
    v_mfma_f32_32x32x16_bf16 v[112:127], v[28:31], a[20:23], v[112:127]
    ds_read_b64_tr_b16 v[52:53], v20 offset:12416
    ds_read_b64_tr_b16 v[54:55], v20 offset:12928
    s_add_u32 m0, s55, 35200
    s_nop 0
    buffer_load_dwordx4 v7, s[20:23], s74 offen lds
    v_mfma_f32_32x32x16_bf16 v[128:143], v[32:35], a[16:19], v[128:143]
    ds_read_b64_tr_b16 v[56:57], v21 offset:12416
    ds_read_b64_tr_b16 v[58:59], v21 offset:12928
    s_add_u32 s74, s74, 294912
    s_cmp_ge_u32 s74, 5308416
    s_cselect_b32 s74, 0, s74
    s_add_u32 m0, s55, 41472
    s_nop 0
    buffer_load_dwordx4 v6, s[12:15], s74 offen lds
    v_mfma_f32_32x32x16_bf16 v[144:159], v[32:35], a[20:23], v[144:159]
    s_add_u32 m0, s55, 45568
    s_nop 0
    buffer_load_dwordx4 v7, s[20:23], s74 offen lds
    v_mfma_f32_32x32x16_bf16 v[160:175], v[36:39], a[16:19], v[160:175]
    s_add_u32 s72, s72, 128
    s_cmp_ge_u32 s72, 1152
    s_cselect_b32 s72, 0, s72
    s_add_u32 m0, s57, 16384
    s_add_u32 s58, s72, 0
    buffer_load_dwordx4 v8, s[8:11], s58 offen lds
    v_mfma_f32_32x32x16_bf16 v[176:191], v[36:39], a[20:23], v[176:191]
    s_add_u32 m0, s57, 17408
    s_add_u32 s58, s72, 589824
    buffer_load_dwordx4 v9, s[8:11], s58 offen lds
    s_waitcnt vmcnt(8) lgkmcnt(0)
    s_barrier
    v_mfma_f32_32x32x16_bf16 v[64:79], v[44:47], a[24:27], v[64:79]
    ds_read_b128 a[32:35], v2 offset:8192
    ds_read_b64_tr_b16 v[24:25], v1 offset:20736
    v_mfma_f32_32x32x16_bf16 v[80:95], v[44:47], a[28:31], v[80:95]
    ds_read_b64_tr_b16 v[26:27], v1 offset:21248
    ds_read_b128 a[36:39], v2 offset:12288
    v_mfma_f32_32x32x16_bf16 v[96:111], v[48:51], a[24:27], v[96:111]
    ds_read_b64_tr_b16 v[28:29], v19 offset:20736
    ds_read_b64_tr_b16 v[30:31], v19 offset:21248
    s_add_u32 m0, s57, 18432
    s_add_u32 s58, s72, 1179648
    buffer_load_dwordx4 v8, s[8:11], s58 offen lds
    v_mfma_f32_32x32x16_bf16 v[112:127], v[48:51], a[28:31], v[112:127]
    ds_read_b64_tr_b16 v[32:33], v20 offset:20736
    ds_read_b64_tr_b16 v[34:35], v20 offset:21248
    s_add_u32 m0, s57, 19456
    s_add_u32 s58, s72, 1769472
    buffer_load_dwordx4 v9, s[8:11], s58 offen lds
    v_mfma_f32_32x32x16_bf16 v[128:143], v[52:55], a[24:27], v[128:143]
    ds_read_b64_tr_b16 v[36:37], v21 offset:20736
    ds_read_b64_tr_b16 v[38:39], v21 offset:21248
    s_add_u32 m0, s57, 20480
    s_add_u32 s58, s72, 36864
    buffer_load_dwordx4 v8, s[8:11], s58 offen lds
    v_mfma_f32_32x32x16_bf16 v[144:159], v[52:55], a[28:31], v[144:159]
    s_add_u32 m0, s57, 21504
    s_add_u32 s58, s72, 626688
    buffer_load_dwordx4 v9, s[8:11], s58 offen lds
    v_mfma_f32_32x32x16_bf16 v[160:175], v[56:59], a[24:27], v[160:175]
    s_add_u32 m0, s57, 22528
    s_add_u32 s58, s72, 1216512
    buffer_load_dwordx4 v8, s[8:11], s58 offen lds
    v_mfma_f32_32x32x16_bf16 v[176:191], v[56:59], a[28:31], v[176:191]
    s_add_u32 m0, s57, 23552
    s_add_u32 s58, s72, 1806336
    buffer_load_dwordx4 v9, s[8:11], s58 offen lds
    s_waitcnt lgkmcnt(0)
    v_mfma_f32_32x32x16_bf16 v[64:79], v[24:27], a[32:35], v[64:79]
    ds_read_b128 a[40:43], v3 offset:8192
    ds_read_b64_tr_b16 v[44:45], v1 offset:22784
    v_mfma_f32_32x32x16_bf16 v[80:95], v[24:27], a[36:39], v[80:95]
    ds_read_b64_tr_b16 v[46:47], v1 offset:23296
    ds_read_b128 a[44:47], v3 offset:12288
    v_mfma_f32_32x32x16_bf16 v[96:111], v[28:31], a[32:35], v[96:111]
    ds_read_b64_tr_b16 v[48:49], v19 offset:22784
    ds_read_b64_tr_b16 v[50:51], v19 offset:23296
    s_add_u32 s74, s74, 294912
    s_cmp_ge_u32 s74, 5308416
    s_cselect_b32 s74, 0, s74
    s_add_u32 m0, s55, 51840
    s_nop 0
    buffer_load_dwordx4 v6, s[12:15], s74 offen lds
    v_mfma_f32_32x32x16_bf16 v[112:127], v[28:31], a[36:39], v[112:127]
    ds_read_b64_tr_b16 v[52:53], v20 offset:22784
    ds_read_b64_tr_b16 v[54:55], v20 offset:23296
    s_add_u32 m0, s55, 55936
    s_nop 0
    buffer_load_dwordx4 v7, s[20:23], s74 offen lds
    v_mfma_f32_32x32x16_bf16 v[128:143], v[32:35], a[32:35], v[128:143]
    ds_read_b64_tr_b16 v[56:57], v21 offset:22784
    ds_read_b64_tr_b16 v[58:59], v21 offset:23296
    s_add_u32 s74, s74, 294912
    s_cmp_ge_u32 s74, 5308416
    s_cselect_b32 s74, 0, s74
    s_add_u32 m0, s55, 0
    s_nop 0
    buffer_load_dwordx4 v6, s[12:15], s74 offen lds
    v_mfma_f32_32x32x16_bf16 v[144:159], v[32:35], a[36:39], v[144:159]
    s_add_u32 m0, s55, 4096
    s_nop 0
    buffer_load_dwordx4 v7, s[20:23], s74 offen lds
    v_mfma_f32_32x32x16_bf16 v[160:175], v[36:39], a[32:35], v[160:175]
    s_add_u32 s72, s72, 128
    s_cmp_ge_u32 s72, 1152
    s_cselect_b32 s72, 0, s72
    s_add_u32 m0, s57, 0
    s_add_u32 s58, s72, 0
    buffer_load_dwordx4 v8, s[8:11], s58 offen lds
    v_mfma_f32_32x32x16_bf16 v[176:191], v[36:39], a[36:39], v[176:191]
    s_add_u32 m0, s57, 1024
    s_add_u32 s58, s72, 589824
    buffer_load_dwordx4 v9, s[8:11], s58 offen lds
    s_waitcnt vmcnt(16) lgkmcnt(0)
    s_barrier
    v_mfma_f32_32x32x16_bf16 v[64:79], v[44:47], a[40:43], v[64:79]
    ds_read_b128 a[48:51], v4 offset:8192
    ds_read_b64_tr_b16 v[24:25], v1 offset:31104
    v_mfma_f32_32x32x16_bf16 v[80:95], v[44:47], a[44:47], v[80:95]
    ds_read_b64_tr_b16 v[26:27], v1 offset:31616
    ds_read_b128 a[52:55], v4 offset:12288
    v_mfma_f32_32x32x16_bf16 v[96:111], v[48:51], a[40:43], v[96:111]
    ds_read_b64_tr_b16 v[28:29], v19 offset:31104
    ds_read_b64_tr_b16 v[30:31], v19 offset:31616
    s_add_u32 m0, s57, 2048
    s_add_u32 s58, s72, 1179648
    buffer_load_dwordx4 v8, s[8:11], s58 offen lds
    v_mfma_f32_32x32x16_bf16 v[112:127], v[48:51], a[44:47], v[112:127]
    ds_read_b64_tr_b16 v[32:33], v20 offset:31104
    ds_read_b64_tr_b16 v[34:35], v20 offset:31616
    s_add_u32 m0, s57, 3072
    s_add_u32 s58, s72, 1769472
    buffer_load_dwordx4 v9, s[8:11], s58 offen lds
    v_mfma_f32_32x32x16_bf16 v[128:143], v[52:55], a[40:43], v[128:143]
    ds_read_b64_tr_b16 v[36:37], v21 offset:31104
    ds_read_b64_tr_b16 v[38:39], v21 offset:31616
    s_add_u32 m0, s57, 4096
    s_add_u32 s58, s72, 36864
    buffer_load_dwordx4 v8, s[8:11], s58 offen lds
    v_mfma_f32_32x32x16_bf16 v[144:159], v[52:55], a[44:47], v[144:159]
    s_add_u32 m0, s57, 5120
    s_add_u32 s58, s72, 626688
    buffer_load_dwordx4 v9, s[8:11], s58 offen lds
    v_mfma_f32_32x32x16_bf16 v[160:175], v[56:59], a[40:43], v[160:175]
    s_add_u32 m0, s57, 6144
    s_add_u32 s58, s72, 1216512
    buffer_load_dwordx4 v8, s[8:11], s58 offen lds
    v_mfma_f32_32x32x16_bf16 v[176:191], v[56:59], a[44:47], v[176:191]
    s_add_u32 m0, s57, 7168
    s_add_u32 s58, s72, 1806336
    buffer_load_dwordx4 v9, s[8:11], s58 offen lds
    s_waitcnt lgkmcnt(0)
    v_mfma_f32_32x32x16_bf16 v[64:79], v[24:27], a[48:51], v[64:79]
    ds_read_b128 a[56:59], v5 offset:8192
    ds_read_b64_tr_b16 v[44:45], v1 offset:33152
    v_mfma_f32_32x32x16_bf16 v[80:95], v[24:27], a[52:55], v[80:95]
    ds_read_b64_tr_b16 v[46:47], v1 offset:33664
    ds_read_b128 a[60:63], v5 offset:12288
    v_mfma_f32_32x32x16_bf16 v[96:111], v[28:31], a[48:51], v[96:111]
    ds_read_b64_tr_b16 v[48:49], v19 offset:33152
    ds_read_b64_tr_b16 v[50:51], v19 offset:33664
    v_mfma_f32_32x32x16_bf16 v[112:127], v[28:31], a[52:55], v[112:127]
    ds_read_b64_tr_b16 v[52:53], v20 offset:33152
    ds_read_b64_tr_b16 v[54:55], v20 offset:33664
    v_mfma_f32_32x32x16_bf16 v[128:143], v[32:35], a[48:51], v[128:143]
    ds_read_b64_tr_b16 v[56:57], v21 offset:33152
    ds_read_b64_tr_b16 v[58:59], v21 offset:33664
    s_add_u32 s74, s74, 294912
    s_cmp_ge_u32 s74, 5308416
    s_cselect_b32 s74, 0, s74
    s_add_u32 m0, s55, 10368
    s_nop 0
    buffer_load_dwordx4 v6, s[12:15], s74 offen lds
    v_mfma_f32_32x32x16_bf16 v[144:159], v[32:35], a[52:55], v[144:159]
    s_add_u32 m0, s55, 14464
    s_nop 0
    buffer_load_dwordx4 v7, s[20:23], s74 offen lds
    v_mfma_f32_32x32x16_bf16 v[160:175], v[36:39], a[48:51], v[160:175]
    s_add_u32 s74, s74, 294912
    s_cmp_ge_u32 s74, 5308416
    s_cselect_b32 s74, 0, s74
    s_add_u32 m0, s55, 20736
    s_nop 0
    buffer_load_dwordx4 v6, s[12:15], s74 offen lds
    v_mfma_f32_32x32x16_bf16 v[176:191], v[36:39], a[52:55], v[176:191]
    s_add_u32 m0, s55, 24832
    s_nop 0
    buffer_load_dwordx4 v7, s[20:23], s74 offen lds
    s_waitcnt vmcnt(16) lgkmcnt(0)
    s_barrier
    v_mfma_f32_32x32x16_bf16 v[64:79], v[44:47], a[56:59], v[64:79]
    ds_read_b128 a[64:67], v2 offset:16384
    ds_read_b64_tr_b16 v[24:25], v1 offset:41472
    v_mfma_f32_32x32x16_bf16 v[80:95], v[44:47], a[60:63], v[80:95]
    ds_read_b64_tr_b16 v[26:27], v1 offset:41984
    ds_read_b128 a[68:71], v2 offset:20480
    v_mfma_f32_32x32x16_bf16 v[96:111], v[48:51], a[56:59], v[96:111]
    ds_read_b64_tr_b16 v[28:29], v19 offset:41472
    ds_read_b64_tr_b16 v[30:31], v19 offset:41984
    v_mfma_f32_32x32x16_bf16 v[112:127], v[48:51], a[60:63], v[112:127]
    ds_read_b64_tr_b16 v[32:33], v20 offset:41472
    ds_read_b64_tr_b16 v[34:35], v20 offset:41984
    buffer_load_dwordx4 v[224:227], v252, s[8:11], s54 offen offset:0
    v_mfma_f32_32x32x16_bf16 v[128:143], v[52:55], a[56:59], v[128:143]
    ds_read_b64_tr_b16 v[36:37], v21 offset:41472
    ds_read_b64_tr_b16 v[38:39], v21 offset:41984
    buffer_load_dwordx4 v[236:239], v253, s[32:35], 0 offen offset:0
    v_mfma_f32_32x32x16_bf16 v[144:159], v[52:55], a[60:63], v[144:159]
    buffer_load_dwordx4 v[228:231], v252, s[8:11], s54 offen offset:512
    v_mfma_f32_32x32x16_bf16 v[160:175], v[56:59], a[56:59], v[160:175]
    buffer_load_dwordx4 v[240:243], v253, s[32:35], 0 offen offset:512
    v_mfma_f32_32x32x16_bf16 v[176:191], v[56:59], a[60:63], v[176:191]
    buffer_load_dwordx4 v[232:235], v252, s[8:11], s54 offen offset:1024
    s_waitcnt lgkmcnt(0)
    v_mfma_f32_32x32x16_bf16 v[64:79], v[24:27], a[64:67], v[64:79]
    ds_read_b128 a[72:75], v3 offset:16384
    ds_read_b64_tr_b16 v[44:45], v1 offset:43520
    v_mfma_f32_32x32x16_bf16 v[80:95], v[24:27], a[68:71], v[80:95]
    ds_read_b64_tr_b16 v[46:47], v1 offset:44032
    ds_read_b128 a[76:79], v3 offset:20480
    v_mfma_f32_32x32x16_bf16 v[96:111], v[28:31], a[64:67], v[96:111]
    ds_read_b64_tr_b16 v[48:49], v19 offset:43520
    ds_read_b64_tr_b16 v[50:51], v19 offset:44032
    v_mfma_f32_32x32x16_bf16 v[112:127], v[28:31], a[68:71], v[112:127]
    ds_read_b64_tr_b16 v[52:53], v20 offset:43520
    ds_read_b64_tr_b16 v[54:55], v20 offset:44032
    buffer_load_dwordx4 v[244:247], v253, s[32:35], 0 offen offset:1024
    v_mfma_f32_32x32x16_bf16 v[128:143], v[32:35], a[64:67], v[128:143]
    ds_read_b64_tr_b16 v[56:57], v21 offset:43520
    ds_read_b64_tr_b16 v[58:59], v21 offset:44032
    s_add_u32 s7, s52, 0
    buffer_load_dwordx3 a[224:226], v254, s[24:27], s7 offen
    v_mfma_f32_32x32x16_bf16 v[144:159], v[32:35], a[68:71], v[144:159]
    buffer_load_dwordx3 a[240:242], v254, s[28:31], s7 offen
    v_mfma_f32_32x32x16_bf16 v[160:175], v[36:39], a[64:67], v[160:175]
    s_add_u32 s7, s52, 36992
    buffer_load_dwordx3 a[228:230], v254, s[24:27], s7 offen
    v_mfma_f32_32x32x16_bf16 v[176:191], v[36:39], a[68:71], v[176:191]
    buffer_load_dwordx3 a[244:246], v254, s[28:31], s7 offen
    s_waitcnt vmcnt(24) lgkmcnt(0)
    s_barrier
    v_mfma_f32_32x32x16_bf16 v[64:79], v[44:47], a[72:75], v[64:79]
    ds_read_b128 a[80:83], v4 offset:16384
    ds_read_b64_tr_b16 v[24:25], v1 offset:51840
    v_mfma_f32_32x32x16_bf16 v[80:95], v[44:47], a[76:79], v[80:95]
    ds_read_b64_tr_b16 v[26:27], v1 offset:52352
    ds_read_b128 a[84:87], v4 offset:20480
    v_mfma_f32_32x32x16_bf16 v[96:111], v[48:51], a[72:75], v[96:111]
    ds_read_b64_tr_b16 v[28:29], v19 offset:51840
    ds_read_b64_tr_b16 v[30:31], v19 offset:52352
    v_mfma_f32_32x32x16_bf16 v[112:127], v[48:51], a[76:79], v[112:127]
    ds_read_b64_tr_b16 v[32:33], v20 offset:51840
    ds_read_b64_tr_b16 v[34:35], v20 offset:52352
    s_add_u32 s7, s52, 73984
    buffer_load_dwordx3 a[232:234], v254, s[24:27], s7 offen
    v_mfma_f32_32x32x16_bf16 v[128:143], v[52:55], a[72:75], v[128:143]
    ds_read_b64_tr_b16 v[36:37], v21 offset:51840
    ds_read_b64_tr_b16 v[38:39], v21 offset:52352
    buffer_load_dwordx3 a[248:250], v254, s[28:31], s7 offen
    v_mfma_f32_32x32x16_bf16 v[144:159], v[52:55], a[76:79], v[144:159]
    s_add_u32 s7, s52, 110976
    buffer_load_dwordx3 a[236:238], v254, s[24:27], s7 offen
    v_mfma_f32_32x32x16_bf16 v[160:175], v[56:59], a[72:75], v[160:175]
    buffer_load_dwordx3 a[252:254], v254, s[28:31], s7 offen
    v_mfma_f32_32x32x16_bf16 v[176:191], v[56:59], a[76:79], v[176:191]
    s_add_u32 s72, s72, 128
    s_cmp_ge_u32 s72, 1152
    s_cselect_b32 s72, 0, s72
    s_add_u32 m0, s57, 8192
    s_add_u32 s58, s72, 0
    buffer_load_dwordx4 v8, s[8:11], s58 offen lds
    s_waitcnt lgkmcnt(0)
    v_mfma_f32_32x32x16_bf16 v[64:79], v[24:27], a[80:83], v[64:79]
    ds_read_b128 a[88:91], v5 offset:16384
    ds_read_b64_tr_b16 v[44:45], v1 offset:53888
    v_mfma_f32_32x32x16_bf16 v[80:95], v[24:27], a[84:87], v[80:95]
    ds_read_b64_tr_b16 v[46:47], v1 offset:54400
    ds_read_b128 a[92:95], v5 offset:20480
    v_mfma_f32_32x32x16_bf16 v[96:111], v[28:31], a[80:83], v[96:111]
    ds_read_b64_tr_b16 v[48:49], v19 offset:53888
    ds_read_b64_tr_b16 v[50:51], v19 offset:54400
    v_mfma_f32_32x32x16_bf16 v[112:127], v[28:31], a[84:87], v[112:127]
    ds_read_b64_tr_b16 v[52:53], v20 offset:53888
    ds_read_b64_tr_b16 v[54:55], v20 offset:54400
    s_add_u32 m0, s57, 9216
    s_add_u32 s58, s72, 589824
    buffer_load_dwordx4 v9, s[8:11], s58 offen lds
    v_mfma_f32_32x32x16_bf16 v[128:143], v[32:35], a[80:83], v[128:143]
    ds_read_b64_tr_b16 v[56:57], v21 offset:53888
    ds_read_b64_tr_b16 v[58:59], v21 offset:54400
    s_add_u32 m0, s57, 10240
    s_add_u32 s58, s72, 1179648
    buffer_load_dwordx4 v8, s[8:11], s58 offen lds
    v_mfma_f32_32x32x16_bf16 v[144:159], v[32:35], a[84:87], v[144:159]
    s_add_u32 m0, s57, 11264
    s_add_u32 s58, s72, 1769472
    buffer_load_dwordx4 v9, s[8:11], s58 offen lds
    v_mfma_f32_32x32x16_bf16 v[160:175], v[36:39], a[80:83], v[160:175]
    s_add_u32 m0, s57, 12288
    s_add_u32 s58, s72, 36864
    buffer_load_dwordx4 v8, s[8:11], s58 offen lds
    v_mfma_f32_32x32x16_bf16 v[176:191], v[36:39], a[84:87], v[176:191]
    s_add_u32 m0, s57, 13312
    s_add_u32 s58, s72, 626688
    buffer_load_dwordx4 v9, s[8:11], s58 offen lds
    s_waitcnt vmcnt(24) lgkmcnt(0)
    s_barrier
    v_mfma_f32_32x32x16_bf16 v[64:79], v[44:47], a[88:91], v[64:79]
    ds_read_b128 a[96:99], v2 offset:0
    ds_read_b64_tr_b16 v[24:25], v1 offset:0
    v_mfma_f32_32x32x16_bf16 v[80:95], v[44:47], a[92:95], v[80:95]
    ds_read_b64_tr_b16 v[26:27], v1 offset:512
    ds_read_b128 a[100:103], v2 offset:4096
    v_mfma_f32_32x32x16_bf16 v[96:111], v[48:51], a[88:91], v[96:111]
    ds_read_b64_tr_b16 v[28:29], v19 offset:0
    ds_read_b64_tr_b16 v[30:31], v19 offset:512
    v_mfma_f32_32x32x16_bf16 v[112:127], v[48:51], a[92:95], v[112:127]
    ds_read_b64_tr_b16 v[32:33], v20 offset:0
    ds_read_b64_tr_b16 v[34:35], v20 offset:512
    s_add_u32 m0, s57, 14336
    s_add_u32 s58, s72, 1216512
    buffer_load_dwordx4 v8, s[8:11], s58 offen lds
    v_mfma_f32_32x32x16_bf16 v[128:143], v[52:55], a[88:91], v[128:143]
    ds_read_b64_tr_b16 v[36:37], v21 offset:0
    ds_read_b64_tr_b16 v[38:39], v21 offset:512
    s_add_u32 m0, s57, 15360
    s_add_u32 s58, s72, 1806336
    buffer_load_dwordx4 v9, s[8:11], s58 offen lds
    v_mfma_f32_32x32x16_bf16 v[144:159], v[52:55], a[92:95], v[144:159]
    s_add_u32 s74, s74, 294912
    s_cmp_ge_u32 s74, 5308416
    s_cselect_b32 s74, 0, s74
    s_add_u32 m0, s55, 31104
    s_nop 0
    buffer_load_dwordx4 v6, s[12:15], s74 offen lds
    v_mfma_f32_32x32x16_bf16 v[160:175], v[56:59], a[88:91], v[160:175]
    s_add_u32 m0, s55, 35200
    s_nop 0
    buffer_load_dwordx4 v7, s[20:23], s74 offen lds
    v_mfma_f32_32x32x16_bf16 v[176:191], v[56:59], a[92:95], v[176:191]
    s_add_u32 s74, s74, 294912
    s_cmp_ge_u32 s74, 5308416
    s_cselect_b32 s74, 0, s74
    s_add_u32 m0, s55, 41472
    s_nop 0
    buffer_load_dwordx4 v6, s[12:15], s74 offen lds
    s_waitcnt lgkmcnt(0)
    v_mfma_f32_32x32x16_bf16 v[64:79], v[24:27], a[96:99], v[64:79]
    ds_read_b128 a[104:107], v3 offset:0
    ds_read_b64_tr_b16 v[44:45], v1 offset:2048
    v_mfma_f32_32x32x16_bf16 v[80:95], v[24:27], a[100:103], v[80:95]
    ds_read_b64_tr_b16 v[46:47], v1 offset:2560
    ds_read_b128 a[108:111], v3 offset:4096
    v_mfma_f32_32x32x16_bf16 v[96:111], v[28:31], a[96:99], v[96:111]
    ds_read_b64_tr_b16 v[48:49], v19 offset:2048
    ds_read_b64_tr_b16 v[50:51], v19 offset:2560
    v_mfma_f32_32x32x16_bf16 v[112:127], v[28:31], a[100:103], v[112:127]
    ds_read_b64_tr_b16 v[52:53], v20 offset:2048
    ds_read_b64_tr_b16 v[54:55], v20 offset:2560
    s_add_u32 m0, s55, 45568
    s_nop 0
    buffer_load_dwordx4 v7, s[20:23], s74 offen lds
    v_mfma_f32_32x32x16_bf16 v[128:143], v[32:35], a[96:99], v[128:143]
    ds_read_b64_tr_b16 v[56:57], v21 offset:2048
    ds_read_b64_tr_b16 v[58:59], v21 offset:2560
    s_add_u32 s72, s72, 128
    s_cmp_ge_u32 s72, 1152
    s_cselect_b32 s72, 0, s72
    s_add_u32 m0, s57, 16384
    s_add_u32 s58, s72, 0
    buffer_load_dwordx4 v8, s[8:11], s58 offen lds
    v_mfma_f32_32x32x16_bf16 v[144:159], v[32:35], a[100:103], v[144:159]
    s_add_u32 m0, s57, 17408
    s_add_u32 s58, s72, 589824
    buffer_load_dwordx4 v9, s[8:11], s58 offen lds
    v_mfma_f32_32x32x16_bf16 v[160:175], v[36:39], a[96:99], v[160:175]
    s_add_u32 m0, s57, 18432
    s_add_u32 s58, s72, 1179648
    buffer_load_dwordx4 v8, s[8:11], s58 offen lds
    v_mfma_f32_32x32x16_bf16 v[176:191], v[36:39], a[100:103], v[176:191]
    s_add_u32 m0, s57, 19456
    s_add_u32 s58, s72, 1769472
    buffer_load_dwordx4 v9, s[8:11], s58 offen lds
    s_mov_b32 s24, s76
    s_mov_b32 s25, s77
    s_mov_b32 s26, 5308416
    s_mov_b32 s27, 0x20000
    s_mov_b32 s28, s80
    s_mov_b32 s29, s81
    s_mov_b32 s30, 2359296
    s_mov_b32 s31, 0x20000
    s_mov_b32 s32, s82
    s_mov_b32 s33, s83
    s_mov_b32 s34, 256
    s_mov_b32 s35, 0x20000
    s_waitcnt vmcnt(16) lgkmcnt(0)
    s_barrier
    v_mfma_f32_32x32x16_bf16 v[64:79], v[44:47], a[104:107], v[64:79]
    ds_read_b128 a[112:115], v4 offset:0
    ds_read_b64_tr_b16 v[24:25], v1 offset:10368
    v_mov_b32 v248, 0
    v_mov_b32 v249, 0
    v_lshlrev_b32 v250, 16, v224
    v_and_b32 v251, s6, v224
    v_lshlrev_b32 v252, 16, v236
    v_mfma_f32_32x32x16_bf16 v[80:95], v[44:47], a[108:111], v[80:95]
    ds_read_b64_tr_b16 v[26:27], v1 offset:10880
    ds_read_b128 a[116:119], v4 offset:4096
    v_and_b32 v253, s6, v236
    v_mul_f32 v250, v250, v252
    v_mul_f32 v251, v251, v253
    v_cvt_pk_bf16_f32 v252, v250, v251
    v_lshlrev_b32 v250, 16, v252
    v_mfma_f32_32x32x16_bf16 v[96:111], v[48:51], a[104:107], v[96:111]
    ds_read_b64_tr_b16 v[28:29], v19 offset:10368
    ds_read_b64_tr_b16 v[30:31], v19 offset:10880
    v_and_b32 v251, s6, v252
    v_add_f32 v248, v248, v250
    v_add_f32 v249, v249, v251
    v_lshlrev_b32 v250, 16, v225
    v_and_b32 v251, s6, v225
    v_mfma_f32_32x32x16_bf16 v[112:127], v[48:51], a[108:111], v[112:127]
    ds_read_b64_tr_b16 v[32:33], v20 offset:10368
    ds_read_b64_tr_b16 v[34:35], v20 offset:10880
    s_add_u32 m0, s57, 20480
    s_add_u32 s58, s72, 36864
    buffer_load_dwordx4 v8, s[8:11], s58 offen lds
    v_mfma_f32_32x32x16_bf16 v[128:143], v[52:55], a[104:107], v[128:143]
    ds_read_b64_tr_b16 v[36:37], v21 offset:10368
    ds_read_b64_tr_b16 v[38:39], v21 offset:10880
    s_add_u32 m0, s57, 21504
    s_add_u32 s58, s72, 626688
    buffer_load_dwordx4 v9, s[8:11], s58 offen lds
    v_mfma_f32_32x32x16_bf16 v[144:159], v[52:55], a[108:111], v[144:159]
    s_add_u32 m0, s57, 22528
    s_add_u32 s58, s72, 1216512
    buffer_load_dwordx4 v8, s[8:11], s58 offen lds
    v_lshlrev_b32 v252, 16, v237
    v_and_b32 v253, s6, v237
    v_mfma_f32_32x32x16_bf16 v[160:175], v[56:59], a[104:107], v[160:175]
    s_add_u32 m0, s57, 23552
    s_add_u32 s58, s72, 1806336
    buffer_load_dwordx4 v9, s[8:11], s58 offen lds
    v_mfma_f32_32x32x16_bf16 v[176:191], v[56:59], a[108:111], v[176:191]
    s_add_u32 s74, s74, 294912
    s_cmp_ge_u32 s74, 5308416
    s_cselect_b32 s74, 0, s74
    s_add_u32 m0, s55, 51840
    s_nop 0
    buffer_load_dwordx4 v6, s[12:15], s74 offen lds
    s_waitcnt lgkmcnt(0)
    v_mfma_f32_32x32x16_bf16 v[64:79], v[24:27], a[112:115], v[64:79]
    ds_read_b128 a[120:123], v5 offset:0
    ds_read_b64_tr_b16 v[44:45], v1 offset:12416
    v_mul_f32 v250, v250, v252
    v_mul_f32 v251, v251, v253
    v_cvt_pk_bf16_f32 v252, v250, v251
    v_mfma_f32_32x32x16_bf16 v[80:95], v[24:27], a[116:119], v[80:95]
    ds_read_b64_tr_b16 v[46:47], v1 offset:12928
    ds_read_b128 a[124:127], v5 offset:4096
    v_lshlrev_b32 v250, 16, v252
    v_and_b32 v251, s6, v252
    v_add_f32 v248, v248, v250
    v_mfma_f32_32x32x16_bf16 v[96:111], v[28:31], a[112:115], v[96:111]
    ds_read_b64_tr_b16 v[48:49], v19 offset:12416
    ds_read_b64_tr_b16 v[50:51], v19 offset:12928
    v_add_f32 v249, v249, v251
    v_lshlrev_b32 v250, 16, v226
    v_and_b32 v251, s6, v226
    v_mfma_f32_32x32x16_bf16 v[112:127], v[28:31], a[116:119], v[112:127]
    ds_read_b64_tr_b16 v[52:53], v20 offset:12416
    ds_read_b64_tr_b16 v[54:55], v20 offset:12928
    v_lshlrev_b32 v252, 16, v238
    v_and_b32 v253, s6, v238
    v_mul_f32 v250, v250, v252
    v_mfma_f32_32x32x16_bf16 v[128:143], v[32:35], a[112:115], v[128:143]
    ds_read_b64_tr_b16 v[56:57], v21 offset:12416
    ds_read_b64_tr_b16 v[58:59], v21 offset:12928
    s_add_u32 m0, s55, 55936
    s_nop 0
    buffer_load_dwordx4 v7, s[20:23], s74 offen lds
    v_mfma_f32_32x32x16_bf16 v[144:159], v[32:35], a[116:119], v[144:159]
    s_add_u32 s74, s74, 294912
    s_cmp_ge_u32 s74, 5308416
    s_cselect_b32 s74, 0, s74
    s_add_u32 m0, s55, 0
    s_nop 0
    buffer_load_dwordx4 v6, s[12:15], s74 offen lds
    v_mfma_f32_32x32x16_bf16 v[160:175], v[36:39], a[112:115], v[160:175]
    s_add_u32 m0, s55, 4096
    s_nop 0
    buffer_load_dwordx4 v7, s[20:23], s74 offen lds
    v_mul_f32 v251, v251, v253
    v_mfma_f32_32x32x16_bf16 v[176:191], v[36:39], a[116:119], v[176:191]
    v_cvt_pk_bf16_f32 v252, v250, v251
    v_lshlrev_b32 v250, 16, v252
    v_and_b32 v251, s6, v252
    v_add_f32 v248, v248, v250
    s_waitcnt vmcnt(16) lgkmcnt(0)
    s_barrier
    v_mfma_f32_32x32x16_bf16 v[64:79], v[44:47], a[120:123], v[64:79]
    ds_read_b128 a[128:131], v2 offset:8192
    ds_read_b64_tr_b16 v[24:25], v1 offset:20736
    v_add_f32 v249, v249, v251
    v_lshlrev_b32 v250, 16, v227
    v_and_b32 v251, s6, v227
    v_lshlrev_b32 v252, 16, v239
    v_and_b32 v253, s6, v239
    v_mfma_f32_32x32x16_bf16 v[80:95], v[44:47], a[124:127], v[80:95]
    ds_read_b64_tr_b16 v[26:27], v1 offset:21248
    ds_read_b128 a[132:135], v2 offset:12288
    v_mul_f32 v250, v250, v252
    v_mul_f32 v251, v251, v253
    v_cvt_pk_bf16_f32 v252, v250, v251
    v_lshlrev_b32 v250, 16, v252
    v_and_b32 v251, s6, v252
    v_mfma_f32_32x32x16_bf16 v[96:111], v[48:51], a[120:123], v[96:111]
    ds_read_b64_tr_b16 v[28:29], v19 offset:20736
    ds_read_b64_tr_b16 v[30:31], v19 offset:21248
    v_add_f32 v248, v248, v250
    v_add_f32 v249, v249, v251
    v_lshlrev_b32 v250, 16, v228
    v_and_b32 v251, s6, v228
    v_lshlrev_b32 v252, 16, v240
    v_mfma_f32_32x32x16_bf16 v[112:127], v[48:51], a[124:127], v[112:127]
    ds_read_b64_tr_b16 v[32:33], v20 offset:20736
    ds_read_b64_tr_b16 v[34:35], v20 offset:21248
    s_add_u32 s72, s72, 128
    s_cmp_ge_u32 s72, 1152
    s_cselect_b32 s72, 0, s72
    s_add_u32 m0, s57, 0
    s_add_u32 s58, s72, 0
    buffer_load_dwordx4 v8, s[8:11], s58 offen lds
    v_mfma_f32_32x32x16_bf16 v[128:143], v[52:55], a[120:123], v[128:143]
    ds_read_b64_tr_b16 v[36:37], v21 offset:20736
    ds_read_b64_tr_b16 v[38:39], v21 offset:21248
    s_add_u32 m0, s57, 1024
    s_add_u32 s58, s72, 589824
    buffer_load_dwordx4 v9, s[8:11], s58 offen lds
    v_mfma_f32_32x32x16_bf16 v[144:159], v[52:55], a[124:127], v[144:159]
    s_add_u32 m0, s57, 2048
    s_add_u32 s58, s72, 1179648
    buffer_load_dwordx4 v8, s[8:11], s58 offen lds
    v_and_b32 v253, s6, v240
    v_mul_f32 v250, v250, v252
    v_mfma_f32_32x32x16_bf16 v[160:175], v[56:59], a[120:123], v[160:175]
    s_add_u32 m0, s57, 3072
    s_add_u32 s58, s72, 1769472
    buffer_load_dwordx4 v9, s[8:11], s58 offen lds
    v_mfma_f32_32x32x16_bf16 v[176:191], v[56:59], a[124:127], v[176:191]
    s_add_u32 m0, s57, 4096
    s_add_u32 s58, s72, 36864
    buffer_load_dwordx4 v8, s[8:11], s58 offen lds
    s_waitcnt lgkmcnt(0)
    v_mfma_f32_32x32x16_bf16 v[64:79], v[24:27], a[128:131], v[64:79]
    ds_read_b128 a[136:139], v3 offset:8192
    ds_read_b64_tr_b16 v[44:45], v1 offset:22784
    v_mul_f32 v251, v251, v253
    v_cvt_pk_bf16_f32 v252, v250, v251
    v_lshlrev_b32 v250, 16, v252
    v_and_b32 v251, s6, v252
    v_mfma_f32_32x32x16_bf16 v[80:95], v[24:27], a[132:135], v[80:95]
    ds_read_b64_tr_b16 v[46:47], v1 offset:23296
    ds_read_b128 a[140:143], v3 offset:12288
    v_add_f32 v248, v248, v250
    v_add_f32 v249, v249, v251
    v_lshlrev_b32 v250, 16, v229
    v_and_b32 v251, s6, v229
    v_mfma_f32_32x32x16_bf16 v[96:111], v[28:31], a[128:131], v[96:111]
    ds_read_b64_tr_b16 v[48:49], v19 offset:22784
    ds_read_b64_tr_b16 v[50:51], v19 offset:23296
    v_lshlrev_b32 v252, 16, v241
    v_and_b32 v253, s6, v241
    v_mul_f32 v250, v250, v252
    v_mul_f32 v251, v251, v253
    v_mfma_f32_32x32x16_bf16 v[112:127], v[28:31], a[132:135], v[112:127]
    ds_read_b64_tr_b16 v[52:53], v20 offset:22784
    ds_read_b64_tr_b16 v[54:55], v20 offset:23296
    v_cvt_pk_bf16_f32 v252, v250, v251
    v_lshlrev_b32 v250, 16, v252
    v_and_b32 v251, s6, v252
    v_add_f32 v248, v248, v250
    v_mfma_f32_32x32x16_bf16 v[128:143], v[32:35], a[128:131], v[128:143]
    ds_read_b64_tr_b16 v[56:57], v21 offset:22784
    ds_read_b64_tr_b16 v[58:59], v21 offset:23296
    s_add_u32 m0, s57, 5120
    s_add_u32 s58, s72, 626688
    buffer_load_dwordx4 v9, s[8:11], s58 offen lds
    v_mfma_f32_32x32x16_bf16 v[144:159], v[32:35], a[132:135], v[144:159]
    s_add_u32 m0, s57, 6144
    s_add_u32 s58, s72, 1216512
    buffer_load_dwordx4 v8, s[8:11], s58 offen lds
    v_add_f32 v249, v249, v251
    v_mfma_f32_32x32x16_bf16 v[160:175], v[36:39], a[128:131], v[160:175]
    s_add_u32 m0, s57, 7168
    s_add_u32 s58, s72, 1806336
    buffer_load_dwordx4 v9, s[8:11], s58 offen lds
    v_mfma_f32_32x32x16_bf16 v[176:191], v[36:39], a[132:135], v[176:191]
    s_add_u32 s74, s74, 294912
    s_cmp_ge_u32 s74, 5308416
    s_cselect_b32 s74, 0, s74
    s_add_u32 m0, s55, 10368
    s_nop 0
    buffer_load_dwordx4 v6, s[12:15], s74 offen lds
    s_waitcnt vmcnt(23) lgkmcnt(0)
    s_barrier
    v_mfma_f32_32x32x16_bf16 v[64:79], v[44:47], a[136:139], v[64:79]
    ds_read_b128 a[144:147], v4 offset:8192
    ds_read_b64_tr_b16 v[24:25], v1 offset:31104
    v_lshlrev_b32 v250, 16, v230
    v_and_b32 v251, s6, v230
    v_lshlrev_b32 v252, 16, v242
    v_mfma_f32_32x32x16_bf16 v[80:95], v[44:47], a[140:143], v[80:95]
    ds_read_b64_tr_b16 v[26:27], v1 offset:31616
    ds_read_b128 a[148:151], v4 offset:12288
    v_and_b32 v253, s6, v242
    v_mul_f32 v250, v250, v252
    v_mul_f32 v251, v251, v253
    v_mfma_f32_32x32x16_bf16 v[96:111], v[48:51], a[136:139], v[96:111]
    ds_read_b64_tr_b16 v[28:29], v19 offset:31104
    ds_read_b64_tr_b16 v[30:31], v19 offset:31616
    v_cvt_pk_bf16_f32 v252, v250, v251
    v_lshlrev_b32 v250, 16, v252
    v_and_b32 v251, s6, v252
    v_mfma_f32_32x32x16_bf16 v[112:127], v[48:51], a[140:143], v[112:127]
    ds_read_b64_tr_b16 v[32:33], v20 offset:31104
    ds_read_b64_tr_b16 v[34:35], v20 offset:31616
    v_add_f32 v248, v248, v250
    v_add_f32 v249, v249, v251
    v_lshlrev_b32 v250, 16, v231
    v_mfma_f32_32x32x16_bf16 v[128:143], v[52:55], a[136:139], v[128:143]
    ds_read_b64_tr_b16 v[36:37], v21 offset:31104
    ds_read_b64_tr_b16 v[38:39], v21 offset:31616
    s_add_u32 m0, s55, 14464
    s_nop 0
    buffer_load_dwordx4 v7, s[20:23], s74 offen lds
    v_mfma_f32_32x32x16_bf16 v[144:159], v[52:55], a[140:143], v[144:159]
    s_add_u32 s74, s74, 294912
    s_cmp_ge_u32 s74, 5308416
    s_cselect_b32 s74, 0, s74
    s_add_u32 m0, s55, 20736
    s_nop 0
    buffer_load_dwordx4 v6, s[12:15], s74 offen lds
    v_mfma_f32_32x32x16_bf16 v[160:175], v[56:59], a[136:139], v[160:175]
    s_add_u32 m0, s55, 24832
    s_nop 0
    buffer_load_dwordx4 v7, s[20:23], s74 offen lds
    v_and_b32 v251, s6, v231
    v_mfma_f32_32x32x16_bf16 v[176:191], v[56:59], a[140:143], v[176:191]
    v_lshlrev_b32 v252, 16, v243
    v_and_b32 v253, s6, v243
    v_mul_f32 v250, v250, v252
    v_mul_f32 v251, v251, v253
    s_waitcnt lgkmcnt(0)
    v_mfma_f32_32x32x16_bf16 v[64:79], v[24:27], a[144:147], v[64:79]
    ds_read_b128 a[152:155], v5 offset:8192
    ds_read_b64_tr_b16 v[44:45], v1 offset:33152
    v_cvt_pk_bf16_f32 v252, v250, v251
    v_lshlrev_b32 v250, 16, v252
    v_mfma_f32_32x32x16_bf16 v[80:95], v[24:27], a[148:151], v[80:95]
    ds_read_b64_tr_b16 v[46:47], v1 offset:33664
    ds_read_b128 a[156:159], v5 offset:12288
    v_and_b32 v251, s6, v252
    v_add_f32 v248, v248, v250
    v_mfma_f32_32x32x16_bf16 v[96:111], v[28:31], a[144:147], v[96:111]
    ds_read_b64_tr_b16 v[48:49], v19 offset:33152
    ds_read_b64_tr_b16 v[50:51], v19 offset:33664
    v_add_f32 v249, v249, v251
    v_lshlrev_b32 v250, 16, v232
    v_mfma_f32_32x32x16_bf16 v[112:127], v[28:31], a[148:151], v[112:127]
    ds_read_b64_tr_b16 v[52:53], v20 offset:33152
    ds_read_b64_tr_b16 v[54:55], v20 offset:33664
    v_and_b32 v251, s6, v232
    v_lshlrev_b32 v252, 16, v244
    v_mfma_f32_32x32x16_bf16 v[128:143], v[32:35], a[144:147], v[128:143]
    ds_read_b64_tr_b16 v[56:57], v21 offset:33152
    ds_read_b64_tr_b16 v[58:59], v21 offset:33664
    v_and_b32 v253, s6, v244
    v_mul_f32 v250, v250, v252
    v_mfma_f32_32x32x16_bf16 v[144:159], v[32:35], a[148:151], v[144:159]
    v_mul_f32 v251, v251, v253
    v_cvt_pk_bf16_f32 v252, v250, v251
    v_lshlrev_b32 v250, 16, v252
    v_and_b32 v251, s6, v252
    v_mfma_f32_32x32x16_bf16 v[160:175], v[36:39], a[144:147], v[160:175]
    v_add_f32 v248, v248, v250
    v_add_f32 v249, v249, v251
    v_lshlrev_b32 v250, 16, v233
    v_mfma_f32_32x32x16_bf16 v[176:191], v[36:39], a[148:151], v[176:191]
    s_waitcnt vmcnt(16) lgkmcnt(0)
    s_barrier
    v_mfma_f32_32x32x16_bf16 v[64:79], v[44:47], a[152:155], v[64:79]
    ds_read_b128 a[160:163], v2 offset:16384
    ds_read_b64_tr_b16 v[24:25], v1 offset:41472
    v_and_b32 v251, s6, v233
    v_lshlrev_b32 v252, 16, v245
    v_and_b32 v253, s6, v245
    v_mul_f32 v250, v250, v252
    v_mfma_f32_32x32x16_bf16 v[80:95], v[44:47], a[156:159], v[80:95]
    ds_read_b64_tr_b16 v[26:27], v1 offset:41984
    ds_read_b128 a[164:167], v2 offset:20480
    v_mul_f32 v251, v251, v253
    v_cvt_pk_bf16_f32 v252, v250, v251
    v_lshlrev_b32 v250, 16, v252
    v_and_b32 v251, s6, v252
    v_mfma_f32_32x32x16_bf16 v[96:111], v[48:51], a[152:155], v[96:111]
    ds_read_b64_tr_b16 v[28:29], v19 offset:41472
    ds_read_b64_tr_b16 v[30:31], v19 offset:41984
    v_add_f32 v248, v248, v250
    v_add_f32 v249, v249, v251
    v_lshlrev_b32 v250, 16, v234
    v_and_b32 v251, s6, v234
    v_mfma_f32_32x32x16_bf16 v[112:127], v[48:51], a[156:159], v[112:127]
    ds_read_b64_tr_b16 v[32:33], v20 offset:41472
    ds_read_b64_tr_b16 v[34:35], v20 offset:41984
    v_lshlrev_b32 v252, 16, v246
    v_and_b32 v253, s6, v246
    v_mul_f32 v250, v250, v252
    v_mul_f32 v251, v251, v253
    v_mfma_f32_32x32x16_bf16 v[128:143], v[52:55], a[152:155], v[128:143]
    ds_read_b64_tr_b16 v[36:37], v21 offset:41472
    ds_read_b64_tr_b16 v[38:39], v21 offset:41984
    s_add_u32 s72, s72, 128
    s_cmp_ge_u32 s72, 1152
    s_cselect_b32 s72, 0, s72
    s_add_u32 m0, s57, 8192
    s_add_u32 s58, s72, 0
    buffer_load_dwordx4 v8, s[8:11], s58 offen lds
    v_mfma_f32_32x32x16_bf16 v[144:159], v[52:55], a[156:159], v[144:159]
    s_add_u32 m0, s57, 9216
    s_add_u32 s58, s72, 589824
    buffer_load_dwordx4 v9, s[8:11], s58 offen lds
    v_cvt_pk_bf16_f32 v252, v250, v251
    v_mfma_f32_32x32x16_bf16 v[160:175], v[56:59], a[152:155], v[160:175]
    s_add_u32 m0, s57, 10240
    s_add_u32 s58, s72, 1179648
    buffer_load_dwordx4 v8, s[8:11], s58 offen lds
    v_mfma_f32_32x32x16_bf16 v[176:191], v[56:59], a[156:159], v[176:191]
    s_add_u32 m0, s57, 11264
    s_add_u32 s58, s72, 1769472
    buffer_load_dwordx4 v9, s[8:11], s58 offen lds
    s_waitcnt lgkmcnt(0)
    v_mfma_f32_32x32x16_bf16 v[64:79], v[24:27], a[160:163], v[64:79]
    ds_read_b128 a[168:171], v3 offset:16384
    ds_read_b64_tr_b16 v[44:45], v1 offset:43520
    v_lshlrev_b32 v250, 16, v252
    v_and_b32 v251, s6, v252
    v_add_f32 v248, v248, v250
    v_add_f32 v249, v249, v251
    v_mfma_f32_32x32x16_bf16 v[80:95], v[24:27], a[164:167], v[80:95]
    ds_read_b64_tr_b16 v[46:47], v1 offset:44032
    ds_read_b128 a[172:175], v3 offset:20480
    v_lshlrev_b32 v250, 16, v235
    v_and_b32 v251, s6, v235
    v_lshlrev_b32 v252, 16, v247
    v_and_b32 v253, s6, v247
    v_mfma_f32_32x32x16_bf16 v[96:111], v[28:31], a[160:163], v[96:111]
    ds_read_b64_tr_b16 v[48:49], v19 offset:43520
    ds_read_b64_tr_b16 v[50:51], v19 offset:44032
    v_mul_f32 v250, v250, v252
    v_mul_f32 v251, v251, v253
    v_cvt_pk_bf16_f32 v252, v250, v251
    v_lshlrev_b32 v250, 16, v252
    v_mfma_f32_32x32x16_bf16 v[112:127], v[28:31], a[164:167], v[112:127]
    ds_read_b64_tr_b16 v[52:53], v20 offset:43520
    ds_read_b64_tr_b16 v[54:55], v20 offset:44032
    v_and_b32 v251, s6, v252
    v_add_f32 v248, v248, v250
    v_add_f32 v249, v249, v251
    v_add_f32 v248, v248, v249
    v_mfma_f32_32x32x16_bf16 v[128:143], v[32:35], a[160:163], v[128:143]
    ds_read_b64_tr_b16 v[56:57], v21 offset:43520
    ds_read_b64_tr_b16 v[58:59], v21 offset:44032
    s_add_u32 m0, s57, 12288
    s_add_u32 s58, s72, 36864
    buffer_load_dwordx4 v8, s[8:11], s58 offen lds
    v_mfma_f32_32x32x16_bf16 v[144:159], v[32:35], a[164:167], v[144:159]
    s_add_u32 m0, s57, 13312
    s_add_u32 s58, s72, 626688
    buffer_load_dwordx4 v9, s[8:11], s58 offen lds
    v_add_f32_dpp v248, v248, v248 quad_perm:[1,0,3,2] row_mask:0xf bank_mask:0xf
    v_mfma_f32_32x32x16_bf16 v[160:175], v[36:39], a[160:163], v[160:175]
    s_add_u32 m0, s57, 14336
    s_add_u32 s58, s72, 1216512
    buffer_load_dwordx4 v8, s[8:11], s58 offen lds
    v_mfma_f32_32x32x16_bf16 v[176:191], v[36:39], a[164:167], v[176:191]
    s_add_u32 m0, s57, 15360
    s_add_u32 s58, s72, 1806336
    buffer_load_dwordx4 v9, s[8:11], s58 offen lds
    s_waitcnt vmcnt(22) lgkmcnt(0)
    s_barrier
    v_mfma_f32_32x32x16_bf16 v[64:79], v[44:47], a[168:171], v[64:79]
    ds_read_b128 a[176:179], v4 offset:16384
    ds_read_b64_tr_b16 v[24:25], v1 offset:51840
    v_add_f32_dpp v248, v248, v248 quad_perm:[2,3,0,1] row_mask:0xf bank_mask:0xf
    s_nop 1
    v_add_f32_dpp v248, v248, v248 row_half_mirror row_mask:0xf bank_mask:0xf
    s_nop 1
    v_add_f32_dpp v248, v248, v248 row_mirror row_mask:0xf bank_mask:0xf
    v_mov_b32 v249, v248
    s_nop 1
    v_permlane16_swap_b32 v248, v249
    v_mfma_f32_32x32x16_bf16 v[80:95], v[44:47], a[172:175], v[80:95]
    ds_read_b64_tr_b16 v[26:27], v1 offset:52352
    ds_read_b128 a[180:183], v4 offset:20480
    v_add_f32 v248, v248, v249
    v_cvt_pk_bf16_f32 v248, v248, v248
    v_lshlrev_b32 v248, 16, v248
    v_mul_f32 v248, 0xbfb8aa3b, v248
    v_mfma_f32_32x32x16_bf16 v[96:111], v[48:51], a[168:171], v[96:111]
    ds_read_b64_tr_b16 v[28:29], v19 offset:51840
    ds_read_b64_tr_b16 v[30:31], v19 offset:52352
    v_exp_f32 v248, v248
    s_nop 0
    v_add_f32 v248, 1.0, v248
    v_rcp_f32 v248, v248
    v_mfma_f32_32x32x16_bf16 v[112:127], v[48:51], a[172:175], v[112:127]
    ds_read_b64_tr_b16 v[32:33], v20 offset:51840
    ds_read_b64_tr_b16 v[34:35], v20 offset:52352
    v_cvt_pk_bf16_f32 v248, v248, v248
    v_lshlrev_b32 v248, 16, v248
    buffer_store_dword v248, v22, s[16:19], s53 offen sc0 sc1
    v_mfma_f32_32x32x16_bf16 v[128:143], v[52:55], a[168:171], v[128:143]
    ds_read_b64_tr_b16 v[36:37], v21 offset:51840
    ds_read_b64_tr_b16 v[38:39], v21 offset:52352
    s_add_u32 s74, s74, 294912
    s_cmp_ge_u32 s74, 5308416
    s_cselect_b32 s74, 0, s74
    s_add_u32 m0, s55, 31104
    s_nop 0
    buffer_load_dwordx4 v6, s[12:15], s74 offen lds
    v_mfma_f32_32x32x16_bf16 v[144:159], v[52:55], a[172:175], v[144:159]
    s_add_u32 m0, s55, 35200
    s_nop 0
    buffer_load_dwordx4 v7, s[20:23], s74 offen lds
    v_accvgpr_read_b32 v250, a224
    v_accvgpr_read_b32 v251, a225
    v_mfma_f32_32x32x16_bf16 v[160:175], v[56:59], a[168:171], v[160:175]
    s_add_u32 s74, s74, 294912
    s_cmp_ge_u32 s74, 5308416
    s_cselect_b32 s74, 0, s74
    s_add_u32 m0, s55, 41472
    s_nop 0
    buffer_load_dwordx4 v6, s[12:15], s74 offen lds
    v_mfma_f32_32x32x16_bf16 v[176:191], v[56:59], a[172:175], v[176:191]
    s_add_u32 m0, s55, 45568
    s_nop 0
    buffer_load_dwordx4 v7, s[20:23], s74 offen lds
    s_waitcnt lgkmcnt(0)
    v_mfma_f32_32x32x16_bf16 v[64:79], v[24:27], a[176:179], v[64:79]
    ds_read_b128 a[184:187], v5 offset:16384
    ds_read_b64_tr_b16 v[44:45], v1 offset:53888
    v_accvgpr_read_b32 v252, a226
    v_alignbit_b32 v224, v251, v250, s63
    v_mfma_f32_32x32x16_bf16 v[80:95], v[24:27], a[180:183], v[80:95]
    ds_read_b64_tr_b16 v[46:47], v1 offset:54400
    ds_read_b128 a[188:191], v5 offset:20480
    v_alignbit_b32 v225, v252, v251, s63
    v_accvgpr_read_b32 v250, a240
    v_mfma_f32_32x32x16_bf16 v[96:111], v[28:31], a[176:179], v[96:111]
    ds_read_b64_tr_b16 v[48:49], v19 offset:53888
    ds_read_b64_tr_b16 v[50:51], v19 offset:54400
    v_accvgpr_read_b32 v251, a241
    v_accvgpr_read_b32 v252, a242
    v_mfma_f32_32x32x16_bf16 v[112:127], v[28:31], a[180:183], v[112:127]
    ds_read_b64_tr_b16 v[52:53], v20 offset:53888
    ds_read_b64_tr_b16 v[54:55], v20 offset:54400
    v_alignbit_b32 v232, v251, v250, s63
    v_alignbit_b32 v233, v252, v251, s63
    v_mfma_f32_32x32x16_bf16 v[128:143], v[32:35], a[176:179], v[128:143]
    ds_read_b64_tr_b16 v[56:57], v21 offset:53888
    ds_read_b64_tr_b16 v[58:59], v21 offset:54400
    v_accvgpr_read_b32 v250, a228
    v_accvgpr_read_b32 v251, a229
    v_mfma_f32_32x32x16_bf16 v[144:159], v[32:35], a[180:183], v[144:159]
    v_accvgpr_read_b32 v252, a230
    v_alignbit_b32 v226, v251, v250, s63
    v_alignbit_b32 v227, v252, v251, s63
    v_accvgpr_read_b32 v250, a244
    v_mfma_f32_32x32x16_bf16 v[160:175], v[36:39], a[176:179], v[160:175]
    v_accvgpr_read_b32 v251, a245
    v_accvgpr_read_b32 v252, a246
    v_alignbit_b32 v234, v251, v250, s63
    v_mfma_f32_32x32x16_bf16 v[176:191], v[36:39], a[180:183], v[176:191]
    s_waitcnt vmcnt(17) lgkmcnt(0)
    s_barrier
    v_mfma_f32_32x32x16_bf16 v[64:79], v[44:47], a[184:187], v[64:79]
    ds_read_b128 a[192:195], v2 offset:0
    ds_read_b64_tr_b16 v[24:25], v1 offset:0
    v_alignbit_b32 v235, v252, v251, s63
    v_accvgpr_read_b32 v250, a232
    v_accvgpr_read_b32 v251, a233
    v_accvgpr_read_b32 v252, a234
    v_mfma_f32_32x32x16_bf16 v[80:95], v[44:47], a[188:191], v[80:95]
    ds_read_b64_tr_b16 v[26:27], v1 offset:512
    ds_read_b128 a[196:199], v2 offset:4096
    v_alignbit_b32 v228, v251, v250, s63
    v_alignbit_b32 v229, v252, v251, s63
    v_accvgpr_read_b32 v250, a248
    v_accvgpr_read_b32 v251, a249
    v_mfma_f32_32x32x16_bf16 v[96:111], v[48:51], a[184:187], v[96:111]
    ds_read_b64_tr_b16 v[28:29], v19 offset:0
    ds_read_b64_tr_b16 v[30:31], v19 offset:512
    v_accvgpr_read_b32 v252, a250
    v_alignbit_b32 v236, v251, v250, s63
    v_alignbit_b32 v237, v252, v251, s63
    v_accvgpr_read_b32 v250, a236
    v_mfma_f32_32x32x16_bf16 v[112:127], v[48:51], a[188:191], v[112:127]
    ds_read_b64_tr_b16 v[32:33], v20 offset:0
    ds_read_b64_tr_b16 v[34:35], v20 offset:512
    v_accvgpr_read_b32 v251, a237
    v_accvgpr_read_b32 v252, a238
    v_alignbit_b32 v230, v251, v250, s63
    v_alignbit_b32 v231, v252, v251, s63
    v_mfma_f32_32x32x16_bf16 v[128:143], v[52:55], a[184:187], v[128:143]
    ds_read_b64_tr_b16 v[36:37], v21 offset:0
    ds_read_b64_tr_b16 v[38:39], v21 offset:512
    s_add_u32 s72, s72, 128
    s_cmp_ge_u32 s72, 1152
    s_cselect_b32 s72, 0, s72
    s_add_u32 m0, s57, 16384
    s_add_u32 s58, s72, 0
    buffer_load_dwordx4 v8, s[8:11], s58 offen lds
    v_mfma_f32_32x32x16_bf16 v[144:159], v[52:55], a[188:191], v[144:159]
    s_add_u32 m0, s57, 17408
    s_add_u32 s58, s72, 589824
    buffer_load_dwordx4 v9, s[8:11], s58 offen lds
    v_accvgpr_read_b32 v250, a252
    v_mfma_f32_32x32x16_bf16 v[160:175], v[56:59], a[184:187], v[160:175]
    s_add_u32 m0, s57, 18432
    s_add_u32 s58, s72, 1179648
    buffer_load_dwordx4 v8, s[8:11], s58 offen lds
    v_mfma_f32_32x32x16_bf16 v[176:191], v[56:59], a[188:191], v[176:191]
    s_add_u32 m0, s57, 19456
    s_add_u32 s58, s72, 1769472
    buffer_load_dwordx4 v9, s[8:11], s58 offen lds
    s_waitcnt lgkmcnt(0)
    v_mfma_f32_32x32x16_bf16 v[64:79], v[24:27], a[192:195], v[64:79]
    ds_read_b128 a[200:203], v3 offset:0
    ds_read_b64_tr_b16 v[44:45], v1 offset:2048
    v_accvgpr_read_b32 v251, a253
    v_accvgpr_read_b32 v252, a254
    v_alignbit_b32 v238, v251, v250, s63
    v_alignbit_b32 v239, v252, v251, s63
    v_perm_b32 v240, v232, v224, s50
    v_perm_b32 v241, v234, v226, s50
    v_mfma_f32_32x32x16_bf16 v[80:95], v[24:27], a[196:199], v[80:95]
    ds_read_b64_tr_b16 v[46:47], v1 offset:2560
    ds_read_b128 a[204:207], v3 offset:4096
    v_perm_b32 v242, v236, v228, s50
    v_perm_b32 v243, v238, v230, s50
    s_add_u32 s7, s49, 0
    buffer_store_dwordx4 v[240:243], v23, s[16:19], s7 offen sc0 sc1
    v_mfma_f32_32x32x16_bf16 v[96:111], v[28:31], a[192:195], v[96:111]
    ds_read_b64_tr_b16 v[48:49], v19 offset:2048
    ds_read_b64_tr_b16 v[50:51], v19 offset:2560
    v_perm_b32 v244, v232, v224, s51
    v_perm_b32 v245, v234, v226, s51
    v_perm_b32 v246, v236, v228, s51
    v_perm_b32 v247, v238, v230, s51
    v_mfma_f32_32x32x16_bf16 v[112:127], v[28:31], a[196:199], v[112:127]
    ds_read_b64_tr_b16 v[52:53], v20 offset:2048
    ds_read_b64_tr_b16 v[54:55], v20 offset:2560
    s_add_u32 s7, s49, 65536
    buffer_store_dwordx4 v[244:247], v255, s[16:19], s7 offen sc0 sc1
    v_perm_b32 v240, v233, v225, s50
    v_perm_b32 v241, v235, v227, s50
    v_mfma_f32_32x32x16_bf16 v[128:143], v[32:35], a[192:195], v[128:143]
    ds_read_b64_tr_b16 v[56:57], v21 offset:2048
    ds_read_b64_tr_b16 v[58:59], v21 offset:2560
    s_add_u32 m0, s57, 20480
    s_add_u32 s58, s72, 36864
    buffer_load_dwordx4 v8, s[8:11], s58 offen lds
    v_perm_b32 v242, v237, v229, s50
    v_mfma_f32_32x32x16_bf16 v[144:159], v[32:35], a[196:199], v[144:159]
    s_add_u32 m0, s57, 21504
    s_add_u32 s58, s72, 626688
    buffer_load_dwordx4 v9, s[8:11], s58 offen lds
    v_mfma_f32_32x32x16_bf16 v[160:175], v[36:39], a[192:195], v[160:175]
    s_add_u32 m0, s57, 22528
    s_add_u32 s58, s72, 1216512
    buffer_load_dwordx4 v8, s[8:11], s58 offen lds
    v_mfma_f32_32x32x16_bf16 v[176:191], v[36:39], a[196:199], v[176:191]
    s_add_u32 m0, s57, 23552
    s_add_u32 s58, s72, 1806336
    buffer_load_dwordx4 v9, s[8:11], s58 offen lds
    s_waitcnt vmcnt(25) lgkmcnt(0)
    s_barrier
    v_mfma_f32_32x32x16_bf16 v[64:79], v[44:47], a[200:203], v[64:79]
    ds_read_b128 a[208:211], v4 offset:0
    ds_read_b64_tr_b16 v[24:25], v1 offset:10368
    v_perm_b32 v243, v239, v231, s50
    v_mfma_f32_32x32x16_bf16 v[80:95], v[44:47], a[204:207], v[80:95]
    ds_read_b64_tr_b16 v[26:27], v1 offset:10880
    ds_read_b128 a[212:215], v4 offset:4096
    s_add_u32 s7, s49, 131072
    buffer_store_dwordx4 v[240:243], v255, s[16:19], s7 offen sc0 sc1
    v_mfma_f32_32x32x16_bf16 v[96:111], v[48:51], a[200:203], v[96:111]
    ds_read_b64_tr_b16 v[28:29], v19 offset:10368
    ds_read_b64_tr_b16 v[30:31], v19 offset:10880
    v_perm_b32 v244, v233, v225, s51
    v_perm_b32 v245, v235, v227, s51
    v_perm_b32 v246, v237, v229, s51
    v_perm_b32 v247, v239, v231, s51
    v_mfma_f32_32x32x16_bf16 v[112:127], v[48:51], a[204:207], v[112:127]
    ds_read_b64_tr_b16 v[32:33], v20 offset:10368
    ds_read_b64_tr_b16 v[34:35], v20 offset:10880
    s_add_u32 s7, s49, 196608
    buffer_store_dwordx4 v[244:247], v255, s[16:19], s7 offen sc0 sc1
    v_mfma_f32_32x32x16_bf16 v[128:143], v[52:55], a[200:203], v[128:143]
    ds_read_b64_tr_b16 v[36:37], v21 offset:10368
    ds_read_b64_tr_b16 v[38:39], v21 offset:10880
    s_add_u32 s74, s74, 294912
    s_cmp_ge_u32 s74, 5308416
    s_cselect_b32 s74, 0, s74
    s_add_u32 m0, s55, 51840
    s_nop 0
    buffer_load_dwordx4 v6, s[12:15], s74 offen lds
    v_mfma_f32_32x32x16_bf16 v[144:159], v[52:55], a[204:207], v[144:159]
    s_add_u32 m0, s55, 55936
    s_nop 0
    buffer_load_dwordx4 v7, s[20:23], s74 offen lds
    v_mfma_f32_32x32x16_bf16 v[160:175], v[56:59], a[200:203], v[160:175]
    v_mfma_f32_32x32x16_bf16 v[176:191], v[56:59], a[204:207], v[176:191]
    v_lshlrev_b32 v8, 4, v0
    v_mul_hi_u32 v9, v8, s46
    v_mul_u32_u24 v6, 160, v9
    v_sub_u32 v8, v8, v6
    v_mul_u32_u24 v6, 9216, v9
    v_add3_u32 v6, v6, v8, s45
    v_cmp_le_u32 vcc, s47, v8
    v_add_u32 v9, 128, v6
    s_nop 0
    v_cndmask_b32 v6, v6, v9, vcc
    v_lshlrev_b32 v8, 2, v0
    v_add_u32 v8, 1024, v8
    v_mul_hi_u32 v9, v8, s46
    v_mul_u32_u24 v7, 160, v9
    v_sub_u32 v8, v8, v7
    v_mul_u32_u24 v7, 9216, v9
    v_add3_u32 v7, v7, v8, s45
    v_cmp_le_u32 vcc, s47, v8
    v_add_u32 v9, 128, v7
    s_nop 0
    v_cndmask_b32 v7, v7, v9, vcc
    v_subrev_u32 v7, 1024, v7
    s_waitcnt lgkmcnt(0)
    v_mfma_f32_32x32x16_bf16 v[64:79], v[24:27], a[208:211], v[64:79]
    ds_read_b128 a[216:219], v5 offset:0
    ds_read_b64_tr_b16 v[44:45], v1 offset:12416
    v_mfma_f32_32x32x16_bf16 v[80:95], v[24:27], a[212:215], v[80:95]
    ds_read_b64_tr_b16 v[46:47], v1 offset:12928
    ds_read_b128 a[220:223], v5 offset:4096
    v_mfma_f32_32x32x16_bf16 v[96:111], v[28:31], a[208:211], v[96:111]
    ds_read_b64_tr_b16 v[48:49], v19 offset:12416
    ds_read_b64_tr_b16 v[50:51], v19 offset:12928
    v_mfma_f32_32x32x16_bf16 v[112:127], v[28:31], a[212:215], v[112:127]
    ds_read_b64_tr_b16 v[52:53], v20 offset:12416
    ds_read_b64_tr_b16 v[54:55], v20 offset:12928
    v_mfma_f32_32x32x16_bf16 v[128:143], v[32:35], a[208:211], v[128:143]
    ds_read_b64_tr_b16 v[56:57], v21 offset:12416
    ds_read_b64_tr_b16 v[58:59], v21 offset:12928
    s_add_u32 s74, s74, 294912
    s_cmp_ge_u32 s74, 5308416
    s_cselect_b32 s74, 0, s74
    s_add_u32 m0, s56, 0
    s_nop 0
    buffer_load_dwordx4 v6, s[12:15], s74 offen lds
    v_mfma_f32_32x32x16_bf16 v[144:159], v[32:35], a[212:215], v[144:159]
    s_add_u32 m0, s56, 0
    s_nop 0
    buffer_load_dword v7, s[12:15], s74 offen offset:1024 lds
    v_mfma_f32_32x32x16_bf16 v[160:175], v[36:39], a[208:211], v[160:175]
    s_add_u32 m0, s56, 5248
    s_nop 0
    buffer_load_dwordx4 v6, s[20:23], s74 offen lds
    v_mfma_f32_32x32x16_bf16 v[176:191], v[36:39], a[212:215], v[176:191]
    s_add_u32 m0, s56, 5248
    s_nop 0
    buffer_load_dword v7, s[20:23], s74 offen offset:1024 lds
    s_waitcnt vmcnt(23) lgkmcnt(0)
    s_barrier
    v_mfma_f32_32x32x16_bf16 v[64:79], v[44:47], a[216:219], v[64:79]
    ds_read_b128 a[224:227], v2 offset:8192
    ds_read_b64_tr_b16 v[24:25], v1 offset:20736
    v_mfma_f32_32x32x16_bf16 v[80:95], v[44:47], a[220:223], v[80:95]
    ds_read_b64_tr_b16 v[26:27], v1 offset:21248
    ds_read_b128 a[228:231], v2 offset:12288
    v_mfma_f32_32x32x16_bf16 v[96:111], v[48:51], a[216:219], v[96:111]
    ds_read_b64_tr_b16 v[28:29], v19 offset:20736
    ds_read_b64_tr_b16 v[30:31], v19 offset:21248
    v_mfma_f32_32x32x16_bf16 v[112:127], v[48:51], a[220:223], v[112:127]
    ds_read_b64_tr_b16 v[32:33], v20 offset:20736
    ds_read_b64_tr_b16 v[34:35], v20 offset:21248
    v_mfma_f32_32x32x16_bf16 v[128:143], v[52:55], a[216:219], v[128:143]
    ds_read_b64_tr_b16 v[36:37], v21 offset:20736
    ds_read_b64_tr_b16 v[38:39], v21 offset:21248
    s_add_u32 s74, s74, 294912
    s_cmp_ge_u32 s74, 5308416
    s_cselect_b32 s74, 0, s74
    s_add_u32 m0, s56, 10368
    s_nop 0
    buffer_load_dwordx4 v6, s[12:15], s74 offen lds
    v_mfma_f32_32x32x16_bf16 v[144:159], v[52:55], a[220:223], v[144:159]
    s_add_u32 m0, s56, 10368
    s_nop 0
    buffer_load_dword v7, s[12:15], s74 offen offset:1024 lds
    v_mfma_f32_32x32x16_bf16 v[160:175], v[56:59], a[216:219], v[160:175]
    s_add_u32 m0, s56, 15616
    s_nop 0
    buffer_load_dwordx4 v6, s[20:23], s74 offen lds
    v_mfma_f32_32x32x16_bf16 v[176:191], v[56:59], a[220:223], v[176:191]
    s_add_u32 m0, s56, 15616
    s_nop 0
    buffer_load_dword v7, s[20:23], s74 offen offset:1024 lds
    s_waitcnt lgkmcnt(0)
    v_mfma_f32_32x32x16_bf16 v[64:79], v[24:27], a[224:227], v[64:79]
    ds_read_b128 a[232:235], v3 offset:8192
    ds_read_b64_tr_b16 v[44:45], v1 offset:22784
    v_mfma_f32_32x32x16_bf16 v[80:95], v[24:27], a[228:231], v[80:95]
    ds_read_b64_tr_b16 v[46:47], v1 offset:23296
    ds_read_b128 a[236:239], v3 offset:12288
    v_mfma_f32_32x32x16_bf16 v[96:111], v[28:31], a[224:227], v[96:111]
    ds_read_b64_tr_b16 v[48:49], v19 offset:22784
    ds_read_b64_tr_b16 v[50:51], v19 offset:23296
    v_mfma_f32_32x32x16_bf16 v[112:127], v[28:31], a[228:231], v[112:127]
    ds_read_b64_tr_b16 v[52:53], v20 offset:22784
    ds_read_b64_tr_b16 v[54:55], v20 offset:23296
    v_mfma_f32_32x32x16_bf16 v[128:143], v[32:35], a[224:227], v[128:143]
    ds_read_b64_tr_b16 v[56:57], v21 offset:22784
    ds_read_b64_tr_b16 v[58:59], v21 offset:23296
    v_mfma_f32_32x32x16_bf16 v[144:159], v[32:35], a[228:231], v[144:159]
    v_mfma_f32_32x32x16_bf16 v[160:175], v[36:39], a[224:227], v[160:175]
    v_mfma_f32_32x32x16_bf16 v[176:191], v[36:39], a[228:231], v[176:191]
    s_waitcnt vmcnt(24) lgkmcnt(0)
    s_barrier
    v_mfma_f32_32x32x16_bf16 v[64:79], v[44:47], a[232:235], v[64:79]
    ds_read_b128 a[240:243], v4 offset:8192
    ds_read_b64_tr_b16 v[24:25], v1 offset:31104
    v_mfma_f32_32x32x16_bf16 v[80:95], v[44:47], a[236:239], v[80:95]
    ds_read_b64_tr_b16 v[26:27], v1 offset:31616
    ds_read_b128 a[244:247], v4 offset:12288
    v_mfma_f32_32x32x16_bf16 v[96:111], v[48:51], a[232:235], v[96:111]
    ds_read_b64_tr_b16 v[28:29], v19 offset:31104
    ds_read_b64_tr_b16 v[30:31], v19 offset:31616
    v_mfma_f32_32x32x16_bf16 v[112:127], v[48:51], a[236:239], v[112:127]
    ds_read_b64_tr_b16 v[32:33], v20 offset:31104
    ds_read_b64_tr_b16 v[34:35], v20 offset:31616
    v_mfma_f32_32x32x16_bf16 v[128:143], v[52:55], a[232:235], v[128:143]
    ds_read_b64_tr_b16 v[36:37], v21 offset:31104
    ds_read_b64_tr_b16 v[38:39], v21 offset:31616
    s_add_u32 s74, s74, 294912
    s_cmp_ge_u32 s74, 5308416
    s_cselect_b32 s74, 0, s74
    s_add_u32 m0, s56, 20736
    s_nop 0
    buffer_load_dwordx4 v6, s[12:15], s74 offen lds
    v_mfma_f32_32x32x16_bf16 v[144:159], v[52:55], a[236:239], v[144:159]
    s_add_u32 m0, s56, 20736
    s_nop 0
    buffer_load_dword v7, s[12:15], s74 offen offset:1024 lds
    v_mfma_f32_32x32x16_bf16 v[160:175], v[56:59], a[232:235], v[160:175]
    s_add_u32 m0, s56, 25984
    s_nop 0
    buffer_load_dwordx4 v6, s[20:23], s74 offen lds
    v_mfma_f32_32x32x16_bf16 v[176:191], v[56:59], a[236:239], v[176:191]
    s_add_u32 m0, s56, 25984
    s_nop 0
    buffer_load_dword v7, s[20:23], s74 offen offset:1024 lds
    s_waitcnt lgkmcnt(0)
    v_mfma_f32_32x32x16_bf16 v[64:79], v[24:27], a[240:243], v[64:79]
    ds_read_b128 a[248:251], v5 offset:8192
    ds_read_b64_tr_b16 v[44:45], v1 offset:33152
    v_mfma_f32_32x32x16_bf16 v[80:95], v[24:27], a[244:247], v[80:95]
    ds_read_b64_tr_b16 v[46:47], v1 offset:33664
    ds_read_b128 a[252:255], v5 offset:12288
    v_mfma_f32_32x32x16_bf16 v[96:111], v[28:31], a[240:243], v[96:111]
    ds_read_b64_tr_b16 v[48:49], v19 offset:33152
    ds_read_b64_tr_b16 v[50:51], v19 offset:33664
    v_mfma_f32_32x32x16_bf16 v[112:127], v[28:31], a[244:247], v[112:127]
    ds_read_b64_tr_b16 v[52:53], v20 offset:33152
    ds_read_b64_tr_b16 v[54:55], v20 offset:33664
    v_mfma_f32_32x32x16_bf16 v[128:143], v[32:35], a[240:243], v[128:143]
    ds_read_b64_tr_b16 v[56:57], v21 offset:33152
    ds_read_b64_tr_b16 v[58:59], v21 offset:33664
    v_mfma_f32_32x32x16_bf16 v[144:159], v[32:35], a[244:247], v[144:159]
    v_mfma_f32_32x32x16_bf16 v[160:175], v[36:39], a[240:243], v[160:175]
    v_mfma_f32_32x32x16_bf16 v[176:191], v[36:39], a[244:247], v[176:191]
    s_waitcnt vmcnt(14) lgkmcnt(0)
    s_barrier
    v_mfma_f32_32x32x16_bf16 v[64:79], v[44:47], a[248:251], v[64:79]
    ds_read_b128 v[224:227], v2 offset:16384
    ds_read_b64_tr_b16 v[24:25], v1 offset:41472
    v_mfma_f32_32x32x16_bf16 v[80:95], v[44:47], a[252:255], v[80:95]
    ds_read_b64_tr_b16 v[26:27], v1 offset:41984
    ds_read_b128 v[228:231], v2 offset:20480
    v_mfma_f32_32x32x16_bf16 v[96:111], v[48:51], a[248:251], v[96:111]
    ds_read_b64_tr_b16 v[28:29], v19 offset:41472
    ds_read_b64_tr_b16 v[30:31], v19 offset:41984
    v_mfma_f32_32x32x16_bf16 v[112:127], v[48:51], a[252:255], v[112:127]
    ds_read_b64_tr_b16 v[32:33], v20 offset:41472
    ds_read_b64_tr_b16 v[34:35], v20 offset:41984
    v_mfma_f32_32x32x16_bf16 v[128:143], v[52:55], a[248:251], v[128:143]
    ds_read_b64_tr_b16 v[36:37], v21 offset:41472
    ds_read_b64_tr_b16 v[38:39], v21 offset:41984
    s_add_u32 s74, s74, 294912
    s_cmp_ge_u32 s74, 5308416
    s_cselect_b32 s74, 0, s74
    s_add_u32 m0, s56, 31104
    s_nop 0
    buffer_load_dwordx4 v6, s[12:15], s74 offen lds
    v_mfma_f32_32x32x16_bf16 v[144:159], v[52:55], a[252:255], v[144:159]
    s_add_u32 m0, s56, 31104
    s_nop 0
    buffer_load_dword v7, s[12:15], s74 offen offset:1024 lds
    v_mfma_f32_32x32x16_bf16 v[160:175], v[56:59], a[248:251], v[160:175]
    s_add_u32 m0, s56, 36352
    s_nop 0
    buffer_load_dwordx4 v6, s[20:23], s74 offen lds
    v_mfma_f32_32x32x16_bf16 v[176:191], v[56:59], a[252:255], v[176:191]
    s_add_u32 m0, s56, 36352
    s_nop 0
    buffer_load_dword v7, s[20:23], s74 offen offset:1024 lds
    s_waitcnt lgkmcnt(0)
    v_mfma_f32_32x32x16_bf16 v[64:79], v[24:27], v[224:227], v[64:79]
    ds_read_b128 v[232:235], v3 offset:16384
    ds_read_b64_tr_b16 v[44:45], v1 offset:43520
    v_mfma_f32_32x32x16_bf16 v[80:95], v[24:27], v[228:231], v[80:95]
    ds_read_b64_tr_b16 v[46:47], v1 offset:44032
    ds_read_b128 v[236:239], v3 offset:20480
    v_mfma_f32_32x32x16_bf16 v[96:111], v[28:31], v[224:227], v[96:111]
    ds_read_b64_tr_b16 v[48:49], v19 offset:43520
    ds_read_b64_tr_b16 v[50:51], v19 offset:44032
    v_mfma_f32_32x32x16_bf16 v[112:127], v[28:31], v[228:231], v[112:127]
    ds_read_b64_tr_b16 v[52:53], v20 offset:43520
    ds_read_b64_tr_b16 v[54:55], v20 offset:44032
    v_mfma_f32_32x32x16_bf16 v[128:143], v[32:35], v[224:227], v[128:143]
    ds_read_b64_tr_b16 v[56:57], v21 offset:43520
    ds_read_b64_tr_b16 v[58:59], v21 offset:44032
    v_mov_b32 v22, 1
    v_min_u32 v23, 1, v0
    v_lshlrev_b32 v23, 30, v23
    buffer_atomic_add v22, v23, s[32:35], s61 offen sc1
    v_mfma_f32_32x32x16_bf16 v[144:159], v[32:35], v[228:231], v[144:159]
    v_mfma_f32_32x32x16_bf16 v[160:175], v[36:39], v[224:227], v[160:175]
    v_mfma_f32_32x32x16_bf16 v[176:191], v[36:39], v[228:231], v[176:191]
    s_waitcnt vmcnt(17) lgkmcnt(0)
    s_barrier
    v_mfma_f32_32x32x16_bf16 v[64:79], v[44:47], v[232:235], v[64:79]
    ds_read_b128 v[240:243], v4 offset:16384
    ds_read_b64_tr_b16 v[24:25], v1 offset:51840
    v_mfma_f32_32x32x16_bf16 v[80:95], v[44:47], v[236:239], v[80:95]
    ds_read_b64_tr_b16 v[26:27], v1 offset:52352
    ds_read_b128 v[244:247], v4 offset:20480
    v_mfma_f32_32x32x16_bf16 v[96:111], v[48:51], v[232:235], v[96:111]
    ds_read_b64_tr_b16 v[28:29], v19 offset:51840
    ds_read_b64_tr_b16 v[30:31], v19 offset:52352
    v_mfma_f32_32x32x16_bf16 v[112:127], v[48:51], v[236:239], v[112:127]
    ds_read_b64_tr_b16 v[32:33], v20 offset:51840
    ds_read_b64_tr_b16 v[34:35], v20 offset:52352
    v_mfma_f32_32x32x16_bf16 v[128:143], v[52:55], v[232:235], v[128:143]
    ds_read_b64_tr_b16 v[36:37], v21 offset:51840
    ds_read_b64_tr_b16 v[38:39], v21 offset:52352
    s_add_u32 s74, s74, 294912
    s_cmp_ge_u32 s74, 5308416
    s_cselect_b32 s74, 0, s74
    s_add_u32 m0, s56, 41472
    s_nop 0
    buffer_load_dwordx4 v6, s[12:15], s74 offen lds
    v_mfma_f32_32x32x16_bf16 v[144:159], v[52:55], v[236:239], v[144:159]
    s_add_u32 m0, s56, 41472
    s_nop 0
    buffer_load_dword v7, s[12:15], s74 offen offset:1024 lds
    v_mfma_f32_32x32x16_bf16 v[160:175], v[56:59], v[232:235], v[160:175]
    s_add_u32 m0, s56, 46720
    s_nop 0
    buffer_load_dwordx4 v6, s[20:23], s74 offen lds
    v_mfma_f32_32x32x16_bf16 v[176:191], v[56:59], v[236:239], v[176:191]
    s_add_u32 m0, s56, 46720
    s_nop 0
    buffer_load_dword v7, s[20:23], s74 offen offset:1024 lds
    s_waitcnt lgkmcnt(0)
    v_mfma_f32_32x32x16_bf16 v[64:79], v[24:27], v[240:243], v[64:79]
    ds_read_b128 v[248:251], v5 offset:16384
    ds_read_b64_tr_b16 v[44:45], v1 offset:53888
    v_mfma_f32_32x32x16_bf16 v[80:95], v[24:27], v[244:247], v[80:95]
    ds_read_b64_tr_b16 v[46:47], v1 offset:54400
    ds_read_b128 v[252:255], v5 offset:20480
    v_mfma_f32_32x32x16_bf16 v[96:111], v[28:31], v[240:243], v[96:111]
    ds_read_b64_tr_b16 v[48:49], v19 offset:53888
    ds_read_b64_tr_b16 v[50:51], v19 offset:54400
    v_mfma_f32_32x32x16_bf16 v[112:127], v[28:31], v[244:247], v[112:127]
    ds_read_b64_tr_b16 v[52:53], v20 offset:53888
    ds_read_b64_tr_b16 v[54:55], v20 offset:54400
    v_mfma_f32_32x32x16_bf16 v[128:143], v[32:35], v[240:243], v[128:143]
    ds_read_b64_tr_b16 v[56:57], v21 offset:53888
    ds_read_b64_tr_b16 v[58:59], v21 offset:54400
    v_mfma_f32_32x32x16_bf16 v[144:159], v[32:35], v[244:247], v[144:159]
    v_mfma_f32_32x32x16_bf16 v[160:175], v[36:39], v[240:243], v[160:175]
    v_mfma_f32_32x32x16_bf16 v[176:191], v[36:39], v[244:247], v[176:191]
    v_bfe_u32 v8, v0, 4, 1
    v_mul_u32_u24 v1, 5248, v8
    v_lshrrev_b32 v8, 5, v0
    v_mul_u32_u24 v8, 1280, v8
    v_add_u32 v1, v1, v8
    v_bfe_u32 v8, v0, 2, 2
    v_mul_u32_u24 v8, 160, v8
    v_add_u32 v1, v1, v8
    v_and_b32 v8, 3, v0
    v_lshl_add_u32 v1, v8, 3, v1
    v_and_b32 v9, 3, v0
    v_lshlrev_b32 v9, 15, v9
    v_bfe_u32 v8, v0, 2, 3
    v_lshl_add_u32 v9, v8, 5, v9
    v_lshrrev_b32 v8, 5, v0
    v_lshl_add_u32 v9, v8, 4, v9
    s_lshl_b32 s44, s41, 17
    s_lshl_b32 s49, s38, 2
    s_add_u32 s49, s49, s36
    s_lshl_b32 s50, s49, 11
    s_lshl_b32 s49, s49, 10
    s_add_u32 s44, s44, s49
    s_add_u32 s44, s44, 21495808
    v_lshlrev_b32 v11, 4, v0
    v_add_u32 v11, s50, v11
    s_mul_i32 s49, s37, 9
    s_mov_b32 s44, 0x80000000
    s_waitcnt vmcnt(17) lgkmcnt(0)
    s_barrier
    v_mfma_f32_32x32x16_bf16 v[64:79], v[44:47], v[248:251], v[64:79]
    ds_read_b64_tr_b16 v[24:25], v1 offset:0
    ds_read_b64_tr_b16 v[26:27], v1 offset:640
    v_mfma_f32_32x32x16_bf16 v[80:95], v[44:47], v[252:255], v[80:95]
    ds_read_b64_tr_b16 v[28:29], v1 offset:32
    ds_read_b64_tr_b16 v[30:31], v1 offset:672
    v_mfma_f32_32x32x16_bf16 v[96:111], v[48:51], v[248:251], v[96:111]
    ds_read_b64_tr_b16 v[32:33], v1 offset:64
    ds_read_b64_tr_b16 v[34:35], v1 offset:704
    v_mfma_f32_32x32x16_bf16 v[112:127], v[48:51], v[252:255], v[112:127]
    ds_read_b64_tr_b16 v[36:37], v1 offset:96
    ds_read_b64_tr_b16 v[38:39], v1 offset:736
    v_mfma_f32_32x32x16_bf16 v[128:143], v[52:55], v[248:251], v[128:143]
    ds_read_b64_tr_b16 v[40:41], v1 offset:128
    ds_read_b64_tr_b16 v[42:43], v1 offset:768
    s_add_u32 s74, s74, 294912
    s_cmp_ge_u32 s74, 5308416
    s_cselect_b32 s74, 0, s74
    s_add_u32 m0, s56, 51840
    s_nop 0
    buffer_load_dwordx4 v6, s[12:15], s74 offen lds
    v_mfma_f32_32x32x16_bf16 v[144:159], v[52:55], v[252:255], v[144:159]
    s_add_u32 m0, s56, 51840
    s_nop 0
    buffer_load_dword v7, s[12:15], s74 offen offset:1024 lds
    v_mfma_f32_32x32x16_bf16 v[160:175], v[56:59], v[248:251], v[160:175]
    s_add_u32 m0, s56, 57088
    s_nop 0
    buffer_load_dwordx4 v6, s[20:23], s74 offen lds
    v_mfma_f32_32x32x16_bf16 v[176:191], v[56:59], v[252:255], v[176:191]
    s_add_u32 m0, s56, 57088
    s_nop 0
    buffer_load_dword v7, s[20:23], s74 offen offset:1024 lds
    s_waitcnt lgkmcnt(0)
    s_add_u32 s50, s49, s48
    s_lshl_b32 s50, s50, 16
    v_max_f32 v64, 0, v64
    v_max_f32 v65, 0, v65
    v_max_f32 v66, 0, v66
    v_max_f32 v67, 0, v67
    v_max_f32 v68, 0, v68
    v_max_f32 v69, 0, v69
    v_max_f32 v70, 0, v70
    v_max_f32 v71, 0, v71
    v_mul_f32 v64, v64, v72
    v_mul_f32 v65, v65, v73
    v_mul_f32 v66, v66, v74
    v_mul_f32 v67, v67, v75
    v_mul_f32 v68, v68, v76
    v_mul_f32 v69, v69, v77
    v_mul_f32 v70, v70, v78
    v_mul_f32 v71, v71, v79
    v_cvt_pk_bf16_f32 v72, v64, v65
    v_cvt_pk_bf16_f32 v73, v66, v67
    v_cvt_pk_bf16_f32 v74, v68, v69
    v_cvt_pk_bf16_f32 v75, v70, v71
    buffer_store_dwordx4 v[72:75], v11, s[16:19], s50 offen offset:0 sc0 sc1
    s_nop 0
    v_mfma_f32_32x32x16_bf16 v[64:79], v[24:27], a[0:3], 0
    ds_read_b64_tr_b16 v[44:45], v1 offset:2560
    ds_read_b64_tr_b16 v[46:47], v1 offset:3200
    v_max_f32 v80, 0, v80
    v_max_f32 v81, 0, v81
    v_max_f32 v82, 0, v82
    v_max_f32 v83, 0, v83
    v_max_f32 v84, 0, v84
    v_max_f32 v85, 0, v85
    v_max_f32 v86, 0, v86
    v_max_f32 v87, 0, v87
    v_mul_f32 v80, v80, v88
    v_mul_f32 v81, v81, v89
    v_mul_f32 v82, v82, v90
    v_mul_f32 v83, v83, v91
    v_mul_f32 v84, v84, v92
    v_mul_f32 v85, v85, v93
    v_mul_f32 v86, v86, v94
    v_mul_f32 v87, v87, v95
    v_cvt_pk_bf16_f32 v88, v80, v81
    v_cvt_pk_bf16_f32 v89, v82, v83
    v_cvt_pk_bf16_f32 v90, v84, v85
    v_cvt_pk_bf16_f32 v91, v86, v87
    buffer_store_dwordx4 v[88:91], v11, s[16:19], s50 offen offset:1024 sc0 sc1
    s_nop 0
    v_mfma_f32_32x32x16_bf16 v[80:95], v[24:27], a[4:7], 0
    ds_read_b64_tr_b16 v[48:49], v1 offset:2592
    ds_read_b64_tr_b16 v[50:51], v1 offset:3232
    s_add_u32 s50, s49, s48
    s_add_u32 s50, s50, 1
    s_lshl_b32 s50, s50, 16
    v_max_f32 v96, 0, v96
    v_max_f32 v97, 0, v97
    v_max_f32 v98, 0, v98
    v_max_f32 v99, 0, v99
    v_max_f32 v100, 0, v100
    v_max_f32 v101, 0, v101
    v_max_f32 v102, 0, v102
    v_max_f32 v103, 0, v103
    v_mul_f32 v96, v96, v104
    v_mul_f32 v97, v97, v105
    v_mul_f32 v98, v98, v106
    v_mul_f32 v99, v99, v107
    v_mul_f32 v100, v100, v108
    v_mul_f32 v101, v101, v109
    v_mul_f32 v102, v102, v110
    v_mul_f32 v103, v103, v111
    v_cvt_pk_bf16_f32 v104, v96, v97
    v_cvt_pk_bf16_f32 v105, v98, v99
    v_cvt_pk_bf16_f32 v106, v100, v101
    v_cvt_pk_bf16_f32 v107, v102, v103
    buffer_store_dwordx4 v[104:107], v11, s[16:19], s50 offen offset:0 sc0 sc1
    s_nop 0
    v_mfma_f32_32x32x16_bf16 v[96:111], v[28:31], a[0:3], 0
    ds_read_b64_tr_b16 v[52:53], v1 offset:2624
    ds_read_b64_tr_b16 v[54:55], v1 offset:3264
    v_max_f32 v112, 0, v112
    v_max_f32 v113, 0, v113
    v_max_f32 v114, 0, v114
    v_max_f32 v115, 0, v115
    v_max_f32 v116, 0, v116
    v_max_f32 v117, 0, v117
    v_max_f32 v118, 0, v118
    v_max_f32 v119, 0, v119
    v_mul_f32 v112, v112, v120
    v_mul_f32 v113, v113, v121
    v_mul_f32 v114, v114, v122
    v_mul_f32 v115, v115, v123
    v_mul_f32 v116, v116, v124
    v_mul_f32 v117, v117, v125
    v_mul_f32 v118, v118, v126
    v_mul_f32 v119, v119, v127
    v_cvt_pk_bf16_f32 v120, v112, v113
    v_cvt_pk_bf16_f32 v121, v114, v115
    v_cvt_pk_bf16_f32 v122, v116, v117
    v_cvt_pk_bf16_f32 v123, v118, v119
    buffer_store_dwordx4 v[120:123], v11, s[16:19], s50 offen offset:1024 sc0 sc1
    s_nop 0
    v_mfma_f32_32x32x16_bf16 v[112:127], v[28:31], a[4:7], 0
    ds_read_b64_tr_b16 v[56:57], v1 offset:2656
    ds_read_b64_tr_b16 v[58:59], v1 offset:3296
    s_add_u32 s50, s49, s48
    s_add_u32 s50, s50, 2
    s_lshl_b32 s50, s50, 16
    v_max_f32 v128, 0, v128
    v_max_f32 v129, 0, v129
    v_max_f32 v130, 0, v130
    v_max_f32 v131, 0, v131
    v_max_f32 v132, 0, v132
    v_max_f32 v133, 0, v133
    v_max_f32 v134, 0, v134
    v_max_f32 v135, 0, v135
    v_mul_f32 v128, v128, v136
    v_mul_f32 v129, v129, v137
    v_mul_f32 v130, v130, v138
    v_mul_f32 v131, v131, v139
    v_mul_f32 v132, v132, v140
    v_mul_f32 v133, v133, v141
    v_mul_f32 v134, v134, v142
    v_mul_f32 v135, v135, v143
    v_cvt_pk_bf16_f32 v136, v128, v129
    v_cvt_pk_bf16_f32 v137, v130, v131
    v_cvt_pk_bf16_f32 v138, v132, v133
    v_cvt_pk_bf16_f32 v139, v134, v135
    buffer_store_dwordx4 v[136:139], v11, s[16:19], s50 offen offset:0 sc0 sc1
    s_nop 0
    v_mfma_f32_32x32x16_bf16 v[128:143], v[32:35], a[0:3], 0
    ds_read_b64_tr_b16 v[60:61], v1 offset:2688
    ds_read_b64_tr_b16 v[62:63], v1 offset:3328
    v_max_f32 v144, 0, v144
    v_max_f32 v145, 0, v145
    v_max_f32 v146, 0, v146
    v_max_f32 v147, 0, v147
    v_max_f32 v148, 0, v148
    v_max_f32 v149, 0, v149
    v_max_f32 v150, 0, v150
    v_max_f32 v151, 0, v151
    v_mul_f32 v144, v144, v152
    v_mul_f32 v145, v145, v153
    v_mul_f32 v146, v146, v154
    v_mul_f32 v147, v147, v155
    v_mul_f32 v148, v148, v156
    v_mul_f32 v149, v149, v157
    v_mul_f32 v150, v150, v158
    v_mul_f32 v151, v151, v159
    v_cvt_pk_bf16_f32 v152, v144, v145
    v_cvt_pk_bf16_f32 v153, v146, v147
    v_cvt_pk_bf16_f32 v154, v148, v149
    v_cvt_pk_bf16_f32 v155, v150, v151
    buffer_store_dwordx4 v[152:155], v11, s[16:19], s50 offen offset:1024 sc0 sc1
    s_nop 0
    v_mfma_f32_32x32x16_bf16 v[144:159], v[32:35], a[4:7], 0
    s_add_u32 s50, s49, s48
    s_add_u32 s50, s50, 3
    s_lshl_b32 s50, s50, 16
    v_max_f32 v160, 0, v160
    v_max_f32 v161, 0, v161
    v_max_f32 v162, 0, v162
    v_max_f32 v163, 0, v163
    v_max_f32 v164, 0, v164
    v_max_f32 v165, 0, v165
    v_max_f32 v166, 0, v166
    v_max_f32 v167, 0, v167
    v_mul_f32 v160, v160, v168
    v_mul_f32 v161, v161, v169
    v_mul_f32 v162, v162, v170
    v_mul_f32 v163, v163, v171
    v_mul_f32 v164, v164, v172
    v_mul_f32 v165, v165, v173
    v_mul_f32 v166, v166, v174
    v_mul_f32 v167, v167, v175
    v_cvt_pk_bf16_f32 v168, v160, v161
    v_cvt_pk_bf16_f32 v169, v162, v163
    v_cvt_pk_bf16_f32 v170, v164, v165
    v_cvt_pk_bf16_f32 v171, v166, v167
    buffer_store_dwordx4 v[168:171], v11, s[16:19], s50 offen offset:0 sc0 sc1
    s_nop 0
    v_mfma_f32_32x32x16_bf16 v[160:175], v[36:39], a[0:3], 0
    v_max_f32 v176, 0, v176
    v_max_f32 v177, 0, v177
    v_max_f32 v178, 0, v178
    v_max_f32 v179, 0, v179
    v_max_f32 v180, 0, v180
    v_max_f32 v181, 0, v181
    v_max_f32 v182, 0, v182
    v_max_f32 v183, 0, v183
    v_mul_f32 v176, v176, v184
    v_mul_f32 v177, v177, v185
    v_mul_f32 v178, v178, v186
    v_mul_f32 v179, v179, v187
    v_mul_f32 v180, v180, v188
    v_mul_f32 v181, v181, v189
    v_mul_f32 v182, v182, v190
    v_mul_f32 v183, v183, v191
    v_cvt_pk_bf16_f32 v184, v176, v177
    v_cvt_pk_bf16_f32 v185, v178, v179
    v_cvt_pk_bf16_f32 v186, v180, v181
    v_cvt_pk_bf16_f32 v187, v182, v183
    buffer_store_dwordx4 v[184:187], v11, s[16:19], s50 offen offset:1024 sc0 sc1
    s_nop 0
    v_mfma_f32_32x32x16_bf16 v[176:191], v[36:39], a[4:7], 0
    buffer_store_dwordx4 v[192:195], v9, s[16:19], s44 offen offset:0 sc0 sc1
    buffer_store_dwordx4 v[196:199], v9, s[16:19], s44 offen offset:256 sc0 sc1
    s_nop 0
    v_mfma_f32_32x32x16_bf16 v[192:207], v[40:43], a[0:3], 0
    buffer_store_dwordx4 v[208:211], v9, s[16:19], s44 offen offset:512 sc0 sc1
    buffer_store_dwordx4 v[212:215], v9, s[16:19], s44 offen offset:768 sc0 sc1
    s_nop 0
    v_mfma_f32_32x32x16_bf16 v[208:223], v[40:43], a[4:7], 0
L_r2:
    s_mov_b32 s75, 26970112
    s_cmp_eq_u32 s40, 3
    s_cbranch_scc1 L_r2_side
    s_mul_i32 s45, s39, 2359296
    s_mul_i32 s46, s39, 663552
    s_mul_i32 s3, s36, 4608
    s_mul_i32 s4, s40, 384
    s_add_u32 s3, s3, s4
    v_bfe_u32 v2, v0, 3, 2
    v_mul_u32_u24 v2, 1152, v2
    v_lshrrev_b32 v3, 5, v0
    v_mul_u32_u24 v3, 18432, v3
    v_bfe_u32 v4, v0, 4, 1
    v_lshlrev_b32 v4, 2, v4
    v_and_b32 v5, 7, v0
    v_xor_b32 v4, v4, v5
    v_lshl_add_u32 v10, v4, 4, v2
    v_add3_u32 v10, v10, v3, s3
    s_lshl_b32 s3, s38, 3
    s_add_u32 s3, s3, s39
    s_lshl_b32 s3, s3, 5
    v_and_b32 v12, 3, v0
    v_add_lshl_u32 v12, v12, s3, 2
    v_min_u32 v13, 3, v0
    v_lshlrev_b32 v13, 6, v13
    s_waitcnt vmcnt(29) lgkmcnt(0)
    s_barrier
    v_mfma_f32_32x32x16_bf16 v[64:79], v[44:47], a[8:11], v[64:79]
    ds_read_b64_tr_b16 v[24:25], v1 offset:10368
    ds_read_b64_tr_b16 v[26:27], v1 offset:11008
    s_mul_i32 s3, s38, 12
    v_mfma_f32_32x32x16_bf16 v[80:95], v[44:47], a[12:15], v[80:95]
    ds_read_b64_tr_b16 v[28:29], v1 offset:10400
    ds_read_b64_tr_b16 v[30:31], v1 offset:11040
    s_lshl_b32 s4, s40, 2
    v_mfma_f32_32x32x16_bf16 v[96:111], v[48:51], a[8:11], v[96:111]
    ds_read_b64_tr_b16 v[32:33], v1 offset:10432
    ds_read_b64_tr_b16 v[34:35], v1 offset:11072
    s_add_u32 s3, s3, s4
    v_mfma_f32_32x32x16_bf16 v[112:127], v[48:51], a[12:15], v[112:127]
    ds_read_b64_tr_b16 v[36:37], v1 offset:10464
    ds_read_b64_tr_b16 v[38:39], v1 offset:11104
    s_add_u32 s3, s3, s36
    v_mfma_f32_32x32x16_bf16 v[128:143], v[52:55], a[8:11], v[128:143]
    ds_read_b64_tr_b16 v[40:41], v1 offset:10496
    ds_read_b64_tr_b16 v[42:43], v1 offset:11136
    s_mul_i32 s3, s3, 9
    v_mfma_f32_32x32x16_bf16 v[144:159], v[52:55], a[12:15], v[144:159]
    v_min_u32 v18, 8, v0
    v_add_u32 v18, s3, v18
    v_lshlrev_b32 v18, 7, v18
    v_mfma_f32_32x32x16_bf16 v[160:175], v[56:59], a[8:11], v[160:175]
    s_add_u32 s74, s74, 294912
    s_cmp_ge_u32 s74, 5308416
    s_cselect_b32 s74, 0, s74
    s_add_u32 m0, s56, 0
    s_nop 0
    buffer_load_dwordx4 v6, s[12:15], s74 offen lds
    v_mfma_f32_32x32x16_bf16 v[176:191], v[56:59], a[12:15], v[176:191]
    s_add_u32 m0, s56, 0
    s_nop 0
    buffer_load_dword v7, s[12:15], s74 offen offset:1024 lds
    v_mfma_f32_32x32x16_bf16 v[192:207], v[60:63], a[8:11], v[192:207]
    s_add_u32 m0, s56, 5248
    s_nop 0
    buffer_load_dwordx4 v6, s[20:23], s74 offen lds
    v_mfma_f32_32x32x16_bf16 v[208:223], v[60:63], a[12:15], v[208:223]
    s_add_u32 m0, s56, 5248
    s_nop 0
    buffer_load_dword v7, s[20:23], s74 offen offset:1024 lds
    s_waitcnt lgkmcnt(0)
    v_mfma_f32_32x32x16_bf16 v[64:79], v[24:27], a[16:19], v[64:79]
    ds_read_b64_tr_b16 v[44:45], v1 offset:12928
    ds_read_b64_tr_b16 v[46:47], v1 offset:13568
    v_mfma_f32_32x32x16_bf16 v[80:95], v[24:27], a[20:23], v[80:95]
    ds_read_b64_tr_b16 v[48:49], v1 offset:12960
    ds_read_b64_tr_b16 v[50:51], v1 offset:13600
    v_mfma_f32_32x32x16_bf16 v[96:111], v[28:31], a[16:19], v[96:111]
    ds_read_b64_tr_b16 v[52:53], v1 offset:12992
    ds_read_b64_tr_b16 v[54:55], v1 offset:13632
    v_mfma_f32_32x32x16_bf16 v[112:127], v[28:31], a[20:23], v[112:127]
    ds_read_b64_tr_b16 v[56:57], v1 offset:13024
    ds_read_b64_tr_b16 v[58:59], v1 offset:13664
    v_mfma_f32_32x32x16_bf16 v[128:143], v[32:35], a[16:19], v[128:143]
    ds_read_b64_tr_b16 v[60:61], v1 offset:13056
    ds_read_b64_tr_b16 v[62:63], v1 offset:13696
    v_mfma_f32_32x32x16_bf16 v[144:159], v[32:35], a[20:23], v[144:159]
    v_mfma_f32_32x32x16_bf16 v[160:175], v[36:39], a[16:19], v[160:175]
    s_add_u32 s3, s46, 0
    buffer_load_dword v19, v18, s[24:27], s3 offen
    v_mfma_f32_32x32x16_bf16 v[176:191], v[36:39], a[20:23], v[176:191]
    v_mfma_f32_32x32x16_bf16 v[192:207], v[40:43], a[16:19], v[192:207]
    v_mfma_f32_32x32x16_bf16 v[208:223], v[40:43], a[20:23], v[208:223]
    s_waitcnt vmcnt(30) lgkmcnt(0)
    s_barrier
    v_mfma_f32_32x32x16_bf16 v[64:79], v[44:47], a[24:27], v[64:79]
    ds_read_b64_tr_b16 v[24:25], v1 offset:20736
    ds_read_b64_tr_b16 v[26:27], v1 offset:21376
    v_mfma_f32_32x32x16_bf16 v[80:95], v[44:47], a[28:31], v[80:95]
    ds_read_b64_tr_b16 v[28:29], v1 offset:20768
    ds_read_b64_tr_b16 v[30:31], v1 offset:21408
    v_mfma_f32_32x32x16_bf16 v[96:111], v[48:51], a[24:27], v[96:111]
    ds_read_b64_tr_b16 v[32:33], v1 offset:20800
    ds_read_b64_tr_b16 v[34:35], v1 offset:21440
    v_mfma_f32_32x32x16_bf16 v[112:127], v[48:51], a[28:31], v[112:127]
    ds_read_b64_tr_b16 v[36:37], v1 offset:20832
    ds_read_b64_tr_b16 v[38:39], v1 offset:21472
    v_mfma_f32_32x32x16_bf16 v[128:143], v[52:55], a[24:27], v[128:143]
    ds_read_b64_tr_b16 v[40:41], v1 offset:20864
    ds_read_b64_tr_b16 v[42:43], v1 offset:21504
    v_mfma_f32_32x32x16_bf16 v[144:159], v[52:55], a[28:31], v[144:159]
    v_mfma_f32_32x32x16_bf16 v[160:175], v[56:59], a[24:27], v[160:175]
    s_add_u32 s74, s74, 294912
    s_cmp_ge_u32 s74, 5308416
    s_cselect_b32 s74, 0, s74
    s_add_u32 m0, s56, 10368
    s_nop 0
    buffer_load_dwordx4 v6, s[12:15], s74 offen lds
    v_mfma_f32_32x32x16_bf16 v[176:191], v[56:59], a[28:31], v[176:191]
    s_add_u32 m0, s56, 10368
    s_nop 0
    buffer_load_dword v7, s[12:15], s74 offen offset:1024 lds
    v_mfma_f32_32x32x16_bf16 v[192:207], v[60:63], a[24:27], v[192:207]
    s_add_u32 m0, s56, 15616
    s_nop 0
    buffer_load_dwordx4 v6, s[20:23], s74 offen lds
    v_mfma_f32_32x32x16_bf16 v[208:223], v[60:63], a[28:31], v[208:223]
    s_add_u32 m0, s56, 15616
    s_nop 0
    buffer_load_dword v7, s[20:23], s74 offen offset:1024 lds
    s_waitcnt lgkmcnt(0)
    v_mfma_f32_32x32x16_bf16 v[64:79], v[24:27], a[32:35], v[64:79]
    ds_read_b64_tr_b16 v[44:45], v1 offset:23296
    ds_read_b64_tr_b16 v[46:47], v1 offset:23936
    v_lshrrev_b32 v8, 5, v0
    v_mfma_f32_32x32x16_bf16 v[80:95], v[24:27], a[36:39], v[80:95]
    ds_read_b64_tr_b16 v[48:49], v1 offset:23328
    ds_read_b64_tr_b16 v[50:51], v1 offset:23968
    v_lshlrev_b32 v2, 10, v8
    v_mfma_f32_32x32x16_bf16 v[96:111], v[28:31], a[32:35], v[96:111]
    ds_read_b64_tr_b16 v[52:53], v1 offset:23360
    ds_read_b64_tr_b16 v[54:55], v1 offset:24000
    v_bfe_u32 v8, v0, 2, 2
    v_mfma_f32_32x32x16_bf16 v[112:127], v[28:31], a[36:39], v[112:127]
    ds_read_b64_tr_b16 v[56:57], v1 offset:23392
    ds_read_b64_tr_b16 v[58:59], v1 offset:24032
    v_lshl_add_u32 v2, v8, 7, v2
    v_mfma_f32_32x32x16_bf16 v[128:143], v[32:35], a[32:35], v[128:143]
    ds_read_b64_tr_b16 v[60:61], v1 offset:23424
    ds_read_b64_tr_b16 v[62:63], v1 offset:24064
    v_bfe_u32 v8, v0, 3, 1
    v_mfma_f32_32x32x16_bf16 v[144:159], v[32:35], a[36:39], v[144:159]
    v_lshl_add_u32 v2, v8, 6, v2
    v_bfe_u32 v8, v0, 4, 1
    v_lshl_add_u32 v2, v8, 5, v2
    v_mfma_f32_32x32x16_bf16 v[160:175], v[36:39], a[32:35], v[160:175]
    s_add_u32 s3, s46, 110592
    buffer_load_dword v19, v18, s[24:27], s3 offen
    v_mfma_f32_32x32x16_bf16 v[176:191], v[36:39], a[36:39], v[176:191]
    v_and_b32 v8, 3, v0
    v_lshl_add_u32 v2, v8, 3, v2
    v_add_u32 v2, 62208, v2
    v_mfma_f32_32x32x16_bf16 v[192:207], v[40:43], a[32:35], v[192:207]
    v_xor_b32 v3, 64, v2
    v_mfma_f32_32x32x16_bf16 v[208:223], v[40:43], a[36:39], v[208:223]
    s_waitcnt vmcnt(31) lgkmcnt(0)
    s_barrier
    v_mfma_f32_32x32x16_bf16 v[64:79], v[44:47], a[40:43], v[64:79]
    ds_read_b64_tr_b16 v[24:25], v1 offset:31104
    ds_read_b64_tr_b16 v[26:27], v1 offset:31744
    v_add_u32 v4, 49152, v2
    v_add_u32 v5, 49152, v3
    v_mfma_f32_32x32x16_bf16 v[80:95], v[44:47], a[44:47], v[80:95]
    ds_read_b64_tr_b16 v[28:29], v1 offset:31136
    ds_read_b64_tr_b16 v[30:31], v1 offset:31776
    s_mul_i32 s76, s39, 2359296
    s_lshl_b32 s77, s38, 3
    v_mfma_f32_32x32x16_bf16 v[96:111], v[48:51], a[40:43], v[96:111]
    ds_read_b64_tr_b16 v[32:33], v1 offset:31168
    ds_read_b64_tr_b16 v[34:35], v1 offset:31808
    s_lshl_b32 s78, s36, 1
    s_add_u32 s77, s77, s78
    v_mfma_f32_32x32x16_bf16 v[112:127], v[48:51], a[44:47], v[112:127]
    ds_read_b64_tr_b16 v[36:37], v1 offset:31200
    ds_read_b64_tr_b16 v[38:39], v1 offset:31840
    s_mul_i32 s78, s77, 36864
    s_add_u32 s76, s76, s78
    v_mfma_f32_32x32x16_bf16 v[128:143], v[52:55], a[40:43], v[128:143]
    ds_read_b64_tr_b16 v[40:41], v1 offset:31232
    ds_read_b64_tr_b16 v[42:43], v1 offset:31872
    s_mul_i32 s78, s40, 12288
    s_add_u32 s76, s76, s78
    v_mfma_f32_32x32x16_bf16 v[144:159], v[52:55], a[44:47], v[144:159]
    s_add_u32 s76, s76, 27002880
    s_lshr_b32 s77, s39, 1
    v_mfma_f32_32x32x16_bf16 v[160:175], v[56:59], a[40:43], v[160:175]
    s_add_u32 s74, s74, 294912
    s_cmp_ge_u32 s74, 5308416
    s_cselect_b32 s74, 0, s74
    s_add_u32 m0, s56, 20736
    s_nop 0
    buffer_load_dwordx4 v6, s[12:15], s74 offen lds
    v_mfma_f32_32x32x16_bf16 v[176:191], v[56:59], a[44:47], v[176:191]
    s_add_u32 m0, s56, 20736
    s_nop 0
    buffer_load_dword v7, s[12:15], s74 offen offset:1024 lds
    v_mfma_f32_32x32x16_bf16 v[192:207], v[60:63], a[40:43], v[192:207]
    s_add_u32 m0, s56, 25984
    s_nop 0
    buffer_load_dwordx4 v6, s[20:23], s74 offen lds
    v_mfma_f32_32x32x16_bf16 v[208:223], v[60:63], a[44:47], v[208:223]
    s_add_u32 m0, s56, 25984
    s_nop 0
    buffer_load_dword v7, s[20:23], s74 offen offset:1024 lds
    s_waitcnt lgkmcnt(0)
    v_mfma_f32_32x32x16_bf16 v[64:79], v[24:27], a[48:51], v[64:79]
    ds_read_b64_tr_b16 v[44:45], v1 offset:33664
    ds_read_b64_tr_b16 v[46:47], v1 offset:34304
    s_lshl_b32 s77, s77, 1
    v_mfma_f32_32x32x16_bf16 v[80:95], v[24:27], a[52:55], v[80:95]
    ds_read_b64_tr_b16 v[48:49], v1 offset:33696
    ds_read_b64_tr_b16 v[50:51], v1 offset:34336
    s_lshl_b32 s78, s38, 3
    v_mfma_f32_32x32x16_bf16 v[96:111], v[28:31], a[48:51], v[96:111]
    ds_read_b64_tr_b16 v[52:53], v1 offset:33728
    ds_read_b64_tr_b16 v[54:55], v1 offset:34368
    s_add_u32 s77, s77, s78
    v_mfma_f32_32x32x16_bf16 v[112:127], v[28:31], a[52:55], v[112:127]
    ds_read_b64_tr_b16 v[56:57], v1 offset:33760
    ds_read_b64_tr_b16 v[58:59], v1 offset:34400
    s_lshl_b32 s64, s36, 15
    v_mfma_f32_32x32x16_bf16 v[128:143], v[32:35], a[48:51], v[128:143]
    ds_read_b64_tr_b16 v[60:61], v1 offset:33792
    ds_read_b64_tr_b16 v[62:63], v1 offset:34432
    s_lshl_b32 s78, s77, 6
    v_mfma_f32_32x32x16_bf16 v[144:159], v[32:35], a[52:55], v[144:159]
    s_add_u32 s64, s64, s78
    s_add_u32 s64, s64, 18874368
    s_and_b32 s79, s39, 1
    v_mfma_f32_32x32x16_bf16 v[160:175], v[36:39], a[48:51], v[160:175]
    s_add_u32 s3, s46, 221184
    buffer_load_dword v19, v18, s[24:27], s3 offen
    v_mfma_f32_32x32x16_bf16 v[176:191], v[36:39], a[52:55], v[176:191]
    s_min_u32 s78, s36, 2
    s_lshl_b32 s78, s78, 1
    s_add_u32 s78, s78, s79
    v_mfma_f32_32x32x16_bf16 v[192:207], v[40:43], a[48:51], v[192:207]
    s_mul_i32 s66, s40, 6
    v_mfma_f32_32x32x16_bf16 v[208:223], v[40:43], a[52:55], v[208:223]
    s_waitcnt vmcnt(31) lgkmcnt(0)
    s_barrier
    v_mfma_f32_32x32x16_bf16 v[64:79], v[44:47], a[56:59], v[64:79]
    ds_read_b64_tr_b16 v[24:25], v1 offset:41472
    ds_read_b64_tr_b16 v[26:27], v1 offset:42112
    s_add_u32 s66, s66, s78
    s_lshl_b32 s66, s66, 5
    v_mfma_f32_32x32x16_bf16 v[80:95], v[44:47], a[60:63], v[80:95]
    ds_read_b64_tr_b16 v[28:29], v1 offset:41504
    ds_read_b64_tr_b16 v[30:31], v1 offset:42144
    s_lshr_b32 s78, s36, 1
    s_add_u32 s77, s77, s78
    v_mfma_f32_32x32x16_bf16 v[96:111], v[48:51], a[56:59], v[96:111]
    ds_read_b64_tr_b16 v[32:33], v1 offset:41536
    ds_read_b64_tr_b16 v[34:35], v1 offset:42176
    s_mul_i32 s67, s77, 36864
    s_mul_i32 s78, s40, 12288
    v_mfma_f32_32x32x16_bf16 v[112:127], v[48:51], a[60:63], v[112:127]
    ds_read_b64_tr_b16 v[36:37], v1 offset:41568
    ds_read_b64_tr_b16 v[38:39], v1 offset:42208
    s_add_u32 s67, s67, s78
    s_and_b32 s78, s36, 1
    v_mfma_f32_32x32x16_bf16 v[128:143], v[52:55], a[56:59], v[128:143]
    ds_read_b64_tr_b16 v[40:41], v1 offset:41600
    ds_read_b64_tr_b16 v[42:43], v1 offset:42240
    s_lshl_b32 s78, s78, 10
    s_add_u32 s67, s67, s78
    v_mfma_f32_32x32x16_bf16 v[144:159], v[52:55], a[60:63], v[144:159]
    s_add_u32 s67, s67, 27002880
    s_lshl_b32 s78, s79, 11
    v_mfma_f32_32x32x16_bf16 v[160:175], v[56:59], a[56:59], v[160:175]
    s_add_u32 s74, s74, 294912
    s_cmp_ge_u32 s74, 5308416
    s_cselect_b32 s74, 0, s74
    s_add_u32 m0, s56, 31104
    s_nop 0
    buffer_load_dwordx4 v6, s[12:15], s74 offen lds
    v_mfma_f32_32x32x16_bf16 v[176:191], v[56:59], a[60:63], v[176:191]
    s_add_u32 m0, s56, 31104
    s_nop 0
    buffer_load_dword v7, s[12:15], s74 offen offset:1024 lds
    v_mfma_f32_32x32x16_bf16 v[192:207], v[60:63], a[56:59], v[192:207]
    s_add_u32 m0, s56, 36352
    s_nop 0
    buffer_load_dwordx4 v6, s[20:23], s74 offen lds
    v_mfma_f32_32x32x16_bf16 v[208:223], v[60:63], a[60:63], v[208:223]
    s_add_u32 m0, s56, 36352
    s_nop 0
    buffer_load_dword v7, s[20:23], s74 offen offset:1024 lds
    s_waitcnt lgkmcnt(0)
    v_mfma_f32_32x32x16_bf16 v[64:79], v[24:27], a[64:67], v[64:79]
    ds_read_b64_tr_b16 v[44:45], v1 offset:44032
    ds_read_b64_tr_b16 v[46:47], v1 offset:44672
    s_add_u32 s67, s67, s78
    v_mfma_f32_32x32x16_bf16 v[80:95], v[24:27], a[68:71], v[80:95]
    ds_read_b64_tr_b16 v[48:49], v1 offset:44064
    ds_read_b64_tr_b16 v[50:51], v1 offset:44704
    s_lshr_b32 s78, s77, 1
    v_mfma_f32_32x32x16_bf16 v[96:111], v[28:31], a[64:67], v[96:111]
    ds_read_b64_tr_b16 v[52:53], v1 offset:44096
    ds_read_b64_tr_b16 v[54:55], v1 offset:44736
    s_and_b32 s80, s77, 1
    v_mfma_f32_32x32x16_bf16 v[112:127], v[28:31], a[68:71], v[112:127]
    ds_read_b64_tr_b16 v[56:57], v1 offset:44128
    ds_read_b64_tr_b16 v[58:59], v1 offset:44768
    s_lshl_b32 s80, s80, 5
    v_mfma_f32_32x32x16_bf16 v[128:143], v[32:35], a[64:67], v[128:143]
    ds_read_b64_tr_b16 v[60:61], v1 offset:44160
    ds_read_b64_tr_b16 v[62:63], v1 offset:44800
    s_add_u32 s78, s78, s80
    v_mfma_f32_32x32x16_bf16 v[144:159], v[32:35], a[68:71], v[144:159]
    s_mul_i32 s69, s78, 1152
    s_mul_i32 s78, s40, 384
    s_add_u32 s69, s69, s78
    v_mfma_f32_32x32x16_bf16 v[160:175], v[36:39], a[64:67], v[160:175]
    s_add_u32 s3, s46, 331776
    buffer_load_dword v19, v18, s[24:27], s3 offen
    v_mfma_f32_32x32x16_bf16 v[176:191], v[36:39], a[68:71], v[176:191]
    s_and_b32 s78, s36, 1
    s_lshl_b32 s78, s78, 5
    s_add_u32 s69, s69, s78
    v_mfma_f32_32x32x16_bf16 v[192:207], v[40:43], a[64:67], v[192:207]
    s_lshl_b32 s78, s79, 6
    v_mfma_f32_32x32x16_bf16 v[208:223], v[40:43], a[68:71], v[208:223]
    s_waitcnt vmcnt(32) lgkmcnt(0)
    s_barrier
    v_mfma_f32_32x32x16_bf16 v[64:79], v[44:47], a[72:75], v[64:79]
    ds_read_b64_tr_b16 v[24:25], v1 offset:51840
    ds_read_b64_tr_b16 v[26:27], v1 offset:52480
    s_add_u32 s69, s69, s78
    s_lshl_b32 s77, s77, 7
    v_mfma_f32_32x32x16_bf16 v[80:95], v[44:47], a[76:79], v[80:95]
    ds_read_b64_tr_b16 v[28:29], v1 offset:51872
    ds_read_b64_tr_b16 v[30:31], v1 offset:52512
    s_add_u32 s77, s77, 26961920
    v_bfe_u32 v9, v0, 2, 1
    v_mfma_f32_32x32x16_bf16 v[96:111], v[48:51], a[72:75], v[96:111]
    ds_read_b64_tr_b16 v[32:33], v1 offset:51904
    ds_read_b64_tr_b16 v[34:35], v1 offset:52544
    v_lshlrev_b32 v9, 4, v9
    v_and_b32 v8, 3, v0
    v_mfma_f32_32x32x16_bf16 v[112:127], v[48:51], a[76:79], v[112:127]
    ds_read_b64_tr_b16 v[36:37], v1 offset:51936
    ds_read_b64_tr_b16 v[38:39], v1 offset:52576
    v_add_u32 v9, v9, v8
    v_bfe_u32 v8, v0, 3, 2
    v_mfma_f32_32x32x16_bf16 v[128:143], v[52:55], a[72:75], v[128:143]
    ds_read_b64_tr_b16 v[40:41], v1 offset:51968
    ds_read_b64_tr_b16 v[42:43], v1 offset:52608
    v_lshl_add_u32 v9, v8, 2, v9
    v_lshlrev_b32 v9, 2, v9
    v_mfma_f32_32x32x16_bf16 v[144:159], v[52:55], a[76:79], v[144:159]
    s_lshl_b32 s68, 1, s40
    s_xor_b32 s68, s68, 7
    v_mfma_f32_32x32x16_bf16 v[160:175], v[56:59], a[72:75], v[160:175]
    s_add_u32 s74, s74, 294912
    s_cmp_ge_u32 s74, 5308416
    s_cselect_b32 s74, 0, s74
    s_add_u32 m0, s56, 41472
    s_nop 0
    buffer_load_dwordx4 v6, s[12:15], s74 offen lds
    v_mfma_f32_32x32x16_bf16 v[176:191], v[56:59], a[76:79], v[176:191]
    s_add_u32 m0, s56, 41472
    s_nop 0
    buffer_load_dword v7, s[12:15], s74 offen offset:1024 lds
    v_mfma_f32_32x32x16_bf16 v[192:207], v[60:63], a[72:75], v[192:207]
    s_add_u32 m0, s56, 46720
    s_nop 0
    buffer_load_dwordx4 v6, s[20:23], s74 offen lds
    v_mfma_f32_32x32x16_bf16 v[208:223], v[60:63], a[76:79], v[208:223]
    s_add_u32 m0, s56, 46720
    s_nop 0
    buffer_load_dword v7, s[20:23], s74 offen offset:1024 lds
    s_waitcnt lgkmcnt(0)
    v_mfma_f32_32x32x16_bf16 v[64:79], v[24:27], a[80:83], v[64:79]
    ds_read_b64_tr_b16 v[44:45], v1 offset:54400
    ds_read_b64_tr_b16 v[46:47], v1 offset:55040
    v_mfma_f32_32x32x16_bf16 v[80:95], v[24:27], a[84:87], v[80:95]
    ds_read_b64_tr_b16 v[48:49], v1 offset:54432
    ds_read_b64_tr_b16 v[50:51], v1 offset:55072
    v_mfma_f32_32x32x16_bf16 v[96:111], v[28:31], a[80:83], v[96:111]
    ds_read_b64_tr_b16 v[52:53], v1 offset:54464
    ds_read_b64_tr_b16 v[54:55], v1 offset:55104
    v_mfma_f32_32x32x16_bf16 v[112:127], v[28:31], a[84:87], v[112:127]
    ds_read_b64_tr_b16 v[56:57], v1 offset:54496
    ds_read_b64_tr_b16 v[58:59], v1 offset:55136
    v_mfma_f32_32x32x16_bf16 v[128:143], v[32:35], a[80:83], v[128:143]
    ds_read_b64_tr_b16 v[60:61], v1 offset:54528
    ds_read_b64_tr_b16 v[62:63], v1 offset:55168
    v_mfma_f32_32x32x16_bf16 v[144:159], v[32:35], a[84:87], v[144:159]
    v_mfma_f32_32x32x16_bf16 v[160:175], v[36:39], a[80:83], v[160:175]
    s_add_u32 s3, s46, 442368
    buffer_load_dword v19, v18, s[24:27], s3 offen
    v_mfma_f32_32x32x16_bf16 v[176:191], v[36:39], a[84:87], v[176:191]
    v_mfma_f32_32x32x16_bf16 v[192:207], v[40:43], a[80:83], v[192:207]
    v_mfma_f32_32x32x16_bf16 v[208:223], v[40:43], a[84:87], v[208:223]
    s_waitcnt vmcnt(21) lgkmcnt(0)
    s_barrier
    v_mfma_f32_32x32x16_bf16 v[64:79], v[44:47], a[88:91], v[64:79]
    ds_read_b64_tr_b16 v[24:25], v1 offset:0
    ds_read_b64_tr_b16 v[26:27], v1 offset:640
    v_mfma_f32_32x32x16_bf16 v[80:95], v[44:47], a[92:95], v[80:95]
    ds_read_b64_tr_b16 v[28:29], v1 offset:32
    ds_read_b64_tr_b16 v[30:31], v1 offset:672
    v_mfma_f32_32x32x16_bf16 v[96:111], v[48:51], a[88:91], v[96:111]
    ds_read_b64_tr_b16 v[32:33], v1 offset:64
    ds_read_b64_tr_b16 v[34:35], v1 offset:704
    v_mfma_f32_32x32x16_bf16 v[112:127], v[48:51], a[92:95], v[112:127]
    ds_read_b64_tr_b16 v[36:37], v1 offset:96
    ds_read_b64_tr_b16 v[38:39], v1 offset:736
    v_mfma_f32_32x32x16_bf16 v[128:143], v[52:55], a[88:91], v[128:143]
    ds_read_b64_tr_b16 v[40:41], v1 offset:128
    ds_read_b64_tr_b16 v[42:43], v1 offset:768
    v_mfma_f32_32x32x16_bf16 v[144:159], v[52:55], a[92:95], v[144:159]
    v_mfma_f32_32x32x16_bf16 v[160:175], v[56:59], a[88:91], v[160:175]
    s_add_u32 s74, s74, 294912
    s_cmp_ge_u32 s74, 5308416
    s_cselect_b32 s74, 0, s74
    s_add_u32 m0, s56, 51840
    s_nop 0
    buffer_load_dwordx4 v6, s[12:15], s74 offen lds
    v_mfma_f32_32x32x16_bf16 v[176:191], v[56:59], a[92:95], v[176:191]
    s_add_u32 m0, s56, 51840
    s_nop 0
    buffer_load_dword v7, s[12:15], s74 offen offset:1024 lds
    v_mfma_f32_32x32x16_bf16 v[192:207], v[60:63], a[88:91], v[192:207]
    s_add_u32 m0, s56, 57088
    s_nop 0
    buffer_load_dwordx4 v6, s[20:23], s74 offen lds
    v_mfma_f32_32x32x16_bf16 v[208:223], v[60:63], a[92:95], v[208:223]
    s_add_u32 m0, s55, 62208
    s_add_u32 s59, s46, 0
    buffer_load_dwordx4 v10, s[24:27], s59 offen lds
    v_mov_b32 v22, 1
    v_min_u32 v23, 1, v0
    v_lshlrev_b32 v23, 30, v23
    buffer_store_dword v22, v23, s[16:19], s60 offen sc0 sc1
    s_waitcnt lgkmcnt(0)
    v_mfma_f32_32x32x16_bf16 v[64:79], v[24:27], a[96:99], v[64:79]
    ds_read_b64_tr_b16 v[44:45], v1 offset:2560
    ds_read_b64_tr_b16 v[46:47], v1 offset:3200
    v_mfma_f32_32x32x16_bf16 v[80:95], v[24:27], a[100:103], v[80:95]
    ds_read_b64_tr_b16 v[48:49], v1 offset:2592
    ds_read_b64_tr_b16 v[50:51], v1 offset:3232
    v_mfma_f32_32x32x16_bf16 v[96:111], v[28:31], a[96:99], v[96:111]
    ds_read_b64_tr_b16 v[52:53], v1 offset:2624
    ds_read_b64_tr_b16 v[54:55], v1 offset:3264
    v_mfma_f32_32x32x16_bf16 v[112:127], v[28:31], a[100:103], v[112:127]
    ds_read_b64_tr_b16 v[56:57], v1 offset:2656
    ds_read_b64_tr_b16 v[58:59], v1 offset:3296
    v_mfma_f32_32x32x16_bf16 v[128:143], v[32:35], a[96:99], v[128:143]
    ds_read_b64_tr_b16 v[60:61], v1 offset:2688
    ds_read_b64_tr_b16 v[62:63], v1 offset:3328
    v_mfma_f32_32x32x16_bf16 v[144:159], v[32:35], a[100:103], v[144:159]
    v_mfma_f32_32x32x16_bf16 v[160:175], v[36:39], a[96:99], v[160:175]
    s_add_u32 m0, s56, 57088
    s_nop 0
    buffer_load_dword v7, s[20:23], s74 offen offset:1024 lds
    v_mfma_f32_32x32x16_bf16 v[176:191], v[36:39], a[100:103], v[176:191]
    s_add_u32 m0, s55, 66304
    s_add_u32 s59, s46, 36864
    buffer_load_dwordx4 v10, s[24:27], s59 offen lds
    v_mfma_f32_32x32x16_bf16 v[192:207], v[40:43], a[96:99], v[192:207]
    s_add_u32 s3, s46, 552960
    buffer_load_dword v19, v18, s[24:27], s3 offen
    v_mfma_f32_32x32x16_bf16 v[208:223], v[40:43], a[100:103], v[208:223]
    s_waitcnt vmcnt(24) lgkmcnt(0)
    s_barrier
    v_mfma_f32_32x32x16_bf16 v[64:79], v[44:47], a[104:107], v[64:79]
    ds_read_b64_tr_b16 v[24:25], v1 offset:10368
    ds_read_b64_tr_b16 v[26:27], v1 offset:11008
    v_mfma_f32_32x32x16_bf16 v[80:95], v[44:47], a[108:111], v[80:95]
    ds_read_b64_tr_b16 v[28:29], v1 offset:10400
    ds_read_b64_tr_b16 v[30:31], v1 offset:11040
    v_mfma_f32_32x32x16_bf16 v[96:111], v[48:51], a[104:107], v[96:111]
    ds_read_b64_tr_b16 v[32:33], v1 offset:10432
    ds_read_b64_tr_b16 v[34:35], v1 offset:11072
    v_mfma_f32_32x32x16_bf16 v[112:127], v[48:51], a[108:111], v[112:127]
    ds_read_b64_tr_b16 v[36:37], v1 offset:10464
    ds_read_b64_tr_b16 v[38:39], v1 offset:11104
    v_mfma_f32_32x32x16_bf16 v[128:143], v[52:55], a[104:107], v[128:143]
    ds_read_b64_tr_b16 v[40:41], v1 offset:10496
    ds_read_b64_tr_b16 v[42:43], v1 offset:11136
    v_mfma_f32_32x32x16_bf16 v[144:159], v[52:55], a[108:111], v[144:159]
    v_mfma_f32_32x32x16_bf16 v[160:175], v[56:59], a[104:107], v[160:175]
    s_add_u32 s74, s74, 294912
    s_cmp_ge_u32 s74, 5308416
    s_cselect_b32 s74, 0, s74
    s_add_u32 m0, s56, 0
    s_nop 0
    buffer_load_dwordx4 v6, s[12:15], s74 offen lds
    v_mfma_f32_32x32x16_bf16 v[176:191], v[56:59], a[108:111], v[176:191]
    s_add_u32 m0, s56, 0
    s_nop 0
    buffer_load_dword v7, s[12:15], s74 offen offset:1024 lds
    v_mfma_f32_32x32x16_bf16 v[192:207], v[60:63], a[104:107], v[192:207]
    s_add_u32 m0, s56, 5248
    s_nop 0
    buffer_load_dwordx4 v6, s[20:23], s74 offen lds
    v_mfma_f32_32x32x16_bf16 v[208:223], v[60:63], a[108:111], v[208:223]
    s_add_u32 m0, s55, 70400
    s_add_u32 s59, s46, 221184
    buffer_load_dwordx4 v10, s[24:27], s59 offen lds
    s_waitcnt lgkmcnt(0)
    v_mfma_f32_32x32x16_bf16 v[64:79], v[24:27], a[112:115], v[64:79]
    ds_read_b64_tr_b16 v[44:45], v1 offset:12928
    ds_read_b64_tr_b16 v[46:47], v1 offset:13568
    v_mfma_f32_32x32x16_bf16 v[80:95], v[24:27], a[116:119], v[80:95]
    ds_read_b64_tr_b16 v[48:49], v1 offset:12960
    ds_read_b64_tr_b16 v[50:51], v1 offset:13600
    v_mfma_f32_32x32x16_bf16 v[96:111], v[28:31], a[112:115], v[96:111]
    ds_read_b64_tr_b16 v[52:53], v1 offset:12992
    ds_read_b64_tr_b16 v[54:55], v1 offset:13632
    v_mfma_f32_32x32x16_bf16 v[112:127], v[28:31], a[116:119], v[112:127]
    ds_read_b64_tr_b16 v[56:57], v1 offset:13024
    ds_read_b64_tr_b16 v[58:59], v1 offset:13664
    v_mfma_f32_32x32x16_bf16 v[128:143], v[32:35], a[112:115], v[128:143]
    ds_read_b64_tr_b16 v[60:61], v1 offset:13056
    ds_read_b64_tr_b16 v[62:63], v1 offset:13696
    v_mfma_f32_32x32x16_bf16 v[144:159], v[32:35], a[116:119], v[144:159]
    v_mfma_f32_32x32x16_bf16 v[160:175], v[36:39], a[112:115], v[160:175]
    s_add_u32 m0, s56, 5248
    s_nop 0
    buffer_load_dword v7, s[20:23], s74 offen offset:1024 lds
    v_mfma_f32_32x32x16_bf16 v[176:191], v[36:39], a[116:119], v[176:191]
    s_add_u32 m0, s55, 74496
    s_add_u32 s59, s46, 258048
    buffer_load_dwordx4 v10, s[24:27], s59 offen lds
    v_mfma_f32_32x32x16_bf16 v[192:207], v[40:43], a[112:115], v[192:207]
    v_mfma_f32_32x32x16_bf16 v[208:223], v[40:43], a[116:119], v[208:223]
    s_waitcnt vmcnt(25) lgkmcnt(0)
    s_barrier
    v_mfma_f32_32x32x16_bf16 v[64:79], v[44:47], a[120:123], v[64:79]
    ds_read_b64_tr_b16 v[24:25], v1 offset:20736
    ds_read_b64_tr_b16 v[26:27], v1 offset:21376
    v_mfma_f32_32x32x16_bf16 v[80:95], v[44:47], a[124:127], v[80:95]
    ds_read_b64_tr_b16 v[28:29], v1 offset:20768
    ds_read_b64_tr_b16 v[30:31], v1 offset:21408
    v_mfma_f32_32x32x16_bf16 v[96:111], v[48:51], a[120:123], v[96:111]
    ds_read_b64_tr_b16 v[32:33], v1 offset:20800
    ds_read_b64_tr_b16 v[34:35], v1 offset:21440
    v_mfma_f32_32x32x16_bf16 v[112:127], v[48:51], a[124:127], v[112:127]
    ds_read_b64_tr_b16 v[36:37], v1 offset:20832
    ds_read_b64_tr_b16 v[38:39], v1 offset:21472
    v_mfma_f32_32x32x16_bf16 v[128:143], v[52:55], a[120:123], v[128:143]
    ds_read_b64_tr_b16 v[40:41], v1 offset:20864
    ds_read_b64_tr_b16 v[42:43], v1 offset:21504
    v_mfma_f32_32x32x16_bf16 v[144:159], v[52:55], a[124:127], v[144:159]
    v_mfma_f32_32x32x16_bf16 v[160:175], v[56:59], a[120:123], v[160:175]
    s_add_u32 s74, s74, 294912
    s_cmp_ge_u32 s74, 5308416
    s_cselect_b32 s74, 0, s74
    s_add_u32 m0, s56, 10368
    s_nop 0
    buffer_load_dwordx4 v6, s[12:15], s74 offen lds
    v_mfma_f32_32x32x16_bf16 v[176:191], v[56:59], a[124:127], v[176:191]
    s_add_u32 m0, s56, 10368
    s_nop 0
    buffer_load_dword v7, s[12:15], s74 offen offset:1024 lds
    v_mfma_f32_32x32x16_bf16 v[192:207], v[60:63], a[120:123], v[192:207]
    s_add_u32 m0, s56, 15616
    s_nop 0
    buffer_load_dwordx4 v6, s[20:23], s74 offen lds
    v_mfma_f32_32x32x16_bf16 v[208:223], v[60:63], a[124:127], v[208:223]
    s_add_u32 m0, s55, 78592
    s_add_u32 s59, s46, 128
    buffer_load_dwordx4 v10, s[24:27], s59 offen lds
    s_waitcnt lgkmcnt(0)
    v_mfma_f32_32x32x16_bf16 v[64:79], v[24:27], a[128:131], v[64:79]
    ds_read_b64_tr_b16 v[44:45], v1 offset:23296
    ds_read_b64_tr_b16 v[46:47], v1 offset:23936
    v_mfma_f32_32x32x16_bf16 v[80:95], v[24:27], a[132:135], v[80:95]
    ds_read_b64_tr_b16 v[48:49], v1 offset:23328
    ds_read_b64_tr_b16 v[50:51], v1 offset:23968
    v_mfma_f32_32x32x16_bf16 v[96:111], v[28:31], a[128:131], v[96:111]
    ds_read_b64_tr_b16 v[52:53], v1 offset:23360
    ds_read_b64_tr_b16 v[54:55], v1 offset:24000
    v_mfma_f32_32x32x16_bf16 v[112:127], v[28:31], a[132:135], v[112:127]
    ds_read_b64_tr_b16 v[56:57], v1 offset:23392
    ds_read_b64_tr_b16 v[58:59], v1 offset:24032
    v_mfma_f32_32x32x16_bf16 v[128:143], v[32:35], a[128:131], v[128:143]
    ds_read_b64_tr_b16 v[60:61], v1 offset:23424
    ds_read_b64_tr_b16 v[62:63], v1 offset:24064
    v_mfma_f32_32x32x16_bf16 v[144:159], v[32:35], a[132:135], v[144:159]
    v_mfma_f32_32x32x16_bf16 v[160:175], v[36:39], a[128:131], v[160:175]
    s_add_u32 m0, s56, 15616
    s_nop 0
    buffer_load_dword v7, s[20:23], s74 offen offset:1024 lds
    v_mfma_f32_32x32x16_bf16 v[176:191], v[36:39], a[132:135], v[176:191]
    s_add_u32 m0, s55, 82688
    s_add_u32 s59, s46, 36992
    buffer_load_dwordx4 v10, s[24:27], s59 offen lds
    v_mfma_f32_32x32x16_bf16 v[192:207], v[40:43], a[128:131], v[192:207]
    v_mfma_f32_32x32x16_bf16 v[208:223], v[40:43], a[132:135], v[208:223]
    s_waitcnt vmcnt(26) lgkmcnt(0)
    s_barrier
    v_mfma_f32_32x32x16_bf16 v[64:79], v[44:47], a[136:139], v[64:79]
    ds_read_b64_tr_b16 v[24:25], v1 offset:31104
    ds_read_b64_tr_b16 v[26:27], v1 offset:31744
    v_mfma_f32_32x32x16_bf16 v[80:95], v[44:47], a[140:143], v[80:95]
    ds_read_b64_tr_b16 v[28:29], v1 offset:31136
    ds_read_b64_tr_b16 v[30:31], v1 offset:31776
    v_mfma_f32_32x32x16_bf16 v[96:111], v[48:51], a[136:139], v[96:111]
    ds_read_b64_tr_b16 v[32:33], v1 offset:31168
    ds_read_b64_tr_b16 v[34:35], v1 offset:31808
    v_mfma_f32_32x32x16_bf16 v[112:127], v[48:51], a[140:143], v[112:127]
    ds_read_b64_tr_b16 v[36:37], v1 offset:31200
    ds_read_b64_tr_b16 v[38:39], v1 offset:31840
    v_mfma_f32_32x32x16_bf16 v[128:143], v[52:55], a[136:139], v[128:143]
    ds_read_b64_tr_b16 v[40:41], v1 offset:31232
    ds_read_b64_tr_b16 v[42:43], v1 offset:31872
    v_mfma_f32_32x32x16_bf16 v[144:159], v[52:55], a[140:143], v[144:159]
    v_mfma_f32_32x32x16_bf16 v[160:175], v[56:59], a[136:139], v[160:175]
    s_add_u32 s74, s74, 294912
    s_cmp_ge_u32 s74, 5308416
    s_cselect_b32 s74, 0, s74
    s_add_u32 m0, s56, 20736
    s_nop 0
    buffer_load_dwordx4 v6, s[12:15], s74 offen lds
    v_mfma_f32_32x32x16_bf16 v[176:191], v[56:59], a[140:143], v[176:191]
    s_add_u32 m0, s56, 20736
    s_nop 0
    buffer_load_dword v7, s[12:15], s74 offen offset:1024 lds
    v_mfma_f32_32x32x16_bf16 v[192:207], v[60:63], a[136:139], v[192:207]
    s_add_u32 m0, s55, 86784
    s_add_u32 s59, s46, 221312
    buffer_load_dwordx4 v10, s[24:27], s59 offen lds
    v_mfma_f32_32x32x16_bf16 v[208:223], v[60:63], a[140:143], v[208:223]
    buffer_load_dword v15, v13, s[32:35], 0 offen sc0 sc1
    s_waitcnt lgkmcnt(0)
    v_mfma_f32_32x32x16_bf16 v[64:79], v[24:27], a[144:147], v[64:79]
    ds_read_b64_tr_b16 v[44:45], v1 offset:33664
    ds_read_b64_tr_b16 v[46:47], v1 offset:34304
    v_mfma_f32_32x32x16_bf16 v[80:95], v[24:27], a[148:151], v[80:95]
    ds_read_b64_tr_b16 v[48:49], v1 offset:33696
    ds_read_b64_tr_b16 v[50:51], v1 offset:34336
    v_mfma_f32_32x32x16_bf16 v[96:111], v[28:31], a[144:147], v[96:111]
    ds_read_b64_tr_b16 v[52:53], v1 offset:33728
    ds_read_b64_tr_b16 v[54:55], v1 offset:34368
    v_mfma_f32_32x32x16_bf16 v[112:127], v[28:31], a[148:151], v[112:127]
    ds_read_b64_tr_b16 v[56:57], v1 offset:33760
    ds_read_b64_tr_b16 v[58:59], v1 offset:34400
    v_mfma_f32_32x32x16_bf16 v[128:143], v[32:35], a[144:147], v[128:143]
    ds_read_b64_tr_b16 v[60:61], v1 offset:33792
    ds_read_b64_tr_b16 v[62:63], v1 offset:34432
    v_mfma_f32_32x32x16_bf16 v[144:159], v[32:35], a[148:151], v[144:159]
    v_mfma_f32_32x32x16_bf16 v[160:175], v[36:39], a[144:147], v[160:175]
    s_add_u32 m0, s56, 25984
    s_nop 0
    buffer_load_dwordx4 v6, s[20:23], s74 offen lds
    v_mfma_f32_32x32x16_bf16 v[176:191], v[36:39], a[148:151], v[176:191]
    s_add_u32 m0, s56, 25984
    s_nop 0
    buffer_load_dword v7, s[20:23], s74 offen offset:1024 lds
    v_mfma_f32_32x32x16_bf16 v[192:207], v[40:43], a[144:147], v[192:207]
    s_add_u32 m0, s55, 90880
    s_add_u32 s59, s46, 258176
    buffer_load_dwordx4 v10, s[24:27], s59 offen lds
    v_mfma_f32_32x32x16_bf16 v[208:223], v[40:43], a[148:151], v[208:223]
    s_waitcnt vmcnt(28) lgkmcnt(0)
    s_barrier
    v_mfma_f32_32x32x16_bf16 v[64:79], v[44:47], a[152:155], v[64:79]
    ds_read_b64_tr_b16 v[24:25], v1 offset:41472
    ds_read_b64_tr_b16 v[26:27], v1 offset:42112
    v_mfma_f32_32x32x16_bf16 v[80:95], v[44:47], a[156:159], v[80:95]
    ds_read_b64_tr_b16 v[28:29], v1 offset:41504
    ds_read_b64_tr_b16 v[30:31], v1 offset:42144
    v_mfma_f32_32x32x16_bf16 v[96:111], v[48:51], a[152:155], v[96:111]
    ds_read_b64_tr_b16 v[32:33], v1 offset:41536
    ds_read_b64_tr_b16 v[34:35], v1 offset:42176
    v_mfma_f32_32x32x16_bf16 v[112:127], v[48:51], a[156:159], v[112:127]
    ds_read_b64_tr_b16 v[36:37], v1 offset:41568
    ds_read_b64_tr_b16 v[38:39], v1 offset:42208
    v_mfma_f32_32x32x16_bf16 v[128:143], v[52:55], a[152:155], v[128:143]
    ds_read_b64_tr_b16 v[40:41], v1 offset:41600
    ds_read_b64_tr_b16 v[42:43], v1 offset:42240
    v_mfma_f32_32x32x16_bf16 v[144:159], v[52:55], a[156:159], v[144:159]
    v_mfma_f32_32x32x16_bf16 v[160:175], v[56:59], a[152:155], v[160:175]
    s_add_u32 s74, s74, 294912
    s_cmp_ge_u32 s74, 5308416
    s_cselect_b32 s74, 0, s74
    s_add_u32 m0, s56, 31104
    s_nop 0
    buffer_load_dwordx4 v6, s[12:15], s74 offen lds
    v_mfma_f32_32x32x16_bf16 v[176:191], v[56:59], a[156:159], v[176:191]
    s_add_u32 m0, s56, 31104
    s_nop 0
    buffer_load_dword v7, s[12:15], s74 offen offset:1024 lds
    v_mfma_f32_32x32x16_bf16 v[192:207], v[60:63], a[152:155], v[192:207]
    s_add_u32 m0, s56, 36352
    s_nop 0
    buffer_load_dwordx4 v6, s[20:23], s74 offen lds
    v_mfma_f32_32x32x16_bf16 v[208:223], v[60:63], a[156:159], v[208:223]
    s_add_u32 m0, s55, 94976
    s_add_u32 s59, s46, 368768
    buffer_load_dwordx4 v10, s[24:27], s59 offen lds
    s_waitcnt lgkmcnt(0)
    v_mfma_f32_32x32x16_bf16 v[64:79], v[24:27], a[160:163], v[64:79]
    ds_read_b64_tr_b16 v[44:45], v1 offset:44032
    ds_read_b64_tr_b16 v[46:47], v1 offset:44672
    v_mfma_f32_32x32x16_bf16 v[80:95], v[24:27], a[164:167], v[80:95]
    ds_read_b64_tr_b16 v[48:49], v1 offset:44064
    ds_read_b64_tr_b16 v[50:51], v1 offset:44704
    v_mfma_f32_32x32x16_bf16 v[96:111], v[28:31], a[160:163], v[96:111]
    ds_read_b64_tr_b16 v[52:53], v1 offset:44096
    ds_read_b64_tr_b16 v[54:55], v1 offset:44736
    v_mfma_f32_32x32x16_bf16 v[112:127], v[28:31], a[164:167], v[112:127]
    ds_read_b64_tr_b16 v[56:57], v1 offset:44128
    ds_read_b64_tr_b16 v[58:59], v1 offset:44768
    v_mfma_f32_32x32x16_bf16 v[128:143], v[32:35], a[160:163], v[128:143]
    ds_read_b64_tr_b16 v[60:61], v1 offset:44160
    ds_read_b64_tr_b16 v[62:63], v1 offset:44800
    v_mfma_f32_32x32x16_bf16 v[144:159], v[32:35], a[164:167], v[144:159]
    v_mfma_f32_32x32x16_bf16 v[160:175], v[36:39], a[160:163], v[160:175]
    s_add_u32 m0, s56, 36352
    s_nop 0
    buffer_load_dword v7, s[20:23], s74 offen offset:1024 lds
    v_mfma_f32_32x32x16_bf16 v[176:191], v[36:39], a[164:167], v[176:191]
    s_add_u32 m0, s55, 99072
    s_add_u32 s59, s46, 405632
    buffer_load_dwordx4 v10, s[24:27], s59 offen lds
    v_mfma_f32_32x32x16_bf16 v[192:207], v[40:43], a[160:163], v[192:207]
    v_mfma_f32_32x32x16_bf16 v[208:223], v[40:43], a[164:167], v[208:223]
    s_waitcnt vmcnt(9)
    s_mov_b32 s62, 0
L_pw0:
    v_cmp_le_u32 vcc, 64, v15
    s_nop 0
    s_and_b32 s3, vcc_lo, 15
    s_cmp_eq_u32 s3, 15
    s_cbranch_scc1 L_pok0
    s_add_u32 s62, s62, 1
    s_cmp_ge_u32 s62, 100000
    s_cbranch_scc1 L_pok0
    s_sleep 4
    buffer_load_dword v15, v13, s[32:35], 0 offen sc0 sc1
    s_waitcnt vmcnt(0)
    s_branch L_pw0
L_pok0:
    s_waitcnt lgkmcnt(0)
    s_barrier
    v_mfma_f32_32x32x16_bf16 v[64:79], v[44:47], a[168:171], v[64:79]
    ds_read_b64_tr_b16 v[24:25], v1 offset:51840
    ds_read_b64_tr_b16 v[26:27], v1 offset:52480
    v_mfma_f32_32x32x16_bf16 v[80:95], v[44:47], a[172:175], v[80:95]
    ds_read_b64_tr_b16 v[28:29], v1 offset:51872
    ds_read_b64_tr_b16 v[30:31], v1 offset:52512
    v_mfma_f32_32x32x16_bf16 v[96:111], v[48:51], a[168:171], v[96:111]
    ds_read_b64_tr_b16 v[32:33], v1 offset:51904
    ds_read_b64_tr_b16 v[34:35], v1 offset:52544
    v_mfma_f32_32x32x16_bf16 v[112:127], v[48:51], a[172:175], v[112:127]
    ds_read_b64_tr_b16 v[36:37], v1 offset:51936
    ds_read_b64_tr_b16 v[38:39], v1 offset:52576
    v_mfma_f32_32x32x16_bf16 v[128:143], v[52:55], a[168:171], v[128:143]
    ds_read_b64_tr_b16 v[40:41], v1 offset:51968
    ds_read_b64_tr_b16 v[42:43], v1 offset:52608
    v_mfma_f32_32x32x16_bf16 v[144:159], v[52:55], a[172:175], v[144:159]
    v_mfma_f32_32x32x16_bf16 v[160:175], v[56:59], a[168:171], v[160:175]
    s_add_u32 s74, s74, 294912
    s_cmp_ge_u32 s74, 5308416
    s_cselect_b32 s74, 0, s74
    s_add_u32 m0, s56, 41472
    s_nop 0
    buffer_load_dwordx4 v6, s[12:15], s74 offen lds
    v_mfma_f32_32x32x16_bf16 v[176:191], v[56:59], a[172:175], v[176:191]
    s_add_u32 m0, s56, 41472
    s_nop 0
    buffer_load_dword v7, s[12:15], s74 offen offset:1024 lds
    v_mfma_f32_32x32x16_bf16 v[192:207], v[60:63], a[168:171], v[192:207]
    s_add_u32 m0, s55, 103168
    s_add_u32 s59, s46, 516224
    buffer_load_dwordx4 v10, s[24:27], s59 offen lds
    v_mfma_f32_32x32x16_bf16 v[208:223], v[60:63], a[172:175], v[208:223]
    buffer_load_dword v14, v12, s[16:19], s75 offen sc0 sc1
    s_waitcnt lgkmcnt(0)
    v_mfma_f32_32x32x16_bf16 v[64:79], v[24:27], a[176:179], v[64:79]
    ds_read_b64_tr_b16 v[44:45], v1 offset:54400
    ds_read_b64_tr_b16 v[46:47], v1 offset:55040
    v_mfma_f32_32x32x16_bf16 v[80:95], v[24:27], a[180:183], v[80:95]
    ds_read_b64_tr_b16 v[48:49], v1 offset:54432
    ds_read_b64_tr_b16 v[50:51], v1 offset:55072
    v_mfma_f32_32x32x16_bf16 v[96:111], v[28:31], a[176:179], v[96:111]
    ds_read_b64_tr_b16 v[52:53], v1 offset:54464
    ds_read_b64_tr_b16 v[54:55], v1 offset:55104
    v_mfma_f32_32x32x16_bf16 v[112:127], v[28:31], a[180:183], v[112:127]
    ds_read_b64_tr_b16 v[56:57], v1 offset:54496
    ds_read_b64_tr_b16 v[58:59], v1 offset:55136
    v_mfma_f32_32x32x16_bf16 v[128:143], v[32:35], a[176:179], v[128:143]
    ds_read_b64_tr_b16 v[60:61], v1 offset:54528
    ds_read_b64_tr_b16 v[62:63], v1 offset:55168
    v_mfma_f32_32x32x16_bf16 v[144:159], v[32:35], a[180:183], v[144:159]
    v_mfma_f32_32x32x16_bf16 v[160:175], v[36:39], a[176:179], v[160:175]
    s_add_u32 m0, s56, 46720
    s_nop 0
    buffer_load_dwordx4 v6, s[20:23], s74 offen lds
    v_mfma_f32_32x32x16_bf16 v[176:191], v[36:39], a[180:183], v[176:191]
    s_add_u32 m0, s56, 46720
    s_nop 0
    buffer_load_dword v7, s[20:23], s74 offen offset:1024 lds
    v_mfma_f32_32x32x16_bf16 v[192:207], v[40:43], a[176:179], v[192:207]
    s_add_u32 m0, s55, 107264
    s_add_u32 s59, s46, 553088
    buffer_load_dwordx4 v10, s[24:27], s59 offen lds
    v_mfma_f32_32x32x16_bf16 v[208:223], v[40:43], a[180:183], v[208:223]
    s_waitcnt lgkmcnt(0)
    s_barrier
    v_mfma_f32_32x32x16_bf16 v[64:79], v[44:47], a[184:187], v[64:79]
    ds_read_b64_tr_b16 v[24:25], v1 offset:0
    ds_read_b64_tr_b16 v[26:27], v1 offset:640
    v_mfma_f32_32x32x16_bf16 v[80:95], v[44:47], a[188:191], v[80:95]
    ds_read_b64_tr_b16 v[28:29], v1 offset:32
    ds_read_b64_tr_b16 v[30:31], v1 offset:672
    v_mfma_f32_32x32x16_bf16 v[96:111], v[48:51], a[184:187], v[96:111]
    ds_read_b64_tr_b16 v[32:33], v1 offset:64
    ds_read_b64_tr_b16 v[34:35], v1 offset:704
    v_mfma_f32_32x32x16_bf16 v[112:127], v[48:51], a[188:191], v[112:127]
    ds_read_b64_tr_b16 v[36:37], v1 offset:96
    ds_read_b64_tr_b16 v[38:39], v1 offset:736
    v_mfma_f32_32x32x16_bf16 v[128:143], v[52:55], a[184:187], v[128:143]
    ds_read_b64_tr_b16 v[40:41], v1 offset:128
    ds_read_b64_tr_b16 v[42:43], v1 offset:768
    v_mfma_f32_32x32x16_bf16 v[144:159], v[52:55], a[188:191], v[144:159]
    v_mfma_f32_32x32x16_bf16 v[160:175], v[56:59], a[184:187], v[160:175]
    s_add_u32 s74, s74, 294912
    s_cmp_ge_u32 s74, 5308416
    s_cselect_b32 s74, 0, s74
    s_add_u32 m0, s56, 51840
    s_nop 0
    buffer_load_dwordx4 v6, s[12:15], s74 offen lds
    v_mfma_f32_32x32x16_bf16 v[176:191], v[56:59], a[188:191], v[176:191]
    s_add_u32 m0, s56, 51840
    s_nop 0
    buffer_load_dword v7, s[12:15], s74 offen offset:1024 lds
    v_mfma_f32_32x32x16_bf16 v[192:207], v[60:63], a[184:187], v[192:207]
    s_add_u32 m0, s56, 57088
    s_nop 0
    buffer_load_dwordx4 v6, s[20:23], s74 offen lds
    v_mfma_f32_32x32x16_bf16 v[208:223], v[60:63], a[188:191], v[208:223]
    s_add_u32 m0, s55, 111360
    s_add_u32 s59, s46, 368640
    buffer_load_dwordx4 v10, s[24:27], s59 offen lds
    s_waitcnt vmcnt(7)
    s_mov_b32 s62, 0
L_pw1:
    v_cmp_le_u32 vcc, 1, v14
    s_nop 0
    s_and_b32 s3, vcc_lo, 15
    s_cmp_eq_u32 s3, 15
    s_cbranch_scc1 L_pok1
    s_add_u32 s62, s62, 1
    s_cmp_ge_u32 s62, 100000
    s_cbranch_scc1 L_pok1
    s_sleep 4
    buffer_load_dword v14, v12, s[16:19], s75 offen sc0 sc1
    s_waitcnt vmcnt(0)
    s_branch L_pw1
L_pok1:
    s_waitcnt lgkmcnt(0)
    v_mfma_f32_32x32x16_bf16 v[64:79], v[24:27], a[192:195], v[64:79]
    ds_read_b64_tr_b16 v[44:45], v1 offset:2560
    ds_read_b64_tr_b16 v[46:47], v1 offset:3200
    v_mfma_f32_32x32x16_bf16 v[80:95], v[24:27], a[196:199], v[80:95]
    ds_read_b64_tr_b16 v[48:49], v1 offset:2592
    ds_read_b64_tr_b16 v[50:51], v1 offset:3232
    v_mfma_f32_32x32x16_bf16 v[96:111], v[28:31], a[192:195], v[96:111]
    ds_read_b64_tr_b16 v[52:53], v1 offset:2624
    ds_read_b64_tr_b16 v[54:55], v1 offset:3264
    v_mfma_f32_32x32x16_bf16 v[112:127], v[28:31], a[196:199], v[112:127]
    ds_read_b64_tr_b16 v[56:57], v1 offset:2656
    ds_read_b64_tr_b16 v[58:59], v1 offset:3296
    v_mfma_f32_32x32x16_bf16 v[128:143], v[32:35], a[192:195], v[128:143]
    ds_read_b64_tr_b16 v[60:61], v1 offset:2688
    ds_read_b64_tr_b16 v[62:63], v1 offset:3328
    v_mfma_f32_32x32x16_bf16 v[144:159], v[32:35], a[196:199], v[144:159]
    v_mfma_f32_32x32x16_bf16 v[160:175], v[36:39], a[192:195], v[160:175]
    s_add_u32 m0, s55, 115456
    s_add_u32 s59, s46, 405504
    buffer_load_dwordx4 v10, s[24:27], s59 offen lds
    v_mfma_f32_32x32x16_bf16 v[176:191], v[36:39], a[196:199], v[176:191]
    s_add_u32 s58, s45, 0
    buffer_load_dwordx4 a[0:3], v11, s[16:19], s58 offen offset:0 sc1
    v_mfma_f32_32x32x16_bf16 v[192:207], v[40:43], a[192:195], v[192:207]
    buffer_load_dwordx4 a[4:7], v11, s[16:19], s58 offen offset:1024 sc1
    v_mfma_f32_32x32x16_bf16 v[208:223], v[40:43], a[196:199], v[208:223]
    s_add_u32 s58, s45, 65536
    buffer_load_dwordx4 a[8:11], v11, s[16:19], s58 offen offset:0 sc1
    s_waitcnt lgkmcnt(0)
    s_barrier
    v_mfma_f32_32x32x16_bf16 v[64:79], v[44:47], a[200:203], v[64:79]
    ds_read_b64_tr_b16 v[24:25], v1 offset:10368
    ds_read_b64_tr_b16 v[26:27], v1 offset:11008
    v_lshlrev_b32 v14, 4, v0
    v_mfma_f32_32x32x16_bf16 v[80:95], v[44:47], a[204:207], v[80:95]
    ds_read_b64_tr_b16 v[28:29], v1 offset:10400
    ds_read_b64_tr_b16 v[30:31], v1 offset:11040
    s_lshl_b32 s78, s39, 8
    v_mfma_f32_32x32x16_bf16 v[96:111], v[48:51], a[200:203], v[96:111]
    ds_read_b64_tr_b16 v[32:33], v1 offset:10432
    ds_read_b64_tr_b16 v[34:35], v1 offset:11072
    s_add_u32 s78, s78, 12288
    v_mfma_f32_32x32x16_bf16 v[112:127], v[48:51], a[204:207], v[112:127]
    ds_read_b64_tr_b16 v[36:37], v1 offset:10464
    ds_read_b64_tr_b16 v[38:39], v1 offset:11104
    v_lshl_add_u32 v13, v0, 2, s78
    v_mfma_f32_32x32x16_bf16 v[128:143], v[52:55], a[200:203], v[128:143]
    ds_read_b64_tr_b16 v[40:41], v1 offset:10496
    ds_read_b64_tr_b16 v[42:43], v1 offset:11136
    v_mfma_f32_32x32x16_bf16 v[144:159], v[52:55], a[204:207], v[144:159]
    s_add_u32 m0, s55, 119552
    s_add_u32 s59, s46, 516096
    buffer_load_dwordx4 v10, s[24:27], s59 offen lds
    v_mfma_f32_32x32x16_bf16 v[160:175], v[56:59], a[200:203], v[160:175]
    buffer_load_dwordx4 a[12:15], v11, s[16:19], s58 offen offset:1024 sc1
    v_mfma_f32_32x32x16_bf16 v[176:191], v[56:59], a[204:207], v[176:191]
    s_add_u32 s58, s45, 131072
    buffer_load_dwordx4 a[16:19], v11, s[16:19], s58 offen offset:0 sc1
    v_mfma_f32_32x32x16_bf16 v[192:207], v[60:63], a[200:203], v[192:207]
    buffer_load_dwordx4 a[20:23], v11, s[16:19], s58 offen offset:1024 sc1
    v_mfma_f32_32x32x16_bf16 v[208:223], v[60:63], a[204:207], v[208:223]
    buffer_load_dword v16, v9, s[16:19], s77 offen sc1
    s_waitcnt lgkmcnt(0)
    v_mfma_f32_32x32x16_bf16 v[64:79], v[24:27], a[208:211], v[64:79]
    ds_read_b64_tr_b16 v[44:45], v1 offset:12928
    ds_read_b64_tr_b16 v[46:47], v1 offset:13568
    v_mfma_f32_32x32x16_bf16 v[80:95], v[24:27], a[212:215], v[80:95]
    ds_read_b64_tr_b16 v[48:49], v1 offset:12960
    ds_read_b64_tr_b16 v[50:51], v1 offset:13600
    v_mfma_f32_32x32x16_bf16 v[96:111], v[28:31], a[208:211], v[96:111]
    ds_read_b64_tr_b16 v[52:53], v1 offset:12992
    ds_read_b64_tr_b16 v[54:55], v1 offset:13632
    v_mfma_f32_32x32x16_bf16 v[112:127], v[28:31], a[212:215], v[112:127]
    ds_read_b64_tr_b16 v[56:57], v1 offset:13024
    ds_read_b64_tr_b16 v[58:59], v1 offset:13664
    v_mfma_f32_32x32x16_bf16 v[128:143], v[32:35], a[208:211], v[128:143]
    ds_read_b64_tr_b16 v[60:61], v1 offset:13056
    ds_read_b64_tr_b16 v[62:63], v1 offset:13696
    v_mfma_f32_32x32x16_bf16 v[144:159], v[32:35], a[212:215], v[144:159]
    v_mfma_f32_32x32x16_bf16 v[160:175], v[36:39], a[208:211], v[160:175]
    s_add_u32 m0, s55, 123648
    s_add_u32 s59, s46, 552960
    buffer_load_dwordx4 v10, s[24:27], s59 offen lds
    v_mfma_f32_32x32x16_bf16 v[176:191], v[36:39], a[212:215], v[176:191]
    s_add_u32 s58, s45, 196608
    buffer_load_dwordx4 a[24:27], v11, s[16:19], s58 offen offset:0 sc1
    v_mfma_f32_32x32x16_bf16 v[192:207], v[40:43], a[208:211], v[192:207]
    buffer_load_dwordx4 a[28:31], v11, s[16:19], s58 offen offset:1024 sc1
    v_mfma_f32_32x32x16_bf16 v[208:223], v[40:43], a[212:215], v[208:223]
    s_add_u32 s58, s45, 786432
    buffer_load_dwordx4 a[32:35], v11, s[16:19], s58 offen offset:0 sc1
    s_waitcnt lgkmcnt(0)
    s_barrier
    v_mfma_f32_32x32x16_bf16 v[64:79], v[44:47], a[216:219], v[64:79]
    ds_read_b64_tr_b16 v[24:25], v1 offset:20736
    ds_read_b64_tr_b16 v[26:27], v1 offset:21376
    v_mfma_f32_32x32x16_bf16 v[80:95], v[44:47], a[220:223], v[80:95]
    ds_read_b64_tr_b16 v[28:29], v1 offset:20768
    ds_read_b64_tr_b16 v[30:31], v1 offset:21408
    v_mfma_f32_32x32x16_bf16 v[96:111], v[48:51], a[216:219], v[96:111]
    ds_read_b64_tr_b16 v[32:33], v1 offset:20800
    ds_read_b64_tr_b16 v[34:35], v1 offset:21440
    v_mfma_f32_32x32x16_bf16 v[112:127], v[48:51], a[220:223], v[112:127]
    ds_read_b64_tr_b16 v[36:37], v1 offset:20832
    ds_read_b64_tr_b16 v[38:39], v1 offset:21472
    v_mfma_f32_32x32x16_bf16 v[128:143], v[52:55], a[216:219], v[128:143]
    ds_read_b64_tr_b16 v[40:41], v1 offset:20864
    ds_read_b64_tr_b16 v[42:43], v1 offset:21504
    v_mfma_f32_32x32x16_bf16 v[144:159], v[52:55], a[220:223], v[144:159]
    v_mfma_f32_32x32x16_bf16 v[160:175], v[56:59], a[216:219], v[160:175]
    s_add_u32 m0, s55, 127744
    s_add_u32 s59, s46, 73728
    buffer_load_dwordx4 v10, s[24:27], s59 offen lds
    v_mfma_f32_32x32x16_bf16 v[176:191], v[56:59], a[220:223], v[176:191]
    buffer_load_dwordx4 a[36:39], v11, s[16:19], s58 offen offset:1024 sc1
    v_mfma_f32_32x32x16_bf16 v[192:207], v[60:63], a[216:219], v[192:207]
    s_add_u32 s58, s45, 851968
    buffer_load_dwordx4 a[40:43], v11, s[16:19], s58 offen offset:0 sc1
    v_mfma_f32_32x32x16_bf16 v[208:223], v[60:63], a[220:223], v[208:223]
    buffer_load_dwordx4 a[44:47], v11, s[16:19], s58 offen offset:1024 sc1
    s_waitcnt lgkmcnt(0)
    v_mfma_f32_32x32x16_bf16 v[64:79], v[24:27], a[224:227], v[64:79]
    ds_read_b64_tr_b16 v[44:45], v1 offset:23296
    ds_read_b64_tr_b16 v[46:47], v1 offset:23936
    v_mfma_f32_32x32x16_bf16 v[80:95], v[24:27], a[228:231], v[80:95]
    ds_read_b64_tr_b16 v[48:49], v1 offset:23328
    ds_read_b64_tr_b16 v[50:51], v1 offset:23968
    v_mfma_f32_32x32x16_bf16 v[96:111], v[28:31], a[224:227], v[96:111]
    ds_read_b64_tr_b16 v[52:53], v1 offset:23360
    ds_read_b64_tr_b16 v[54:55], v1 offset:24000
    v_mfma_f32_32x32x16_bf16 v[112:127], v[28:31], a[228:231], v[112:127]
    ds_read_b64_tr_b16 v[56:57], v1 offset:23392
    ds_read_b64_tr_b16 v[58:59], v1 offset:24032
    v_mfma_f32_32x32x16_bf16 v[128:143], v[32:35], a[224:227], v[128:143]
    ds_read_b64_tr_b16 v[60:61], v1 offset:23424
    ds_read_b64_tr_b16 v[62:63], v1 offset:24064
    v_mfma_f32_32x32x16_bf16 v[144:159], v[32:35], a[228:231], v[144:159]
    v_mfma_f32_32x32x16_bf16 v[160:175], v[36:39], a[224:227], v[160:175]
    s_add_u32 m0, s55, 131840
    s_add_u32 s59, s46, 110592
    buffer_load_dwordx4 v10, s[24:27], s59 offen lds
    v_mfma_f32_32x32x16_bf16 v[176:191], v[36:39], a[228:231], v[176:191]
    s_add_u32 s58, s45, 917504
    buffer_load_dwordx4 a[48:51], v11, s[16:19], s58 offen offset:0 sc1
    v_mfma_f32_32x32x16_bf16 v[192:207], v[40:43], a[224:227], v[192:207]
    buffer_load_dwordx4 a[52:55], v11, s[16:19], s58 offen offset:1024 sc1
    v_mfma_f32_32x32x16_bf16 v[208:223], v[40:43], a[228:231], v[208:223]
    s_add_u32 s58, s45, 983040
    buffer_load_dwordx4 a[56:59], v11, s[16:19], s58 offen offset:0 sc1
    s_waitcnt lgkmcnt(0)
    s_barrier
    v_mfma_f32_32x32x16_bf16 v[64:79], v[44:47], a[232:235], v[64:79]
    ds_read_b64_tr_b16 v[24:25], v1 offset:31104
    ds_read_b64_tr_b16 v[26:27], v1 offset:31744
    v_mfma_f32_32x32x16_bf16 v[80:95], v[44:47], a[236:239], v[80:95]
    ds_read_b64_tr_b16 v[28:29], v1 offset:31136
    ds_read_b64_tr_b16 v[30:31], v1 offset:31776
    v_mfma_f32_32x32x16_bf16 v[96:111], v[48:51], a[232:235], v[96:111]
    ds_read_b64_tr_b16 v[32:33], v1 offset:31168
    ds_read_b64_tr_b16 v[34:35], v1 offset:31808
    v_mfma_f32_32x32x16_bf16 v[112:127], v[48:51], a[236:239], v[112:127]
    ds_read_b64_tr_b16 v[36:37], v1 offset:31200
    ds_read_b64_tr_b16 v[38:39], v1 offset:31840
    v_mfma_f32_32x32x16_bf16 v[128:143], v[52:55], a[232:235], v[128:143]
    ds_read_b64_tr_b16 v[40:41], v1 offset:31232
    ds_read_b64_tr_b16 v[42:43], v1 offset:31872
    v_mfma_f32_32x32x16_bf16 v[144:159], v[52:55], a[236:239], v[144:159]
    v_mfma_f32_32x32x16_bf16 v[160:175], v[56:59], a[232:235], v[160:175]
    s_add_u32 m0, s55, 135936
    s_add_u32 s59, s46, 147456
    buffer_load_dwordx4 v10, s[24:27], s59 offen lds
    v_mfma_f32_32x32x16_bf16 v[176:191], v[56:59], a[236:239], v[176:191]
    buffer_load_dwordx4 a[60:63], v11, s[16:19], s58 offen offset:1024 sc1
    v_mfma_f32_32x32x16_bf16 v[192:207], v[60:63], a[232:235], v[192:207]
    s_add_u32 s58, s45, 1310720
    buffer_load_dwordx4 a[64:67], v11, s[16:19], s58 offen offset:0 sc1
    v_mfma_f32_32x32x16_bf16 v[208:223], v[60:63], a[236:239], v[208:223]
    buffer_load_dwordx4 a[68:71], v11, s[16:19], s58 offen offset:1024 sc1
    s_waitcnt lgkmcnt(0)
    v_mfma_f32_32x32x16_bf16 v[64:79], v[24:27], a[240:243], v[64:79]
    ds_read_b64_tr_b16 v[44:45], v1 offset:33664
    ds_read_b64_tr_b16 v[46:47], v1 offset:34304
    v_mfma_f32_32x32x16_bf16 v[80:95], v[24:27], a[244:247], v[80:95]
    ds_read_b64_tr_b16 v[48:49], v1 offset:33696
    ds_read_b64_tr_b16 v[50:51], v1 offset:34336
    v_mfma_f32_32x32x16_bf16 v[96:111], v[28:31], a[240:243], v[96:111]
    ds_read_b64_tr_b16 v[52:53], v1 offset:33728
    ds_read_b64_tr_b16 v[54:55], v1 offset:34368
    v_mfma_f32_32x32x16_bf16 v[112:127], v[28:31], a[244:247], v[112:127]
    ds_read_b64_tr_b16 v[56:57], v1 offset:33760
    ds_read_b64_tr_b16 v[58:59], v1 offset:34400
    v_mfma_f32_32x32x16_bf16 v[128:143], v[32:35], a[240:243], v[128:143]
    ds_read_b64_tr_b16 v[60:61], v1 offset:33792
    ds_read_b64_tr_b16 v[62:63], v1 offset:34432
    v_mfma_f32_32x32x16_bf16 v[144:159], v[32:35], a[244:247], v[144:159]
    v_mfma_f32_32x32x16_bf16 v[160:175], v[36:39], a[240:243], v[160:175]
    s_add_u32 m0, s55, 140032
    s_add_u32 s59, s46, 184320
    buffer_load_dwordx4 v10, s[24:27], s59 offen lds
    v_mfma_f32_32x32x16_bf16 v[176:191], v[36:39], a[244:247], v[176:191]
    s_add_u32 s58, s45, 1376256
    buffer_load_dwordx4 a[72:75], v11, s[16:19], s58 offen offset:0 sc1
    v_mfma_f32_32x32x16_bf16 v[192:207], v[40:43], a[240:243], v[192:207]
    buffer_load_dwordx4 a[76:79], v11, s[16:19], s58 offen offset:1024 sc1
    v_mfma_f32_32x32x16_bf16 v[208:223], v[40:43], a[244:247], v[208:223]
    s_add_u32 s58, s45, 1441792
    buffer_load_dwordx4 a[80:83], v11, s[16:19], s58 offen offset:0 sc1
    s_waitcnt vmcnt(34) lgkmcnt(0)
    s_barrier
    v_mfma_f32_32x32x16_bf16 v[64:79], v[44:47], a[248:251], v[64:79]
    ds_read_b64_tr_b16 v[24:25], v1 offset:41472
    ds_read_b64_tr_b16 v[26:27], v1 offset:42112
    v_mfma_f32_32x32x16_bf16 v[80:95], v[44:47], a[252:255], v[80:95]
    ds_read_b64_tr_b16 v[28:29], v1 offset:41504
    ds_read_b64_tr_b16 v[30:31], v1 offset:42144
    v_mfma_f32_32x32x16_bf16 v[96:111], v[48:51], a[248:251], v[96:111]
    ds_read_b64_tr_b16 v[32:33], v1 offset:41536
    ds_read_b64_tr_b16 v[34:35], v1 offset:42176
    v_mfma_f32_32x32x16_bf16 v[112:127], v[48:51], a[252:255], v[112:127]
    ds_read_b64_tr_b16 v[36:37], v1 offset:41568
    ds_read_b64_tr_b16 v[38:39], v1 offset:42208
    v_mfma_f32_32x32x16_bf16 v[128:143], v[52:55], a[248:251], v[128:143]
    ds_read_b64_tr_b16 v[40:41], v1 offset:41600
    ds_read_b64_tr_b16 v[42:43], v1 offset:42240
    v_mfma_f32_32x32x16_bf16 v[144:159], v[52:55], a[252:255], v[144:159]
    v_mfma_f32_32x32x16_bf16 v[160:175], v[56:59], a[248:251], v[160:175]
    s_add_u32 m0, s55, 144128
    s_add_u32 s59, s46, 294912
    buffer_load_dwordx4 v10, s[24:27], s59 offen lds
    v_mfma_f32_32x32x16_bf16 v[176:191], v[56:59], a[252:255], v[176:191]
    buffer_load_dwordx4 a[84:87], v11, s[16:19], s58 offen offset:1024 sc1
    v_mfma_f32_32x32x16_bf16 v[192:207], v[60:63], a[248:251], v[192:207]
    s_add_u32 s58, s45, 1507328
    buffer_load_dwordx4 a[88:91], v11, s[16:19], s58 offen offset:0 sc1
    v_mfma_f32_32x32x16_bf16 v[208:223], v[60:63], a[252:255], v[208:223]
    buffer_load_dwordx4 a[92:95], v11, s[16:19], s58 offen offset:1024 sc1
    s_waitcnt lgkmcnt(0)
    v_mfma_f32_32x32x16_bf16 v[64:79], v[24:27], v[224:227], v[64:79]
    ds_read_b64_tr_b16 v[44:45], v1 offset:44032
    ds_read_b64_tr_b16 v[46:47], v1 offset:44672
    v_mfma_f32_32x32x16_bf16 v[80:95], v[24:27], v[228:231], v[80:95]
    ds_read_b64_tr_b16 v[48:49], v1 offset:44064
    ds_read_b64_tr_b16 v[50:51], v1 offset:44704
    v_mfma_f32_32x32x16_bf16 v[96:111], v[28:31], v[224:227], v[96:111]
    ds_read_b64_tr_b16 v[52:53], v1 offset:44096
    ds_read_b64_tr_b16 v[54:55], v1 offset:44736
    v_mfma_f32_32x32x16_bf16 v[112:127], v[28:31], v[228:231], v[112:127]
    ds_read_b64_tr_b16 v[56:57], v1 offset:44128
    ds_read_b64_tr_b16 v[58:59], v1 offset:44768
    v_mfma_f32_32x32x16_bf16 v[128:143], v[32:35], v[224:227], v[128:143]
    ds_read_b64_tr_b16 v[60:61], v1 offset:44160
    ds_read_b64_tr_b16 v[62:63], v1 offset:44800
    v_mfma_f32_32x32x16_bf16 v[144:159], v[32:35], v[228:231], v[144:159]
    v_mfma_f32_32x32x16_bf16 v[160:175], v[36:39], v[224:227], v[160:175]
    s_add_u32 m0, s56, 57088
    s_nop 0
    buffer_load_dword v7, s[20:23], s74 offen offset:1024 lds
    v_mfma_f32_32x32x16_bf16 v[176:191], v[36:39], v[228:231], v[176:191]
    s_add_u32 m0, s55, 148224
    s_add_u32 s59, s46, 331776
    buffer_load_dwordx4 v10, s[24:27], s59 offen lds
    v_mfma_f32_32x32x16_bf16 v[192:207], v[40:43], v[224:227], v[192:207]
    s_add_u32 s58, s45, 1835008
    buffer_load_dwordx4 a[96:99], v11, s[16:19], s58 offen offset:0 sc1
    v_mfma_f32_32x32x16_bf16 v[208:223], v[40:43], v[228:231], v[208:223]
    buffer_load_dwordx4 a[100:103], v11, s[16:19], s58 offen offset:1024 sc1
    s_waitcnt vmcnt(3) lgkmcnt(0)
    s_barrier
    v_mfma_f32_32x32x16_bf16 v[64:79], v[44:47], v[232:235], v[64:79]
    ds_read_b64_tr_b16 v[24:25], v1 offset:51840
    ds_read_b64_tr_b16 v[26:27], v1 offset:52480
    v_mfma_f32_32x32x16_bf16 v[80:95], v[44:47], v[236:239], v[80:95]
    ds_read_b64_tr_b16 v[28:29], v1 offset:51872
    ds_read_b64_tr_b16 v[30:31], v1 offset:52512
    v_mfma_f32_32x32x16_bf16 v[96:111], v[48:51], v[232:235], v[96:111]
    ds_read_b64_tr_b16 v[32:33], v1 offset:51904
    ds_read_b64_tr_b16 v[34:35], v1 offset:52544
    v_mfma_f32_32x32x16_bf16 v[112:127], v[48:51], v[236:239], v[112:127]
    ds_read_b64_tr_b16 v[36:37], v1 offset:51936
    ds_read_b64_tr_b16 v[38:39], v1 offset:52576
    v_mfma_f32_32x32x16_bf16 v[128:143], v[52:55], v[232:235], v[128:143]
    ds_read_b64_tr_b16 v[40:41], v1 offset:51968
    ds_read_b64_tr_b16 v[42:43], v1 offset:52608
    v_mfma_f32_32x32x16_bf16 v[144:159], v[52:55], v[236:239], v[144:159]
    v_mfma_f32_32x32x16_bf16 v[160:175], v[56:59], v[232:235], v[160:175]
    s_add_u32 m0, s55, 152320
    s_add_u32 s59, s46, 442368
    buffer_load_dwordx4 v10, s[24:27], s59 offen lds
    v_mfma_f32_32x32x16_bf16 v[176:191], v[56:59], v[236:239], v[176:191]
    s_add_u32 s58, s45, 1900544
    buffer_load_dwordx4 a[104:107], v11, s[16:19], s58 offen offset:0 sc1
    v_mfma_f32_32x32x16_bf16 v[192:207], v[60:63], v[232:235], v[192:207]
    buffer_load_dwordx4 a[108:111], v11, s[16:19], s58 offen offset:1024 sc1
    v_mfma_f32_32x32x16_bf16 v[208:223], v[60:63], v[236:239], v[208:223]
    s_waitcnt lgkmcnt(0)
    v_mfma_f32_32x32x16_bf16 v[64:79], v[24:27], v[240:243], v[64:79]
    ds_read_b64_tr_b16 v[44:45], v1 offset:54400
    ds_read_b64_tr_b16 v[46:47], v1 offset:55040
    v_mfma_f32_32x32x16_bf16 v[80:95], v[24:27], v[244:247], v[80:95]
    ds_read_b64_tr_b16 v[48:49], v1 offset:54432
    ds_read_b64_tr_b16 v[50:51], v1 offset:55072
    v_mfma_f32_32x32x16_bf16 v[96:111], v[28:31], v[240:243], v[96:111]
    ds_read_b64_tr_b16 v[52:53], v1 offset:54464
    ds_read_b64_tr_b16 v[54:55], v1 offset:55104
    v_mfma_f32_32x32x16_bf16 v[112:127], v[28:31], v[244:247], v[112:127]
    ds_read_b64_tr_b16 v[56:57], v1 offset:54496
    ds_read_b64_tr_b16 v[58:59], v1 offset:55136
    v_mfma_f32_32x32x16_bf16 v[128:143], v[32:35], v[240:243], v[128:143]
    ds_read_b64_tr_b16 v[60:61], v1 offset:54528
    ds_read_b64_tr_b16 v[62:63], v1 offset:55168
    v_mfma_f32_32x32x16_bf16 v[144:159], v[32:35], v[244:247], v[144:159]
    v_mfma_f32_32x32x16_bf16 v[160:175], v[36:39], v[240:243], v[160:175]
    s_add_u32 m0, s55, 156416
    s_add_u32 s59, s46, 479232
    buffer_load_dwordx4 v10, s[24:27], s59 offen lds
    v_mfma_f32_32x32x16_bf16 v[176:191], v[36:39], v[244:247], v[176:191]
    s_add_u32 s58, s45, 1966080
    buffer_load_dwordx4 a[112:115], v11, s[16:19], s58 offen offset:0 sc1
    v_mfma_f32_32x32x16_bf16 v[192:207], v[40:43], v[240:243], v[192:207]
    buffer_load_dwordx4 a[116:119], v11, s[16:19], s58 offen offset:1024 sc1
    v_mfma_f32_32x32x16_bf16 v[208:223], v[40:43], v[244:247], v[208:223]
    s_waitcnt lgkmcnt(0)
    v_mfma_f32_32x32x16_bf16 v[64:79], v[44:47], v[248:251], v[64:79]
    v_mfma_f32_32x32x16_bf16 v[80:95], v[44:47], v[252:255], v[80:95]
    v_mfma_f32_32x32x16_bf16 v[96:111], v[48:51], v[248:251], v[96:111]
    v_mfma_f32_32x32x16_bf16 v[112:127], v[48:51], v[252:255], v[112:127]
    v_mfma_f32_32x32x16_bf16 v[128:143], v[52:55], v[248:251], v[128:143]
    v_mfma_f32_32x32x16_bf16 v[144:159], v[52:55], v[252:255], v[144:159]
    v_mfma_f32_32x32x16_bf16 v[160:175], v[56:59], v[248:251], v[160:175]
    s_add_u32 s58, s45, 2031616
    buffer_load_dwordx4 a[120:123], v11, s[16:19], s58 offen offset:0 sc1
    v_mfma_f32_32x32x16_bf16 v[176:191], v[56:59], v[252:255], v[176:191]
    buffer_load_dwordx4 a[124:127], v11, s[16:19], s58 offen offset:1024 sc1
    v_mfma_f32_32x32x16_bf16 v[192:207], v[60:63], v[248:251], v[192:207]
    v_mfma_f32_32x32x16_bf16 v[208:223], v[60:63], v[252:255], v[208:223]
    ds_read_b64_tr_b16 v[24:25], v2 offset:0
    ds_read_b64_tr_b16 v[26:27], v2 offset:2048
    ds_read_b64_tr_b16 v[28:29], v3 offset:0
    ds_read_b64_tr_b16 v[30:31], v3 offset:2048
    ds_read_b64_tr_b16 v[32:33], v2 offset:512
    ds_read_b64_tr_b16 v[34:35], v2 offset:2560
    ds_read_b64_tr_b16 v[36:37], v3 offset:512
    ds_read_b64_tr_b16 v[38:39], v3 offset:2560
    s_cmp_gt_u32 s48, 0
    s_cselect_b32 s50, 0, 4
    s_add_u32 s50, s50, s49
    s_lshl_b32 s50, s50, 16
    v_max_f32 v64, 0, v64
    v_max_f32 v65, 0, v65
    v_max_f32 v66, 0, v66
    v_max_f32 v67, 0, v67
    v_max_f32 v68, 0, v68
    v_max_f32 v69, 0, v69
    v_max_f32 v70, 0, v70
    v_max_f32 v71, 0, v71
    v_mul_f32 v64, v64, v72
    v_mul_f32 v65, v65, v73
    v_mul_f32 v66, v66, v74
    v_mul_f32 v67, v67, v75
    v_mul_f32 v68, v68, v76
    v_mul_f32 v69, v69, v77
    v_mul_f32 v70, v70, v78
    v_mul_f32 v71, v71, v79
    v_cvt_pk_bf16_f32 v72, v64, v65
    v_cvt_pk_bf16_f32 v73, v66, v67
    v_cvt_pk_bf16_f32 v74, v68, v69
    v_cvt_pk_bf16_f32 v75, v70, v71
    buffer_store_dwordx4 v[72:75], v11, s[16:19], s50 offen offset:0 sc0 sc1
    v_max_f32 v80, 0, v80
    v_max_f32 v81, 0, v81
    v_max_f32 v82, 0, v82
    v_max_f32 v83, 0, v83
    v_max_f32 v84, 0, v84
    v_max_f32 v85, 0, v85
    v_max_f32 v86, 0, v86
    v_max_f32 v87, 0, v87
    v_mul_f32 v80, v80, v88
    v_mul_f32 v81, v81, v89
    v_mul_f32 v82, v82, v90
    v_mul_f32 v83, v83, v91
    v_mul_f32 v84, v84, v92
    v_mul_f32 v85, v85, v93
    v_mul_f32 v86, v86, v94
    v_mul_f32 v87, v87, v95
    v_cvt_pk_bf16_f32 v88, v80, v81
    v_cvt_pk_bf16_f32 v89, v82, v83
    v_cvt_pk_bf16_f32 v90, v84, v85
    v_cvt_pk_bf16_f32 v91, v86, v87
    buffer_store_dwordx4 v[88:91], v11, s[16:19], s50 offen offset:1024 sc0 sc1
    s_cmp_gt_u32 s48, 1
    s_cselect_b32 s50, 1, 5
    s_add_u32 s50, s50, s49
    s_lshl_b32 s50, s50, 16
    v_max_f32 v96, 0, v96
    v_max_f32 v97, 0, v97
    v_max_f32 v98, 0, v98
    v_max_f32 v99, 0, v99
    v_max_f32 v100, 0, v100
    v_max_f32 v101, 0, v101
    v_max_f32 v102, 0, v102
    v_max_f32 v103, 0, v103
    v_mul_f32 v96, v96, v104
    v_mul_f32 v97, v97, v105
    v_mul_f32 v98, v98, v106
    v_mul_f32 v99, v99, v107
    v_mul_f32 v100, v100, v108
    v_mul_f32 v101, v101, v109
    v_mul_f32 v102, v102, v110
    v_mul_f32 v103, v103, v111
    v_cvt_pk_bf16_f32 v104, v96, v97
    v_cvt_pk_bf16_f32 v105, v98, v99
    v_cvt_pk_bf16_f32 v106, v100, v101
    v_cvt_pk_bf16_f32 v107, v102, v103
    buffer_store_dwordx4 v[104:107], v11, s[16:19], s50 offen offset:0 sc0 sc1
    v_max_f32 v112, 0, v112
    v_max_f32 v113, 0, v113
    v_max_f32 v114, 0, v114
    v_max_f32 v115, 0, v115
    v_max_f32 v116, 0, v116
    v_max_f32 v117, 0, v117
    v_max_f32 v118, 0, v118
    v_max_f32 v119, 0, v119
    v_mul_f32 v112, v112, v120
    v_mul_f32 v113, v113, v121
    v_mul_f32 v114, v114, v122
    v_mul_f32 v115, v115, v123
    v_mul_f32 v116, v116, v124
    v_mul_f32 v117, v117, v125
    v_mul_f32 v118, v118, v126
    v_mul_f32 v119, v119, v127
    v_cvt_pk_bf16_f32 v120, v112, v113
    v_cvt_pk_bf16_f32 v121, v114, v115
    v_cvt_pk_bf16_f32 v122, v116, v117
    v_cvt_pk_bf16_f32 v123, v118, v119
    buffer_store_dwordx4 v[120:123], v11, s[16:19], s50 offen offset:1024 sc0 sc1
    s_waitcnt lgkmcnt(0)
    v_mfma_f32_32x32x16_bf16 v[64:79], v[24:27], a[0:3], 0
    ds_read_b64_tr_b16 v[40:41], v2 offset:4096
    ds_read_b64_tr_b16 v[42:43], v2 offset:6144
    s_cmp_gt_u32 s48, 2
    s_cselect_b32 s50, 2, 6
    s_add_u32 s50, s50, s49
    v_mfma_f32_32x32x16_bf16 v[80:95], v[24:27], a[4:7], 0
    ds_read_b64_tr_b16 v[44:45], v3 offset:4096
    ds_read_b64_tr_b16 v[46:47], v3 offset:6144
    s_lshl_b32 s50, s50, 16
    v_max_f32 v128, 0, v128
    v_max_f32 v129, 0, v129
    v_mfma_f32_32x32x16_bf16 v[96:111], v[28:31], a[0:3], 0
    ds_read_b64_tr_b16 v[48:49], v2 offset:4608
    ds_read_b64_tr_b16 v[50:51], v2 offset:6656
    v_max_f32 v130, 0, v130
    v_max_f32 v131, 0, v131
    v_max_f32 v132, 0, v132
    v_mfma_f32_32x32x16_bf16 v[112:127], v[28:31], a[4:7], 0
    ds_read_b64_tr_b16 v[52:53], v3 offset:4608
    ds_read_b64_tr_b16 v[54:55], v3 offset:6656
    v_max_f32 v133, 0, v133
    v_max_f32 v134, 0, v134
    v_max_f32 v135, 0, v135
    v_mfma_f32_32x32x16_bf16 v[64:79], v[32:35], a[8:11], v[64:79]
    v_mul_f32 v128, v128, v136
    v_mul_f32 v129, v129, v137
    v_mul_f32 v130, v130, v138
    v_mul_f32 v131, v131, v139
    v_mul_f32 v132, v132, v140
    v_mfma_f32_32x32x16_bf16 v[80:95], v[32:35], a[12:15], v[80:95]
    v_mul_f32 v133, v133, v141
    v_mul_f32 v134, v134, v142
    v_mul_f32 v135, v135, v143
    v_cvt_pk_bf16_f32 v136, v128, v129
    v_cvt_pk_bf16_f32 v137, v130, v131
    v_mfma_f32_32x32x16_bf16 v[96:111], v[36:39], a[8:11], v[96:111]
    v_cvt_pk_bf16_f32 v138, v132, v133
    v_cvt_pk_bf16_f32 v139, v134, v135
    buffer_store_dwordx4 v[136:139], v11, s[16:19], s50 offen offset:0 sc0 sc1
    v_mfma_f32_32x32x16_bf16 v[112:127], v[36:39], a[12:15], v[112:127]
    s_waitcnt lgkmcnt(0)
    s_barrier
    v_mfma_f32_32x32x16_bf16 v[64:79], v[40:43], a[16:19], v[64:79]
    ds_read_b64_tr_b16 v[24:25], v2 offset:8192
    ds_read_b64_tr_b16 v[26:27], v2 offset:10240
    v_max_f32 v144, 0, v144
    v_max_f32 v145, 0, v145
    v_max_f32 v146, 0, v146
    v_max_f32 v147, 0, v147
    v_mfma_f32_32x32x16_bf16 v[80:95], v[40:43], a[20:23], v[80:95]
    ds_read_b64_tr_b16 v[28:29], v3 offset:8192
    ds_read_b64_tr_b16 v[30:31], v3 offset:10240
    v_max_f32 v148, 0, v148
    v_max_f32 v149, 0, v149
    v_max_f32 v150, 0, v150
    v_max_f32 v151, 0, v151
    v_mfma_f32_32x32x16_bf16 v[96:111], v[44:47], a[16:19], v[96:111]
    ds_read_b64_tr_b16 v[32:33], v2 offset:8704
    ds_read_b64_tr_b16 v[34:35], v2 offset:10752
    v_mul_f32 v144, v144, v152
    v_mul_f32 v145, v145, v153
    v_mul_f32 v146, v146, v154
    v_mul_f32 v147, v147, v155
    v_mfma_f32_32x32x16_bf16 v[112:127], v[44:47], a[20:23], v[112:127]
    ds_read_b64_tr_b16 v[36:37], v3 offset:8704
    ds_read_b64_tr_b16 v[38:39], v3 offset:10752
    v_mul_f32 v148, v148, v156
    v_mul_f32 v149, v149, v157
    v_mul_f32 v150, v150, v158
    v_mul_f32 v151, v151, v159
    v_mfma_f32_32x32x16_bf16 v[64:79], v[48:51], a[24:27], v[64:79]
    s_add_u32 m0, s55, 62208
    s_add_u32 s59, s46, 589824
    buffer_load_dwordx4 v10, s[24:27], s59 offen lds
    v_cvt_pk_bf16_f32 v152, v144, v145
    v_mfma_f32_32x32x16_bf16 v[80:95], v[48:51], a[28:31], v[80:95]
    s_add_u32 m0, s55, 66304
    s_add_u32 s59, s46, 626688
    buffer_load_dwordx4 v10, s[24:27], s59 offen lds
    v_cvt_pk_bf16_f32 v153, v146, v147
    v_mfma_f32_32x32x16_bf16 v[96:111], v[52:55], a[24:27], v[96:111]
    v_cvt_pk_bf16_f32 v154, v148, v149
    v_cvt_pk_bf16_f32 v155, v150, v151
    buffer_store_dwordx4 v[152:155], v11, s[16:19], s50 offen offset:1024 sc0 sc1
    v_mfma_f32_32x32x16_bf16 v[112:127], v[52:55], a[28:31], v[112:127]
    s_cmp_gt_u32 s48, 3
    s_cselect_b32 s50, 3, 7
    s_add_u32 s50, s50, s49
    s_lshl_b32 s50, s50, 16
    s_waitcnt lgkmcnt(0)
    v_mfma_f32_32x32x16_bf16 v[64:79], v[24:27], a[32:35], v[64:79]
    ds_read_b64_tr_b16 v[40:41], v2 offset:12288
    ds_read_b64_tr_b16 v[42:43], v2 offset:14336
    v_max_f32 v160, 0, v160
    v_max_f32 v161, 0, v161
    v_max_f32 v162, 0, v162
    v_mfma_f32_32x32x16_bf16 v[80:95], v[24:27], a[36:39], v[80:95]
    ds_read_b64_tr_b16 v[44:45], v3 offset:12288
    ds_read_b64_tr_b16 v[46:47], v3 offset:14336
    v_max_f32 v163, 0, v163
    v_max_f32 v164, 0, v164
    v_max_f32 v165, 0, v165
    v_mfma_f32_32x32x16_bf16 v[96:111], v[28:31], a[32:35], v[96:111]
    ds_read_b64_tr_b16 v[48:49], v2 offset:12800
    ds_read_b64_tr_b16 v[50:51], v2 offset:14848
    v_max_f32 v166, 0, v166
    v_max_f32 v167, 0, v167
    v_mul_f32 v160, v160, v168
    v_mfma_f32_32x32x16_bf16 v[112:127], v[28:31], a[36:39], v[112:127]
    ds_read_b64_tr_b16 v[52:53], v3 offset:12800
    ds_read_b64_tr_b16 v[54:55], v3 offset:14848
    v_mul_f32 v161, v161, v169
    v_mul_f32 v162, v162, v170
    v_mul_f32 v163, v163, v171
    v_mfma_f32_32x32x16_bf16 v[64:79], v[32:35], a[40:43], v[64:79]
    v_mul_f32 v164, v164, v172
    v_mul_f32 v165, v165, v173
    v_mul_f32 v166, v166, v174
    v_mul_f32 v167, v167, v175
    v_cvt_pk_bf16_f32 v168, v160, v161
    v_mfma_f32_32x32x16_bf16 v[80:95], v[32:35], a[44:47], v[80:95]
    v_cvt_pk_bf16_f32 v169, v162, v163
    v_cvt_pk_bf16_f32 v170, v164, v165
    v_cvt_pk_bf16_f32 v171, v166, v167
    v_mfma_f32_32x32x16_bf16 v[96:111], v[36:39], a[40:43], v[96:111]
    buffer_store_dwordx4 v[168:171], v11, s[16:19], s50 offen offset:0 sc0 sc1
    v_max_f32 v176, 0, v176
    v_max_f32 v177, 0, v177
    v_mfma_f32_32x32x16_bf16 v[112:127], v[36:39], a[44:47], v[112:127]
    v_max_f32 v178, 0, v178
    s_waitcnt lgkmcnt(0)
    s_barrier
    v_mfma_f32_32x32x16_bf16 v[64:79], v[40:43], a[48:51], v[64:79]
    ds_read_b64_tr_b16 v[24:25], v2 offset:16384
    ds_read_b64_tr_b16 v[26:27], v2 offset:18432
    v_max_f32 v179, 0, v179
    v_max_f32 v180, 0, v180
    v_max_f32 v181, 0, v181
    v_max_f32 v182, 0, v182
    v_mfma_f32_32x32x16_bf16 v[80:95], v[40:43], a[52:55], v[80:95]
    ds_read_b64_tr_b16 v[28:29], v3 offset:16384
    ds_read_b64_tr_b16 v[30:31], v3 offset:18432
    v_max_f32 v183, 0, v183
    v_mul_f32 v176, v176, v184
    v_mul_f32 v177, v177, v185
    v_mul_f32 v178, v178, v186
    v_mfma_f32_32x32x16_bf16 v[96:111], v[44:47], a[48:51], v[96:111]
    ds_read_b64_tr_b16 v[32:33], v2 offset:16896
    ds_read_b64_tr_b16 v[34:35], v2 offset:18944
    v_mul_f32 v179, v179, v187
    v_mul_f32 v180, v180, v188
    v_mul_f32 v181, v181, v189
    v_mul_f32 v182, v182, v190
    v_mfma_f32_32x32x16_bf16 v[112:127], v[44:47], a[52:55], v[112:127]
    ds_read_b64_tr_b16 v[36:37], v3 offset:16896
    ds_read_b64_tr_b16 v[38:39], v3 offset:18944
    v_mul_f32 v183, v183, v191
    v_cvt_pk_bf16_f32 v184, v176, v177
    v_cvt_pk_bf16_f32 v185, v178, v179
    v_cvt_pk_bf16_f32 v186, v180, v181
    v_mfma_f32_32x32x16_bf16 v[64:79], v[48:51], a[56:59], v[64:79]
    s_add_u32 m0, s55, 70400
    s_add_u32 s59, s46, 73856
    buffer_load_dwordx4 v10, s[24:27], s59 offen lds
    v_cvt_pk_bf16_f32 v187, v182, v183
    v_mfma_f32_32x32x16_bf16 v[80:95], v[48:51], a[60:63], v[80:95]
    s_add_u32 m0, s55, 74496
    s_add_u32 s59, s46, 110720
    buffer_load_dwordx4 v10, s[24:27], s59 offen lds
    v_mfma_f32_32x32x16_bf16 v[96:111], v[52:55], a[56:59], v[96:111]
    buffer_store_dwordx4 v[184:187], v11, s[16:19], s50 offen offset:1024 sc0 sc1
    s_cmp_gt_u32 s48, 4
    s_cselect_b32 s50, 4, 8
    s_add_u32 s50, s50, s49
    v_mfma_f32_32x32x16_bf16 v[112:127], v[52:55], a[60:63], v[112:127]
    s_lshl_b32 s50, s50, 16
    v_max_f32 v192, 0, v192
    v_max_f32 v193, 0, v193
    v_max_f32 v194, 0, v194
    s_waitcnt lgkmcnt(0)
    v_mfma_f32_32x32x16_bf16 v[128:143], v[24:27], a[0:3], 0
    ds_read_b64_tr_b16 v[40:41], v2 offset:20480
    ds_read_b64_tr_b16 v[42:43], v2 offset:22528
    v_max_f32 v195, 0, v195
    v_max_f32 v196, 0, v196
    v_max_f32 v197, 0, v197
    v_mfma_f32_32x32x16_bf16 v[144:159], v[24:27], a[4:7], 0
    ds_read_b64_tr_b16 v[44:45], v3 offset:20480
    ds_read_b64_tr_b16 v[46:47], v3 offset:22528
    v_max_f32 v198, 0, v198
    v_max_f32 v199, 0, v199
    v_mul_f32 v192, v192, v200
    v_mfma_f32_32x32x16_bf16 v[160:175], v[28:31], a[0:3], 0
    ds_read_b64_tr_b16 v[48:49], v2 offset:20992
    ds_read_b64_tr_b16 v[50:51], v2 offset:23040
    v_mul_f32 v193, v193, v201
    v_mul_f32 v194, v194, v202
    v_mul_f32 v195, v195, v203
    v_mfma_f32_32x32x16_bf16 v[176:191], v[28:31], a[4:7], 0
    ds_read_b64_tr_b16 v[52:53], v3 offset:20992
    ds_read_b64_tr_b16 v[54:55], v3 offset:23040
    v_mul_f32 v196, v196, v204
    v_mul_f32 v197, v197, v205
    v_mul_f32 v198, v198, v206
    v_mfma_f32_32x32x16_bf16 v[128:143], v[32:35], a[8:11], v[128:143]
    v_mul_f32 v199, v199, v207
    v_cvt_pk_bf16_f32 v200, v192, v193
    v_cvt_pk_bf16_f32 v201, v194, v195
    v_cvt_pk_bf16_f32 v202, v196, v197
    v_cvt_pk_bf16_f32 v203, v198, v199
    v_mfma_f32_32x32x16_bf16 v[144:159], v[32:35], a[12:15], v[144:159]
    buffer_store_dwordx4 v[200:203], v11, s[16:19], s50 offen offset:0 sc0 sc1
    v_max_f32 v208, 0, v208
    v_max_f32 v209, 0, v209
    v_mfma_f32_32x32x16_bf16 v[160:175], v[36:39], a[8:11], v[160:175]
    v_max_f32 v210, 0, v210
    v_max_f32 v211, 0, v211
    v_max_f32 v212, 0, v212
    v_max_f32 v213, 0, v213
    v_mfma_f32_32x32x16_bf16 v[176:191], v[36:39], a[12:15], v[176:191]
    s_waitcnt lgkmcnt(0)
    s_barrier
    v_mfma_f32_32x32x16_bf16 v[128:143], v[40:43], a[16:19], v[128:143]
    ds_read_b64_tr_b16 v[24:25], v2 offset:24576
    ds_read_b64_tr_b16 v[26:27], v2 offset:26624
    v_max_f32 v214, 0, v214
    v_max_f32 v215, 0, v215
    v_mul_f32 v208, v208, v216
    v_mfma_f32_32x32x16_bf16 v[144:159], v[40:43], a[20:23], v[144:159]
    ds_read_b64_tr_b16 v[28:29], v3 offset:24576
    ds_read_b64_tr_b16 v[30:31], v3 offset:26624
    v_mul_f32 v209, v209, v217
    v_mul_f32 v210, v210, v218
    v_mul_f32 v211, v211, v219
    v_mfma_f32_32x32x16_bf16 v[160:175], v[44:47], a[16:19], v[160:175]
    ds_read_b64_tr_b16 v[32:33], v2 offset:25088
    ds_read_b64_tr_b16 v[34:35], v2 offset:27136
    v_mul_f32 v212, v212, v220
    v_mul_f32 v213, v213, v221
    v_mul_f32 v214, v214, v222
    v_mfma_f32_32x32x16_bf16 v[176:191], v[44:47], a[20:23], v[176:191]
    ds_read_b64_tr_b16 v[36:37], v3 offset:25088
    ds_read_b64_tr_b16 v[38:39], v3 offset:27136
    v_mul_f32 v215, v215, v223
    v_cvt_pk_bf16_f32 v216, v208, v209
    v_cvt_pk_bf16_f32 v217, v210, v211
    v_mfma_f32_32x32x16_bf16 v[128:143], v[48:51], a[24:27], v[128:143]
    s_add_u32 m0, s55, 78592
    s_add_u32 s59, s46, 147584
    buffer_load_dwordx4 v10, s[24:27], s59 offen lds
    v_mfma_f32_32x32x16_bf16 v[144:159], v[48:51], a[28:31], v[144:159]
    s_add_u32 m0, s55, 82688
    s_add_u32 s59, s46, 184448
    buffer_load_dwordx4 v10, s[24:27], s59 offen lds
    v_mfma_f32_32x32x16_bf16 v[160:175], v[52:55], a[24:27], v[160:175]
    v_cvt_pk_bf16_f32 v218, v212, v213
    v_cvt_pk_bf16_f32 v219, v214, v215
    buffer_store_dwordx4 v[216:219], v11, s[16:19], s50 offen offset:1024 sc0 sc1
    v_mfma_f32_32x32x16_bf16 v[176:191], v[52:55], a[28:31], v[176:191]
    s_waitcnt lgkmcnt(0)
    v_mfma_f32_32x32x16_bf16 v[128:143], v[24:27], a[32:35], v[128:143]
    ds_read_b64_tr_b16 v[40:41], v2 offset:28672
    ds_read_b64_tr_b16 v[42:43], v2 offset:30720
    v_mfma_f32_32x32x16_bf16 v[144:159], v[24:27], a[36:39], v[144:159]
    ds_read_b64_tr_b16 v[44:45], v3 offset:28672
    ds_read_b64_tr_b16 v[46:47], v3 offset:30720
    v_mfma_f32_32x32x16_bf16 v[160:175], v[28:31], a[32:35], v[160:175]
    ds_read_b64_tr_b16 v[48:49], v2 offset:29184
    ds_read_b64_tr_b16 v[50:51], v2 offset:31232
    v_mfma_f32_32x32x16_bf16 v[176:191], v[28:31], a[36:39], v[176:191]
    ds_read_b64_tr_b16 v[52:53], v3 offset:29184
    ds_read_b64_tr_b16 v[54:55], v3 offset:31232
    v_mfma_f32_32x32x16_bf16 v[128:143], v[32:35], a[40:43], v[128:143]
    v_mfma_f32_32x32x16_bf16 v[144:159], v[32:35], a[44:47], v[144:159]
    v_mfma_f32_32x32x16_bf16 v[160:175], v[36:39], a[40:43], v[160:175]
    v_mfma_f32_32x32x16_bf16 v[176:191], v[36:39], a[44:47], v[176:191]
    s_waitcnt vmcnt(0) lgkmcnt(0)
    s_barrier
    v_mov_b32 v22, 2
    v_min_u32 v23, 1, v0
    v_lshlrev_b32 v23, 30, v23
    buffer_store_dword v22, v23, s[16:19], s60 offen sc0 sc1
    v_mfma_f32_32x32x16_bf16 v[128:143], v[40:43], a[48:51], v[128:143]
    ds_read_b64_tr_b16 v[24:25], v2 offset:32768
    ds_read_b64_tr_b16 v[26:27], v2 offset:34816
    v_mfma_f32_32x32x16_bf16 v[144:159], v[40:43], a[52:55], v[144:159]
    ds_read_b64_tr_b16 v[28:29], v3 offset:32768
    ds_read_b64_tr_b16 v[30:31], v3 offset:34816
    v_mfma_f32_32x32x16_bf16 v[160:175], v[44:47], a[48:51], v[160:175]
    ds_read_b64_tr_b16 v[32:33], v2 offset:33280
    ds_read_b64_tr_b16 v[34:35], v2 offset:35328
    v_mfma_f32_32x32x16_bf16 v[176:191], v[44:47], a[52:55], v[176:191]
    ds_read_b64_tr_b16 v[36:37], v3 offset:33280
    ds_read_b64_tr_b16 v[38:39], v3 offset:35328
    v_mfma_f32_32x32x16_bf16 v[128:143], v[48:51], a[56:59], v[128:143]
    s_add_u32 m0, s55, 86784
    s_add_u32 s59, s46, 295040
    buffer_load_dwordx4 v10, s[24:27], s59 offen lds
    v_mfma_f32_32x32x16_bf16 v[144:159], v[48:51], a[60:63], v[144:159]
    s_add_u32 m0, s55, 90880
    s_add_u32 s59, s46, 331904
    buffer_load_dwordx4 v10, s[24:27], s59 offen lds
    v_mfma_f32_32x32x16_bf16 v[160:175], v[52:55], a[56:59], v[160:175]
    v_mfma_f32_32x32x16_bf16 v[176:191], v[52:55], a[60:63], v[176:191]
    s_waitcnt lgkmcnt(0)
    v_mfma_f32_32x32x16_bf16 v[128:143], v[24:27], a[64:67], v[128:143]
    ds_read_b64_tr_b16 v[40:41], v2 offset:36864
    ds_read_b64_tr_b16 v[42:43], v2 offset:38912
    v_mfma_f32_32x32x16_bf16 v[144:159], v[24:27], a[68:71], v[144:159]
    ds_read_b64_tr_b16 v[44:45], v3 offset:36864
    ds_read_b64_tr_b16 v[46:47], v3 offset:38912
    v_mfma_f32_32x32x16_bf16 v[160:175], v[28:31], a[64:67], v[160:175]
    ds_read_b64_tr_b16 v[48:49], v2 offset:37376
    ds_read_b64_tr_b16 v[50:51], v2 offset:39424
    v_mfma_f32_32x32x16_bf16 v[176:191], v[28:31], a[68:71], v[176:191]
    ds_read_b64_tr_b16 v[52:53], v3 offset:37376
    ds_read_b64_tr_b16 v[54:55], v3 offset:39424
    v_mfma_f32_32x32x16_bf16 v[128:143], v[32:35], a[72:75], v[128:143]
    v_mfma_f32_32x32x16_bf16 v[144:159], v[32:35], a[76:79], v[144:159]
    v_mfma_f32_32x32x16_bf16 v[160:175], v[36:39], a[72:75], v[160:175]
    v_mfma_f32_32x32x16_bf16 v[176:191], v[36:39], a[76:79], v[176:191]
    s_waitcnt lgkmcnt(0)
    s_barrier
    v_mfma_f32_32x32x16_bf16 v[128:143], v[40:43], a[80:83], v[128:143]
    ds_read_b64_tr_b16 v[24:25], v2 offset:40960
    ds_read_b64_tr_b16 v[26:27], v2 offset:43008
    v_mfma_f32_32x32x16_bf16 v[144:159], v[40:43], a[84:87], v[144:159]
    ds_read_b64_tr_b16 v[28:29], v3 offset:40960
    ds_read_b64_tr_b16 v[30:31], v3 offset:43008
    v_mfma_f32_32x32x16_bf16 v[160:175], v[44:47], a[80:83], v[160:175]
    ds_read_b64_tr_b16 v[32:33], v2 offset:41472
    ds_read_b64_tr_b16 v[34:35], v2 offset:43520
    v_mfma_f32_32x32x16_bf16 v[176:191], v[44:47], a[84:87], v[176:191]
    ds_read_b64_tr_b16 v[36:37], v3 offset:41472
    ds_read_b64_tr_b16 v[38:39], v3 offset:43520
    v_mfma_f32_32x32x16_bf16 v[128:143], v[48:51], a[88:91], v[128:143]
    buffer_load_dword v15, v12, s[16:19], s75 offen sc0 sc1
    v_mfma_f32_32x32x16_bf16 v[144:159], v[48:51], a[92:95], v[144:159]
    s_add_u32 m0, s55, 94976
    s_add_u32 s59, s46, 442496
    buffer_load_dwordx4 v10, s[24:27], s59 offen lds
    v_mfma_f32_32x32x16_bf16 v[160:175], v[52:55], a[88:91], v[160:175]
    s_add_u32 m0, s55, 99072
    s_add_u32 s59, s46, 479360
    buffer_load_dwordx4 v10, s[24:27], s59 offen lds
    v_mfma_f32_32x32x16_bf16 v[176:191], v[52:55], a[92:95], v[176:191]
    s_waitcnt lgkmcnt(0)
    v_mfma_f32_32x32x16_bf16 v[128:143], v[24:27], a[96:99], v[128:143]
    ds_read_b64_tr_b16 v[40:41], v2 offset:45056
    ds_read_b64_tr_b16 v[42:43], v2 offset:47104
    v_and_b32 v250, 31, v0
    v_add_u32 v250, s66, v250
    v_mfma_f32_32x32x16_bf16 v[144:159], v[24:27], a[100:103], v[144:159]
    ds_read_b64_tr_b16 v[44:45], v3 offset:45056
    ds_read_b64_tr_b16 v[46:47], v3 offset:47104
    v_cvt_f32_u32 v250, v250
    v_mul_f32 v250, 0x3ae38e39, v250
    v_mfma_f32_32x32x16_bf16 v[160:175], v[28:31], a[96:99], v[160:175]
    ds_read_b64_tr_b16 v[48:49], v2 offset:45568
    ds_read_b64_tr_b16 v[50:51], v2 offset:47616
    v_lshrrev_b32 v251, 5, v0
    v_cvt_f32_u32 v251, v251
    v_mfma_f32_32x32x16_bf16 v[176:191], v[28:31], a[100:103], v[176:191]
    ds_read_b64_tr_b16 v[52:53], v3 offset:45568
    ds_read_b64_tr_b16 v[54:55], v3 offset:47616
    v_mul_f32 v251, 0x41800000, v251
    v_mul_f32 v251, v251, v250
    v_mfma_f32_32x32x16_bf16 v[128:143], v[32:35], a[104:107], v[128:143]
    v_mul_f32 v248, 4.0, v250
    v_mul_f32 v249, 0x42000000, v250
    v_cos_f32 v248, v248
    v_mfma_f32_32x32x16_bf16 v[144:159], v[32:35], a[108:111], v[144:159]
    v_cos_f32 v249, v249
    v_add_f32 v248, v248, v248
    v_add_f32 v249, v249, v249
    v_mfma_f32_32x32x16_bf16 v[160:175], v[36:39], a[104:107], v[160:175]
    v_mfma_f32_32x32x16_bf16 v[176:191], v[36:39], a[108:111], v[176:191]
    s_waitcnt lgkmcnt(0)
    s_barrier
    v_mfma_f32_32x32x16_bf16 v[128:143], v[40:43], a[112:115], v[128:143]
    ds_read_b64_tr_b16 v[24:25], v4 offset:0
    ds_read_b64_tr_b16 v[26:27], v4 offset:2048
    s_min_u32 s3, s36, 2
    s_mul_i32 s3, s3, 19456
    v_add_u32 v17, s3, v14
    v_fmamk_f32 v242, v250, 0x0, v251
    v_mfma_f32_32x32x16_bf16 v[144:159], v[40:43], a[116:119], v[144:159]
    ds_read_b64_tr_b16 v[28:29], v5 offset:0
    ds_read_b64_tr_b16 v[30:31], v5 offset:2048
    v_cos_f32 v240, v242
    v_sin_f32 v242, v242
    v_mfma_f32_32x32x16_bf16 v[160:175], v[44:47], a[112:115], v[160:175]
    ds_read_b64_tr_b16 v[32:33], v4 offset:512
    ds_read_b64_tr_b16 v[34:35], v4 offset:2560
    v_add_f32 v240, v240, v240
    v_mul_f32 v242, -2.0, v242
    v_fmamk_f32 v243, v250, 0xc2000000, v251
    v_mfma_f32_32x32x16_bf16 v[176:191], v[44:47], a[116:119], v[176:191]
    ds_read_b64_tr_b16 v[36:37], v5 offset:512
    ds_read_b64_tr_b16 v[38:39], v5 offset:2560
    v_cos_f32 v241, v243
    v_sin_f32 v243, v243
    v_mfma_f32_32x32x16_bf16 v[128:143], v[48:51], a[120:123], v[128:143]
    s_add_u32 m0, s55, 103168
    s_add_u32 s59, s46, 589952
    buffer_load_dwordx4 v10, s[24:27], s59 offen lds
    v_add_f32 v241, v241, v241
    v_mfma_f32_32x32x16_bf16 v[144:159], v[48:51], a[124:127], v[144:159]
    s_add_u32 m0, s55, 107264
    s_add_u32 s59, s46, 626816
    buffer_load_dwordx4 v10, s[24:27], s59 offen lds
    v_mul_f32 v243, -2.0, v243
    v_mfma_f32_32x32x16_bf16 v[160:175], v[52:55], a[120:123], v[160:175]
    v_fmamk_f32 v246, v250, 0x40800000, v251
    v_cos_f32 v244, v246
    v_sin_f32 v246, v246
    v_mfma_f32_32x32x16_bf16 v[176:191], v[52:55], a[124:127], v[176:191]
    s_waitcnt vmcnt(4)
    s_mov_b32 s62, 0
L_pw2:
    v_cmp_le_u32 vcc, 2, v15
    s_nop 0
    s_and_b32 s3, vcc_lo, s68
    s_cmp_eq_u32 s3, s68
    s_cbranch_scc1 L_pok2
    s_add_u32 s62, s62, 1
    s_cmp_ge_u32 s62, 100000
    s_cbranch_scc1 L_pok2
    s_sleep 1
    buffer_load_dword v15, v12, s[16:19], s75 offen sc0 sc1
    s_waitcnt vmcnt(0)
    s_branch L_pw2
L_pok2:
    s_waitcnt lgkmcnt(0)
    v_mfma_f32_32x32x16_bf16 v[64:79], v[24:27], a[64:67], v[64:79]
    ds_read_b64_tr_b16 v[40:41], v4 offset:4096
    ds_read_b64_tr_b16 v[42:43], v4 offset:6144
    v_add_f32 v244, v244, v244
    v_mul_f32 v246, -2.0, v246
    v_fmamk_f32 v247, v250, 0xc1e00000, v251
    v_mfma_f32_32x32x16_bf16 v[80:95], v[24:27], a[68:71], v[80:95]
    ds_read_b64_tr_b16 v[44:45], v5 offset:4096
    ds_read_b64_tr_b16 v[46:47], v5 offset:6144
    v_cos_f32 v245, v247
    v_sin_f32 v247, v247
    v_mfma_f32_32x32x16_bf16 v[96:111], v[28:31], a[64:67], v[96:111]
    ds_read_b64_tr_b16 v[48:49], v4 offset:4608
    ds_read_b64_tr_b16 v[50:51], v4 offset:6656
    v_add_f32 v245, v245, v245
    v_mul_f32 v247, -2.0, v247
    v_fma_f32 v252, v248, v244, -v240
    v_fma_f32 v253, v248, v246, -v242
    v_mfma_f32_32x32x16_bf16 v[112:127], v[28:31], a[68:71], v[112:127]
    ds_read_b64_tr_b16 v[52:53], v5 offset:4608
    ds_read_b64_tr_b16 v[54:55], v5 offset:6656
    v_cvt_pk_bf16_f32 v236, v240, v242
    v_cvt_pk_bf16_f32 v237, v244, v246
    v_fma_f32 v254, v248, v252, -v244
    v_fma_f32 v255, v248, v253, -v246
    v_mfma_f32_32x32x16_bf16 v[64:79], v[32:35], a[72:75], v[64:79]
    s_add_u32 s58, s45, 262144
    buffer_load_dwordx4 a[128:131], v11, s[16:19], s58 offen offset:0 sc1
    v_cvt_pk_bf16_f32 v238, v252, v253
    v_mfma_f32_32x32x16_bf16 v[80:95], v[32:35], a[76:79], v[80:95]
    buffer_load_dwordx4 a[132:135], v11, s[16:19], s58 offen offset:1024 sc1
    v_mfma_f32_32x32x16_bf16 v[96:111], v[36:39], a[72:75], v[96:111]
    s_add_u32 s58, s45, 327680
    buffer_load_dwordx4 a[136:139], v11, s[16:19], s58 offen offset:0 sc1
    v_mfma_f32_32x32x16_bf16 v[112:127], v[36:39], a[76:79], v[112:127]
    buffer_load_dwordx4 a[140:143], v11, s[16:19], s58 offen offset:1024 sc1
    s_waitcnt lgkmcnt(0)
    s_barrier
    v_mfma_f32_32x32x16_bf16 v[64:79], v[40:43], a[80:83], v[64:79]
    ds_read_b64_tr_b16 v[24:25], v4 offset:8192
    ds_read_b64_tr_b16 v[26:27], v4 offset:10240
    v_mov_b32 v252, 0x3f80
    v_cvt_pk_bf16_f32 v239, v254, v255
    v_cmp_gt_u32 vcc, 32, v0
    s_nop 1
    v_cndmask_b32 v236, v236, v252, vcc
    v_mfma_f32_32x32x16_bf16 v[80:95], v[40:43], a[84:87], v[80:95]
    ds_read_b64_tr_b16 v[28:29], v5 offset:8192
    ds_read_b64_tr_b16 v[30:31], v5 offset:10240
    ds_write_b128 v17, v[236:239] offset:0
    v_fma_f32 v241, v249, v240, -v241
    v_mfma_f32_32x32x16_bf16 v[96:111], v[44:47], a[80:83], v[96:111]
    ds_read_b64_tr_b16 v[32:33], v4 offset:8704
    ds_read_b64_tr_b16 v[34:35], v4 offset:10752
    v_fma_f32 v243, v249, v242, -v243
    v_fma_f32 v245, v249, v244, -v245
    v_fma_f32 v247, v249, v246, -v247
    v_fma_f32 v252, v248, v245, -v241
    v_mfma_f32_32x32x16_bf16 v[112:127], v[44:47], a[84:87], v[112:127]
    ds_read_b64_tr_b16 v[36:37], v5 offset:8704
    ds_read_b64_tr_b16 v[38:39], v5 offset:10752
    v_fma_f32 v253, v248, v247, -v243
    v_cvt_pk_bf16_f32 v236, v241, v243
    v_cvt_pk_bf16_f32 v237, v245, v247
    v_fma_f32 v254, v248, v252, -v245
    v_mfma_f32_32x32x16_bf16 v[64:79], v[48:51], a[88:91], v[64:79]
    s_add_u32 s58, s45, 393216
    buffer_load_dwordx4 a[144:147], v11, s[16:19], s58 offen offset:0 sc1
    v_fma_f32 v255, v248, v253, -v247
    v_mfma_f32_32x32x16_bf16 v[80:95], v[48:51], a[92:95], v[80:95]
    buffer_load_dwordx4 a[148:151], v11, s[16:19], s58 offen offset:1024 sc1
    v_mfma_f32_32x32x16_bf16 v[96:111], v[52:55], a[88:91], v[96:111]
    s_add_u32 s58, s45, 458752
    buffer_load_dwordx4 a[152:155], v11, s[16:19], s58 offen offset:0 sc1
    v_mfma_f32_32x32x16_bf16 v[112:127], v[52:55], a[92:95], v[112:127]
    buffer_load_dwordx4 a[156:159], v11, s[16:19], s58 offen offset:1024 sc1
    s_waitcnt lgkmcnt(0)
    v_mfma_f32_32x32x16_bf16 v[64:79], v[24:27], a[96:99], v[64:79]
    ds_read_b64_tr_b16 v[40:41], v4 offset:12288
    ds_read_b64_tr_b16 v[42:43], v4 offset:14336
    v_cvt_pk_bf16_f32 v238, v252, v253
    v_cvt_pk_bf16_f32 v239, v254, v255
    v_mfma_f32_32x32x16_bf16 v[80:95], v[24:27], a[100:103], v[80:95]
    ds_read_b64_tr_b16 v[44:45], v5 offset:12288
    ds_read_b64_tr_b16 v[46:47], v5 offset:14336
    ds_write_b128 v17, v[236:239] offset:1024
    v_fma_f32 v240, v249, v241, -v240
    v_mfma_f32_32x32x16_bf16 v[96:111], v[28:31], a[96:99], v[96:111]
    ds_read_b64_tr_b16 v[48:49], v4 offset:12800
    ds_read_b64_tr_b16 v[50:51], v4 offset:14848
    v_fma_f32 v242, v249, v243, -v242
    v_fma_f32 v244, v249, v245, -v244
    v_fma_f32 v246, v249, v247, -v246
    v_fma_f32 v252, v248, v244, -v240
    v_mfma_f32_32x32x16_bf16 v[112:127], v[28:31], a[100:103], v[112:127]
    ds_read_b64_tr_b16 v[52:53], v5 offset:12800
    ds_read_b64_tr_b16 v[54:55], v5 offset:14848
    v_fma_f32 v253, v248, v246, -v242
    v_cvt_pk_bf16_f32 v236, v240, v242
    v_cvt_pk_bf16_f32 v237, v244, v246
    v_fma_f32 v254, v248, v252, -v244
    v_mfma_f32_32x32x16_bf16 v[64:79], v[32:35], a[104:107], v[64:79]
    s_add_u32 s58, s45, 524288
    buffer_load_dwordx4 a[160:163], v11, s[16:19], s58 offen offset:0 sc1
    v_fma_f32 v255, v248, v253, -v246
    v_cvt_pk_bf16_f32 v238, v252, v253
    v_mfma_f32_32x32x16_bf16 v[80:95], v[32:35], a[108:111], v[80:95]
    buffer_load_dwordx4 a[164:167], v11, s[16:19], s58 offen offset:1024 sc1
    v_mfma_f32_32x32x16_bf16 v[96:111], v[36:39], a[104:107], v[96:111]
    s_add_u32 s58, s45, 589824
    buffer_load_dwordx4 a[168:171], v11, s[16:19], s58 offen offset:0 sc1
    v_mfma_f32_32x32x16_bf16 v[112:127], v[36:39], a[108:111], v[112:127]
    buffer_load_dwordx4 a[172:175], v11, s[16:19], s58 offen offset:1024 sc1
    s_waitcnt lgkmcnt(0)
    s_barrier
    v_mfma_f32_32x32x16_bf16 v[64:79], v[40:43], a[112:115], v[64:79]
    ds_read_b64_tr_b16 v[24:25], v4 offset:16384
    ds_read_b64_tr_b16 v[26:27], v4 offset:18432
    v_cvt_pk_bf16_f32 v239, v254, v255
    ds_write_b128 v17, v[236:239] offset:2048
    v_mfma_f32_32x32x16_bf16 v[80:95], v[40:43], a[116:119], v[80:95]
    ds_read_b64_tr_b16 v[28:29], v5 offset:16384
    ds_read_b64_tr_b16 v[30:31], v5 offset:18432
    v_fma_f32 v241, v249, v240, -v241
    v_fma_f32 v243, v249, v242, -v243
    v_fma_f32 v245, v249, v244, -v245
    v_fma_f32 v247, v249, v246, -v247
    v_mfma_f32_32x32x16_bf16 v[96:111], v[44:47], a[112:115], v[96:111]
    ds_read_b64_tr_b16 v[32:33], v4 offset:16896
    ds_read_b64_tr_b16 v[34:35], v4 offset:18944
    v_fma_f32 v252, v248, v245, -v241
    v_fma_f32 v253, v248, v247, -v243
    v_cvt_pk_bf16_f32 v236, v241, v243
    v_cvt_pk_bf16_f32 v237, v245, v247
    v_mfma_f32_32x32x16_bf16 v[112:127], v[44:47], a[116:119], v[112:127]
    ds_read_b64_tr_b16 v[36:37], v5 offset:16896
    ds_read_b64_tr_b16 v[38:39], v5 offset:18944
    v_fma_f32 v254, v248, v252, -v245
    v_fma_f32 v255, v248, v253, -v247
    v_cvt_pk_bf16_f32 v238, v252, v253
    v_cvt_pk_bf16_f32 v239, v254, v255
    v_mfma_f32_32x32x16_bf16 v[64:79], v[48:51], a[120:123], v[64:79]
    buffer_load_dword v15, v12, s[16:19], s75 offen sc0 sc1
    v_mfma_f32_32x32x16_bf16 v[80:95], v[48:51], a[124:127], v[80:95]
    s_add_u32 s58, s45, 655360
    buffer_load_dwordx4 a[176:179], v11, s[16:19], s58 offen offset:0 sc1
    v_mfma_f32_32x32x16_bf16 v[96:111], v[52:55], a[120:123], v[96:111]
    buffer_load_dwordx4 a[180:183], v11, s[16:19], s58 offen offset:1024 sc1
    v_mfma_f32_32x32x16_bf16 v[112:127], v[52:55], a[124:127], v[112:127]
    s_add_u32 s58, s45, 720896
    buffer_load_dwordx4 a[184:187], v11, s[16:19], s58 offen offset:0 sc1
    s_waitcnt vmcnt(12) lgkmcnt(0)
    v_mfma_f32_32x32x16_bf16 v[64:79], v[24:27], a[128:131], v[64:79]
    ds_read_b64_tr_b16 v[40:41], v4 offset:20480
    ds_read_b64_tr_b16 v[42:43], v4 offset:22528
    ds_write_b128 v17, v[236:239] offset:3072
    v_fma_f32 v240, v249, v241, -v240
    v_fma_f32 v242, v249, v243, -v242
    v_mfma_f32_32x32x16_bf16 v[80:95], v[24:27], a[132:135], v[80:95]
    ds_read_b64_tr_b16 v[44:45], v5 offset:20480
    ds_read_b64_tr_b16 v[46:47], v5 offset:22528
    v_fma_f32 v244, v249, v245, -v244
    v_fma_f32 v246, v249, v247, -v246
    v_fma_f32 v252, v248, v244, -v240
    v_fma_f32 v253, v248, v246, -v242
    v_cvt_pk_bf16_f32 v236, v240, v242
    v_mfma_f32_32x32x16_bf16 v[96:111], v[28:31], a[128:131], v[96:111]
    ds_read_b64_tr_b16 v[48:49], v4 offset:20992
    ds_read_b64_tr_b16 v[50:51], v4 offset:23040
    v_cvt_pk_bf16_f32 v237, v244, v246
    v_fma_f32 v254, v248, v252, -v244
    v_fma_f32 v255, v248, v253, -v246
    v_cvt_pk_bf16_f32 v238, v252, v253
    v_cvt_pk_bf16_f32 v239, v254, v255
    v_mfma_f32_32x32x16_bf16 v[112:127], v[28:31], a[132:135], v[112:127]
    ds_read_b64_tr_b16 v[52:53], v5 offset:20992
    ds_read_b64_tr_b16 v[54:55], v5 offset:23040
    ds_write_b128 v17, v[236:239] offset:4096
    v_mfma_f32_32x32x16_bf16 v[64:79], v[32:35], a[136:139], v[64:79]
    buffer_load_dwordx4 a[188:191], v11, s[16:19], s58 offen offset:1024 sc1
    v_mfma_f32_32x32x16_bf16 v[80:95], v[32:35], a[140:143], v[80:95]
    s_add_u32 s58, s45, 1048576
    buffer_load_dwordx4 a[192:195], v11, s[16:19], s58 offen offset:0 sc1
    v_mfma_f32_32x32x16_bf16 v[96:111], v[36:39], a[136:139], v[96:111]
    buffer_load_dwordx4 a[196:199], v11, s[16:19], s58 offen offset:1024 sc1
    v_mfma_f32_32x32x16_bf16 v[112:127], v[36:39], a[140:143], v[112:127]
    s_add_u32 s58, s45, 1114112
    buffer_load_dwordx4 a[200:203], v11, s[16:19], s58 offen offset:0 sc1
    s_waitcnt vmcnt(12) lgkmcnt(0)
    s_barrier
    v_mfma_f32_32x32x16_bf16 v[64:79], v[40:43], a[144:147], v[64:79]
    ds_read_b64_tr_b16 v[24:25], v4 offset:24576
    ds_read_b64_tr_b16 v[26:27], v4 offset:26624
    v_fma_f32 v241, v249, v240, -v241
    v_fma_f32 v243, v249, v242, -v243
    v_fma_f32 v245, v249, v244, -v245
    v_fma_f32 v247, v249, v246, -v247
    v_mfma_f32_32x32x16_bf16 v[80:95], v[40:43], a[148:151], v[80:95]
    ds_read_b64_tr_b16 v[28:29], v5 offset:24576
    ds_read_b64_tr_b16 v[30:31], v5 offset:26624
    v_fma_f32 v252, v248, v245, -v241
    v_fma_f32 v253, v248, v247, -v243
    v_cvt_pk_bf16_f32 v236, v241, v243
    v_cvt_pk_bf16_f32 v237, v245, v247
    v_mfma_f32_32x32x16_bf16 v[96:111], v[44:47], a[144:147], v[96:111]
    ds_read_b64_tr_b16 v[32:33], v4 offset:25088
    ds_read_b64_tr_b16 v[34:35], v4 offset:27136
    v_fma_f32 v254, v248, v252, -v245
    v_fma_f32 v255, v248, v253, -v247
    v_cvt_pk_bf16_f32 v238, v252, v253
    v_cvt_pk_bf16_f32 v239, v254, v255
    v_mfma_f32_32x32x16_bf16 v[112:127], v[44:47], a[148:151], v[112:127]
    ds_read_b64_tr_b16 v[36:37], v5 offset:25088
    ds_read_b64_tr_b16 v[38:39], v5 offset:27136
    ds_write_b128 v17, v[236:239] offset:5120
    v_fma_f32 v240, v249, v241, -v240
    v_mfma_f32_32x32x16_bf16 v[64:79], v[48:51], a[152:155], v[64:79]
    buffer_load_dwordx4 a[204:207], v11, s[16:19], s58 offen offset:1024 sc1
    v_mfma_f32_32x32x16_bf16 v[80:95], v[48:51], a[156:159], v[80:95]
    s_add_u32 s58, s45, 1179648
    buffer_load_dwordx4 a[208:211], v11, s[16:19], s58 offen offset:0 sc1
    v_mfma_f32_32x32x16_bf16 v[96:111], v[52:55], a[152:155], v[96:111]
    buffer_load_dwordx4 a[212:215], v11, s[16:19], s58 offen offset:1024 sc1
    v_mfma_f32_32x32x16_bf16 v[112:127], v[52:55], a[156:159], v[112:127]
    s_add_u32 s58, s45, 1245184
    buffer_load_dwordx4 a[216:219], v11, s[16:19], s58 offen offset:0 sc1
    s_waitcnt vmcnt(11)
    s_mov_b32 s62, 0
L_pw3:
    v_cmp_le_u32 vcc, 2, v15
    s_nop 0
    s_and_b32 s3, vcc_lo, 8
    s_cmp_eq_u32 s3, 8
    s_cbranch_scc1 L_pok3
    s_add_u32 s62, s62, 1
    s_cmp_ge_u32 s62, 100000
    s_cbranch_scc1 L_pok3
    s_sleep 1
    buffer_load_dword v15, v12, s[16:19], s75 offen sc0 sc1
    s_waitcnt vmcnt(0)
    s_branch L_pw3
L_pok3:
    s_waitcnt lgkmcnt(0)
    v_mfma_f32_32x32x16_bf16 v[64:79], v[24:27], a[160:163], v[64:79]
    ds_read_b64_tr_b16 v[40:41], v4 offset:28672
    ds_read_b64_tr_b16 v[42:43], v4 offset:30720
    s_mul_i32 s3, s38, 3
    s_add_u32 s3, s3, s40
    s_lshl_b32 s3, s3, 5
    v_mfma_f32_32x32x16_bf16 v[80:95], v[24:27], a[164:167], v[80:95]
    ds_read_b64_tr_b16 v[44:45], v5 offset:28672
    ds_read_b64_tr_b16 v[46:47], v5 offset:30720
    s_add_u32 s3, s3, 2048
    v_and_b32 v12, 7, v0
    v_add_lshl_u32 v12, v12, s3, 2
    v_mfma_f32_32x32x16_bf16 v[96:111], v[28:31], a[160:163], v[96:111]
    ds_read_b64_tr_b16 v[48:49], v4 offset:29184
    ds_read_b64_tr_b16 v[50:51], v4 offset:31232
    v_fma_f32 v242, v249, v243, -v242
    v_fma_f32 v244, v249, v245, -v244
    v_fma_f32 v246, v249, v247, -v246
    v_mfma_f32_32x32x16_bf16 v[112:127], v[28:31], a[164:167], v[112:127]
    ds_read_b64_tr_b16 v[52:53], v5 offset:29184
    ds_read_b64_tr_b16 v[54:55], v5 offset:31232
    v_fma_f32 v252, v248, v244, -v240
    v_fma_f32 v253, v248, v246, -v242
    v_cvt_pk_bf16_f32 v236, v240, v242
    v_mfma_f32_32x32x16_bf16 v[64:79], v[32:35], a[168:171], v[64:79]
    s_add_u32 s58, s45, 1245184
    buffer_load_dwordx4 a[220:223], v11, s[16:19], s58 offen offset:1024 sc1
    v_cvt_pk_bf16_f32 v237, v244, v246
    v_mfma_f32_32x32x16_bf16 v[80:95], v[32:35], a[172:175], v[80:95]
    s_add_u32 s58, s45, 1572864
    buffer_load_dwordx4 a[224:227], v11, s[16:19], s58 offen offset:0 sc1
    v_fma_f32 v254, v248, v252, -v244
    v_mfma_f32_32x32x16_bf16 v[96:111], v[36:39], a[168:171], v[96:111]
    buffer_load_dwordx4 a[228:231], v11, s[16:19], s58 offen offset:1024 sc1
    v_mfma_f32_32x32x16_bf16 v[112:127], v[36:39], a[172:175], v[112:127]
    s_add_u32 s58, s45, 1638400
    buffer_load_dwordx4 a[232:235], v11, s[16:19], s58 offen offset:0 sc1
    s_waitcnt vmcnt(11) lgkmcnt(0)
    s_barrier
    v_mfma_f32_32x32x16_bf16 v[64:79], v[40:43], a[176:179], v[64:79]
    ds_read_b64_tr_b16 v[24:25], v4 offset:32768
    ds_read_b64_tr_b16 v[26:27], v4 offset:34816
    v_fma_f32 v255, v248, v253, -v246
    v_cvt_pk_bf16_f32 v238, v252, v253
    v_cvt_pk_bf16_f32 v239, v254, v255
    v_mfma_f32_32x32x16_bf16 v[80:95], v[40:43], a[180:183], v[80:95]
    ds_read_b64_tr_b16 v[28:29], v5 offset:32768
    ds_read_b64_tr_b16 v[30:31], v5 offset:34816
    ds_write_b128 v17, v[236:239] offset:6144
    v_mfma_f32_32x32x16_bf16 v[96:111], v[44:47], a[176:179], v[96:111]
    ds_read_b64_tr_b16 v[32:33], v4 offset:33280
    ds_read_b64_tr_b16 v[34:35], v4 offset:35328
    v_fma_f32 v241, v249, v240, -v241
    v_fma_f32 v243, v249, v242, -v243
    v_fma_f32 v245, v249, v244, -v245
    v_mfma_f32_32x32x16_bf16 v[112:127], v[44:47], a[180:183], v[112:127]
    ds_read_b64_tr_b16 v[36:37], v5 offset:33280
    ds_read_b64_tr_b16 v[38:39], v5 offset:35328
    v_fma_f32 v247, v249, v246, -v247
    v_fma_f32 v252, v248, v245, -v241
    v_fma_f32 v253, v248, v247, -v243
    v_mfma_f32_32x32x16_bf16 v[64:79], v[48:51], a[184:187], v[64:79]
    buffer_load_dwordx4 a[236:239], v11, s[16:19], s58 offen offset:1024 sc1
    v_cvt_pk_bf16_f32 v236, v241, v243
    v_mfma_f32_32x32x16_bf16 v[80:95], v[48:51], a[188:191], v[80:95]
    s_add_u32 s58, s45, 1703936
    buffer_load_dwordx4 a[240:243], v11, s[16:19], s58 offen offset:0 sc1
    v_cvt_pk_bf16_f32 v237, v245, v247
    v_mfma_f32_32x32x16_bf16 v[96:111], v[52:55], a[184:187], v[96:111]
    buffer_load_dwordx4 a[244:247], v11, s[16:19], s58 offen offset:1024 sc1
    v_fma_f32 v254, v248, v252, -v245
    v_mfma_f32_32x32x16_bf16 v[112:127], v[52:55], a[188:191], v[112:127]
    s_add_u32 s58, s45, 1769472
    buffer_load_dwordx4 a[248:251], v11, s[16:19], s58 offen offset:0 sc1
    v_fma_f32 v255, v248, v253, -v247
    s_waitcnt vmcnt(11) lgkmcnt(0)
    v_mfma_f32_32x32x16_bf16 v[64:79], v[24:27], a[192:195], v[64:79]
    ds_read_b64_tr_b16 v[40:41], v4 offset:36864
    ds_read_b64_tr_b16 v[42:43], v4 offset:38912
    v_cvt_pk_bf16_f32 v238, v252, v253
    v_cvt_pk_bf16_f32 v239, v254, v255
    v_mfma_f32_32x32x16_bf16 v[80:95], v[24:27], a[196:199], v[80:95]
    ds_read_b64_tr_b16 v[44:45], v5 offset:36864
    ds_read_b64_tr_b16 v[46:47], v5 offset:38912
    ds_write_b128 v17, v[236:239] offset:7168
    v_fma_f32 v240, v249, v241, -v240
    v_mfma_f32_32x32x16_bf16 v[96:111], v[28:31], a[192:195], v[96:111]
    ds_read_b64_tr_b16 v[48:49], v4 offset:37376
    ds_read_b64_tr_b16 v[50:51], v4 offset:39424
    v_fma_f32 v242, v249, v243, -v242
    v_fma_f32 v244, v249, v245, -v244
    v_fma_f32 v246, v249, v247, -v246
    v_fma_f32 v252, v248, v244, -v240
    v_mfma_f32_32x32x16_bf16 v[112:127], v[28:31], a[196:199], v[112:127]
    ds_read_b64_tr_b16 v[52:53], v5 offset:37376
    ds_read_b64_tr_b16 v[54:55], v5 offset:39424
    v_fma_f32 v253, v248, v246, -v242
    v_cvt_pk_bf16_f32 v236, v240, v242
    v_cvt_pk_bf16_f32 v237, v244, v246
    v_fma_f32 v254, v248, v252, -v244
    v_mfma_f32_32x32x16_bf16 v[64:79], v[32:35], a[200:203], v[64:79]
    buffer_load_dwordx4 a[252:255], v11, s[16:19], s58 offen offset:1024 sc1
    v_fma_f32 v255, v248, v253, -v246
    v_cvt_pk_bf16_f32 v238, v252, v253
    v_mfma_f32_32x32x16_bf16 v[80:95], v[32:35], a[204:207], v[80:95]
    s_add_u32 s58, s45, 2097152
    buffer_load_dwordx4 v[192:195], v11, s[16:19], s58 offen offset:0 sc1
    v_mfma_f32_32x32x16_bf16 v[96:111], v[36:39], a[200:203], v[96:111]
    buffer_load_dwordx4 v[196:199], v11, s[16:19], s58 offen offset:1024 sc1
    v_mfma_f32_32x32x16_bf16 v[112:127], v[36:39], a[204:207], v[112:127]
    s_add_u32 s58, s45, 2162688
    buffer_load_dwordx4 v[200:203], v11, s[16:19], s58 offen offset:0 sc1
    s_waitcnt vmcnt(11) lgkmcnt(0)
    s_barrier
    v_mfma_f32_32x32x16_bf16 v[64:79], v[40:43], a[208:211], v[64:79]
    ds_read_b64_tr_b16 v[24:25], v4 offset:40960
    ds_read_b64_tr_b16 v[26:27], v4 offset:43008
    v_cvt_pk_bf16_f32 v239, v254, v255
    ds_write_b128 v17, v[236:239] offset:8192
    v_mfma_f32_32x32x16_bf16 v[80:95], v[40:43], a[212:215], v[80:95]
    ds_read_b64_tr_b16 v[28:29], v5 offset:40960
    ds_read_b64_tr_b16 v[30:31], v5 offset:43008
    v_fma_f32 v241, v249, v240, -v241
    v_mul_f32 v252, 0.5, v241
    v_cvt_pk_bf16_f32 v252, v252, 0
    v_mov_b32 v237, 0
    v_mfma_f32_32x32x16_bf16 v[96:111], v[44:47], a[208:211], v[96:111]
    ds_read_b64_tr_b16 v[32:33], v4 offset:41472
    ds_read_b64_tr_b16 v[34:35], v4 offset:43520
    v_mov_b32 v238, 0
    v_cmp_gt_u32 vcc, 32, v0
    s_nop 1
    v_cndmask_b32 v236, 0, v252, vcc
    v_mov_b32 v239, 0
    v_mfma_f32_32x32x16_bf16 v[112:127], v[44:47], a[212:215], v[112:127]
    ds_read_b64_tr_b16 v[36:37], v5 offset:41472
    ds_read_b64_tr_b16 v[38:39], v5 offset:43520
    ds_write_b128 v17, v[236:239] offset:9216
    v_fmamk_f32 v242, v250, 0x3f800000, v251
    v_mfma_f32_32x32x16_bf16 v[64:79], v[48:51], a[216:219], v[64:79]
    buffer_load_dwordx4 v[204:207], v11, s[16:19], s58 offen offset:1024 sc1
    v_cos_f32 v240, v242
    v_mfma_f32_32x32x16_bf16 v[80:95], v[48:51], a[220:223], v[80:95]
    s_add_u32 s58, s45, 2228224
    buffer_load_dwordx4 v[208:211], v11, s[16:19], s58 offen offset:0 sc1
    v_sin_f32 v242, v242
    v_mfma_f32_32x32x16_bf16 v[96:111], v[52:55], a[216:219], v[96:111]
    buffer_load_dwordx4 v[212:215], v11, s[16:19], s58 offen offset:1024 sc1
    v_add_f32 v240, v240, v240
    v_mfma_f32_32x32x16_bf16 v[112:127], v[52:55], a[220:223], v[112:127]
    s_add_u32 s58, s45, 2293760
    buffer_load_dwordx4 v[216:219], v11, s[16:19], s58 offen offset:0 sc1
    s_waitcnt vmcnt(11) lgkmcnt(0)
    v_mfma_f32_32x32x16_bf16 v[64:79], v[24:27], a[224:227], v[64:79]
    ds_read_b64_tr_b16 v[40:41], v4 offset:45056
    ds_read_b64_tr_b16 v[42:43], v4 offset:47104
    v_mul_f32 v242, -2.0, v242
    v_fmamk_f32 v243, v250, 0xc1f80000, v251
    v_cos_f32 v241, v243
    v_mfma_f32_32x32x16_bf16 v[80:95], v[24:27], a[228:231], v[80:95]
    ds_read_b64_tr_b16 v[44:45], v5 offset:45056
    ds_read_b64_tr_b16 v[46:47], v5 offset:47104
    v_sin_f32 v243, v243
    v_add_f32 v241, v241, v241
    v_mul_f32 v243, -2.0, v243
    v_mfma_f32_32x32x16_bf16 v[96:111], v[28:31], a[224:227], v[96:111]
    ds_read_b64_tr_b16 v[48:49], v4 offset:45568
    ds_read_b64_tr_b16 v[50:51], v4 offset:47616
    v_fmamk_f32 v246, v250, 0x40a00000, v251
    v_cos_f32 v244, v246
    v_mfma_f32_32x32x16_bf16 v[112:127], v[28:31], a[228:231], v[112:127]
    ds_read_b64_tr_b16 v[52:53], v5 offset:45568
    ds_read_b64_tr_b16 v[54:55], v5 offset:47616
    v_sin_f32 v246, v246
    v_add_f32 v244, v244, v244
    v_mul_f32 v246, -2.0, v246
    v_mfma_f32_32x32x16_bf16 v[64:79], v[32:35], a[232:235], v[64:79]
    buffer_load_dwordx4 v[220:223], v11, s[16:19], s58 offen offset:1024 sc1
    v_fmamk_f32 v247, v250, 0xc1d80000, v251
    v_mfma_f32_32x32x16_bf16 v[80:95], v[32:35], a[236:239], v[80:95]
    s_add_u32 m0, s55, 111360
    s_add_u32 s59, s46, 256
    buffer_load_dwordx4 v10, s[24:27], s59 offen lds
    v_mfma_f32_32x32x16_bf16 v[96:111], v[36:39], a[232:235], v[96:111]
    s_add_u32 m0, s55, 115456
    s_add_u32 s59, s46, 37120
    buffer_load_dwordx4 v10, s[24:27], s59 offen lds
    v_mfma_f32_32x32x16_bf16 v[112:127], v[36:39], a[236:239], v[112:127]
    v_cos_f32 v245, v247
    v_sin_f32 v247, v247
    s_waitcnt vmcnt(10) lgkmcnt(0)
    s_barrier
    v_mfma_f32_32x32x16_bf16 v[64:79], v[40:43], a[240:243], v[64:79]
    ds_read_b64_tr_b16 v[24:25], v2 offset:0
    ds_read_b64_tr_b16 v[26:27], v2 offset:2048
    v_add_f32 v245, v245, v245
    v_mul_f32 v247, -2.0, v247
    v_fma_f32 v252, v248, v244, -v240
    v_fma_f32 v253, v248, v246, -v242
    v_mfma_f32_32x32x16_bf16 v[80:95], v[40:43], a[244:247], v[80:95]
    ds_read_b64_tr_b16 v[28:29], v3 offset:0
    ds_read_b64_tr_b16 v[30:31], v3 offset:2048
    v_cvt_pk_bf16_f32 v236, v240, v242
    v_cvt_pk_bf16_f32 v237, v244, v246
    v_fma_f32 v254, v248, v252, -v244
    v_fma_f32 v255, v248, v253, -v246
    v_mfma_f32_32x32x16_bf16 v[96:111], v[44:47], a[240:243], v[96:111]
    ds_read_b64_tr_b16 v[32:33], v2 offset:512
    ds_read_b64_tr_b16 v[34:35], v2 offset:2560
    v_cvt_pk_bf16_f32 v238, v252, v253
    v_cvt_pk_bf16_f32 v239, v254, v255
    v_mfma_f32_32x32x16_bf16 v[112:127], v[44:47], a[244:247], v[112:127]
    ds_read_b64_tr_b16 v[36:37], v3 offset:512
    ds_read_b64_tr_b16 v[38:39], v3 offset:2560
    ds_write_b128 v17, v[236:239] offset:10240
    v_fma_f32 v241, v249, v240, -v241
    v_mfma_f32_32x32x16_bf16 v[64:79], v[48:51], a[248:251], v[64:79]
    s_add_u32 m0, s55, 119552
    s_add_u32 s59, s46, 221440
    buffer_load_dwordx4 v10, s[24:27], s59 offen lds
    v_fma_f32 v243, v249, v242, -v243
    v_mfma_f32_32x32x16_bf16 v[80:95], v[48:51], a[252:255], v[80:95]
    s_add_u32 m0, s55, 123648
    s_add_u32 s59, s46, 258304
    buffer_load_dwordx4 v10, s[24:27], s59 offen lds
    v_fma_f32 v245, v249, v244, -v245
    v_mfma_f32_32x32x16_bf16 v[96:111], v[52:55], a[248:251], v[96:111]
    s_add_u32 m0, s55, 127744
    s_add_u32 s59, s46, 368896
    buffer_load_dwordx4 v10, s[24:27], s59 offen lds
    v_mfma_f32_32x32x16_bf16 v[112:127], v[52:55], a[252:255], v[112:127]
    s_waitcnt vmcnt(9) lgkmcnt(0)
    v_mfma_f32_32x32x16_bf16 v[64:79], v[24:27], v[192:195], v[64:79]
    ds_read_b64_tr_b16 v[40:41], v2 offset:4096
    ds_read_b64_tr_b16 v[42:43], v2 offset:6144
    v_fma_f32 v247, v249, v246, -v247
    v_fma_f32 v252, v248, v245, -v241
    v_fma_f32 v253, v248, v247, -v243
    v_mfma_f32_32x32x16_bf16 v[80:95], v[24:27], v[196:199], v[80:95]
    ds_read_b64_tr_b16 v[44:45], v3 offset:4096
    ds_read_b64_tr_b16 v[46:47], v3 offset:6144
    v_cvt_pk_bf16_f32 v236, v241, v243
    v_cvt_pk_bf16_f32 v237, v245, v247
    v_fma_f32 v254, v248, v252, -v245
    v_mfma_f32_32x32x16_bf16 v[96:111], v[28:31], v[192:195], v[96:111]
    ds_read_b64_tr_b16 v[48:49], v2 offset:4608
    ds_read_b64_tr_b16 v[50:51], v2 offset:6656
    v_fma_f32 v255, v248, v253, -v247
    v_cvt_pk_bf16_f32 v238, v252, v253
    v_cvt_pk_bf16_f32 v239, v254, v255
    v_mfma_f32_32x32x16_bf16 v[112:127], v[28:31], v[196:199], v[112:127]
    ds_read_b64_tr_b16 v[52:53], v3 offset:4608
    ds_read_b64_tr_b16 v[54:55], v3 offset:6656
    ds_write_b128 v17, v[236:239] offset:11264
    v_mfma_f32_32x32x16_bf16 v[64:79], v[32:35], v[200:203], v[64:79]
    s_add_u32 m0, s55, 131840
    s_add_u32 s59, s46, 405760
    buffer_load_dwordx4 v10, s[24:27], s59 offen lds
    v_mfma_f32_32x32x16_bf16 v[80:95], v[32:35], v[204:207], v[80:95]
    s_add_u32 m0, s55, 135936
    s_add_u32 s59, s46, 516352
    buffer_load_dwordx4 v10, s[24:27], s59 offen lds
    v_mfma_f32_32x32x16_bf16 v[96:111], v[36:39], v[200:203], v[96:111]
    s_add_u32 m0, s55, 140032
    s_add_u32 s59, s46, 553216
    buffer_load_dwordx4 v10, s[24:27], s59 offen lds
    v_mfma_f32_32x32x16_bf16 v[112:127], v[36:39], v[204:207], v[112:127]
    v_fma_f32 v240, v249, v241, -v240
    v_fma_f32 v242, v249, v243, -v242
    v_fma_f32 v244, v249, v245, -v244
    v_fma_f32 v246, v249, v247, -v246
    s_waitcnt vmcnt(8) lgkmcnt(0)
    s_barrier
    v_mfma_f32_32x32x16_bf16 v[64:79], v[40:43], v[208:211], v[64:79]
    ds_read_b64_tr_b16 v[24:25], v2 offset:8192
    ds_read_b64_tr_b16 v[26:27], v2 offset:10240
    v_fma_f32 v252, v248, v244, -v240
    v_fma_f32 v253, v248, v246, -v242
    v_cvt_pk_bf16_f32 v236, v240, v242
    v_mfma_f32_32x32x16_bf16 v[80:95], v[40:43], v[212:215], v[80:95]
    ds_read_b64_tr_b16 v[28:29], v3 offset:8192
    ds_read_b64_tr_b16 v[30:31], v3 offset:10240
    v_cvt_pk_bf16_f32 v237, v244, v246
    v_fma_f32 v254, v248, v252, -v244
    v_fma_f32 v255, v248, v253, -v246
    v_mfma_f32_32x32x16_bf16 v[96:111], v[44:47], v[208:211], v[96:111]
    ds_read_b64_tr_b16 v[32:33], v2 offset:8704
    ds_read_b64_tr_b16 v[34:35], v2 offset:10752
    v_cvt_pk_bf16_f32 v238, v252, v253
    v_cvt_pk_bf16_f32 v239, v254, v255
    v_mfma_f32_32x32x16_bf16 v[112:127], v[44:47], v[212:215], v[112:127]
    ds_read_b64_tr_b16 v[36:37], v3 offset:8704
    ds_read_b64_tr_b16 v[38:39], v3 offset:10752
    ds_write_b128 v17, v[236:239] offset:12288
    v_mfma_f32_32x32x16_bf16 v[64:79], v[48:51], v[216:219], v[64:79]
    s_add_u32 m0, s55, 144128
    s_add_u32 s59, s46, 73984
    buffer_load_dwordx4 v10, s[24:27], s59 offen lds
    v_mfma_f32_32x32x16_bf16 v[80:95], v[48:51], v[220:223], v[80:95]
    s_add_u32 m0, s55, 148224
    s_add_u32 s59, s46, 110848
    buffer_load_dwordx4 v10, s[24:27], s59 offen lds
    v_mfma_f32_32x32x16_bf16 v[96:111], v[52:55], v[216:219], v[96:111]
    s_add_u32 m0, s55, 152320
    s_add_u32 s59, s46, 147712
    buffer_load_dwordx4 v10, s[24:27], s59 offen lds
    v_mfma_f32_32x32x16_bf16 v[112:127], v[52:55], v[220:223], v[112:127]
    v_fma_f32 v241, v249, v240, -v241
    v_fma_f32 v243, v249, v242, -v243
    v_fma_f32 v245, v249, v244, -v245
    v_fma_f32 v247, v249, v246, -v247
    v_fma_f32 v252, v248, v245, -v241
    s_waitcnt lgkmcnt(0)
    v_mfma_f32_32x32x16_bf16 v[128:143], v[24:27], a[128:131], v[128:143]
    ds_read_b64_tr_b16 v[40:41], v2 offset:12288
    ds_read_b64_tr_b16 v[42:43], v2 offset:14336
    v_mfma_f32_32x32x16_bf16 v[144:159], v[24:27], a[132:135], v[144:159]
    ds_read_b64_tr_b16 v[44:45], v3 offset:12288
    ds_read_b64_tr_b16 v[46:47], v3 offset:14336
    v_mfma_f32_32x32x16_bf16 v[160:175], v[28:31], a[128:131], v[160:175]
    ds_read_b64_tr_b16 v[48:49], v2 offset:12800
    ds_read_b64_tr_b16 v[50:51], v2 offset:14848
    v_cvt_pk_bf16_f32 v64, v64, v65
    v_cvt_pk_bf16_f32 v65, v66, v67
    v_cvt_pk_bf16_f32 v66, v68, v69
    v_cvt_pk_bf16_f32 v67, v70, v71
    v_mfma_f32_32x32x16_bf16 v[176:191], v[28:31], a[132:135], v[176:191]
    ds_read_b64_tr_b16 v[52:53], v3 offset:12800
    ds_read_b64_tr_b16 v[54:55], v3 offset:14848
    v_cvt_pk_bf16_f32 v72, v72, v73
    v_cvt_pk_bf16_f32 v73, v74, v75
    v_cvt_pk_bf16_f32 v74, v76, v77
    v_cvt_pk_bf16_f32 v75, v78, v79
    v_mfma_f32_32x32x16_bf16 v[128:143], v[32:35], a[136:139], v[128:143]
    s_add_u32 m0, s55, 156416
    s_add_u32 s59, s46, 184576
    buffer_load_dwordx4 v10, s[24:27], s59 offen lds
    v_cvt_pk_bf16_f32 v80, v80, v81
    v_mfma_f32_32x32x16_bf16 v[144:159], v[32:35], a[140:143], v[144:159]
    s_add_u32 m0, s55, 62208
    s_add_u32 s59, s46, 295168
    buffer_load_dwordx4 v10, s[24:27], s59 offen lds
    v_cvt_pk_bf16_f32 v81, v82, v83
    v_mfma_f32_32x32x16_bf16 v[160:175], v[36:39], a[136:139], v[160:175]
    s_add_u32 m0, s55, 66304
    s_add_u32 s59, s46, 332032
    buffer_load_dwordx4 v10, s[24:27], s59 offen lds
    v_cvt_pk_bf16_f32 v82, v84, v85
    v_mfma_f32_32x32x16_bf16 v[176:191], v[36:39], a[140:143], v[176:191]
    v_cvt_pk_bf16_f32 v83, v86, v87
    v_cvt_pk_bf16_f32 v88, v88, v89
    v_cvt_pk_bf16_f32 v89, v90, v91
    v_cvt_pk_bf16_f32 v90, v92, v93
    v_cvt_pk_bf16_f32 v91, v94, v95
    s_waitcnt lgkmcnt(0)
    s_barrier
    v_mfma_f32_32x32x16_bf16 v[128:143], v[40:43], a[144:147], v[128:143]
    ds_read_b64_tr_b16 v[24:25], v2 offset:16384
    ds_read_b64_tr_b16 v[26:27], v2 offset:18432
    v_cvt_pk_bf16_f32 v96, v96, v97
    v_cvt_pk_bf16_f32 v97, v98, v99
    v_cvt_pk_bf16_f32 v98, v100, v101
    v_mfma_f32_32x32x16_bf16 v[144:159], v[40:43], a[148:151], v[144:159]
    ds_read_b64_tr_b16 v[28:29], v3 offset:16384
    ds_read_b64_tr_b16 v[30:31], v3 offset:18432
    v_cvt_pk_bf16_f32 v99, v102, v103
    v_cvt_pk_bf16_f32 v104, v104, v105
    v_cvt_pk_bf16_f32 v105, v106, v107
    v_mfma_f32_32x32x16_bf16 v[160:175], v[44:47], a[144:147], v[160:175]
    ds_read_b64_tr_b16 v[32:33], v2 offset:16896
    ds_read_b64_tr_b16 v[34:35], v2 offset:18944
    v_cvt_pk_bf16_f32 v106, v108, v109
    v_cvt_pk_bf16_f32 v107, v110, v111
    v_cvt_pk_bf16_f32 v112, v112, v113
    v_mfma_f32_32x32x16_bf16 v[176:191], v[44:47], a[148:151], v[176:191]
    ds_read_b64_tr_b16 v[36:37], v3 offset:16896
    ds_read_b64_tr_b16 v[38:39], v3 offset:18944
    v_cvt_pk_bf16_f32 v113, v114, v115
    v_cvt_pk_bf16_f32 v114, v116, v117
    v_cvt_pk_bf16_f32 v115, v118, v119
    v_mfma_f32_32x32x16_bf16 v[128:143], v[48:51], a[152:155], v[128:143]
    s_add_u32 s57, s76, 0
    buffer_store_dwordx4 v[64:67], v14, s[16:19], s57 offen offset:0 sc0 sc1
    v_cvt_pk_bf16_f32 v120, v120, v121
    v_mfma_f32_32x32x16_bf16 v[144:159], v[48:51], a[156:159], v[144:159]
    buffer_store_dwordx4 v[72:75], v14, s[16:19], s57 offen offset:1024 sc0 sc1
    v_cvt_pk_bf16_f32 v121, v122, v123
    v_mfma_f32_32x32x16_bf16 v[160:175], v[52:55], a[152:155], v[160:175]
    s_add_u32 m0, s55, 70400
    s_add_u32 s59, s46, 442624
    buffer_load_dwordx4 v10, s[24:27], s59 offen lds
    v_mfma_f32_32x32x16_bf16 v[176:191], v[52:55], a[156:159], v[176:191]
    v_cvt_pk_bf16_f32 v122, v124, v125
    v_cvt_pk_bf16_f32 v123, v126, v127
    s_waitcnt lgkmcnt(0)
    v_mfma_f32_32x32x16_bf16 v[128:143], v[24:27], a[160:163], v[128:143]
    ds_read_b64_tr_b16 v[40:41], v2 offset:20480
    ds_read_b64_tr_b16 v[42:43], v2 offset:22528
    v_and_b32 v22, 3, v0
    v_bfe_u32 v23, v0, 3, 1
    v_lshl_add_u32 v22, v23, 2, v22
    v_mfma_f32_32x32x16_bf16 v[144:159], v[24:27], a[164:167], v[144:159]
    ds_read_b64_tr_b16 v[44:45], v3 offset:20480
    ds_read_b64_tr_b16 v[46:47], v3 offset:22528
    v_and_b32 v23, 1, v22
    v_lshlrev_b32 v23, 4, v23
    v_mov_b32 v8, 0x3f80
    v_mfma_f32_32x32x16_bf16 v[160:175], v[28:31], a[160:163], v[160:175]
    ds_read_b64_tr_b16 v[48:49], v2 offset:20992
    ds_read_b64_tr_b16 v[50:51], v2 offset:23040
    v_lshlrev_b32 v8, v23, v8
    v_lshrrev_b32 v22, 1, v22
    v_bfe_u32 v23, v0, 2, 1
    v_mfma_f32_32x32x16_bf16 v[176:191], v[28:31], a[164:167], v[176:191]
    ds_read_b64_tr_b16 v[52:53], v3 offset:20992
    ds_read_b64_tr_b16 v[54:55], v3 offset:23040
    v_lshrrev_b32 v9, 5, v0
    v_xor_b32 v23, v23, v9
    v_lshl_add_u32 v22, v23, 3, v22
    v_mfma_f32_32x32x16_bf16 v[128:143], v[32:35], a[168:171], v[128:143]
    s_add_u32 s57, s76, 36864
    buffer_store_dwordx4 v[80:83], v14, s[16:19], s57 offen offset:0 sc0 sc1
    v_bfe_u32 v23, v0, 4, 1
    v_mfma_f32_32x32x16_bf16 v[144:159], v[32:35], a[172:175], v[144:159]
    buffer_store_dwordx4 v[88:91], v14, s[16:19], s57 offen offset:1024 sc0 sc1
    v_lshl_add_u32 v22, v23, 2, v22
    v_mfma_f32_32x32x16_bf16 v[160:175], v[36:39], a[168:171], v[160:175]
    s_add_u32 m0, s55, 74496
    s_add_u32 s59, s46, 479488
    buffer_load_dwordx4 v10, s[24:27], s59 offen lds
    v_mfma_f32_32x32x16_bf16 v[176:191], v[36:39], a[172:175], v[176:191]
    v_cmp_eq_u32 vcc, 0, v22
    s_nop 1
    v_cndmask_b32 v56, 0, v8, vcc
    v_cmp_eq_u32 vcc, 1, v22
    s_nop 1
    v_cndmask_b32 v57, 0, v8, vcc
    s_waitcnt lgkmcnt(0)
    s_barrier
    v_mfma_f32_32x32x16_bf16 v[128:143], v[40:43], a[176:179], v[128:143]
    ds_read_b64_tr_b16 v[24:25], v2 offset:24576
    ds_read_b64_tr_b16 v[26:27], v2 offset:26624
    v_cmp_eq_u32 vcc, 2, v22
    s_nop 1
    v_cndmask_b32 v58, 0, v8, vcc
    v_cmp_eq_u32 vcc, 3, v22
    s_nop 1
    v_cndmask_b32 v59, 0, v8, vcc
    v_mfma_f32_32x32x16_bf16 v[144:159], v[40:43], a[180:183], v[144:159]
    ds_read_b64_tr_b16 v[28:29], v3 offset:24576
    ds_read_b64_tr_b16 v[30:31], v3 offset:26624
    v_cmp_eq_u32 vcc, 4, v22
    s_nop 1
    v_cndmask_b32 v60, 0, v8, vcc
    v_cmp_eq_u32 vcc, 5, v22
    s_nop 1
    v_cndmask_b32 v61, 0, v8, vcc
    v_mfma_f32_32x32x16_bf16 v[160:175], v[44:47], a[176:179], v[160:175]
    ds_read_b64_tr_b16 v[32:33], v2 offset:25088
    ds_read_b64_tr_b16 v[34:35], v2 offset:27136
    v_cmp_eq_u32 vcc, 6, v22
    s_nop 1
    v_cndmask_b32 v62, 0, v8, vcc
    v_cmp_eq_u32 vcc, 7, v22
    s_nop 1
    v_cndmask_b32 v63, 0, v8, vcc
    v_mfma_f32_32x32x16_bf16 v[176:191], v[44:47], a[180:183], v[176:191]
    ds_read_b64_tr_b16 v[36:37], v3 offset:25088
    ds_read_b64_tr_b16 v[38:39], v3 offset:27136
    v_fma_f32 v253, v248, v247, -v243
    v_cvt_pk_bf16_f32 v236, v241, v243
    v_cvt_pk_bf16_f32 v237, v245, v247
    v_fma_f32 v254, v248, v252, -v245
    v_mfma_f32_32x32x16_bf16 v[128:143], v[48:51], a[184:187], v[128:143]
    s_add_u32 s57, s76, 2048
    buffer_store_dwordx4 v[96:99], v14, s[16:19], s57 offen offset:0 sc0 sc1
    v_fma_f32 v255, v248, v253, -v247
    v_cvt_pk_bf16_f32 v238, v252, v253
    v_mfma_f32_32x32x16_bf16 v[144:159], v[48:51], a[188:191], v[144:159]
    buffer_store_dwordx4 v[104:107], v14, s[16:19], s57 offen offset:1024 sc0 sc1
    v_cvt_pk_bf16_f32 v239, v254, v255
    v_mfma_f32_32x32x16_bf16 v[160:175], v[52:55], a[184:187], v[160:175]
    s_add_u32 m0, s55, 78592
    s_add_u32 s59, s46, 590080
    buffer_load_dwordx4 v10, s[24:27], s59 offen lds
    v_mfma_f32_32x32x16_bf16 v[176:191], v[52:55], a[188:191], v[176:191]
    ds_write_b128 v17, v[236:239] offset:13312
    s_waitcnt lgkmcnt(0)
    v_mfma_f32_32x32x16_bf16 v[128:143], v[24:27], a[192:195], v[128:143]
    ds_read_b64_tr_b16 v[40:41], v2 offset:28672
    ds_read_b64_tr_b16 v[42:43], v2 offset:30720
    v_fma_f32 v240, v249, v241, -v240
    v_fma_f32 v242, v249, v243, -v242
    v_fma_f32 v244, v249, v245, -v244
    v_mfma_f32_32x32x16_bf16 v[144:159], v[24:27], a[196:199], v[144:159]
    ds_read_b64_tr_b16 v[44:45], v3 offset:28672
    ds_read_b64_tr_b16 v[46:47], v3 offset:30720
    v_fma_f32 v246, v249, v247, -v246
    v_fma_f32 v252, v248, v244, -v240
    v_fma_f32 v253, v248, v246, -v242
    v_mfma_f32_32x32x16_bf16 v[160:175], v[28:31], a[192:195], v[160:175]
    ds_read_b64_tr_b16 v[48:49], v2 offset:29184
    ds_read_b64_tr_b16 v[50:51], v2 offset:31232
    v_cvt_pk_bf16_f32 v236, v240, v242
    v_cvt_pk_bf16_f32 v237, v244, v246
    v_fma_f32 v254, v248, v252, -v244
    v_mfma_f32_32x32x16_bf16 v[176:191], v[28:31], a[196:199], v[176:191]
    ds_read_b64_tr_b16 v[52:53], v3 offset:29184
    ds_read_b64_tr_b16 v[54:55], v3 offset:31232
    v_fma_f32 v255, v248, v253, -v246
    v_cvt_pk_bf16_f32 v238, v252, v253
    v_cvt_pk_bf16_f32 v239, v254, v255
    v_mfma_f32_32x32x16_bf16 v[128:143], v[32:35], a[200:203], v[128:143]
    s_add_u32 s57, s76, 38912
    buffer_store_dwordx4 v[112:115], v14, s[16:19], s57 offen offset:0 sc0 sc1
    v_mfma_f32_32x32x16_bf16 v[144:159], v[32:35], a[204:207], v[144:159]
    buffer_store_dwordx4 v[120:123], v14, s[16:19], s57 offen offset:1024 sc0 sc1
    v_mfma_f32_32x32x16_bf16 v[160:175], v[36:39], a[200:203], v[160:175]
    s_add_u32 m0, s55, 82688
    s_add_u32 s59, s46, 626944
    buffer_load_dwordx4 v10, s[24:27], s59 offen lds
    v_mfma_f32_32x32x16_bf16 v[176:191], v[36:39], a[204:207], v[176:191]
    ds_write_b128 v17, v[236:239] offset:14336
    v_fma_f32 v241, v249, v240, -v241
    s_waitcnt lgkmcnt(0)
    s_barrier
    v_mfma_f32_32x32x16_bf16 v[128:143], v[40:43], a[208:211], v[128:143]
    ds_read_b64_tr_b16 v[24:25], v2 offset:32768
    ds_read_b64_tr_b16 v[26:27], v2 offset:34816
    v_fma_f32 v243, v249, v242, -v243
    v_fma_f32 v245, v249, v244, -v245
    v_mfma_f32_32x32x16_bf16 v[144:159], v[40:43], a[212:215], v[144:159]
    ds_read_b64_tr_b16 v[28:29], v3 offset:32768
    ds_read_b64_tr_b16 v[30:31], v3 offset:34816
    v_fma_f32 v247, v249, v246, -v247
    v_fma_f32 v252, v248, v245, -v241
    v_mfma_f32_32x32x16_bf16 v[160:175], v[44:47], a[208:211], v[160:175]
    ds_read_b64_tr_b16 v[32:33], v2 offset:33280
    ds_read_b64_tr_b16 v[34:35], v2 offset:35328
    v_fma_f32 v253, v248, v247, -v243
    v_cvt_pk_bf16_f32 v236, v241, v243
    v_mfma_f32_32x32x16_bf16 v[176:191], v[44:47], a[212:215], v[176:191]
    ds_read_b64_tr_b16 v[36:37], v3 offset:33280
    ds_read_b64_tr_b16 v[38:39], v3 offset:35328
    v_cvt_pk_bf16_f32 v237, v245, v247
    v_fma_f32 v254, v248, v252, -v245
    v_mfma_f32_32x32x16_bf16 v[128:143], v[48:51], a[216:219], v[128:143]
    v_fma_f32 v255, v248, v253, -v247
    v_cvt_pk_bf16_f32 v238, v252, v253
    v_cvt_pk_bf16_f32 v239, v254, v255
    v_mfma_f32_32x32x16_bf16 v[144:159], v[48:51], a[220:223], v[144:159]
    ds_write_b128 v17, v[236:239] offset:15360
    v_fma_f32 v240, v249, v241, -v240
    v_mfma_f32_32x32x16_bf16 v[160:175], v[52:55], a[216:219], v[160:175]
    v_fma_f32 v242, v249, v243, -v242
    v_mfma_f32_32x32x16_bf16 v[176:191], v[52:55], a[220:223], v[176:191]
    s_waitcnt lgkmcnt(0)
    v_mfma_f32_32x32x16_bf16 v[128:143], v[24:27], a[224:227], v[128:143]
    ds_read_b64_tr_b16 v[40:41], v2 offset:36864
    ds_read_b64_tr_b16 v[42:43], v2 offset:38912
    v_lshrrev_b32 v6, 3, v0
    v_mfma_f32_32x32x16_bf16 v[144:159], v[24:27], a[228:231], v[144:159]
    ds_read_b64_tr_b16 v[44:45], v3 offset:36864
    ds_read_b64_tr_b16 v[46:47], v3 offset:38912
    v_lshlrev_b32 v6, 12, v6
    v_mfma_f32_32x32x16_bf16 v[160:175], v[28:31], a[224:227], v[160:175]
    ds_read_b64_tr_b16 v[48:49], v2 offset:37376
    ds_read_b64_tr_b16 v[50:51], v2 offset:39424
    v_bfe_u32 v7, v0, 4, 1
    v_mfma_f32_32x32x16_bf16 v[176:191], v[28:31], a[228:231], v[176:191]
    ds_read_b64_tr_b16 v[52:53], v3 offset:37376
    ds_read_b64_tr_b16 v[54:55], v3 offset:39424
    v_lshlrev_b32 v7, 2, v7
    v_mfma_f32_32x32x16_bf16 v[128:143], v[32:35], a[232:235], v[128:143]
    v_and_b32 v8, 7, v0
    v_xor_b32 v7, v7, v8
    v_lshl_add_u32 v6, v7, 4, v6
    v_mfma_f32_32x32x16_bf16 v[144:159], v[32:35], a[236:239], v[144:159]
    v_lshrrev_b32 v7, 4, v0
    v_min_u32 v7, 1, v7
    v_lshl_add_u32 v7, v7, 30, v6
    v_mfma_f32_32x32x16_bf16 v[160:175], v[36:39], a[232:235], v[160:175]
    v_bfe_u32 v18, v0, 2, 2
    v_lshrrev_b32 v8, 5, v0
    v_lshl_add_u32 v18, v8, 3, v18
    v_mfma_f32_32x32x16_bf16 v[176:191], v[36:39], a[236:239], v[176:191]
    v_lshlrev_b32 v18, 7, v18
    v_and_b32 v8, 1, v0
    v_lshl_add_u32 v18, v8, 5, v18
    s_waitcnt vmcnt(1) lgkmcnt(0)
    s_barrier
    v_mov_b32 v22, 3
    v_min_u32 v23, 1, v0
    v_lshlrev_b32 v23, 30, v23
    buffer_store_dword v22, v23, s[16:19], s84 offen sc0 sc1
    v_mfma_f32_32x32x16_bf16 v[128:143], v[40:43], a[240:243], v[128:143]
    ds_read_b64_tr_b16 v[24:25], v2 offset:40960
    ds_read_b64_tr_b16 v[26:27], v2 offset:43008
    v_bfe_u32 v8, v0, 1, 1
    v_mfma_f32_32x32x16_bf16 v[144:159], v[40:43], a[244:247], v[144:159]
    ds_read_b64_tr_b16 v[28:29], v3 offset:40960
    ds_read_b64_tr_b16 v[30:31], v3 offset:43008
    v_lshl_add_u32 v18, v8, 3, v18
    v_mfma_f32_32x32x16_bf16 v[160:175], v[44:47], a[240:243], v[160:175]
    ds_read_b64_tr_b16 v[32:33], v2 offset:41472
    ds_read_b64_tr_b16 v[34:35], v2 offset:43520
    v_bfe_u32 v8, v0, 4, 1
    v_mfma_f32_32x32x16_bf16 v[176:191], v[44:47], a[244:247], v[176:191]
    ds_read_b64_tr_b16 v[36:37], v3 offset:41472
    ds_read_b64_tr_b16 v[38:39], v3 offset:43520
    v_lshl_add_u32 v18, v8, 4, v18
    v_mfma_f32_32x32x16_bf16 v[128:143], v[48:51], a[248:251], v[128:143]
    v_bfe_u32 v8, v0, 3, 1
    v_lshl_add_u32 v18, v8, 6, v18
    v_add_u32 v20, 62208, v18
    v_mfma_f32_32x32x16_bf16 v[144:159], v[48:51], a[252:255], v[144:159]
    v_xor_b32 v21, 64, v20
    v_add_u32 v18, 32768, v20
    v_add_u32 v19, 32768, v21
    v_mfma_f32_32x32x16_bf16 v[160:175], v[52:55], a[248:251], v[160:175]
    v_min_u32 v1, 32, v0
    v_lshl_add_u32 v1, v1, 2, s78
    v_add_u32 v1, 2048, v1
    v_mfma_f32_32x32x16_bf16 v[176:191], v[52:55], a[252:255], v[176:191]
    v_fma_f32 v244, v249, v245, -v244
    s_waitcnt lgkmcnt(0)
    v_mfma_f32_32x32x16_bf16 v[128:143], v[24:27], v[192:195], v[128:143]
    ds_read_b64_tr_b16 v[40:41], v2 offset:45056
    ds_read_b64_tr_b16 v[42:43], v2 offset:47104
    v_fma_f32 v246, v249, v247, -v246
    v_fma_f32 v252, v248, v244, -v240
    v_mfma_f32_32x32x16_bf16 v[144:159], v[24:27], v[196:199], v[144:159]
    ds_read_b64_tr_b16 v[44:45], v3 offset:45056
    ds_read_b64_tr_b16 v[46:47], v3 offset:47104
    v_fma_f32 v253, v248, v246, -v242
    v_cvt_pk_bf16_f32 v236, v240, v242
    v_mfma_f32_32x32x16_bf16 v[160:175], v[28:31], v[192:195], v[160:175]
    ds_read_b64_tr_b16 v[48:49], v2 offset:45568
    ds_read_b64_tr_b16 v[50:51], v2 offset:47616
    v_cvt_pk_bf16_f32 v237, v244, v246
    v_fma_f32 v254, v248, v252, -v244
    v_mfma_f32_32x32x16_bf16 v[176:191], v[28:31], v[196:199], v[176:191]
    ds_read_b64_tr_b16 v[52:53], v3 offset:45568
    ds_read_b64_tr_b16 v[54:55], v3 offset:47616
    v_fma_f32 v255, v248, v253, -v246
    v_cvt_pk_bf16_f32 v238, v252, v253
    v_mfma_f32_32x32x16_bf16 v[128:143], v[32:35], v[200:203], v[128:143]
    v_cvt_pk_bf16_f32 v239, v254, v255
    ds_write_b128 v17, v[236:239] offset:16384
    v_mfma_f32_32x32x16_bf16 v[144:159], v[32:35], v[204:207], v[144:159]
    v_fma_f32 v241, v249, v240, -v241
    v_fma_f32 v243, v249, v242, -v243
    v_fma_f32 v245, v249, v244, -v245
    v_fma_f32 v247, v249, v246, -v247
    v_mfma_f32_32x32x16_bf16 v[160:175], v[36:39], v[200:203], v[160:175]
    v_mfma_f32_32x32x16_bf16 v[176:191], v[36:39], v[204:207], v[176:191]
    s_waitcnt lgkmcnt(0)
    s_barrier
    v_mfma_f32_32x32x16_bf16 v[128:143], v[40:43], v[208:211], v[128:143]
    ds_read_b64_tr_b16 v[24:25], v4 offset:0
    ds_read_b64_tr_b16 v[26:27], v4 offset:2048
    v_fma_f32 v252, v248, v245, -v241
    v_fma_f32 v253, v248, v247, -v243
    v_mfma_f32_32x32x16_bf16 v[144:159], v[40:43], v[212:215], v[144:159]
    ds_read_b64_tr_b16 v[28:29], v5 offset:0
    ds_read_b64_tr_b16 v[30:31], v5 offset:2048
    v_cvt_pk_bf16_f32 v236, v241, v243
    v_cvt_pk_bf16_f32 v237, v245, v247
    v_mfma_f32_32x32x16_bf16 v[160:175], v[44:47], v[208:211], v[160:175]
    ds_read_b64_tr_b16 v[32:33], v4 offset:512
    ds_read_b64_tr_b16 v[34:35], v4 offset:2560
    v_fma_f32 v254, v248, v252, -v245
    v_fma_f32 v255, v248, v253, -v247
    v_mfma_f32_32x32x16_bf16 v[176:191], v[44:47], v[212:215], v[176:191]
    ds_read_b64_tr_b16 v[36:37], v5 offset:512
    ds_read_b64_tr_b16 v[38:39], v5 offset:2560
    v_cvt_pk_bf16_f32 v238, v252, v253
    v_cvt_pk_bf16_f32 v239, v254, v255
    v_mfma_f32_32x32x16_bf16 v[128:143], v[48:51], v[216:219], v[128:143]
    ds_write_b128 v17, v[236:239] offset:17408
    v_fma_f32 v240, v249, v241, -v240
    v_mfma_f32_32x32x16_bf16 v[144:159], v[48:51], v[220:223], v[144:159]
    v_fma_f32 v242, v249, v243, -v242
    v_fma_f32 v244, v249, v245, -v244
    v_fma_f32 v246, v249, v247, -v246
    v_fma_f32 v252, v248, v244, -v240
    v_mfma_f32_32x32x16_bf16 v[160:175], v[52:55], v[216:219], v[160:175]
    v_mfma_f32_32x32x16_bf16 v[176:191], v[52:55], v[220:223], v[176:191]
    s_waitcnt lgkmcnt(0)
    v_mfma_f32_32x32x16_bf16 v[64:79], v[24:27], a[0:3], 0
    ds_read_b64_tr_b16 v[40:41], v4 offset:4096
    ds_read_b64_tr_b16 v[42:43], v4 offset:6144
    v_mfma_f32_32x32x16_bf16 v[80:95], v[24:27], a[4:7], 0
    ds_read_b64_tr_b16 v[44:45], v5 offset:4096
    ds_read_b64_tr_b16 v[46:47], v5 offset:6144
    v_mfma_f32_32x32x16_bf16 v[96:111], v[28:31], a[0:3], 0
    ds_read_b64_tr_b16 v[48:49], v4 offset:4608
    ds_read_b64_tr_b16 v[50:51], v4 offset:6656
    v_cvt_pk_bf16_f32 v128, v128, v129
    v_cvt_pk_bf16_f32 v129, v130, v131
    v_cvt_pk_bf16_f32 v130, v132, v133
    v_mfma_f32_32x32x16_bf16 v[112:127], v[28:31], a[4:7], 0
    ds_read_b64_tr_b16 v[52:53], v5 offset:4608
    ds_read_b64_tr_b16 v[54:55], v5 offset:6656
    v_cvt_pk_bf16_f32 v131, v134, v135
    v_cvt_pk_bf16_f32 v136, v136, v137
    v_cvt_pk_bf16_f32 v137, v138, v139
    v_mfma_f32_32x32x16_bf16 v[64:79], v[32:35], a[8:11], v[64:79]
    v_cvt_pk_bf16_f32 v138, v140, v141
    v_cvt_pk_bf16_f32 v139, v142, v143
    v_cvt_pk_bf16_f32 v144, v144, v145
    v_cvt_pk_bf16_f32 v145, v146, v147
    v_cvt_pk_bf16_f32 v146, v148, v149
    v_mfma_f32_32x32x16_bf16 v[80:95], v[32:35], a[12:15], v[80:95]
    v_cvt_pk_bf16_f32 v147, v150, v151
    v_cvt_pk_bf16_f32 v152, v152, v153
    v_cvt_pk_bf16_f32 v153, v154, v155
    v_cvt_pk_bf16_f32 v154, v156, v157
    v_cvt_pk_bf16_f32 v155, v158, v159
    v_mfma_f32_32x32x16_bf16 v[96:111], v[36:39], a[8:11], v[96:111]
    v_fma_f32 v253, v248, v246, -v242
    v_cvt_pk_bf16_f32 v236, v240, v242
    v_cvt_pk_bf16_f32 v237, v244, v246
    v_fma_f32 v254, v248, v252, -v244
    v_fma_f32 v255, v248, v253, -v246
    v_mfma_f32_32x32x16_bf16 v[112:127], v[36:39], a[12:15], v[112:127]
    v_cvt_pk_bf16_f32 v238, v252, v253
    v_cvt_pk_bf16_f32 v239, v254, v255
    ds_write_b128 v17, v[236:239] offset:18432
    s_waitcnt lgkmcnt(0)
    s_barrier
    v_mfma_f32_32x32x16_bf16 v[64:79], v[40:43], a[16:19], v[64:79]
    ds_read_b64_tr_b16 v[24:25], v4 offset:8192
    ds_read_b64_tr_b16 v[26:27], v4 offset:10240
    v_cvt_pk_bf16_f32 v160, v160, v161
    v_cvt_pk_bf16_f32 v161, v162, v163
    v_cvt_pk_bf16_f32 v162, v164, v165
    v_mfma_f32_32x32x16_bf16 v[80:95], v[40:43], a[20:23], v[80:95]
    ds_read_b64_tr_b16 v[28:29], v5 offset:8192
    ds_read_b64_tr_b16 v[30:31], v5 offset:10240
    v_cvt_pk_bf16_f32 v163, v166, v167
    v_cvt_pk_bf16_f32 v168, v168, v169
    v_cvt_pk_bf16_f32 v169, v170, v171
    v_mfma_f32_32x32x16_bf16 v[96:111], v[44:47], a[16:19], v[96:111]
    ds_read_b64_tr_b16 v[32:33], v4 offset:8704
    ds_read_b64_tr_b16 v[34:35], v4 offset:10752
    v_cvt_pk_bf16_f32 v170, v172, v173
    v_cvt_pk_bf16_f32 v171, v174, v175
    v_cvt_pk_bf16_f32 v176, v176, v177
    v_mfma_f32_32x32x16_bf16 v[112:127], v[44:47], a[20:23], v[112:127]
    ds_read_b64_tr_b16 v[36:37], v5 offset:8704
    ds_read_b64_tr_b16 v[38:39], v5 offset:10752
    v_cvt_pk_bf16_f32 v177, v178, v179
    v_cvt_pk_bf16_f32 v178, v180, v181
    v_cvt_pk_bf16_f32 v179, v182, v183
    v_mfma_f32_32x32x16_bf16 v[64:79], v[48:51], a[24:27], v[64:79]
    v_cvt_pk_bf16_f32 v184, v184, v185
    v_cvt_pk_bf16_f32 v185, v186, v187
    v_cvt_pk_bf16_f32 v186, v188, v189
    v_cvt_pk_bf16_f32 v187, v190, v191
    v_fmamk_f32 v242, v250, 0x40000000, v251
    v_mfma_f32_32x32x16_bf16 v[80:95], v[48:51], a[28:31], v[80:95]
    v_cos_f32 v240, v242
    v_sin_f32 v242, v242
    v_add_f32 v240, v240, v240
    v_mfma_f32_32x32x16_bf16 v[96:111], v[52:55], a[24:27], v[96:111]
    v_mul_f32 v242, -2.0, v242
    v_fmamk_f32 v243, v250, 0xc1f00000, v251
    v_cos_f32 v241, v243
    v_mfma_f32_32x32x16_bf16 v[112:127], v[52:55], a[28:31], v[112:127]
    v_sin_f32 v243, v243
    v_add_f32 v241, v241, v241
    v_mul_f32 v243, -2.0, v243
    s_waitcnt lgkmcnt(0)
    v_mfma_f32_32x32x16_bf16 v[64:79], v[24:27], a[32:35], v[64:79]
    ds_read_b64_tr_b16 v[40:41], v4 offset:12288
    ds_read_b64_tr_b16 v[42:43], v4 offset:14336
    v_fmamk_f32 v246, v250, 0x40c00000, v251
    v_cos_f32 v244, v246
    v_mfma_f32_32x32x16_bf16 v[80:95], v[24:27], a[36:39], v[80:95]
    ds_read_b64_tr_b16 v[44:45], v5 offset:12288
    ds_read_b64_tr_b16 v[46:47], v5 offset:14336
    v_sin_f32 v246, v246
    v_add_f32 v244, v244, v244
    v_mfma_f32_32x32x16_bf16 v[96:111], v[28:31], a[32:35], v[96:111]
    ds_read_b64_tr_b16 v[48:49], v4 offset:12800
    ds_read_b64_tr_b16 v[50:51], v4 offset:14848
    v_mul_f32 v246, -2.0, v246
    v_fmamk_f32 v247, v250, 0xc1d00000, v251
    v_mfma_f32_32x32x16_bf16 v[112:127], v[28:31], a[36:39], v[112:127]
    ds_read_b64_tr_b16 v[52:53], v5 offset:12800
    ds_read_b64_tr_b16 v[54:55], v5 offset:14848
    v_cos_f32 v245, v247
    v_mfma_f32_32x32x16_bf16 v[64:79], v[32:35], a[40:43], v[64:79]
    v_sin_f32 v247, v247
    v_add_f32 v245, v245, v245
    v_mul_f32 v247, -2.0, v247
    v_fma_f32 v252, v248, v244, -v240
    v_mfma_f32_32x32x16_bf16 v[80:95], v[32:35], a[44:47], v[80:95]
    v_fma_f32 v253, v248, v246, -v242
    v_cvt_pk_bf16_f32 v236, v240, v242
    v_cvt_pk_bf16_f32 v237, v244, v246
    v_fma_f32 v254, v248, v252, -v244
    v_fma_f32 v255, v248, v253, -v246
    v_mfma_f32_32x32x16_bf16 v[96:111], v[36:39], a[40:43], v[96:111]
    v_cvt_pk_bf16_f32 v238, v252, v253
    v_cvt_pk_bf16_f32 v239, v254, v255
    v_accvgpr_write_b32 a0, v236
    v_accvgpr_write_b32 a1, v237
    v_accvgpr_write_b32 a2, v238
    v_mfma_f32_32x32x16_bf16 v[112:127], v[36:39], a[44:47], v[112:127]
    v_accvgpr_write_b32 a3, v239
    v_fma_f32 v241, v249, v240, -v241
    v_fma_f32 v243, v249, v242, -v243
    v_fma_f32 v245, v249, v244, -v245
    v_fma_f32 v247, v249, v246, -v247
    s_waitcnt lgkmcnt(0)
    s_barrier
    v_mfma_f32_32x32x16_bf16 v[64:79], v[40:43], a[48:51], v[64:79]
    ds_read_b64_tr_b16 v[24:25], v4 offset:16384
    ds_read_b64_tr_b16 v[26:27], v4 offset:18432
    v_fma_f32 v252, v248, v245, -v241
    v_fma_f32 v253, v248, v247, -v243
    v_cvt_pk_bf16_f32 v236, v241, v243
    v_cvt_pk_bf16_f32 v237, v245, v247
    v_mfma_f32_32x32x16_bf16 v[80:95], v[40:43], a[52:55], v[80:95]
    ds_read_b64_tr_b16 v[28:29], v5 offset:16384
    ds_read_b64_tr_b16 v[30:31], v5 offset:18432
    v_fma_f32 v254, v248, v252, -v245
    v_fma_f32 v255, v248, v253, -v247
    v_cvt_pk_bf16_f32 v238, v252, v253
    v_cvt_pk_bf16_f32 v239, v254, v255
    v_mfma_f32_32x32x16_bf16 v[96:111], v[44:47], a[48:51], v[96:111]
    ds_read_b64_tr_b16 v[32:33], v4 offset:16896
    ds_read_b64_tr_b16 v[34:35], v4 offset:18944
    v_accvgpr_write_b32 a4, v236
    v_accvgpr_write_b32 a5, v237
    v_accvgpr_write_b32 a6, v238
    v_accvgpr_write_b32 a7, v239
    v_mfma_f32_32x32x16_bf16 v[112:127], v[44:47], a[52:55], v[112:127]
    ds_read_b64_tr_b16 v[36:37], v5 offset:16896
    ds_read_b64_tr_b16 v[38:39], v5 offset:18944
    v_fma_f32 v240, v249, v241, -v240
    v_fma_f32 v242, v249, v243, -v242
    v_fma_f32 v244, v249, v245, -v244
    v_fma_f32 v246, v249, v247, -v246
    v_mfma_f32_32x32x16_bf16 v[64:79], v[48:51], a[56:59], v[64:79]
    buffer_load_dword v10, v13, s[16:19], s75 offen sc0 sc1
    v_fma_f32 v252, v248, v244, -v240
    v_fma_f32 v253, v248, v246, -v242
    v_cvt_pk_bf16_f32 v236, v240, v242
    v_mfma_f32_32x32x16_bf16 v[80:95], v[48:51], a[60:63], v[80:95]
    s_add_u32 s57, s76, 4096
    buffer_store_dwordx4 v[128:131], v14, s[16:19], s57 offen offset:0 sc0 sc1
    v_cvt_pk_bf16_f32 v237, v244, v246
    v_fma_f32 v254, v248, v252, -v244
    v_mfma_f32_32x32x16_bf16 v[96:111], v[52:55], a[56:59], v[96:111]
    buffer_store_dwordx4 v[136:139], v14, s[16:19], s57 offen offset:1024 sc0 sc1
    v_fma_f32 v255, v248, v253, -v246
    v_cvt_pk_bf16_f32 v238, v252, v253
    v_mfma_f32_32x32x16_bf16 v[112:127], v[52:55], a[60:63], v[112:127]
    v_cvt_pk_bf16_f32 v239, v254, v255
    v_accvgpr_write_b32 a8, v236
    v_accvgpr_write_b32 a9, v237
    s_waitcnt lgkmcnt(0)
    v_mfma_f32_32x32x16_bf16 v[64:79], v[24:27], a[64:67], v[64:79]
    ds_read_b64_tr_b16 v[40:41], v4 offset:20480
    ds_read_b64_tr_b16 v[42:43], v4 offset:22528
    v_accvgpr_write_b32 a10, v238
    v_accvgpr_write_b32 a11, v239
    v_fma_f32 v241, v249, v240, -v241
    v_fma_f32 v243, v249, v242, -v243
    v_mfma_f32_32x32x16_bf16 v[80:95], v[24:27], a[68:71], v[80:95]
    ds_read_b64_tr_b16 v[44:45], v5 offset:20480
    ds_read_b64_tr_b16 v[46:47], v5 offset:22528
    v_fma_f32 v245, v249, v244, -v245
    v_fma_f32 v247, v249, v246, -v247
    v_fma_f32 v252, v248, v245, -v241
    v_fma_f32 v253, v248, v247, -v243
    v_mfma_f32_32x32x16_bf16 v[96:111], v[28:31], a[64:67], v[96:111]
    ds_read_b64_tr_b16 v[48:49], v4 offset:20992
    ds_read_b64_tr_b16 v[50:51], v4 offset:23040
    v_cvt_pk_bf16_f32 v236, v241, v243
    v_cvt_pk_bf16_f32 v237, v245, v247
    v_fma_f32 v254, v248, v252, -v245
    v_fma_f32 v255, v248, v253, -v247
    v_mfma_f32_32x32x16_bf16 v[112:127], v[28:31], a[68:71], v[112:127]
    ds_read_b64_tr_b16 v[52:53], v5 offset:20992
    ds_read_b64_tr_b16 v[54:55], v5 offset:23040
    v_cvt_pk_bf16_f32 v238, v252, v253
    v_cvt_pk_bf16_f32 v239, v254, v255
    v_accvgpr_write_b32 a12, v236
    v_accvgpr_write_b32 a13, v237
    v_mfma_f32_32x32x16_bf16 v[64:79], v[32:35], a[72:75], v[64:79]
    s_add_u32 s57, s76, 40960
    buffer_store_dwordx4 v[144:147], v14, s[16:19], s57 offen offset:0 sc0 sc1
    v_accvgpr_write_b32 a14, v238
    v_accvgpr_write_b32 a15, v239
    v_mfma_f32_32x32x16_bf16 v[80:95], v[32:35], a[76:79], v[80:95]
    buffer_store_dwordx4 v[152:155], v14, s[16:19], s57 offen offset:1024 sc0 sc1
    v_fma_f32 v240, v249, v241, -v240
    v_fma_f32 v242, v249, v243, -v242
    v_mfma_f32_32x32x16_bf16 v[96:111], v[36:39], a[72:75], v[96:111]
    v_fma_f32 v244, v249, v245, -v244
    v_fma_f32 v246, v249, v247, -v246
    v_fma_f32 v252, v248, v244, -v240
    v_fma_f32 v253, v248, v246, -v242
    v_cvt_pk_bf16_f32 v236, v240, v242
    v_cvt_pk_bf16_f32 v237, v244, v246
    v_mfma_f32_32x32x16_bf16 v[112:127], v[36:39], a[76:79], v[112:127]
    s_waitcnt lgkmcnt(0)
    s_barrier
    v_mfma_f32_32x32x16_bf16 v[64:79], v[40:43], a[80:83], v[64:79]
    ds_read_b64_tr_b16 v[24:25], v4 offset:24576
    ds_read_b64_tr_b16 v[26:27], v4 offset:26624
    v_fma_f32 v254, v248, v252, -v244
    v_fma_f32 v255, v248, v253, -v246
    v_cvt_pk_bf16_f32 v238, v252, v253
    v_cvt_pk_bf16_f32 v239, v254, v255
    v_mfma_f32_32x32x16_bf16 v[80:95], v[40:43], a[84:87], v[80:95]
    ds_read_b64_tr_b16 v[28:29], v5 offset:24576
    ds_read_b64_tr_b16 v[30:31], v5 offset:26624
    v_accvgpr_write_b32 a16, v236
    v_accvgpr_write_b32 a17, v237
    v_accvgpr_write_b32 a18, v238
    v_accvgpr_write_b32 a19, v239
    v_mfma_f32_32x32x16_bf16 v[96:111], v[44:47], a[80:83], v[96:111]
    ds_read_b64_tr_b16 v[32:33], v4 offset:25088
    ds_read_b64_tr_b16 v[34:35], v4 offset:27136
    v_fma_f32 v241, v249, v240, -v241
    v_fma_f32 v243, v249, v242, -v243
    v_fma_f32 v245, v249, v244, -v245
    v_fma_f32 v247, v249, v246, -v247
    v_mfma_f32_32x32x16_bf16 v[112:127], v[44:47], a[84:87], v[112:127]
    ds_read_b64_tr_b16 v[36:37], v5 offset:25088
    ds_read_b64_tr_b16 v[38:39], v5 offset:27136
    v_fma_f32 v252, v248, v245, -v241
    v_fma_f32 v253, v248, v247, -v243
    v_cvt_pk_bf16_f32 v236, v241, v243
    v_cvt_pk_bf16_f32 v237, v245, v247
    v_mfma_f32_32x32x16_bf16 v[64:79], v[48:51], a[88:91], v[64:79]
    s_add_u32 s57, s76, 6144
    buffer_store_dwordx4 v[160:163], v14, s[16:19], s57 offen offset:0 sc0 sc1
    v_fma_f32 v254, v248, v252, -v245
    v_fma_f32 v255, v248, v253, -v247
    v_mfma_f32_32x32x16_bf16 v[80:95], v[48:51], a[92:95], v[80:95]
    buffer_store_dwordx4 v[168:171], v14, s[16:19], s57 offen offset:1024 sc0 sc1
    v_cvt_pk_bf16_f32 v238, v252, v253
    v_cvt_pk_bf16_f32 v239, v254, v255
    v_mfma_f32_32x32x16_bf16 v[96:111], v[52:55], a[88:91], v[96:111]
    v_accvgpr_write_b32 a20, v236
    v_accvgpr_write_b32 a21, v237
    v_accvgpr_write_b32 a22, v238
    v_accvgpr_write_b32 a23, v239
    v_fma_f32 v240, v249, v241, -v240
    v_fma_f32 v242, v249, v243, -v242
    v_mfma_f32_32x32x16_bf16 v[112:127], v[52:55], a[92:95], v[112:127]
    s_waitcnt vmcnt(6)
    s_mov_b32 s62, 0
L_pw4:
    v_cmp_le_u32 vcc, 3, v10
    s_nop 0
    s_cmp_eq_u64 vcc, -1
    s_cbranch_scc1 L_pok4
    s_add_u32 s62, s62, 1
    s_cmp_ge_u32 s62, 100000
    s_cbranch_scc1 L_pok4
    s_sleep 4
    buffer_load_dword v10, v13, s[16:19], s75 offen sc0 sc1
    s_waitcnt vmcnt(0)
    s_branch L_pw4
L_pok4:
    s_waitcnt lgkmcnt(0)
    v_mfma_f32_32x32x16_bf16 v[64:79], v[24:27], a[96:99], v[64:79]
    ds_read_b64_tr_b16 v[40:41], v4 offset:28672
    ds_read_b64_tr_b16 v[42:43], v4 offset:30720
    v_fma_f32 v244, v249, v245, -v244
    v_fma_f32 v246, v249, v247, -v246
    v_fma_f32 v252, v248, v244, -v240
    v_fma_f32 v253, v248, v246, -v242
    v_cvt_pk_bf16_f32 v236, v240, v242
    v_mfma_f32_32x32x16_bf16 v[80:95], v[24:27], a[100:103], v[80:95]
    ds_read_b64_tr_b16 v[44:45], v5 offset:28672
    ds_read_b64_tr_b16 v[46:47], v5 offset:30720
    v_cvt_pk_bf16_f32 v237, v244, v246
    v_fma_f32 v254, v248, v252, -v244
    v_fma_f32 v255, v248, v253, -v246
    v_cvt_pk_bf16_f32 v238, v252, v253
    v_cvt_pk_bf16_f32 v239, v254, v255
    v_mfma_f32_32x32x16_bf16 v[96:111], v[28:31], a[96:99], v[96:111]
    ds_read_b64_tr_b16 v[48:49], v4 offset:29184
    ds_read_b64_tr_b16 v[50:51], v4 offset:31232
    v_accvgpr_write_b32 a24, v236
    v_accvgpr_write_b32 a25, v237
    v_accvgpr_write_b32 a26, v238
    v_accvgpr_write_b32 a27, v239
    v_fma_f32 v241, v249, v240, -v241
    v_mfma_f32_32x32x16_bf16 v[112:127], v[28:31], a[100:103], v[112:127]
    ds_read_b64_tr_b16 v[52:53], v5 offset:29184
    ds_read_b64_tr_b16 v[54:55], v5 offset:31232
    v_fma_f32 v243, v249, v242, -v243
    v_fma_f32 v245, v249, v244, -v245
    v_fma_f32 v247, v249, v246, -v247
    v_fma_f32 v252, v248, v245, -v241
    v_fma_f32 v253, v248, v247, -v243
    v_mfma_f32_32x32x16_bf16 v[64:79], v[32:35], a[104:107], v[64:79]
    s_add_u32 s57, s76, 43008
    buffer_store_dwordx4 v[176:179], v14, s[16:19], s57 offen offset:0 sc0 sc1
    v_cvt_pk_bf16_f32 v236, v241, v243
    v_cvt_pk_bf16_f32 v237, v245, v247
    v_fma_f32 v254, v248, v252, -v245
    v_mfma_f32_32x32x16_bf16 v[80:95], v[32:35], a[108:111], v[80:95]
    buffer_store_dwordx4 v[184:187], v14, s[16:19], s57 offen offset:1024 sc0 sc1
    v_fma_f32 v255, v248, v253, -v247
    v_cvt_pk_bf16_f32 v238, v252, v253
    v_cvt_pk_bf16_f32 v239, v254, v255
    v_mfma_f32_32x32x16_bf16 v[96:111], v[36:39], a[104:107], v[96:111]
    s_add_u32 m0, s55, 86784
    s_add_u32 s58, s64, 0
    buffer_load_dwordx4 v6, s[16:19], s58 offen sc1 lds
    v_mfma_f32_32x32x16_bf16 v[112:127], v[36:39], a[108:111], v[112:127]
    s_add_u32 m0, s55, 90880
    s_add_u32 s58, s64, 131072
    buffer_load_dwordx4 v6, s[16:19], s58 offen sc1 lds
    s_waitcnt lgkmcnt(0)
    s_barrier
    v_mfma_f32_32x32x16_bf16 v[64:79], v[40:43], a[112:115], v[64:79]
    ds_read_b64_tr_b16 v[24:25], v4 offset:32768
    ds_read_b64_tr_b16 v[26:27], v4 offset:34816
    v_accvgpr_write_b32 a28, v236
    v_accvgpr_write_b32 a29, v237
    v_accvgpr_write_b32 a30, v238
    v_accvgpr_write_b32 a31, v239
    v_fma_f32 v240, v249, v241, -v240
    v_fma_f32 v242, v249, v243, -v242
    v_mfma_f32_32x32x16_bf16 v[80:95], v[40:43], a[116:119], v[80:95]
    ds_read_b64_tr_b16 v[28:29], v5 offset:32768
    ds_read_b64_tr_b16 v[30:31], v5 offset:34816
    v_fma_f32 v244, v249, v245, -v244
    v_fma_f32 v246, v249, v247, -v246
    v_fma_f32 v252, v248, v244, -v240
    v_fma_f32 v253, v248, v246, -v242
    v_cvt_pk_bf16_f32 v236, v240, v242
    v_cvt_pk_bf16_f32 v237, v244, v246
    v_mfma_f32_32x32x16_bf16 v[96:111], v[44:47], a[112:115], v[96:111]
    ds_read_b64_tr_b16 v[32:33], v4 offset:33280
    ds_read_b64_tr_b16 v[34:35], v4 offset:35328
    v_fma_f32 v254, v248, v252, -v244
    v_fma_f32 v255, v248, v253, -v246
    v_cvt_pk_bf16_f32 v238, v252, v253
    v_cvt_pk_bf16_f32 v239, v254, v255
    v_accvgpr_write_b32 a32, v236
    v_accvgpr_write_b32 a33, v237
    v_mfma_f32_32x32x16_bf16 v[112:127], v[44:47], a[116:119], v[112:127]
    ds_read_b64_tr_b16 v[36:37], v5 offset:33280
    ds_read_b64_tr_b16 v[38:39], v5 offset:35328
    v_accvgpr_write_b32 a34, v238
    v_accvgpr_write_b32 a35, v239
    v_fmamk_f32 v242, v250, 0x40400000, v251
    v_cos_f32 v240, v242
    v_mfma_f32_32x32x16_bf16 v[64:79], v[48:51], a[120:123], v[64:79]
    s_add_u32 m0, s55, 94976
    s_add_u32 s58, s64, 262144
    buffer_load_dwordx4 v6, s[16:19], s58 offen sc1 lds
    v_sin_f32 v242, v242
    v_add_f32 v240, v240, v240
    v_mfma_f32_32x32x16_bf16 v[80:95], v[48:51], a[124:127], v[80:95]
    s_add_u32 m0, s55, 99072
    s_add_u32 s58, s64, 393216
    buffer_load_dwordx4 v6, s[16:19], s58 offen sc1 lds
    v_mul_f32 v242, -2.0, v242
    v_fmamk_f32 v243, v250, 0xc1e80000, v251
    v_mfma_f32_32x32x16_bf16 v[96:111], v[52:55], a[120:123], v[96:111]
    s_add_u32 m0, s55, 103168
    s_add_u32 s58, s64, 524288
    buffer_load_dwordx4 v6, s[16:19], s58 offen sc1 lds
    v_mfma_f32_32x32x16_bf16 v[112:127], v[52:55], a[124:127], v[112:127]
    s_add_u32 m0, s55, 107264
    s_add_u32 s58, s64, 655360
    buffer_load_dwordx4 v6, s[16:19], s58 offen sc1 lds
    s_waitcnt lgkmcnt(0)
    v_mfma_f32_32x32x16_bf16 v[64:79], v[24:27], a[128:131], v[64:79]
    ds_read_b64_tr_b16 v[40:41], v4 offset:36864
    ds_read_b64_tr_b16 v[42:43], v4 offset:38912
    v_cos_f32 v241, v243
    v_sin_f32 v243, v243
    v_add_f32 v241, v241, v241
    v_mul_f32 v243, -2.0, v243
    v_mfma_f32_32x32x16_bf16 v[80:95], v[24:27], a[132:135], v[80:95]
    ds_read_b64_tr_b16 v[44:45], v5 offset:36864
    ds_read_b64_tr_b16 v[46:47], v5 offset:38912
    v_fmamk_f32 v246, v250, 0x40e00000, v251
    v_cos_f32 v244, v246
    v_sin_f32 v246, v246
    v_add_f32 v244, v244, v244
    v_mfma_f32_32x32x16_bf16 v[96:111], v[28:31], a[128:131], v[96:111]
    ds_read_b64_tr_b16 v[48:49], v4 offset:37376
    ds_read_b64_tr_b16 v[50:51], v4 offset:39424
    v_mul_f32 v246, -2.0, v246
    v_fmamk_f32 v247, v250, 0xc1c80000, v251
    v_cos_f32 v245, v247
    v_sin_f32 v247, v247
    v_mfma_f32_32x32x16_bf16 v[112:127], v[28:31], a[132:135], v[112:127]
    ds_read_b64_tr_b16 v[52:53], v5 offset:37376
    ds_read_b64_tr_b16 v[54:55], v5 offset:39424
    v_add_f32 v245, v245, v245
    v_mul_f32 v247, -2.0, v247
    v_fma_f32 v252, v248, v244, -v240
    v_fma_f32 v253, v248, v246, -v242
    v_cvt_pk_bf16_f32 v236, v240, v242
    v_cvt_pk_bf16_f32 v237, v244, v246
    v_mfma_f32_32x32x16_bf16 v[64:79], v[32:35], a[136:139], v[64:79]
    s_add_u32 m0, s55, 111360
    s_add_u32 s58, s64, 786432
    buffer_load_dwordx4 v6, s[16:19], s58 offen sc1 lds
    v_fma_f32 v254, v248, v252, -v244
    v_fma_f32 v255, v248, v253, -v246
    v_cvt_pk_bf16_f32 v238, v252, v253
    v_mfma_f32_32x32x16_bf16 v[80:95], v[32:35], a[140:143], v[80:95]
    s_add_u32 m0, s55, 115456
    s_add_u32 s58, s64, 917504
    buffer_load_dwordx4 v6, s[16:19], s58 offen sc1 lds
    v_cvt_pk_bf16_f32 v239, v254, v255
    v_accvgpr_write_b32 a36, v236
    v_accvgpr_write_b32 a37, v237
    v_mfma_f32_32x32x16_bf16 v[96:111], v[36:39], a[136:139], v[96:111]
    s_add_u32 m0, s55, 119552
    s_add_u32 s58, s64, 1048576
    buffer_load_dwordx4 v6, s[16:19], s58 offen sc1 lds
    v_accvgpr_write_b32 a38, v238
    v_accvgpr_write_b32 a39, v239
    v_mfma_f32_32x32x16_bf16 v[112:127], v[36:39], a[140:143], v[112:127]
    s_add_u32 m0, s55, 123648
    s_add_u32 s58, s64, 1179648
    buffer_load_dwordx4 v6, s[16:19], s58 offen sc1 lds
    s_waitcnt lgkmcnt(0)
    s_barrier
    v_mfma_f32_32x32x16_bf16 v[64:79], v[40:43], a[144:147], v[64:79]
    ds_read_b64_tr_b16 v[24:25], v4 offset:40960
    ds_read_b64_tr_b16 v[26:27], v4 offset:43008
    v_fma_f32 v241, v249, v240, -v241
    v_fma_f32 v243, v249, v242, -v243
    v_fma_f32 v245, v249, v244, -v245
    v_fma_f32 v247, v249, v246, -v247
    v_fma_f32 v252, v248, v245, -v241
    v_mfma_f32_32x32x16_bf16 v[80:95], v[40:43], a[148:151], v[80:95]
    ds_read_b64_tr_b16 v[28:29], v4 offset:41472
    ds_read_b64_tr_b16 v[30:31], v4 offset:43520
    v_fma_f32 v253, v248, v247, -v243
    v_cvt_pk_bf16_f32 v236, v241, v243
    v_cvt_pk_bf16_f32 v237, v245, v247
    v_fma_f32 v254, v248, v252, -v245
    v_fma_f32 v255, v248, v253, -v247
    v_mfma_f32_32x32x16_bf16 v[96:111], v[44:47], a[144:147], v[96:111]
    ds_read_b64_tr_b16 v[32:33], v4 offset:45056
    ds_read_b64_tr_b16 v[34:35], v4 offset:47104
    v_cvt_pk_bf16_f32 v238, v252, v253
    v_cvt_pk_bf16_f32 v239, v254, v255
    v_accvgpr_write_b32 a40, v236
    v_accvgpr_write_b32 a41, v237
    v_accvgpr_write_b32 a42, v238
    v_mfma_f32_32x32x16_bf16 v[112:127], v[44:47], a[148:151], v[112:127]
    ds_read_b64_tr_b16 v[36:37], v4 offset:45568
    ds_read_b64_tr_b16 v[38:39], v4 offset:47616
    v_accvgpr_write_b32 a43, v239
    v_fma_f32 v240, v249, v241, -v240
    v_fma_f32 v242, v249, v243, -v242
    v_fma_f32 v244, v249, v245, -v244
    v_fma_f32 v246, v249, v247, -v246
    v_mfma_f32_32x32x16_bf16 v[64:79], v[48:51], a[152:155], v[64:79]
    s_add_u32 m0, s55, 127744
    s_add_u32 s58, s64, 1310720
    buffer_load_dwordx4 v6, s[16:19], s58 offen sc1 lds
    v_fma_f32 v252, v248, v244, -v240
    v_fma_f32 v253, v248, v246, -v242
    v_mfma_f32_32x32x16_bf16 v[80:95], v[48:51], a[156:159], v[80:95]
    s_add_u32 m0, s55, 131840
    s_add_u32 s58, s64, 1441792
    buffer_load_dwordx4 v6, s[16:19], s58 offen sc1 lds
    v_cvt_pk_bf16_f32 v236, v240, v242
    v_cvt_pk_bf16_f32 v237, v244, v246
    v_mfma_f32_32x32x16_bf16 v[96:111], v[52:55], a[152:155], v[96:111]
    s_add_u32 m0, s55, 135936
    s_add_u32 s58, s64, 1572864
    buffer_load_dwordx4 v6, s[16:19], s58 offen sc1 lds
    v_fma_f32 v254, v248, v252, -v244
    v_fma_f32 v255, v248, v253, -v246
    v_mfma_f32_32x32x16_bf16 v[112:127], v[52:55], a[156:159], v[112:127]
    s_add_u32 m0, s55, 140032
    s_add_u32 s58, s64, 1703936
    buffer_load_dwordx4 v6, s[16:19], s58 offen sc1 lds
    s_waitcnt lgkmcnt(0)
    v_mfma_f32_32x32x16_bf16 v[64:79], v[24:27], a[160:163], v[64:79]
    ds_read_b64_tr_b16 v[40:41], v2 offset:0
    ds_read_b64_tr_b16 v[42:43], v2 offset:2048
    v_cvt_pk_bf16_f32 v238, v252, v253
    v_cvt_pk_bf16_f32 v239, v254, v255
    v_accvgpr_write_b32 a44, v236
    v_accvgpr_write_b32 a45, v237
    v_mfma_f32_32x32x16_bf16 v[80:95], v[24:27], a[164:167], v[80:95]
    ds_read_b64_tr_b16 v[44:45], v2 offset:512
    ds_read_b64_tr_b16 v[46:47], v2 offset:2560
    v_accvgpr_write_b32 a46, v238
    v_accvgpr_write_b32 a47, v239
    v_fma_f32 v241, v249, v240, -v241
    v_fma_f32 v243, v249, v242, -v243
    v_mfma_f32_32x32x16_bf16 v[64:79], v[28:31], a[168:171], v[64:79]
    ds_read_b64_tr_b16 v[48:49], v2 offset:4096
    ds_read_b64_tr_b16 v[50:51], v2 offset:6144
    v_fma_f32 v245, v249, v244, -v245
    v_fma_f32 v247, v249, v246, -v247
    v_fma_f32 v252, v248, v245, -v241
    v_fma_f32 v253, v248, v247, -v243
    v_mfma_f32_32x32x16_bf16 v[80:95], v[28:31], a[172:175], v[80:95]
    ds_read_b64_tr_b16 v[52:53], v2 offset:4608
    ds_read_b64_tr_b16 v[54:55], v2 offset:6656
    v_cvt_pk_bf16_f32 v236, v241, v243
    v_cvt_pk_bf16_f32 v237, v245, v247
    v_fma_f32 v254, v248, v252, -v245
    v_fma_f32 v255, v248, v253, -v247
    v_mfma_f32_32x32x16_bf16 v[64:79], v[32:35], a[176:179], v[64:79]
    buffer_load_dword v15, v12, s[16:19], s75 offen sc0 sc1
    v_cvt_pk_bf16_f32 v238, v252, v253
    v_cvt_pk_bf16_f32 v239, v254, v255
    v_accvgpr_write_b32 a48, v236
    v_mfma_f32_32x32x16_bf16 v[80:95], v[32:35], a[180:183], v[80:95]
    s_add_u32 m0, s55, 144128
    s_add_u32 s58, s64, 1835008
    buffer_load_dwordx4 v6, s[16:19], s58 offen sc1 lds
    v_accvgpr_write_b32 a49, v237
    v_mfma_f32_32x32x16_bf16 v[64:79], v[36:39], a[184:187], v[64:79]
    s_add_u32 m0, s55, 148224
    s_add_u32 s58, s64, 1966080
    buffer_load_dwordx4 v6, s[16:19], s58 offen sc1 lds
    v_accvgpr_write_b32 a50, v238
    v_mfma_f32_32x32x16_bf16 v[80:95], v[36:39], a[188:191], v[80:95]
    v_accvgpr_write_b32 a51, v239
    v_fma_f32 v240, v249, v241, -v240
    v_fma_f32 v242, v249, v243, -v242
    v_fma_f32 v244, v249, v245, -v244
    v_fma_f32 v246, v249, v247, -v246
    s_waitcnt vmcnt(17) lgkmcnt(0)
    s_barrier
    v_mov_b32 v22, 4
    v_min_u32 v23, 1, v0
    v_lshlrev_b32 v23, 30, v23
    buffer_store_dword v22, v23, s[16:19], s84 offen sc0 sc1
    v_mfma_f32_32x32x16_bf16 v[64:79], v[40:43], a[192:195], v[64:79]
    ds_read_b64_tr_b16 v[24:25], v2 offset:8192
    ds_read_b64_tr_b16 v[26:27], v2 offset:10240
    v_fma_f32 v252, v248, v244, -v240
    v_fma_f32 v253, v248, v246, -v242
    v_cvt_pk_bf16_f32 v236, v240, v242
    v_mfma_f32_32x32x16_bf16 v[80:95], v[40:43], a[196:199], v[80:95]
    ds_read_b64_tr_b16 v[28:29], v2 offset:8704
    ds_read_b64_tr_b16 v[30:31], v2 offset:10752
    v_cvt_pk_bf16_f32 v237, v244, v246
    v_fma_f32 v254, v248, v252, -v244
    v_fma_f32 v255, v248, v253, -v246
    v_mfma_f32_32x32x16_bf16 v[64:79], v[44:47], a[200:203], v[64:79]
    ds_read_b64_tr_b16 v[32:33], v2 offset:12288
    ds_read_b64_tr_b16 v[34:35], v2 offset:14336
    v_cvt_pk_bf16_f32 v238, v252, v253
    v_cvt_pk_bf16_f32 v239, v254, v255
    v_accvgpr_write_b32 a52, v236
    v_mfma_f32_32x32x16_bf16 v[80:95], v[44:47], a[204:207], v[80:95]
    ds_read_b64_tr_b16 v[36:37], v2 offset:12800
    ds_read_b64_tr_b16 v[38:39], v2 offset:14848
    v_accvgpr_write_b32 a53, v237
    v_accvgpr_write_b32 a54, v238
    v_accvgpr_write_b32 a55, v239
    v_mfma_f32_32x32x16_bf16 v[64:79], v[48:51], a[208:211], v[64:79]
    v_fma_f32 v241, v249, v240, -v241
    v_fma_f32 v243, v249, v242, -v243
    v_fma_f32 v245, v249, v244, -v245
    v_fma_f32 v247, v249, v246, -v247
    v_fma_f32 v252, v248, v245, -v241
    v_mfma_f32_32x32x16_bf16 v[80:95], v[48:51], a[212:215], v[80:95]
    v_fma_f32 v253, v248, v247, -v243
    v_cvt_pk_bf16_f32 v236, v241, v243
    v_cvt_pk_bf16_f32 v237, v245, v247
    v_fma_f32 v254, v248, v252, -v245
    v_fma_f32 v255, v248, v253, -v247
    v_mfma_f32_32x32x16_bf16 v[64:79], v[52:55], a[216:219], v[64:79]
    v_cvt_pk_bf16_f32 v238, v252, v253
    v_cvt_pk_bf16_f32 v239, v254, v255
    v_accvgpr_write_b32 a56, v236
    v_accvgpr_write_b32 a57, v237
    v_mfma_f32_32x32x16_bf16 v[80:95], v[52:55], a[220:223], v[80:95]
    s_waitcnt lgkmcnt(0)
    v_mfma_f32_32x32x16_bf16 v[64:79], v[24:27], a[224:227], v[64:79]
    ds_read_b64_tr_b16 v[40:41], v2 offset:16384
    ds_read_b64_tr_b16 v[42:43], v2 offset:18432
    v_accvgpr_write_b32 a58, v238
    v_accvgpr_write_b32 a59, v239
    v_fma_f32 v240, v249, v241, -v240
    v_mfma_f32_32x32x16_bf16 v[80:95], v[24:27], a[228:231], v[80:95]
    ds_read_b64_tr_b16 v[44:45], v2 offset:16896
    ds_read_b64_tr_b16 v[46:47], v2 offset:18944
    v_fma_f32 v242, v249, v243, -v242
    v_fma_f32 v244, v249, v245, -v244
    v_fma_f32 v246, v249, v247, -v246
    v_mfma_f32_32x32x16_bf16 v[64:79], v[28:31], a[232:235], v[64:79]
    ds_read_b64_tr_b16 v[48:49], v2 offset:20480
    ds_read_b64_tr_b16 v[50:51], v2 offset:22528
    v_fma_f32 v252, v248, v244, -v240
    v_fma_f32 v253, v248, v246, -v242
    v_cvt_pk_bf16_f32 v236, v240, v242
    v_mfma_f32_32x32x16_bf16 v[80:95], v[28:31], a[236:239], v[80:95]
    ds_read_b64_tr_b16 v[52:53], v2 offset:20992
    ds_read_b64_tr_b16 v[54:55], v2 offset:23040
    v_cvt_pk_bf16_f32 v237, v244, v246
    v_fma_f32 v254, v248, v252, -v244
    v_fma_f32 v255, v248, v253, -v246
    v_mfma_f32_32x32x16_bf16 v[64:79], v[32:35], a[240:243], v[64:79]
    v_cvt_pk_bf16_f32 v238, v252, v253
    v_cvt_pk_bf16_f32 v239, v254, v255
    v_accvgpr_write_b32 a60, v236
    v_accvgpr_write_b32 a61, v237
    v_accvgpr_write_b32 a62, v238
    v_mfma_f32_32x32x16_bf16 v[80:95], v[32:35], a[244:247], v[80:95]
    v_accvgpr_write_b32 a63, v239
    v_fma_f32 v241, v249, v240, -v241
    v_fma_f32 v243, v249, v242, -v243
    v_fma_f32 v245, v249, v244, -v245
    v_fma_f32 v247, v249, v246, -v247
    v_mfma_f32_32x32x16_bf16 v[64:79], v[36:39], a[248:251], v[64:79]
    v_fma_f32 v252, v248, v245, -v241
    v_fma_f32 v253, v248, v247, -v243
    v_cvt_pk_bf16_f32 v236, v241, v243
    v_cvt_pk_bf16_f32 v237, v245, v247
    v_mfma_f32_32x32x16_bf16 v[80:95], v[36:39], a[252:255], v[80:95]
    s_waitcnt vmcnt(3)
    s_mov_b32 s62, 0
L_pw5:
    v_cmp_le_u32 vcc, 3, v15
    s_nop 0
    s_cmp_eq_u64 vcc, -1
    s_cbranch_scc1 L_pok5
    s_add_u32 s62, s62, 1
    s_cmp_ge_u32 s62, 100000
    s_cbranch_scc1 L_pok5
    s_sleep 1
    buffer_load_dword v15, v12, s[16:19], s75 offen sc0 sc1
    s_waitcnt vmcnt(0)
    s_branch L_pw5
L_pok5:
    s_waitcnt lgkmcnt(0)
    s_barrier
    v_mfma_f32_32x32x16_bf16 v[64:79], v[40:43], v[192:195], v[64:79]
    ds_read_b64_tr_b16 v[24:25], v5 offset:40960
    ds_read_b64_tr_b16 v[26:27], v5 offset:43008
    v_fma_f32 v254, v248, v252, -v245
    v_fma_f32 v255, v248, v253, -v247
    v_cvt_pk_bf16_f32 v238, v252, v253
    v_cvt_pk_bf16_f32 v239, v254, v255
    v_mfma_f32_32x32x16_bf16 v[80:95], v[40:43], v[196:199], v[80:95]
    ds_read_b64_tr_b16 v[28:29], v5 offset:41472
    ds_read_b64_tr_b16 v[30:31], v5 offset:43520
    v_accvgpr_write_b32 a64, v236
    v_accvgpr_write_b32 a65, v237
    v_accvgpr_write_b32 a66, v238
    v_accvgpr_write_b32 a67, v239
    v_mfma_f32_32x32x16_bf16 v[64:79], v[44:47], v[200:203], v[64:79]
    ds_read_b64_tr_b16 v[32:33], v5 offset:45056
    ds_read_b64_tr_b16 v[34:35], v5 offset:47104
    v_fma_f32 v240, v249, v241, -v240
    v_fma_f32 v242, v249, v243, -v242
    v_fma_f32 v244, v249, v245, -v244
    v_fma_f32 v246, v249, v247, -v246
    v_mfma_f32_32x32x16_bf16 v[80:95], v[44:47], v[204:207], v[80:95]
    ds_read_b64_tr_b16 v[36:37], v5 offset:45568
    ds_read_b64_tr_b16 v[38:39], v5 offset:47616
    v_fma_f32 v252, v248, v244, -v240
    v_fma_f32 v253, v248, v246, -v242
    v_cvt_pk_bf16_f32 v236, v240, v242
    v_cvt_pk_bf16_f32 v237, v244, v246
    v_mfma_f32_32x32x16_bf16 v[64:79], v[48:51], v[208:211], v[64:79]
    s_add_u32 s58, s67, 0
    buffer_load_dwordx4 a[72:75], v14, s[16:19], s58 offen sc1
    v_fma_f32 v254, v248, v252, -v244
    v_fma_f32 v255, v248, v253, -v246
    v_mfma_f32_32x32x16_bf16 v[80:95], v[48:51], v[212:215], v[80:95]
    s_add_u32 s58, s67, 2359296
    buffer_load_dwordx4 a[76:79], v14, s[16:19], s58 offen sc1
    v_cvt_pk_bf16_f32 v238, v252, v253
    v_cvt_pk_bf16_f32 v239, v254, v255
    v_mfma_f32_32x32x16_bf16 v[64:79], v[52:55], v[216:219], v[64:79]
    s_add_u32 s58, s67, 4718592
    buffer_load_dwordx4 a[80:83], v14, s[16:19], s58 offen sc1
    v_accvgpr_write_b32 a68, v236
    v_accvgpr_write_b32 a69, v237
    v_mfma_f32_32x32x16_bf16 v[80:95], v[52:55], v[220:223], v[80:95]
    s_add_u32 s58, s67, 7077888
    buffer_load_dwordx4 a[84:87], v14, s[16:19], s58 offen sc1
    v_accvgpr_write_b32 a70, v238
    v_accvgpr_write_b32 a71, v239
    s_waitcnt lgkmcnt(0)
    v_mfma_f32_32x32x16_bf16 v[96:111], v[24:27], a[160:163], v[96:111]
    ds_read_b64_tr_b16 v[40:41], v3 offset:0
    ds_read_b64_tr_b16 v[42:43], v3 offset:2048
    v_mfma_f32_32x32x16_bf16 v[112:127], v[24:27], a[164:167], v[112:127]
    ds_read_b64_tr_b16 v[44:45], v3 offset:512
    ds_read_b64_tr_b16 v[46:47], v3 offset:2560
    v_mfma_f32_32x32x16_bf16 v[96:111], v[28:31], a[168:171], v[96:111]
    ds_read_b64_tr_b16 v[48:49], v3 offset:4096
    ds_read_b64_tr_b16 v[50:51], v3 offset:6144
    v_cvt_pk_bf16_f32 v64, v64, v65
    v_cvt_pk_bf16_f32 v65, v66, v67
    v_cvt_pk_bf16_f32 v66, v68, v69
    v_cvt_pk_bf16_f32 v67, v70, v71
    v_mfma_f32_32x32x16_bf16 v[112:127], v[28:31], a[172:175], v[112:127]
    ds_read_b64_tr_b16 v[52:53], v3 offset:4608
    ds_read_b64_tr_b16 v[54:55], v3 offset:6656
    v_cvt_pk_bf16_f32 v72, v72, v73
    v_cvt_pk_bf16_f32 v73, v74, v75
    v_cvt_pk_bf16_f32 v74, v76, v77
    v_cvt_pk_bf16_f32 v75, v78, v79
    v_mfma_f32_32x32x16_bf16 v[96:111], v[32:35], a[176:179], v[96:111]
    s_add_u32 s58, s67, 9437184
    buffer_load_dwordx4 a[88:91], v14, s[16:19], s58 offen sc1
    v_cvt_pk_bf16_f32 v80, v80, v81
    v_cvt_pk_bf16_f32 v81, v82, v83
    v_mfma_f32_32x32x16_bf16 v[112:127], v[32:35], a[180:183], v[112:127]
    s_add_u32 s58, s67, 11796480
    buffer_load_dwordx4 a[92:95], v14, s[16:19], s58 offen sc1
    v_cvt_pk_bf16_f32 v82, v84, v85
    v_cvt_pk_bf16_f32 v83, v86, v87
    v_mfma_f32_32x32x16_bf16 v[96:111], v[36:39], a[184:187], v[96:111]
    s_add_u32 s58, s67, 14155776
    buffer_load_dwordx4 a[96:99], v14, s[16:19], s58 offen sc1
    v_cvt_pk_bf16_f32 v88, v88, v89
    v_cvt_pk_bf16_f32 v89, v90, v91
    v_mfma_f32_32x32x16_bf16 v[112:127], v[36:39], a[188:191], v[112:127]
    s_add_u32 s58, s67, 16515072
    buffer_load_dwordx4 a[100:103], v14, s[16:19], s58 offen sc1
    v_cvt_pk_bf16_f32 v90, v92, v93
    v_cvt_pk_bf16_f32 v91, v94, v95
    s_waitcnt lgkmcnt(0)
    s_barrier
    v_mfma_f32_32x32x16_bf16 v[96:111], v[40:43], a[192:195], v[96:111]
    ds_read_b64_tr_b16 v[24:25], v3 offset:8192
    ds_read_b64_tr_b16 v[26:27], v3 offset:10240
    v_mfma_f32_32x32x16_bf16 v[112:127], v[40:43], a[196:199], v[112:127]
    ds_read_b64_tr_b16 v[28:29], v3 offset:8704
    ds_read_b64_tr_b16 v[30:31], v3 offset:10752
    v_mfma_f32_32x32x16_bf16 v[96:111], v[44:47], a[200:203], v[96:111]
    ds_read_b64_tr_b16 v[32:33], v3 offset:12288
    ds_read_b64_tr_b16 v[34:35], v3 offset:14336
    v_mfma_f32_32x32x16_bf16 v[112:127], v[44:47], a[204:207], v[112:127]
    ds_read_b64_tr_b16 v[36:37], v3 offset:12800
    ds_read_b64_tr_b16 v[38:39], v3 offset:14848
    v_mfma_f32_32x32x16_bf16 v[96:111], v[48:51], a[208:211], v[96:111]
    s_add_u32 s57, s76, 8192
    buffer_store_dwordx4 v[64:67], v14, s[16:19], s57 offen offset:0 sc0 sc1
    v_mfma_f32_32x32x16_bf16 v[112:127], v[48:51], a[212:215], v[112:127]
    buffer_store_dwordx4 v[72:75], v14, s[16:19], s57 offen offset:1024 sc0 sc1
    v_mfma_f32_32x32x16_bf16 v[96:111], v[52:55], a[216:219], v[96:111]
    v_mfma_f32_32x32x16_bf16 v[112:127], v[52:55], a[220:223], v[112:127]
    s_waitcnt lgkmcnt(0)
    v_mfma_f32_32x32x16_bf16 v[96:111], v[24:27], a[224:227], v[96:111]
    ds_read_b64_tr_b16 v[40:41], v3 offset:16384
    ds_read_b64_tr_b16 v[42:43], v3 offset:18432
    v_mfma_f32_32x32x16_bf16 v[112:127], v[24:27], a[228:231], v[112:127]
    ds_read_b64_tr_b16 v[44:45], v3 offset:16896
    ds_read_b64_tr_b16 v[46:47], v3 offset:18944
    v_mfma_f32_32x32x16_bf16 v[96:111], v[28:31], a[232:235], v[96:111]
    ds_read_b64_tr_b16 v[48:49], v3 offset:20480
    ds_read_b64_tr_b16 v[50:51], v3 offset:22528
    v_mfma_f32_32x32x16_bf16 v[112:127], v[28:31], a[236:239], v[112:127]
    ds_read_b64_tr_b16 v[52:53], v3 offset:20992
    ds_read_b64_tr_b16 v[54:55], v3 offset:23040
    v_mfma_f32_32x32x16_bf16 v[96:111], v[32:35], a[240:243], v[96:111]
    buffer_load_dword v15, v12, s[16:19], s75 offen sc0 sc1
    v_mfma_f32_32x32x16_bf16 v[112:127], v[32:35], a[244:247], v[112:127]
    s_add_u32 s57, s76, 45056
    buffer_store_dwordx4 v[80:83], v14, s[16:19], s57 offen offset:0 sc0 sc1
    v_mfma_f32_32x32x16_bf16 v[96:111], v[36:39], a[248:251], v[96:111]
    buffer_store_dwordx4 v[88:91], v14, s[16:19], s57 offen offset:1024 sc0 sc1
    v_mfma_f32_32x32x16_bf16 v[112:127], v[36:39], a[252:255], v[112:127]
    s_waitcnt vmcnt(14) lgkmcnt(0)
    s_barrier
    v_mfma_f32_32x32x16_bf16 v[96:111], v[40:43], v[192:195], v[96:111]
    v_mfma_f32_32x32x16_bf16 v[112:127], v[40:43], v[196:199], v[112:127]
    v_mfma_f32_32x32x16_bf16 v[96:111], v[44:47], v[200:203], v[96:111]
    v_mfma_f32_32x32x16_bf16 v[112:127], v[44:47], v[204:207], v[112:127]
    v_mfma_f32_32x32x16_bf16 v[96:111], v[48:51], v[208:211], v[96:111]
    buffer_load_dword v10, v1, s[16:19], s75 offen sc0 sc1
    v_mfma_f32_32x32x16_bf16 v[112:127], v[48:51], v[212:215], v[112:127]
    v_mfma_f32_32x32x16_bf16 v[96:111], v[52:55], v[216:219], v[96:111]
    v_mfma_f32_32x32x16_bf16 v[112:127], v[52:55], v[220:223], v[112:127]
    ds_read_b64_tr_b16 v[24:25], v20 offset:24576
    ds_read_b64_tr_b16 v[26:27], v20 offset:25088
    ds_read_b64_tr_b16 v[28:29], v21 offset:24576
    ds_read_b64_tr_b16 v[30:31], v21 offset:25088
    ds_read_b128 v[128:131], v17 offset:0
    ds_read_b64_tr_b16 v[32:33], v20 offset:26624
    ds_read_b64_tr_b16 v[34:35], v20 offset:27136
    ds_read_b64_tr_b16 v[36:37], v21 offset:26624
    ds_read_b64_tr_b16 v[38:39], v21 offset:27136
    ds_read_b128 v[132:135], v17 offset:10240
    ds_read_b64_tr_b16 v[40:41], v20 offset:28672
    ds_read_b64_tr_b16 v[42:43], v20 offset:29184
    ds_read_b64_tr_b16 v[44:45], v21 offset:28672
    ds_read_b64_tr_b16 v[46:47], v21 offset:29184
    v_cvt_pk_bf16_f32 v96, v96, v97
    v_cvt_pk_bf16_f32 v97, v98, v99
    v_cvt_pk_bf16_f32 v98, v100, v101
    v_cvt_pk_bf16_f32 v99, v102, v103
    s_add_u32 s57, s76, 10240
    buffer_store_dwordx4 v[96:99], v14, s[16:19], s57 offen offset:0 sc0 sc1
    v_cvt_pk_bf16_f32 v104, v104, v105
    v_cvt_pk_bf16_f32 v105, v106, v107
    v_cvt_pk_bf16_f32 v106, v108, v109
    v_cvt_pk_bf16_f32 v107, v110, v111
    buffer_store_dwordx4 v[104:107], v14, s[16:19], s57 offen offset:1024 sc0 sc1
    v_cvt_pk_bf16_f32 v112, v112, v113
    v_cvt_pk_bf16_f32 v113, v114, v115
    v_cvt_pk_bf16_f32 v114, v116, v117
    v_cvt_pk_bf16_f32 v115, v118, v119
    s_add_u32 s57, s76, 47104
    buffer_store_dwordx4 v[112:115], v14, s[16:19], s57 offen offset:0 sc0 sc1
    v_cvt_pk_bf16_f32 v120, v120, v121
    v_cvt_pk_bf16_f32 v121, v122, v123
    v_cvt_pk_bf16_f32 v122, v124, v125
    v_cvt_pk_bf16_f32 v123, v126, v127
    buffer_store_dwordx4 v[120:123], v14, s[16:19], s57 offen offset:1024 sc0 sc1
    s_waitcnt vmcnt(7)
    s_mov_b32 s62, 0
L_pw6:
    v_cmp_le_u32 vcc, 4, v15
    s_nop 0
    s_cmp_eq_u64 vcc, -1
    s_cbranch_scc1 L_pok6
    s_add_u32 s62, s62, 1
    s_cmp_ge_u32 s62, 100000
    s_cbranch_scc1 L_pok6
    s_sleep 1
    buffer_load_dword v15, v12, s[16:19], s75 offen sc0 sc1
    s_waitcnt vmcnt(0)
    s_branch L_pw6
L_pok6:
    s_waitcnt lgkmcnt(9)
    v_mfma_f32_32x32x16_bf16 v[192:207], v[128:131], v[24:27], 0
    ds_read_b64_tr_b16 v[48:49], v20 offset:30720
    ds_read_b64_tr_b16 v[50:51], v20 offset:31232
    ds_read_b64_tr_b16 v[52:53], v21 offset:30720
    s_add_u32 s58, s67, 4096
    buffer_load_dwordx4 a[128:131], v14, s[16:19], s58 offen sc1
    s_lshl_b32 s3, s36, 13
    s_add_u32 s3, s3, 0
    v_add_u32 v2, s3, v14
    v_mfma_f32_32x32x16_bf16 v[208:223], v[128:131], v[28:31], 0
    ds_read_b64_tr_b16 v[54:55], v21 offset:31232
    s_add_u32 s58, s67, 2363392
    buffer_load_dwordx4 a[132:135], v14, s[16:19], s58 offen sc1
    s_lshl_b32 s3, s36, 11
    s_add_u32 s3, s3, 0
    v_add_u32 v3, s3, v14
    s_waitcnt lgkmcnt(8)
    v_mfma_f32_32x32x16_bf16 v[192:207], v[132:135], v[32:35], v[192:207]
    ds_read_b64_tr_b16 v[24:25], v18 offset:0
    ds_read_b64_tr_b16 v[26:27], v18 offset:512
    ds_read_b64_tr_b16 v[28:29], v19 offset:0
    s_add_u32 s58, s67, 4722688
    buffer_load_dwordx4 a[136:139], v14, s[16:19], s58 offen sc1
    v_and_b32 v4, 31, v0
    s_mov_b32 s3, 73728
    v_mul_lo_u32 v4, v4, s3
    v_mfma_f32_32x32x16_bf16 v[208:223], v[132:135], v[36:39], v[208:223]
    ds_read_b64_tr_b16 v[30:31], v19 offset:512
    ds_read_b128 v[128:131], v17 offset:1024
    s_add_u32 s58, s67, 7081984
    buffer_load_dwordx4 a[140:143], v14, s[16:19], s58 offen sc1
    v_lshrrev_b32 v5, 5, v0
    v_lshl_add_u32 v4, v5, 4, v4
    v_sub_f32 v9, 1.0, v16
    s_waitcnt lgkmcnt(9)
    v_mfma_f32_32x32x16_bf16 v[192:207], a[0:3], v[40:43], v[192:207]
    ds_read_b64_tr_b16 v[32:33], v18 offset:2048
    ds_read_b64_tr_b16 v[34:35], v18 offset:2560
    ds_read_b64_tr_b16 v[36:37], v19 offset:2048
    s_add_u32 s58, s67, 9441280
    buffer_load_dwordx4 a[144:147], v14, s[16:19], s58 offen sc1
    v_cvt_pk_bf16_f32 v9, v9, v9
    v_lshlrev_b32 v9, 16, v9
    v_mul_f32 v16, 0x35638e39, v16
    v_mfma_f32_32x32x16_bf16 v[208:223], a[0:3], v[44:47], v[208:223]
    ds_read_b64_tr_b16 v[38:39], v19 offset:2560
    ds_read_b128 v[132:135], v17 offset:11264
    s_add_u32 s58, s67, 11800576
    buffer_load_dwordx4 a[148:151], v14, s[16:19], s58 offen sc1
    s_waitcnt lgkmcnt(10)
    v_mfma_f32_32x32x16_bf16 v[192:207], a[36:39], v[48:51], v[192:207]
    ds_read_b64_tr_b16 v[40:41], v18 offset:4096
    ds_read_b64_tr_b16 v[42:43], v18 offset:4608
    ds_read_b64_tr_b16 v[44:45], v19 offset:4096
    s_add_u32 s58, s67, 14159872
    buffer_load_dwordx4 a[152:155], v14, s[16:19], s58 offen sc1
    v_mfma_f32_32x32x16_bf16 v[208:223], a[36:39], v[52:55], v[208:223]
    ds_read_b64_tr_b16 v[46:47], v19 offset:4608
    s_add_u32 s58, s67, 16519168
    buffer_load_dwordx4 a[156:159], v14, s[16:19], s58 offen sc1
    s_waitcnt lgkmcnt(9)
    v_mfma_f32_32x32x16_bf16 v[192:207], v[128:131], v[24:27], v[192:207]
    ds_read_b64_tr_b16 v[48:49], v18 offset:6144
    ds_read_b64_tr_b16 v[50:51], v18 offset:6656
    ds_read_b64_tr_b16 v[52:53], v19 offset:6144
    v_mfma_f32_32x32x16_bf16 v[208:223], v[128:131], v[28:31], v[208:223]
    ds_read_b64_tr_b16 v[54:55], v19 offset:6656
    s_waitcnt lgkmcnt(8)
    v_mfma_f32_32x32x16_bf16 v[192:207], v[132:135], v[32:35], v[192:207]
    ds_read_b64_tr_b16 v[24:25], v18 offset:8192
    ds_read_b64_tr_b16 v[26:27], v18 offset:8704
    ds_read_b64_tr_b16 v[28:29], v19 offset:8192
    v_mfma_f32_32x32x16_bf16 v[208:223], v[132:135], v[36:39], v[208:223]
    ds_read_b64_tr_b16 v[30:31], v19 offset:8704
    ds_read_b128 v[128:131], v17 offset:2048
    s_waitcnt lgkmcnt(9)
    v_mfma_f32_32x32x16_bf16 v[192:207], a[4:7], v[40:43], v[192:207]
    ds_read_b64_tr_b16 v[32:33], v18 offset:10240
    ds_read_b64_tr_b16 v[34:35], v18 offset:10752
    ds_read_b64_tr_b16 v[36:37], v19 offset:10240
    v_mfma_f32_32x32x16_bf16 v[208:223], a[4:7], v[44:47], v[208:223]
    ds_read_b64_tr_b16 v[38:39], v19 offset:10752
    ds_read_b128 v[132:135], v17 offset:12288
    s_waitcnt lgkmcnt(10)
    v_mfma_f32_32x32x16_bf16 v[192:207], a[40:43], v[48:51], v[192:207]
    ds_read_b64_tr_b16 v[40:41], v18 offset:12288
    ds_read_b64_tr_b16 v[42:43], v18 offset:12800
    ds_read_b64_tr_b16 v[44:45], v19 offset:12288
    v_mfma_f32_32x32x16_bf16 v[208:223], a[40:43], v[52:55], v[208:223]
    ds_read_b64_tr_b16 v[46:47], v19 offset:12800
    s_waitcnt lgkmcnt(9)
    v_mfma_f32_32x32x16_bf16 v[192:207], v[128:131], v[24:27], v[192:207]
    ds_read_b64_tr_b16 v[48:49], v18 offset:14336
    ds_read_b64_tr_b16 v[50:51], v18 offset:14848
    ds_read_b64_tr_b16 v[52:53], v19 offset:14336
    v_mfma_f32_32x32x16_bf16 v[208:223], v[128:131], v[28:31], v[208:223]
    ds_read_b64_tr_b16 v[54:55], v19 offset:14848
    s_waitcnt lgkmcnt(8)
    v_mfma_f32_32x32x16_bf16 v[192:207], v[132:135], v[32:35], v[192:207]
    ds_read_b64_tr_b16 v[24:25], v18 offset:16384
    ds_read_b64_tr_b16 v[26:27], v18 offset:16896
    ds_read_b64_tr_b16 v[28:29], v19 offset:16384
    v_mfma_f32_32x32x16_bf16 v[208:223], v[132:135], v[36:39], v[208:223]
    ds_read_b64_tr_b16 v[30:31], v19 offset:16896
    ds_read_b128 v[128:131], v17 offset:3072
    s_waitcnt lgkmcnt(9)
    v_mfma_f32_32x32x16_bf16 v[192:207], a[8:11], v[40:43], v[192:207]
    ds_read_b64_tr_b16 v[32:33], v18 offset:18432
    ds_read_b64_tr_b16 v[34:35], v18 offset:18944
    ds_read_b64_tr_b16 v[36:37], v19 offset:18432
    v_mfma_f32_32x32x16_bf16 v[208:223], a[8:11], v[44:47], v[208:223]
    ds_read_b64_tr_b16 v[38:39], v19 offset:18944
    ds_read_b128 v[132:135], v17 offset:13312
    s_waitcnt lgkmcnt(10)
    v_mfma_f32_32x32x16_bf16 v[192:207], a[44:47], v[48:51], v[192:207]
    ds_read_b64_tr_b16 v[40:41], v18 offset:20480
    ds_read_b64_tr_b16 v[42:43], v18 offset:20992
    ds_read_b64_tr_b16 v[44:45], v19 offset:20480
    v_mfma_f32_32x32x16_bf16 v[208:223], a[44:47], v[52:55], v[208:223]
    ds_read_b64_tr_b16 v[46:47], v19 offset:20992
    s_waitcnt lgkmcnt(9)
    v_mfma_f32_32x32x16_bf16 v[192:207], v[128:131], v[24:27], v[192:207]
    ds_read_b64_tr_b16 v[48:49], v18 offset:22528
    ds_read_b64_tr_b16 v[50:51], v18 offset:23040
    ds_read_b64_tr_b16 v[52:53], v19 offset:22528
    v_mfma_f32_32x32x16_bf16 v[208:223], v[128:131], v[28:31], v[208:223]
    ds_read_b64_tr_b16 v[54:55], v19 offset:23040
    s_waitcnt lgkmcnt(8)
    v_mfma_f32_32x32x16_bf16 v[192:207], v[132:135], v[32:35], v[192:207]
    ds_read_b64_tr_b16 v[24:25], v18 offset:24576
    ds_read_b64_tr_b16 v[26:27], v18 offset:25088
    ds_read_b64_tr_b16 v[28:29], v19 offset:24576
    v_mfma_f32_32x32x16_bf16 v[208:223], v[132:135], v[36:39], v[208:223]
    ds_read_b64_tr_b16 v[30:31], v19 offset:25088
    ds_read_b128 v[128:131], v17 offset:4096
    s_waitcnt lgkmcnt(9)
    s_waitcnt vmcnt(8)
    s_barrier
    v_mov_b32 v22, 5
    v_min_u32 v23, 1, v0
    v_lshlrev_b32 v23, 30, v23
    buffer_store_dword v22, v23, s[16:19], s84 offen sc0 sc1
    v_mfma_f32_32x32x16_bf16 v[192:207], a[12:15], v[40:43], v[192:207]
    ds_read_b64_tr_b16 v[32:33], v18 offset:26624
    ds_read_b64_tr_b16 v[34:35], v18 offset:27136
    ds_read_b64_tr_b16 v[36:37], v19 offset:26624
    v_mfma_f32_32x32x16_bf16 v[208:223], a[12:15], v[44:47], v[208:223]
    ds_read_b64_tr_b16 v[38:39], v19 offset:27136
    ds_read_b128 v[132:135], v17 offset:14336
    s_waitcnt lgkmcnt(10)
    v_mfma_f32_32x32x16_bf16 v[192:207], a[48:51], v[48:51], v[192:207]
    ds_read_b64_tr_b16 v[40:41], v18 offset:28672
    ds_read_b64_tr_b16 v[42:43], v18 offset:29184
    ds_read_b64_tr_b16 v[44:45], v19 offset:28672
    v_mfma_f32_32x32x16_bf16 v[208:223], a[48:51], v[52:55], v[208:223]
    ds_read_b64_tr_b16 v[46:47], v19 offset:29184
    s_waitcnt lgkmcnt(9)
    v_mfma_f32_32x32x16_bf16 v[192:207], v[128:131], v[24:27], v[192:207]
    ds_read_b64_tr_b16 v[48:49], v18 offset:30720
    ds_read_b64_tr_b16 v[50:51], v18 offset:31232
    ds_read_b64_tr_b16 v[52:53], v19 offset:30720
    v_mfma_f32_32x32x16_bf16 v[208:223], v[128:131], v[28:31], v[208:223]
    ds_read_b64_tr_b16 v[54:55], v19 offset:31232
    s_waitcnt lgkmcnt(8)
    v_mfma_f32_32x32x16_bf16 v[192:207], v[132:135], v[32:35], v[192:207]
    ds_read_b64_tr_b16 v[24:25], v18 offset:32768
    ds_read_b64_tr_b16 v[26:27], v18 offset:33280
    ds_read_b64_tr_b16 v[28:29], v19 offset:32768
    v_mfma_f32_32x32x16_bf16 v[208:223], v[132:135], v[36:39], v[208:223]
    ds_read_b64_tr_b16 v[30:31], v19 offset:33280
    ds_read_b128 v[128:131], v17 offset:5120
    s_waitcnt lgkmcnt(9)
    s_mov_b32 s62, 0
L_pw7:
    v_cmp_le_u32 vcc, 1, v10
    s_nop 0
    s_cmp_eq_u64 vcc, -1
    s_cbranch_scc1 L_pok7
    s_add_u32 s62, s62, 1
    s_cmp_ge_u32 s62, 100000
    s_cbranch_scc1 L_pok7
    s_sleep 1
    buffer_load_dword v10, v1, s[16:19], s75 offen sc0 sc1
    s_waitcnt vmcnt(0)
    s_branch L_pw7
L_pok7:
    v_mfma_f32_32x32x16_bf16 v[192:207], a[16:19], v[40:43], v[192:207]
    ds_read_b64_tr_b16 v[32:33], v18 offset:34816
    ds_read_b64_tr_b16 v[34:35], v18 offset:35328
    ds_read_b64_tr_b16 v[36:37], v19 offset:34816
    s_add_u32 m0, s55, 152320
    s_add_u32 s58, s64, 2097152
    buffer_load_dwordx4 v6, s[16:19], s58 offen sc1 lds
    v_mfma_f32_32x32x16_bf16 v[208:223], a[16:19], v[44:47], v[208:223]
    ds_read_b64_tr_b16 v[38:39], v19 offset:35328
    ds_read_b128 v[132:135], v17 offset:15360
    s_add_u32 m0, s55, 156416
    s_add_u32 s58, s64, 2228224
    buffer_load_dwordx4 v6, s[16:19], s58 offen sc1 lds
    v_mfma_f32_32x32x16_bf16 v[224:239], v[56:59], a[72:75], 0
    s_waitcnt lgkmcnt(10)
    v_mfma_f32_32x32x16_bf16 v[192:207], a[52:55], v[48:51], v[192:207]
    ds_read_b64_tr_b16 v[40:41], v18 offset:36864
    ds_read_b64_tr_b16 v[42:43], v18 offset:37376
    ds_read_b64_tr_b16 v[44:45], v19 offset:36864
    s_add_u32 m0, s55, 62208
    s_add_u32 s58, s64, 2359296
    s_cmp_eq_u32 s36, 0
    s_cselect_b32 s58, s58, 0x80000000
    buffer_load_dwordx4 v7, s[16:19], s58 offen sc1 lds
    v_mfma_f32_32x32x16_bf16 v[208:223], a[52:55], v[52:55], v[208:223]
    ds_read_b64_tr_b16 v[46:47], v19 offset:37376
    v_mfma_f32_32x32x16_bf16 v[224:239], v[56:59], a[76:79], v[224:239]
    s_waitcnt lgkmcnt(9)
    v_mfma_f32_32x32x16_bf16 v[192:207], v[128:131], v[24:27], v[192:207]
    ds_read_b64_tr_b16 v[48:49], v18 offset:38912
    ds_read_b64_tr_b16 v[50:51], v18 offset:39424
    ds_read_b64_tr_b16 v[52:53], v19 offset:38912
    v_mfma_f32_32x32x16_bf16 v[208:223], v[128:131], v[28:31], v[208:223]
    ds_read_b64_tr_b16 v[54:55], v19 offset:39424
    v_mfma_f32_32x32x16_bf16 v[224:239], v[56:59], a[80:83], v[224:239]
    s_waitcnt lgkmcnt(8)
    v_mfma_f32_32x32x16_bf16 v[192:207], v[132:135], v[32:35], v[192:207]
    ds_read_b64_tr_b16 v[24:25], v18 offset:40960
    ds_read_b64_tr_b16 v[26:27], v18 offset:41472
    ds_read_b64_tr_b16 v[28:29], v19 offset:40960
    v_mfma_f32_32x32x16_bf16 v[208:223], v[132:135], v[36:39], v[208:223]
    ds_read_b64_tr_b16 v[30:31], v19 offset:41472
    ds_read_b128 v[128:131], v17 offset:6144
    v_mfma_f32_32x32x16_bf16 v[224:239], v[56:59], a[84:87], v[224:239]
    s_waitcnt lgkmcnt(9)
    v_mfma_f32_32x32x16_bf16 v[192:207], a[20:23], v[40:43], v[192:207]
    ds_read_b64_tr_b16 v[32:33], v18 offset:43008
    ds_read_b64_tr_b16 v[34:35], v18 offset:43520
    ds_read_b64_tr_b16 v[36:37], v19 offset:43008
    v_mfma_f32_32x32x16_bf16 v[208:223], a[20:23], v[44:47], v[208:223]
    ds_read_b64_tr_b16 v[38:39], v19 offset:43520
    ds_read_b128 v[132:135], v17 offset:16384
    v_mfma_f32_32x32x16_bf16 v[224:239], v[56:59], a[88:91], v[224:239]
    s_waitcnt lgkmcnt(10)
    v_mfma_f32_32x32x16_bf16 v[192:207], a[56:59], v[48:51], v[192:207]
    ds_read_b64_tr_b16 v[40:41], v18 offset:45056
    ds_read_b64_tr_b16 v[42:43], v18 offset:45568
    ds_read_b64_tr_b16 v[44:45], v19 offset:45056
    v_mfma_f32_32x32x16_bf16 v[208:223], a[56:59], v[52:55], v[208:223]
    ds_read_b64_tr_b16 v[46:47], v19 offset:45568
    v_mfma_f32_32x32x16_bf16 v[224:239], v[56:59], a[92:95], v[224:239]
    s_waitcnt lgkmcnt(9)
    v_mfma_f32_32x32x16_bf16 v[192:207], v[128:131], v[24:27], v[192:207]
    ds_read_b64_tr_b16 v[48:49], v18 offset:47104
    ds_read_b64_tr_b16 v[50:51], v18 offset:47616
    ds_read_b64_tr_b16 v[52:53], v19 offset:47104
    v_mfma_f32_32x32x16_bf16 v[208:223], v[128:131], v[28:31], v[208:223]
    ds_read_b64_tr_b16 v[54:55], v19 offset:47616
    v_mfma_f32_32x32x16_bf16 v[224:239], v[56:59], a[96:99], v[224:239]
    s_waitcnt lgkmcnt(8)
    v_mfma_f32_32x32x16_bf16 v[192:207], v[132:135], v[32:35], v[192:207]
    ds_read_b64_tr_b16 v[24:25], v18 offset:49152
    ds_read_b64_tr_b16 v[26:27], v18 offset:49664
    ds_read_b64_tr_b16 v[28:29], v19 offset:49152
    v_mfma_f32_32x32x16_bf16 v[208:223], v[132:135], v[36:39], v[208:223]
    ds_read_b64_tr_b16 v[30:31], v19 offset:49664
    ds_read_b128 v[128:131], v17 offset:7168
    v_mfma_f32_32x32x16_bf16 v[224:239], v[56:59], a[100:103], v[224:239]
    s_waitcnt lgkmcnt(9)
    buffer_load_dword v15, v12, s[16:19], s75 offen sc0 sc1
    v_mfma_f32_32x32x16_bf16 v[192:207], a[24:27], v[40:43], v[192:207]
    ds_read_b64_tr_b16 v[32:33], v18 offset:51200
    ds_read_b64_tr_b16 v[34:35], v18 offset:51712
    ds_read_b64_tr_b16 v[36:37], v19 offset:51200
    v_mfma_f32_32x32x16_bf16 v[208:223], a[24:27], v[44:47], v[208:223]
    ds_read_b64_tr_b16 v[38:39], v19 offset:51712
    ds_read_b128 v[132:135], v17 offset:17408
    s_waitcnt vmcnt(12)
    v_mfma_f32_32x32x16_bf16 v[224:239], v[60:63], a[128:131], v[224:239]
    s_waitcnt lgkmcnt(10)
    v_mfma_f32_32x32x16_bf16 v[192:207], a[60:63], v[48:51], v[192:207]
    ds_read_b64_tr_b16 v[40:41], v18 offset:53248
    ds_read_b64_tr_b16 v[42:43], v18 offset:53760
    ds_read_b64_tr_b16 v[44:45], v19 offset:53248
    v_mfma_f32_32x32x16_bf16 v[208:223], a[60:63], v[52:55], v[208:223]
    ds_read_b64_tr_b16 v[46:47], v19 offset:53760
    s_waitcnt vmcnt(11)
    v_mfma_f32_32x32x16_bf16 v[224:239], v[60:63], a[132:135], v[224:239]
    s_waitcnt lgkmcnt(9)
    v_mfma_f32_32x32x16_bf16 v[192:207], v[128:131], v[24:27], v[192:207]
    ds_read_b64_tr_b16 v[48:49], v18 offset:55296
    ds_read_b64_tr_b16 v[50:51], v18 offset:55808
    ds_read_b64_tr_b16 v[52:53], v19 offset:55296
    v_mfma_f32_32x32x16_bf16 v[208:223], v[128:131], v[28:31], v[208:223]
    ds_read_b64_tr_b16 v[54:55], v19 offset:55808
    s_waitcnt vmcnt(10)
    v_mfma_f32_32x32x16_bf16 v[224:239], v[60:63], a[136:139], v[224:239]
    s_waitcnt vmcnt(1) lgkmcnt(0)
    s_barrier
    v_mfma_f32_32x32x16_bf16 v[192:207], v[132:135], v[32:35], v[192:207]
    ds_read_b64_tr_b16 v[24:25], v18 offset:57344
    ds_read_b64_tr_b16 v[26:27], v18 offset:57856
    ds_read_b64_tr_b16 v[28:29], v19 offset:57344
    v_mfma_f32_32x32x16_bf16 v[208:223], v[132:135], v[36:39], v[208:223]
    ds_read_b64_tr_b16 v[30:31], v19 offset:57856
    ds_read_b128 v[128:131], v17 offset:8192
    v_mfma_f32_32x32x16_bf16 v[224:239], v[60:63], a[140:143], v[224:239]
    s_waitcnt lgkmcnt(9)
    v_mfma_f32_32x32x16_bf16 v[192:207], a[28:31], v[40:43], v[192:207]
    ds_read_b64_tr_b16 v[32:33], v18 offset:59392
    ds_read_b64_tr_b16 v[34:35], v18 offset:59904
    ds_read_b64_tr_b16 v[36:37], v19 offset:59392
    v_mfma_f32_32x32x16_bf16 v[208:223], a[28:31], v[44:47], v[208:223]
    ds_read_b64_tr_b16 v[38:39], v19 offset:59904
    ds_read_b128 v[132:135], v17 offset:18432
    v_mfma_f32_32x32x16_bf16 v[224:239], v[60:63], a[144:147], v[224:239]
    s_waitcnt lgkmcnt(10)
    v_mfma_f32_32x32x16_bf16 v[192:207], a[64:67], v[48:51], v[192:207]
    ds_read_b64_tr_b16 v[40:41], v18 offset:61440
    ds_read_b64_tr_b16 v[42:43], v18 offset:61952
    ds_read_b64_tr_b16 v[44:45], v19 offset:61440
    v_mfma_f32_32x32x16_bf16 v[208:223], a[64:67], v[52:55], v[208:223]
    ds_read_b64_tr_b16 v[46:47], v19 offset:61952
    s_waitcnt vmcnt(0)
    s_mov_b32 s62, 0
L_pw8:
    v_cmp_le_u32 vcc, 5, v15
    s_nop 0
    s_cmp_eq_u64 vcc, -1
    s_cbranch_scc1 L_pok8
    s_add_u32 s62, s62, 1
    s_cmp_ge_u32 s62, 100000
    s_cbranch_scc1 L_pok8
    buffer_load_dword v15, v12, s[16:19], s75 offen sc0 sc1
    s_waitcnt vmcnt(0)
    s_branch L_pw8
L_pok8:
    v_mfma_f32_32x32x16_bf16 v[224:239], v[60:63], a[148:151], v[224:239]
    s_waitcnt lgkmcnt(9)
    v_mfma_f32_32x32x16_bf16 v[192:207], v[128:131], v[24:27], v[192:207]
    ds_read_b64_tr_b16 v[48:49], v18 offset:63488
    ds_read_b64_tr_b16 v[50:51], v18 offset:64000
    ds_read_b64_tr_b16 v[52:53], v19 offset:63488
    s_add_u32 s58, s67, 8192
    buffer_load_dwordx4 a[160:163], v14, s[16:19], s58 offen sc1
    v_mfma_f32_32x32x16_bf16 v[208:223], v[128:131], v[28:31], v[208:223]
    ds_read_b64_tr_b16 v[54:55], v19 offset:64000
    s_add_u32 s58, s67, 2367488
    buffer_load_dwordx4 a[164:167], v14, s[16:19], s58 offen sc1
    v_mfma_f32_32x32x16_bf16 v[224:239], v[60:63], a[152:155], v[224:239]
    s_waitcnt lgkmcnt(8)
    v_mfma_f32_32x32x16_bf16 v[192:207], v[132:135], v[32:35], v[192:207]
    ds_read_b64_tr_b16 v[24:25], v20 offset:0
    ds_read_b64_tr_b16 v[26:27], v20 offset:512
    ds_read_b64_tr_b16 v[28:29], v21 offset:0
    s_add_u32 s58, s67, 4726784
    buffer_load_dwordx4 a[168:171], v14, s[16:19], s58 offen sc1
    v_mfma_f32_32x32x16_bf16 v[208:223], v[132:135], v[36:39], v[208:223]
    ds_read_b64_tr_b16 v[30:31], v21 offset:512
    ds_read_b128 v[128:131], v17 offset:9216
    s_add_u32 s58, s67, 7086080
    buffer_load_dwordx4 a[172:175], v14, s[16:19], s58 offen sc1
    v_mfma_f32_32x32x16_bf16 v[224:239], v[60:63], a[156:159], v[224:239]
    s_waitcnt lgkmcnt(9)
    v_mfma_f32_32x32x16_bf16 v[192:207], a[32:35], v[40:43], v[192:207]
    s_add_u32 s58, s67, 9445376
    buffer_load_dwordx4 a[176:179], v14, s[16:19], s58 offen sc1
    v_mfma_f32_32x32x16_bf16 v[208:223], a[32:35], v[44:47], v[208:223]
    s_add_u32 s58, s67, 11804672
    buffer_load_dwordx4 a[180:183], v14, s[16:19], s58 offen sc1
    s_waitcnt lgkmcnt(5)
    v_mfma_f32_32x32x16_bf16 v[192:207], a[68:71], v[48:51], v[192:207]
    s_add_u32 s58, s67, 14163968
    buffer_load_dwordx4 a[184:187], v14, s[16:19], s58 offen sc1
    v_mfma_f32_32x32x16_bf16 v[208:223], a[68:71], v[52:55], v[208:223]
    s_add_u32 s58, s67, 16523264
    buffer_load_dwordx4 a[188:191], v14, s[16:19], s58 offen sc1
    s_waitcnt lgkmcnt(0)
    v_mfma_f32_32x32x16_bf16 v[192:207], v[128:131], v[24:27], v[192:207]
    v_mfma_f32_32x32x16_bf16 v[208:223], v[128:131], v[28:31], v[208:223]
    s_barrier
    s_nop 9
    ds_write_b128 v2, v[192:195] offset:0
    ds_write_b128 v2, v[196:199] offset:1024
    ds_write_b128 v2, v[200:203] offset:2048
    ds_write_b128 v2, v[204:207] offset:3072
    ds_write_b128 v2, v[208:211] offset:4096
    ds_write_b128 v2, v[212:215] offset:5120
    ds_write_b128 v2, v[216:219] offset:6144
    ds_write_b128 v2, v[220:223] offset:7168
    s_waitcnt lgkmcnt(0)
    s_barrier
    ds_read_b128 v[24:27], v3 offset:0
    ds_read_b128 v[28:31], v3 offset:1024
    ds_read_b128 v[32:35], v3 offset:8192
    ds_read_b128 v[36:39], v3 offset:9216
    ds_read_b128 v[40:43], v3 offset:16384
    ds_read_b128 v[44:47], v3 offset:17408
    s_waitcnt lgkmcnt(0)
    v_mul_f32 v224, v9, v224
    v_mul_f32 v225, v9, v225
    v_mul_f32 v226, v9, v226
    v_mul_f32 v227, v9, v227
    v_mul_f32 v228, v9, v228
    v_mul_f32 v229, v9, v229
    v_mul_f32 v230, v9, v230
    v_mul_f32 v231, v9, v231
    v_fmac_f32 v224, v16, v24
    v_fmac_f32 v225, v16, v25
    v_fmac_f32 v226, v16, v26
    v_fmac_f32 v227, v16, v27
    v_fmac_f32 v228, v16, v28
    v_fmac_f32 v229, v16, v29
    v_fmac_f32 v230, v16, v30
    v_fmac_f32 v231, v16, v31
    v_cvt_pk_bf16_f32 v64, v224, v225
    v_cvt_pk_bf16_f32 v65, v226, v227
    v_cvt_pk_bf16_f32 v66, v228, v229
    v_cvt_pk_bf16_f32 v67, v230, v231
    s_nop 0
    v_permlane32_swap_b32 v64, v66
    v_permlane32_swap_b32 v65, v67
    buffer_store_dwordx4 v[64:67], v4, s[28:31], s69 offen offset:0
    v_mul_f32 v232, v9, v232
    v_mul_f32 v233, v9, v233
    v_mul_f32 v234, v9, v234
    v_mul_f32 v235, v9, v235
    v_mul_f32 v236, v9, v236
    v_mul_f32 v237, v9, v237
    v_mul_f32 v238, v9, v238
    v_mul_f32 v239, v9, v239
    v_fmac_f32 v232, v16, v32
    v_fmac_f32 v233, v16, v33
    v_fmac_f32 v234, v16, v34
    v_fmac_f32 v235, v16, v35
    v_fmac_f32 v236, v16, v36
    v_fmac_f32 v237, v16, v37
    v_fmac_f32 v238, v16, v38
    v_fmac_f32 v239, v16, v39
    v_cvt_pk_bf16_f32 v68, v232, v233
    v_cvt_pk_bf16_f32 v69, v234, v235
    v_cvt_pk_bf16_f32 v70, v236, v237
    v_cvt_pk_bf16_f32 v71, v238, v239
    s_nop 0
    v_permlane32_swap_b32 v68, v70
    v_permlane32_swap_b32 v69, v71
    buffer_store_dwordx4 v[68:71], v4, s[28:31], s69 offen offset:128
    s_waitcnt vmcnt(9)
    v_mfma_f32_32x32x16_bf16 v[240:255], v[56:59], a[160:163], 0
    s_waitcnt vmcnt(8)
    v_mfma_f32_32x32x16_bf16 v[240:255], v[56:59], a[164:167], v[240:255]
    s_waitcnt vmcnt(7)
    v_mfma_f32_32x32x16_bf16 v[240:255], v[56:59], a[168:171], v[240:255]
    s_waitcnt vmcnt(6)
    v_mfma_f32_32x32x16_bf16 v[240:255], v[56:59], a[172:175], v[240:255]
    s_waitcnt vmcnt(5)
    v_mfma_f32_32x32x16_bf16 v[240:255], v[56:59], a[176:179], v[240:255]
    s_waitcnt vmcnt(4)
    v_mfma_f32_32x32x16_bf16 v[240:255], v[56:59], a[180:183], v[240:255]
    s_waitcnt vmcnt(3)
    v_mfma_f32_32x32x16_bf16 v[240:255], v[56:59], a[184:187], v[240:255]
    s_waitcnt vmcnt(2)
    v_mfma_f32_32x32x16_bf16 v[240:255], v[56:59], a[188:191], v[240:255]
    s_nop 11
    v_mul_f32 v240, v9, v240
    v_mul_f32 v241, v9, v241
    v_mul_f32 v242, v9, v242
    v_mul_f32 v243, v9, v243
    v_mul_f32 v244, v9, v244
    v_mul_f32 v245, v9, v245
    v_mul_f32 v246, v9, v246
    v_mul_f32 v247, v9, v247
    v_fmac_f32 v240, v16, v40
    v_fmac_f32 v241, v16, v41
    v_fmac_f32 v242, v16, v42
    v_fmac_f32 v243, v16, v43
    v_fmac_f32 v244, v16, v44
    v_fmac_f32 v245, v16, v45
    v_fmac_f32 v246, v16, v46
    v_fmac_f32 v247, v16, v47
    v_cvt_pk_bf16_f32 v72, v240, v241
    v_cvt_pk_bf16_f32 v73, v242, v243
    v_cvt_pk_bf16_f32 v74, v244, v245
    v_cvt_pk_bf16_f32 v75, v246, v247
    s_nop 0
    v_permlane32_swap_b32 v72, v74
    v_permlane32_swap_b32 v73, v75
    buffer_store_dwordx4 v[72:75], v4, s[28:31], s69 offen offset:256
    s_branch L_fin
L_r2_side:
    s_lshl_b32 s43, s38, 3
    s_add_u32 s43, s43, s39
    s_lshr_b32 s44, s43, 3
    s_lshr_b32 s5, s43, 1
    s_lshl_b32 s46, s5, 15
    s_and_b32 s6, s43, 1
    s_lshl_b32 s3, s6, 7
    s_add_u32 s46, s46, s3
    s_lshl_b32 s3, s36, 13
    s_add_u32 s46, s46, s3
    s_add_u32 s46, s46, 21495808
    s_lshl_b32 s64, s43, 15
    s_add_u32 s64, s64, s3
    s_add_u32 s64, s64, 23855104
    s_add_u32 s73, s3, 95488
    s_add_u32 s3, s43, s36
    s_cmp_eq_u32 s3, 0
    s_cselect_b32 s70, 0, -1
    s_mul_i32 s71, s36, 4160
    s_add_u32 s71, s71, 62208
    s_lshl_b32 s66, s43, 2
    s_add_u32 s66, s66, s36
    s_lshl_b32 s66, s66, 13
    s_add_u32 s66, s66, 18874368
    v_and_b32 v2, 31, v0
    v_cvt_f32_u32 v3, v2
    v_lshrrev_b32 v2, 5, v0
    v_cvt_f32_u32 v5, v2
    v_lshlrev_b32 v4, 4, v0
    v_add_u32 v2, 128256, v4
    s_waitcnt vmcnt(29) lgkmcnt(0)
    s_barrier
    v_mfma_f32_32x32x16_bf16 v[64:79], v[44:47], a[8:11], v[64:79]
    ds_read_b64_tr_b16 v[24:25], v1 offset:10368
    ds_read_b64_tr_b16 v[26:27], v1 offset:11008
    v_mul_f32 v9, 0x3d000000, v3
    v_mul_f32 v8, 0x40800000, v5
    v_mul_f32 v8, v8, v9
    v_fmamk_f32 v18, v9, 0x0, v8
    v_mfma_f32_32x32x16_bf16 v[80:95], v[44:47], a[12:15], v[80:95]
    ds_read_b64_tr_b16 v[28:29], v1 offset:10400
    ds_read_b64_tr_b16 v[30:31], v1 offset:11040
    v_fmamk_f32 v19, v9, 0x3f800000, v8
    v_cos_f32 v20, v18
    v_mfma_f32_32x32x16_bf16 v[96:111], v[48:51], a[8:11], v[96:111]
    ds_read_b64_tr_b16 v[32:33], v1 offset:10432
    ds_read_b64_tr_b16 v[34:35], v1 offset:11072
    v_cos_f32 v21, v19
    v_sin_f32 v18, v18
    v_mfma_f32_32x32x16_bf16 v[112:127], v[48:51], a[12:15], v[112:127]
    ds_read_b64_tr_b16 v[36:37], v1 offset:10464
    ds_read_b64_tr_b16 v[38:39], v1 offset:11104
    v_sin_f32 v19, v19
    v_cvt_pk_bf16_f32 v10, v20, v21
    v_cvt_pk_bf16_f32 v14, v18, v19
    v_mfma_f32_32x32x16_bf16 v[128:143], v[52:55], a[8:11], v[128:143]
    ds_read_b64_tr_b16 v[40:41], v1 offset:10496
    ds_read_b64_tr_b16 v[42:43], v1 offset:11136
    v_fmamk_f32 v18, v9, 0x40000000, v8
    v_fmamk_f32 v19, v9, 0x40400000, v8
    v_cos_f32 v20, v18
    v_mfma_f32_32x32x16_bf16 v[144:159], v[52:55], a[12:15], v[144:159]
    v_cos_f32 v21, v19
    v_sin_f32 v18, v18
    v_sin_f32 v19, v19
    v_mfma_f32_32x32x16_bf16 v[160:175], v[56:59], a[8:11], v[160:175]
    s_add_u32 s74, s74, 294912
    s_cmp_ge_u32 s74, 5308416
    s_cselect_b32 s74, 0, s74
    s_add_u32 m0, s56, 0
    s_nop 0
    buffer_load_dwordx4 v6, s[12:15], s74 offen lds
    v_cvt_pk_bf16_f32 v11, v20, v21
    v_mfma_f32_32x32x16_bf16 v[176:191], v[56:59], a[12:15], v[176:191]
    s_add_u32 m0, s56, 0
    s_nop 0
    buffer_load_dword v7, s[12:15], s74 offen offset:1024 lds
    v_mfma_f32_32x32x16_bf16 v[192:207], v[60:63], a[8:11], v[192:207]
    s_add_u32 m0, s56, 5248
    s_nop 0
    buffer_load_dwordx4 v6, s[20:23], s74 offen lds
    v_mfma_f32_32x32x16_bf16 v[208:223], v[60:63], a[12:15], v[208:223]
    s_add_u32 m0, s56, 5248
    s_nop 0
    buffer_load_dword v7, s[20:23], s74 offen offset:1024 lds
    s_waitcnt lgkmcnt(0)
    v_mfma_f32_32x32x16_bf16 v[64:79], v[24:27], a[16:19], v[64:79]
    ds_read_b64_tr_b16 v[44:45], v1 offset:12928
    ds_read_b64_tr_b16 v[46:47], v1 offset:13568
    v_cvt_pk_bf16_f32 v15, v18, v19
    v_fmamk_f32 v18, v9, 0x41000000, v8
    v_mfma_f32_32x32x16_bf16 v[80:95], v[24:27], a[20:23], v[80:95]
    ds_read_b64_tr_b16 v[48:49], v1 offset:12960
    ds_read_b64_tr_b16 v[50:51], v1 offset:13600
    v_fmamk_f32 v19, v9, 0x41100000, v8
    v_mfma_f32_32x32x16_bf16 v[96:111], v[28:31], a[16:19], v[96:111]
    ds_read_b64_tr_b16 v[52:53], v1 offset:12992
    ds_read_b64_tr_b16 v[54:55], v1 offset:13632
    v_cos_f32 v20, v18
    v_mfma_f32_32x32x16_bf16 v[112:127], v[28:31], a[20:23], v[112:127]
    ds_read_b64_tr_b16 v[56:57], v1 offset:13024
    ds_read_b64_tr_b16 v[58:59], v1 offset:13664
    v_cos_f32 v21, v19
    v_mfma_f32_32x32x16_bf16 v[128:143], v[32:35], a[16:19], v[128:143]
    ds_read_b64_tr_b16 v[60:61], v1 offset:13056
    ds_read_b64_tr_b16 v[62:63], v1 offset:13696
    v_sin_f32 v18, v18
    v_mfma_f32_32x32x16_bf16 v[144:159], v[32:35], a[20:23], v[144:159]
    v_sin_f32 v19, v19
    v_cvt_pk_bf16_f32 v12, v20, v21
    v_cvt_pk_bf16_f32 v16, v18, v19
    v_mfma_f32_32x32x16_bf16 v[160:175], v[36:39], a[16:19], v[160:175]
    v_fmamk_f32 v18, v9, 0x41200000, v8
    v_fmamk_f32 v19, v9, 0x41300000, v8
    v_cos_f32 v20, v18
    v_mfma_f32_32x32x16_bf16 v[176:191], v[36:39], a[20:23], v[176:191]
    v_cos_f32 v21, v19
    v_sin_f32 v18, v18
    v_mfma_f32_32x32x16_bf16 v[192:207], v[40:43], a[16:19], v[192:207]
    v_sin_f32 v19, v19
    v_cvt_pk_bf16_f32 v13, v20, v21
    v_cvt_pk_bf16_f32 v17, v18, v19
    v_mfma_f32_32x32x16_bf16 v[208:223], v[40:43], a[20:23], v[208:223]
    ds_write_b128 v2, v[10:13] offset:0
    s_waitcnt vmcnt(29) lgkmcnt(0)
    s_barrier
    v_mfma_f32_32x32x16_bf16 v[64:79], v[44:47], a[24:27], v[64:79]
    ds_read_b64_tr_b16 v[24:25], v1 offset:20736
    ds_read_b64_tr_b16 v[26:27], v1 offset:21376
    ds_write_b128 v2, v[14:17] offset:2048
    v_xor_b32 v18, 0x80008000, v14
    v_mfma_f32_32x32x16_bf16 v[80:95], v[44:47], a[28:31], v[80:95]
    ds_read_b64_tr_b16 v[28:29], v1 offset:20768
    ds_read_b64_tr_b16 v[30:31], v1 offset:21408
    v_xor_b32 v19, 0x80008000, v15
    v_xor_b32 v20, 0x80008000, v16
    v_xor_b32 v21, 0x80008000, v17
    v_mfma_f32_32x32x16_bf16 v[96:111], v[48:51], a[24:27], v[96:111]
    ds_read_b64_tr_b16 v[32:33], v1 offset:20800
    ds_read_b64_tr_b16 v[34:35], v1 offset:21440
    ds_write_b128 v2, v[18:21] offset:4096
    v_fmamk_f32 v18, v9, 0x41800000, v8
    v_mfma_f32_32x32x16_bf16 v[112:127], v[48:51], a[28:31], v[112:127]
    ds_read_b64_tr_b16 v[36:37], v1 offset:20832
    ds_read_b64_tr_b16 v[38:39], v1 offset:21472
    v_fmamk_f32 v19, v9, 0x41880000, v8
    v_cos_f32 v20, v18
    v_mfma_f32_32x32x16_bf16 v[128:143], v[52:55], a[24:27], v[128:143]
    ds_read_b64_tr_b16 v[40:41], v1 offset:20864
    ds_read_b64_tr_b16 v[42:43], v1 offset:21504
    v_cos_f32 v21, v19
    v_sin_f32 v18, v18
    v_mfma_f32_32x32x16_bf16 v[144:159], v[52:55], a[28:31], v[144:159]
    v_sin_f32 v19, v19
    v_cvt_pk_bf16_f32 v10, v20, v21
    v_cvt_pk_bf16_f32 v14, v18, v19
    v_fmamk_f32 v18, v9, 0x41900000, v8
    v_fmamk_f32 v19, v9, 0x41980000, v8
    v_mfma_f32_32x32x16_bf16 v[160:175], v[56:59], a[24:27], v[160:175]
    s_add_u32 s74, s74, 294912
    s_cmp_ge_u32 s74, 5308416
    s_cselect_b32 s74, 0, s74
    s_add_u32 m0, s56, 10368
    s_nop 0
    buffer_load_dwordx4 v6, s[12:15], s74 offen lds
    v_mfma_f32_32x32x16_bf16 v[176:191], v[56:59], a[28:31], v[176:191]
    s_add_u32 m0, s56, 10368
    s_nop 0
    buffer_load_dword v7, s[12:15], s74 offen offset:1024 lds
    v_cos_f32 v20, v18
    v_mfma_f32_32x32x16_bf16 v[192:207], v[60:63], a[24:27], v[192:207]
    s_add_u32 m0, s56, 15616
    s_nop 0
    buffer_load_dwordx4 v6, s[20:23], s74 offen lds
    v_cos_f32 v21, v19
    v_mfma_f32_32x32x16_bf16 v[208:223], v[60:63], a[28:31], v[208:223]
    s_add_u32 m0, s56, 15616
    s_nop 0
    buffer_load_dword v7, s[20:23], s74 offen offset:1024 lds
    s_waitcnt lgkmcnt(0)
    v_mfma_f32_32x32x16_bf16 v[64:79], v[24:27], a[32:35], v[64:79]
    ds_read_b64_tr_b16 v[44:45], v1 offset:23296
    ds_read_b64_tr_b16 v[46:47], v1 offset:23936
    v_sin_f32 v18, v18
    v_mfma_f32_32x32x16_bf16 v[80:95], v[24:27], a[36:39], v[80:95]
    ds_read_b64_tr_b16 v[48:49], v1 offset:23328
    ds_read_b64_tr_b16 v[50:51], v1 offset:23968
    v_sin_f32 v19, v19
    v_mfma_f32_32x32x16_bf16 v[96:111], v[28:31], a[32:35], v[96:111]
    ds_read_b64_tr_b16 v[52:53], v1 offset:23360
    ds_read_b64_tr_b16 v[54:55], v1 offset:24000
    v_cvt_pk_bf16_f32 v11, v20, v21
    v_cvt_pk_bf16_f32 v15, v18, v19
    v_mfma_f32_32x32x16_bf16 v[112:127], v[28:31], a[36:39], v[112:127]
    ds_read_b64_tr_b16 v[56:57], v1 offset:23392
    ds_read_b64_tr_b16 v[58:59], v1 offset:24032
    v_fmamk_f32 v18, v9, 0x41c00000, v8
    v_fmamk_f32 v19, v9, 0x41c80000, v8
    v_mfma_f32_32x32x16_bf16 v[128:143], v[32:35], a[32:35], v[128:143]
    ds_read_b64_tr_b16 v[60:61], v1 offset:23424
    ds_read_b64_tr_b16 v[62:63], v1 offset:24064
    v_cos_f32 v20, v18
    v_mfma_f32_32x32x16_bf16 v[144:159], v[32:35], a[36:39], v[144:159]
    v_cos_f32 v21, v19
    v_sin_f32 v18, v18
    v_mfma_f32_32x32x16_bf16 v[160:175], v[36:39], a[32:35], v[160:175]
    v_sin_f32 v19, v19
    v_cvt_pk_bf16_f32 v12, v20, v21
    v_cvt_pk_bf16_f32 v16, v18, v19
    v_mfma_f32_32x32x16_bf16 v[176:191], v[36:39], a[36:39], v[176:191]
    v_fmamk_f32 v18, v9, 0x41d00000, v8
    v_fmamk_f32 v19, v9, 0x41d80000, v8
    v_cos_f32 v20, v18
    v_mfma_f32_32x32x16_bf16 v[192:207], v[40:43], a[32:35], v[192:207]
    v_cos_f32 v21, v19
    v_sin_f32 v18, v18
    v_mfma_f32_32x32x16_bf16 v[208:223], v[40:43], a[36:39], v[208:223]
    v_sin_f32 v19, v19
    s_waitcnt vmcnt(29) lgkmcnt(0)
    s_barrier
    v_mfma_f32_32x32x16_bf16 v[64:79], v[44:47], a[40:43], v[64:79]
    ds_read_b64_tr_b16 v[24:25], v1 offset:31104
    ds_read_b64_tr_b16 v[26:27], v1 offset:31744
    v_cvt_pk_bf16_f32 v13, v20, v21
    v_cvt_pk_bf16_f32 v17, v18, v19
    v_mfma_f32_32x32x16_bf16 v[80:95], v[44:47], a[44:47], v[80:95]
    ds_read_b64_tr_b16 v[28:29], v1 offset:31136
    ds_read_b64_tr_b16 v[30:31], v1 offset:31776
    ds_write_b128 v2, v[10:13] offset:1024
    v_mfma_f32_32x32x16_bf16 v[96:111], v[48:51], a[40:43], v[96:111]
    ds_read_b64_tr_b16 v[32:33], v1 offset:31168
    ds_read_b64_tr_b16 v[34:35], v1 offset:31808
    ds_write_b128 v2, v[14:17] offset:3072
    v_xor_b32 v18, 0x80008000, v14
    v_mfma_f32_32x32x16_bf16 v[112:127], v[48:51], a[44:47], v[112:127]
    ds_read_b64_tr_b16 v[36:37], v1 offset:31200
    ds_read_b64_tr_b16 v[38:39], v1 offset:31840
    v_xor_b32 v19, 0x80008000, v15
    v_xor_b32 v20, 0x80008000, v16
    v_xor_b32 v21, 0x80008000, v17
    v_mfma_f32_32x32x16_bf16 v[128:143], v[52:55], a[40:43], v[128:143]
    ds_read_b64_tr_b16 v[40:41], v1 offset:31232
    ds_read_b64_tr_b16 v[42:43], v1 offset:31872
    ds_write_b128 v2, v[18:21] offset:5120
    v_mul_f32 v9, 0x3c800000, v3
    v_mfma_f32_32x32x16_bf16 v[144:159], v[52:55], a[44:47], v[144:159]
    v_mul_f32 v8, 0x41000000, v5
    v_add_f32 v8, 1.0, v8
    v_mul_f32 v8, v8, v9
    v_fmamk_f32 v18, v9, 0x0, v8
    v_fmamk_f32 v19, v9, 0x40000000, v8
    v_mfma_f32_32x32x16_bf16 v[160:175], v[56:59], a[40:43], v[160:175]
    s_add_u32 s74, s74, 294912
    s_cmp_ge_u32 s74, 5308416
    s_cselect_b32 s74, 0, s74
    s_add_u32 m0, s56, 20736
    s_nop 0
    buffer_load_dwordx4 v6, s[12:15], s74 offen lds
    v_mfma_f32_32x32x16_bf16 v[176:191], v[56:59], a[44:47], v[176:191]
    s_add_u32 m0, s56, 20736
    s_nop 0
    buffer_load_dword v7, s[12:15], s74 offen offset:1024 lds
    v_cos_f32 v20, v18
    v_mfma_f32_32x32x16_bf16 v[192:207], v[60:63], a[40:43], v[192:207]
    s_add_u32 m0, s56, 25984
    s_nop 0
    buffer_load_dwordx4 v6, s[20:23], s74 offen lds
    v_cos_f32 v21, v19
    v_mfma_f32_32x32x16_bf16 v[208:223], v[60:63], a[44:47], v[208:223]
    s_add_u32 m0, s56, 25984
    s_nop 0
    buffer_load_dword v7, s[20:23], s74 offen offset:1024 lds
    v_sin_f32 v18, v18
    s_waitcnt lgkmcnt(0)
    v_mfma_f32_32x32x16_bf16 v[64:79], v[24:27], a[48:51], v[64:79]
    ds_read_b64_tr_b16 v[44:45], v1 offset:33664
    ds_read_b64_tr_b16 v[46:47], v1 offset:34304
    v_sin_f32 v19, v19
    v_mfma_f32_32x32x16_bf16 v[80:95], v[24:27], a[52:55], v[80:95]
    ds_read_b64_tr_b16 v[48:49], v1 offset:33696
    ds_read_b64_tr_b16 v[50:51], v1 offset:34336
    v_cvt_pk_bf16_f32 v10, v20, v21
    v_cvt_pk_bf16_f32 v14, v18, v19
    v_mfma_f32_32x32x16_bf16 v[96:111], v[28:31], a[48:51], v[96:111]
    ds_read_b64_tr_b16 v[52:53], v1 offset:33728
    ds_read_b64_tr_b16 v[54:55], v1 offset:34368
    v_fmamk_f32 v18, v9, 0x40800000, v8
    v_fmamk_f32 v19, v9, 0x40c00000, v8
    v_mfma_f32_32x32x16_bf16 v[112:127], v[28:31], a[52:55], v[112:127]
    ds_read_b64_tr_b16 v[56:57], v1 offset:33760
    ds_read_b64_tr_b16 v[58:59], v1 offset:34400
    v_cos_f32 v20, v18
    v_mfma_f32_32x32x16_bf16 v[128:143], v[32:35], a[48:51], v[128:143]
    ds_read_b64_tr_b16 v[60:61], v1 offset:33792
    ds_read_b64_tr_b16 v[62:63], v1 offset:34432
    v_cos_f32 v21, v19
    v_mfma_f32_32x32x16_bf16 v[144:159], v[32:35], a[52:55], v[144:159]
    v_sin_f32 v18, v18
    v_sin_f32 v19, v19
    v_mfma_f32_32x32x16_bf16 v[160:175], v[36:39], a[48:51], v[160:175]
    v_cvt_pk_bf16_f32 v11, v20, v21
    v_cvt_pk_bf16_f32 v15, v18, v19
    v_fmamk_f32 v18, v9, 0x41800000, v8
    v_fmamk_f32 v19, v9, 0x41900000, v8
    v_mfma_f32_32x32x16_bf16 v[176:191], v[36:39], a[52:55], v[176:191]
    v_cos_f32 v20, v18
    v_cos_f32 v21, v19
    v_mfma_f32_32x32x16_bf16 v[192:207], v[40:43], a[48:51], v[192:207]
    v_sin_f32 v18, v18
    v_sin_f32 v19, v19
    v_mfma_f32_32x32x16_bf16 v[208:223], v[40:43], a[52:55], v[208:223]
    v_cvt_pk_bf16_f32 v12, v20, v21
    s_waitcnt vmcnt(28) lgkmcnt(0)
    s_barrier
    v_mfma_f32_32x32x16_bf16 v[64:79], v[44:47], a[56:59], v[64:79]
    ds_read_b64_tr_b16 v[24:25], v1 offset:41472
    ds_read_b64_tr_b16 v[26:27], v1 offset:42112
    v_cvt_pk_bf16_f32 v16, v18, v19
    v_fmamk_f32 v18, v9, 0x41a00000, v8
    v_fmamk_f32 v19, v9, 0x41b00000, v8
    v_cos_f32 v20, v18
    v_mfma_f32_32x32x16_bf16 v[80:95], v[44:47], a[60:63], v[80:95]
    ds_read_b64_tr_b16 v[28:29], v1 offset:41504
    ds_read_b64_tr_b16 v[30:31], v1 offset:42144
    v_cos_f32 v21, v19
    v_sin_f32 v18, v18
    v_mfma_f32_32x32x16_bf16 v[96:111], v[48:51], a[56:59], v[96:111]
    ds_read_b64_tr_b16 v[32:33], v1 offset:41536
    ds_read_b64_tr_b16 v[34:35], v1 offset:42176
    v_sin_f32 v19, v19
    v_cvt_pk_bf16_f32 v13, v20, v21
    v_cvt_pk_bf16_f32 v17, v18, v19
    v_mfma_f32_32x32x16_bf16 v[112:127], v[48:51], a[60:63], v[112:127]
    ds_read_b64_tr_b16 v[36:37], v1 offset:41568
    ds_read_b64_tr_b16 v[38:39], v1 offset:42208
    ds_write_b128 v2, v[10:13] offset:6144
    v_mfma_f32_32x32x16_bf16 v[128:143], v[52:55], a[56:59], v[128:143]
    ds_read_b64_tr_b16 v[40:41], v1 offset:41600
    ds_read_b64_tr_b16 v[42:43], v1 offset:42240
    ds_write_b128 v2, v[14:17] offset:8192
    v_xor_b32 v18, 0x80008000, v14
    v_xor_b32 v19, 0x80008000, v15
    v_mfma_f32_32x32x16_bf16 v[144:159], v[52:55], a[60:63], v[144:159]
    v_xor_b32 v20, 0x80008000, v16
    v_xor_b32 v21, 0x80008000, v17
    ds_write_b128 v2, v[18:21] offset:10240
    v_fmamk_f32 v18, v9, 0x42000000, v8
    v_fmamk_f32 v19, v9, 0x42080000, v8
    v_mfma_f32_32x32x16_bf16 v[160:175], v[56:59], a[56:59], v[160:175]
    s_add_u32 s74, s74, 294912
    s_cmp_ge_u32 s74, 5308416
    s_cselect_b32 s74, 0, s74
    s_add_u32 m0, s56, 31104
    s_nop 0
    buffer_load_dwordx4 v6, s[12:15], s74 offen lds
    v_mfma_f32_32x32x16_bf16 v[176:191], v[56:59], a[60:63], v[176:191]
    s_add_u32 m0, s56, 31104
    s_nop 0
    buffer_load_dword v7, s[12:15], s74 offen offset:1024 lds
    v_mfma_f32_32x32x16_bf16 v[192:207], v[60:63], a[56:59], v[192:207]
    s_add_u32 m0, s56, 36352
    s_nop 0
    buffer_load_dwordx4 v6, s[20:23], s74 offen lds
    v_mfma_f32_32x32x16_bf16 v[208:223], v[60:63], a[60:63], v[208:223]
    s_add_u32 m0, s56, 36352
    s_nop 0
    buffer_load_dword v7, s[20:23], s74 offen offset:1024 lds
    s_waitcnt lgkmcnt(0)
    v_mfma_f32_32x32x16_bf16 v[64:79], v[24:27], a[64:67], v[64:79]
    ds_read_b64_tr_b16 v[44:45], v1 offset:44032
    ds_read_b64_tr_b16 v[46:47], v1 offset:44672
    v_cos_f32 v20, v18
    v_mfma_f32_32x32x16_bf16 v[80:95], v[24:27], a[68:71], v[80:95]
    ds_read_b64_tr_b16 v[48:49], v1 offset:44064
    ds_read_b64_tr_b16 v[50:51], v1 offset:44704
    v_cos_f32 v21, v19
    v_mfma_f32_32x32x16_bf16 v[96:111], v[28:31], a[64:67], v[96:111]
    ds_read_b64_tr_b16 v[52:53], v1 offset:44096
    ds_read_b64_tr_b16 v[54:55], v1 offset:44736
    v_sin_f32 v18, v18
    v_mfma_f32_32x32x16_bf16 v[112:127], v[28:31], a[68:71], v[112:127]
    ds_read_b64_tr_b16 v[56:57], v1 offset:44128
    ds_read_b64_tr_b16 v[58:59], v1 offset:44768
    v_sin_f32 v19, v19
    v_mfma_f32_32x32x16_bf16 v[128:143], v[32:35], a[64:67], v[128:143]
    ds_read_b64_tr_b16 v[60:61], v1 offset:44160
    ds_read_b64_tr_b16 v[62:63], v1 offset:44800
    v_cvt_pk_bf16_f32 v10, v20, v21
    v_cvt_pk_bf16_f32 v14, v18, v19
    v_mfma_f32_32x32x16_bf16 v[144:159], v[32:35], a[68:71], v[144:159]
    v_fmamk_f32 v18, v9, 0x42100000, v8
    v_fmamk_f32 v19, v9, 0x42180000, v8
    v_cos_f32 v20, v18
    v_mfma_f32_32x32x16_bf16 v[160:175], v[36:39], a[64:67], v[160:175]
    v_cos_f32 v21, v19
    v_sin_f32 v18, v18
    v_mfma_f32_32x32x16_bf16 v[176:191], v[36:39], a[68:71], v[176:191]
    v_sin_f32 v19, v19
    v_cvt_pk_bf16_f32 v11, v20, v21
    v_cvt_pk_bf16_f32 v15, v18, v19
    v_mfma_f32_32x32x16_bf16 v[192:207], v[40:43], a[64:67], v[192:207]
    v_fmamk_f32 v18, v9, 0x42400000, v8
    v_fmamk_f32 v19, v9, 0x42480000, v8
    v_cos_f32 v20, v18
    v_mfma_f32_32x32x16_bf16 v[208:223], v[40:43], a[68:71], v[208:223]
    v_cos_f32 v21, v19
    s_waitcnt vmcnt(28) lgkmcnt(0)
    s_barrier
    v_mfma_f32_32x32x16_bf16 v[64:79], v[44:47], a[72:75], v[64:79]
    ds_read_b64_tr_b16 v[24:25], v1 offset:51840
    ds_read_b64_tr_b16 v[26:27], v1 offset:52480
    v_sin_f32 v18, v18
    v_sin_f32 v19, v19
    v_mfma_f32_32x32x16_bf16 v[80:95], v[44:47], a[76:79], v[80:95]
    ds_read_b64_tr_b16 v[28:29], v1 offset:51872
    ds_read_b64_tr_b16 v[30:31], v1 offset:52512
    v_cvt_pk_bf16_f32 v12, v20, v21
    v_cvt_pk_bf16_f32 v16, v18, v19
    v_fmamk_f32 v18, v9, 0x42500000, v8
    v_fmamk_f32 v19, v9, 0x42580000, v8
    v_mfma_f32_32x32x16_bf16 v[96:111], v[48:51], a[72:75], v[96:111]
    ds_read_b64_tr_b16 v[32:33], v1 offset:51904
    ds_read_b64_tr_b16 v[34:35], v1 offset:52544
    v_cos_f32 v20, v18
    v_cos_f32 v21, v19
    v_mfma_f32_32x32x16_bf16 v[112:127], v[48:51], a[76:79], v[112:127]
    ds_read_b64_tr_b16 v[36:37], v1 offset:51936
    ds_read_b64_tr_b16 v[38:39], v1 offset:52576
    v_sin_f32 v18, v18
    v_sin_f32 v19, v19
    v_mfma_f32_32x32x16_bf16 v[128:143], v[52:55], a[72:75], v[128:143]
    ds_read_b64_tr_b16 v[40:41], v1 offset:51968
    ds_read_b64_tr_b16 v[42:43], v1 offset:52608
    v_cvt_pk_bf16_f32 v13, v20, v21
    v_cvt_pk_bf16_f32 v17, v18, v19
    v_mfma_f32_32x32x16_bf16 v[144:159], v[52:55], a[76:79], v[144:159]
    ds_write_b128 v2, v[10:13] offset:7168
    ds_write_b128 v2, v[14:17] offset:9216
    v_mfma_f32_32x32x16_bf16 v[160:175], v[56:59], a[72:75], v[160:175]
    s_add_u32 s74, s74, 294912
    s_cmp_ge_u32 s74, 5308416
    s_cselect_b32 s74, 0, s74
    s_add_u32 m0, s56, 41472
    s_nop 0
    buffer_load_dwordx4 v6, s[12:15], s74 offen lds
    v_xor_b32 v18, 0x80008000, v14
    v_mfma_f32_32x32x16_bf16 v[176:191], v[56:59], a[76:79], v[176:191]
    s_add_u32 m0, s56, 41472
    s_nop 0
    buffer_load_dword v7, s[12:15], s74 offen offset:1024 lds
    v_xor_b32 v19, 0x80008000, v15
    v_xor_b32 v20, 0x80008000, v16
    v_mfma_f32_32x32x16_bf16 v[192:207], v[60:63], a[72:75], v[192:207]
    s_add_u32 m0, s56, 46720
    s_nop 0
    buffer_load_dwordx4 v6, s[20:23], s74 offen lds
    v_xor_b32 v21, 0x80008000, v17
    v_mfma_f32_32x32x16_bf16 v[208:223], v[60:63], a[76:79], v[208:223]
    s_add_u32 m0, s56, 46720
    s_nop 0
    buffer_load_dword v7, s[20:23], s74 offen offset:1024 lds
    s_waitcnt lgkmcnt(0)
    v_mfma_f32_32x32x16_bf16 v[64:79], v[24:27], a[80:83], v[64:79]
    ds_read_b64_tr_b16 v[44:45], v1 offset:54400
    ds_read_b64_tr_b16 v[46:47], v1 offset:55040
    ds_write_b128 v2, v[18:21] offset:11264
    v_mfma_f32_32x32x16_bf16 v[80:95], v[24:27], a[84:87], v[80:95]
    ds_read_b64_tr_b16 v[48:49], v1 offset:54432
    ds_read_b64_tr_b16 v[50:51], v1 offset:55072
    v_fma_f32 v9, v3, 2.0, 1.0
    v_mul_f32 v9, 0x3c800000, v9
    v_mul_f32 v8, 0x40800000, v5
    v_mfma_f32_32x32x16_bf16 v[96:111], v[28:31], a[80:83], v[96:111]
    ds_read_b64_tr_b16 v[52:53], v1 offset:54464
    ds_read_b64_tr_b16 v[54:55], v1 offset:55104
    v_mul_f32 v8, v8, v9
    v_fmamk_f32 v18, v9, 0x0, v8
    v_fmamk_f32 v19, v9, 0x3f800000, v8
    v_mfma_f32_32x32x16_bf16 v[112:127], v[28:31], a[84:87], v[112:127]
    ds_read_b64_tr_b16 v[56:57], v1 offset:54496
    ds_read_b64_tr_b16 v[58:59], v1 offset:55136
    v_cos_f32 v20, v18
    v_mfma_f32_32x32x16_bf16 v[128:143], v[32:35], a[80:83], v[128:143]
    ds_read_b64_tr_b16 v[60:61], v1 offset:54528
    ds_read_b64_tr_b16 v[62:63], v1 offset:55168
    v_cos_f32 v21, v19
    v_mfma_f32_32x32x16_bf16 v[144:159], v[32:35], a[84:87], v[144:159]
    v_sin_f32 v18, v18
    v_sin_f32 v19, v19
    v_cvt_pk_bf16_f32 v10, v20, v21
    v_mfma_f32_32x32x16_bf16 v[160:175], v[36:39], a[80:83], v[160:175]
    v_cvt_pk_bf16_f32 v14, v18, v19
    v_fmamk_f32 v18, v9, 0x40000000, v8
    v_fmamk_f32 v19, v9, 0x40400000, v8
    v_cos_f32 v20, v18
    v_mfma_f32_32x32x16_bf16 v[176:191], v[36:39], a[84:87], v[176:191]
    v_cos_f32 v21, v19
    v_sin_f32 v18, v18
    v_mfma_f32_32x32x16_bf16 v[192:207], v[40:43], a[80:83], v[192:207]
    v_mfma_f32_32x32x16_bf16 v[208:223], v[40:43], a[84:87], v[208:223]
    s_waitcnt vmcnt(16) lgkmcnt(0)
    s_barrier
    v_mfma_f32_32x32x16_bf16 v[64:79], v[44:47], a[88:91], v[64:79]
    ds_read_b64_tr_b16 v[24:25], v1 offset:0
    ds_read_b64_tr_b16 v[26:27], v1 offset:640
    v_sin_f32 v19, v19
    v_cvt_pk_bf16_f32 v11, v20, v21
    v_cvt_pk_bf16_f32 v15, v18, v19
    v_mfma_f32_32x32x16_bf16 v[80:95], v[44:47], a[92:95], v[80:95]
    ds_read_b64_tr_b16 v[28:29], v1 offset:32
    ds_read_b64_tr_b16 v[30:31], v1 offset:672
    v_fmamk_f32 v18, v9, 0x41000000, v8
    v_fmamk_f32 v19, v9, 0x41100000, v8
    v_cos_f32 v20, v18
    v_mfma_f32_32x32x16_bf16 v[96:111], v[48:51], a[88:91], v[96:111]
    ds_read_b64_tr_b16 v[32:33], v1 offset:64
    ds_read_b64_tr_b16 v[34:35], v1 offset:704
    v_cos_f32 v21, v19
    v_sin_f32 v18, v18
    v_mfma_f32_32x32x16_bf16 v[112:127], v[48:51], a[92:95], v[112:127]
    ds_read_b64_tr_b16 v[36:37], v1 offset:96
    ds_read_b64_tr_b16 v[38:39], v1 offset:736
    v_sin_f32 v19, v19
    v_cvt_pk_bf16_f32 v12, v20, v21
    v_cvt_pk_bf16_f32 v16, v18, v19
    v_mfma_f32_32x32x16_bf16 v[128:143], v[52:55], a[88:91], v[128:143]
    ds_read_b64_tr_b16 v[40:41], v1 offset:128
    ds_read_b64_tr_b16 v[42:43], v1 offset:768
    v_fmamk_f32 v18, v9, 0x41200000, v8
    v_fmamk_f32 v19, v9, 0x41300000, v8
    v_cos_f32 v20, v18
    v_mfma_f32_32x32x16_bf16 v[144:159], v[52:55], a[92:95], v[144:159]
    v_cos_f32 v21, v19
    v_sin_f32 v18, v18
    v_sin_f32 v19, v19
    v_mfma_f32_32x32x16_bf16 v[160:175], v[56:59], a[88:91], v[160:175]
    s_add_u32 s74, s74, 294912
    s_cmp_ge_u32 s74, 5308416
    s_cselect_b32 s74, 0, s74
    s_add_u32 m0, s56, 51840
    s_nop 0
    buffer_load_dwordx4 v6, s[12:15], s74 offen lds
    v_cvt_pk_bf16_f32 v13, v20, v21
    v_mfma_f32_32x32x16_bf16 v[176:191], v[56:59], a[92:95], v[176:191]
    s_add_u32 m0, s56, 51840
    s_nop 0
    buffer_load_dword v7, s[12:15], s74 offen offset:1024 lds
    v_mfma_f32_32x32x16_bf16 v[192:207], v[60:63], a[88:91], v[192:207]
    s_add_u32 m0, s56, 57088
    s_nop 0
    buffer_load_dwordx4 v6, s[20:23], s74 offen lds
    v_mfma_f32_32x32x16_bf16 v[208:223], v[60:63], a[92:95], v[208:223]
    s_add_u32 m0, s56, 57088
    s_nop 0
    buffer_load_dword v7, s[20:23], s74 offen offset:1024 lds
    v_mov_b32 v22, 1
    v_min_u32 v23, 1, v0
    v_lshlrev_b32 v23, 30, v23
    buffer_store_dword v22, v23, s[16:19], s60 offen sc0 sc1
    s_waitcnt lgkmcnt(0)
    v_mfma_f32_32x32x16_bf16 v[64:79], v[24:27], a[96:99], v[64:79]
    ds_read_b64_tr_b16 v[44:45], v1 offset:2560
    ds_read_b64_tr_b16 v[46:47], v1 offset:3200
    v_cvt_pk_bf16_f32 v17, v18, v19
    v_mfma_f32_32x32x16_bf16 v[80:95], v[24:27], a[100:103], v[80:95]
    ds_read_b64_tr_b16 v[48:49], v1 offset:2592
    ds_read_b64_tr_b16 v[50:51], v1 offset:3232
    ds_write_b128 v2, v[10:13] offset:12288
    v_mfma_f32_32x32x16_bf16 v[96:111], v[28:31], a[96:99], v[96:111]
    ds_read_b64_tr_b16 v[52:53], v1 offset:2624
    ds_read_b64_tr_b16 v[54:55], v1 offset:3264
    ds_write_b128 v2, v[14:17] offset:14336
    v_mfma_f32_32x32x16_bf16 v[112:127], v[28:31], a[100:103], v[112:127]
    ds_read_b64_tr_b16 v[56:57], v1 offset:2656
    ds_read_b64_tr_b16 v[58:59], v1 offset:3296
    v_xor_b32 v18, 0x80008000, v14
    v_xor_b32 v19, 0x80008000, v15
    v_xor_b32 v20, 0x80008000, v16
    v_mfma_f32_32x32x16_bf16 v[128:143], v[32:35], a[96:99], v[128:143]
    ds_read_b64_tr_b16 v[60:61], v1 offset:2688
    ds_read_b64_tr_b16 v[62:63], v1 offset:3328
    v_xor_b32 v21, 0x80008000, v17
    v_mfma_f32_32x32x16_bf16 v[144:159], v[32:35], a[100:103], v[144:159]
    ds_write_b128 v2, v[18:21] offset:16384
    v_fmamk_f32 v18, v9, 0x41800000, v8
    v_fmamk_f32 v19, v9, 0x41880000, v8
    v_mfma_f32_32x32x16_bf16 v[160:175], v[36:39], a[96:99], v[160:175]
    v_cos_f32 v20, v18
    v_cos_f32 v21, v19
    v_mfma_f32_32x32x16_bf16 v[176:191], v[36:39], a[100:103], v[176:191]
    v_sin_f32 v18, v18
    v_sin_f32 v19, v19
    v_cvt_pk_bf16_f32 v10, v20, v21
    v_mfma_f32_32x32x16_bf16 v[192:207], v[40:43], a[96:99], v[192:207]
    v_cvt_pk_bf16_f32 v14, v18, v19
    v_fmamk_f32 v18, v9, 0x41900000, v8
    v_fmamk_f32 v19, v9, 0x41980000, v8
    v_mfma_f32_32x32x16_bf16 v[208:223], v[40:43], a[100:103], v[208:223]
    s_waitcnt vmcnt(17) lgkmcnt(0)
    s_barrier
    v_mfma_f32_32x32x16_bf16 v[64:79], v[44:47], a[104:107], v[64:79]
    ds_read_b64_tr_b16 v[24:25], v1 offset:10368
    ds_read_b64_tr_b16 v[26:27], v1 offset:11008
    v_cos_f32 v20, v18
    v_cos_f32 v21, v19
    v_mfma_f32_32x32x16_bf16 v[80:95], v[44:47], a[108:111], v[80:95]
    ds_read_b64_tr_b16 v[28:29], v1 offset:10400
    ds_read_b64_tr_b16 v[30:31], v1 offset:11040
    v_sin_f32 v18, v18
    v_sin_f32 v19, v19
    v_mfma_f32_32x32x16_bf16 v[96:111], v[48:51], a[104:107], v[96:111]
    ds_read_b64_tr_b16 v[32:33], v1 offset:10432
    ds_read_b64_tr_b16 v[34:35], v1 offset:11072
    v_cvt_pk_bf16_f32 v11, v20, v21
    v_cvt_pk_bf16_f32 v15, v18, v19
    v_fmamk_f32 v18, v9, 0x41c00000, v8
    v_fmamk_f32 v19, v9, 0x41c80000, v8
    v_mfma_f32_32x32x16_bf16 v[112:127], v[48:51], a[108:111], v[112:127]
    ds_read_b64_tr_b16 v[36:37], v1 offset:10464
    ds_read_b64_tr_b16 v[38:39], v1 offset:11104
    v_cos_f32 v20, v18
    v_cos_f32 v21, v19
    v_mfma_f32_32x32x16_bf16 v[128:143], v[52:55], a[104:107], v[128:143]
    ds_read_b64_tr_b16 v[40:41], v1 offset:10496
    ds_read_b64_tr_b16 v[42:43], v1 offset:11136
    v_sin_f32 v18, v18
    v_sin_f32 v19, v19
    v_mfma_f32_32x32x16_bf16 v[144:159], v[52:55], a[108:111], v[144:159]
    v_cvt_pk_bf16_f32 v12, v20, v21
    v_cvt_pk_bf16_f32 v16, v18, v19
    v_fmamk_f32 v18, v9, 0x41d00000, v8
    v_fmamk_f32 v19, v9, 0x41d80000, v8
    v_cos_f32 v20, v18
    v_mfma_f32_32x32x16_bf16 v[160:175], v[56:59], a[104:107], v[160:175]
    s_add_u32 s74, s74, 294912
    s_cmp_ge_u32 s74, 5308416
    s_cselect_b32 s74, 0, s74
    s_add_u32 m0, s56, 0
    s_nop 0
    buffer_load_dwordx4 v6, s[12:15], s74 offen lds
    v_mfma_f32_32x32x16_bf16 v[176:191], v[56:59], a[108:111], v[176:191]
    s_add_u32 m0, s56, 0
    s_nop 0
    buffer_load_dword v7, s[12:15], s74 offen offset:1024 lds
    v_cos_f32 v21, v19
    v_mfma_f32_32x32x16_bf16 v[192:207], v[60:63], a[104:107], v[192:207]
    s_add_u32 m0, s56, 5248
    s_nop 0
    buffer_load_dwordx4 v6, s[20:23], s74 offen lds
    v_mfma_f32_32x32x16_bf16 v[208:223], v[60:63], a[108:111], v[208:223]
    s_add_u32 m0, s56, 5248
    s_nop 0
    buffer_load_dword v7, s[20:23], s74 offen offset:1024 lds
    s_waitcnt lgkmcnt(0)
    v_mfma_f32_32x32x16_bf16 v[64:79], v[24:27], a[112:115], v[64:79]
    ds_read_b64_tr_b16 v[44:45], v1 offset:12928
    ds_read_b64_tr_b16 v[46:47], v1 offset:13568
    v_sin_f32 v18, v18
    v_mfma_f32_32x32x16_bf16 v[80:95], v[24:27], a[116:119], v[80:95]
    ds_read_b64_tr_b16 v[48:49], v1 offset:12960
    ds_read_b64_tr_b16 v[50:51], v1 offset:13600
    v_sin_f32 v19, v19
    v_mfma_f32_32x32x16_bf16 v[96:111], v[28:31], a[112:115], v[96:111]
    ds_read_b64_tr_b16 v[52:53], v1 offset:12992
    ds_read_b64_tr_b16 v[54:55], v1 offset:13632
    v_cvt_pk_bf16_f32 v13, v20, v21
    v_cvt_pk_bf16_f32 v17, v18, v19
    v_mfma_f32_32x32x16_bf16 v[112:127], v[28:31], a[116:119], v[112:127]
    ds_read_b64_tr_b16 v[56:57], v1 offset:13024
    ds_read_b64_tr_b16 v[58:59], v1 offset:13664
    v_mfma_f32_32x32x16_bf16 v[128:143], v[32:35], a[112:115], v[128:143]
    ds_read_b64_tr_b16 v[60:61], v1 offset:13056
    ds_read_b64_tr_b16 v[62:63], v1 offset:13696
    v_mfma_f32_32x32x16_bf16 v[144:159], v[32:35], a[116:119], v[144:159]
    ds_write_b128 v2, v[10:13] offset:13312
    v_mfma_f32_32x32x16_bf16 v[160:175], v[36:39], a[112:115], v[160:175]
    ds_write_b128 v2, v[14:17] offset:15360
    v_xor_b32 v18, 0x80008000, v14
    v_mfma_f32_32x32x16_bf16 v[176:191], v[36:39], a[116:119], v[176:191]
    v_xor_b32 v19, 0x80008000, v15
    v_xor_b32 v20, 0x80008000, v16
    v_xor_b32 v21, 0x80008000, v17
    v_mfma_f32_32x32x16_bf16 v[192:207], v[40:43], a[112:115], v[192:207]
    ds_write_b128 v2, v[18:21] offset:17408
    v_mfma_f32_32x32x16_bf16 v[208:223], v[40:43], a[116:119], v[208:223]
    s_waitcnt vmcnt(17) lgkmcnt(0)
    s_barrier
    v_mfma_f32_32x32x16_bf16 v[64:79], v[44:47], a[120:123], v[64:79]
    ds_read_b64_tr_b16 v[24:25], v1 offset:20736
    ds_read_b64_tr_b16 v[26:27], v1 offset:21376
    v_mfma_f32_32x32x16_bf16 v[80:95], v[44:47], a[124:127], v[80:95]
    ds_read_b64_tr_b16 v[28:29], v1 offset:20768
    ds_read_b64_tr_b16 v[30:31], v1 offset:21408
    v_mfma_f32_32x32x16_bf16 v[96:111], v[48:51], a[120:123], v[96:111]
    ds_read_b64_tr_b16 v[32:33], v1 offset:20800
    ds_read_b64_tr_b16 v[34:35], v1 offset:21440
    v_mfma_f32_32x32x16_bf16 v[112:127], v[48:51], a[124:127], v[112:127]
    ds_read_b64_tr_b16 v[36:37], v1 offset:20832
    ds_read_b64_tr_b16 v[38:39], v1 offset:21472
    v_mfma_f32_32x32x16_bf16 v[128:143], v[52:55], a[120:123], v[128:143]
    ds_read_b64_tr_b16 v[40:41], v1 offset:20864
    ds_read_b64_tr_b16 v[42:43], v1 offset:21504
    v_mfma_f32_32x32x16_bf16 v[144:159], v[52:55], a[124:127], v[144:159]
    v_mfma_f32_32x32x16_bf16 v[160:175], v[56:59], a[120:123], v[160:175]
    s_add_u32 s74, s74, 294912
    s_cmp_ge_u32 s74, 5308416
    s_cselect_b32 s74, 0, s74
    s_add_u32 m0, s56, 10368
    s_nop 0
    buffer_load_dwordx4 v6, s[12:15], s74 offen lds
    v_mfma_f32_32x32x16_bf16 v[176:191], v[56:59], a[124:127], v[176:191]
    s_add_u32 m0, s56, 10368
    s_nop 0
    buffer_load_dword v7, s[12:15], s74 offen offset:1024 lds
    v_mfma_f32_32x32x16_bf16 v[192:207], v[60:63], a[120:123], v[192:207]
    s_add_u32 m0, s56, 15616
    s_nop 0
    buffer_load_dwordx4 v6, s[20:23], s74 offen lds
    v_mfma_f32_32x32x16_bf16 v[208:223], v[60:63], a[124:127], v[208:223]
    s_add_u32 m0, s56, 15616
    s_nop 0
    buffer_load_dword v7, s[20:23], s74 offen offset:1024 lds
    s_waitcnt lgkmcnt(0)
    v_mfma_f32_32x32x16_bf16 v[64:79], v[24:27], a[128:131], v[64:79]
    ds_read_b64_tr_b16 v[44:45], v1 offset:23296
    ds_read_b64_tr_b16 v[46:47], v1 offset:23936
    v_mfma_f32_32x32x16_bf16 v[80:95], v[24:27], a[132:135], v[80:95]
    ds_read_b64_tr_b16 v[48:49], v1 offset:23328
    ds_read_b64_tr_b16 v[50:51], v1 offset:23968
    v_mfma_f32_32x32x16_bf16 v[96:111], v[28:31], a[128:131], v[96:111]
    ds_read_b64_tr_b16 v[52:53], v1 offset:23360
    ds_read_b64_tr_b16 v[54:55], v1 offset:24000
    v_mfma_f32_32x32x16_bf16 v[112:127], v[28:31], a[132:135], v[112:127]
    ds_read_b64_tr_b16 v[56:57], v1 offset:23392
    ds_read_b64_tr_b16 v[58:59], v1 offset:24032
    v_mfma_f32_32x32x16_bf16 v[128:143], v[32:35], a[128:131], v[128:143]
    ds_read_b64_tr_b16 v[60:61], v1 offset:23424
    ds_read_b64_tr_b16 v[62:63], v1 offset:24064
    v_mfma_f32_32x32x16_bf16 v[144:159], v[32:35], a[132:135], v[144:159]
    v_mfma_f32_32x32x16_bf16 v[160:175], v[36:39], a[128:131], v[160:175]
    v_mfma_f32_32x32x16_bf16 v[176:191], v[36:39], a[132:135], v[176:191]
    v_mfma_f32_32x32x16_bf16 v[192:207], v[40:43], a[128:131], v[192:207]
    v_mfma_f32_32x32x16_bf16 v[208:223], v[40:43], a[132:135], v[208:223]
    s_waitcnt vmcnt(17) lgkmcnt(0)
    s_barrier
    v_mfma_f32_32x32x16_bf16 v[64:79], v[44:47], a[136:139], v[64:79]
    ds_read_b64_tr_b16 v[24:25], v1 offset:31104
    ds_read_b64_tr_b16 v[26:27], v1 offset:31744
    s_add_u32 s3, s44, 9
    v_mov_b32 v8, 9
    v_mov_b32 v9, 17
    v_cmp_gt_u32 vcc, 32, v0
    v_mfma_f32_32x32x16_bf16 v[80:95], v[44:47], a[140:143], v[80:95]
    ds_read_b64_tr_b16 v[28:29], v1 offset:31136
    ds_read_b64_tr_b16 v[30:31], v1 offset:31776
    v_cndmask_b32 v8, v8, v9, vcc
    v_cmp_gt_u32 vcc, 24, v0
    s_nop 1
    v_cndmask_b32 v8, v8, 8, vcc
    v_mov_b32 v9, s3
    v_mfma_f32_32x32x16_bf16 v[96:111], v[48:51], a[136:139], v[96:111]
    ds_read_b64_tr_b16 v[32:33], v1 offset:31168
    ds_read_b64_tr_b16 v[34:35], v1 offset:31808
    v_cmp_gt_u32 vcc, 16, v0
    s_nop 1
    v_cndmask_b32 v8, v8, v9, vcc
    v_mov_b32 v9, s44
    v_cmp_gt_u32 vcc, 8, v0
    v_mfma_f32_32x32x16_bf16 v[112:127], v[48:51], a[140:143], v[112:127]
    ds_read_b64_tr_b16 v[36:37], v1 offset:31200
    ds_read_b64_tr_b16 v[38:39], v1 offset:31840
    v_cndmask_b32 v8, v8, v9, vcc
    v_and_b32 v9, 7, v8
    v_lshlrev_b32 v10, 2, v9
    v_add_u32 v10, v10, v0
    v_mfma_f32_32x32x16_bf16 v[128:143], v[52:55], a[136:139], v[128:143]
    ds_read_b64_tr_b16 v[40:41], v1 offset:31232
    ds_read_b64_tr_b16 v[42:43], v1 offset:31872
    v_and_b32 v10, 7, v10
    v_cmp_le_u32 vcc, 16, v8
    s_nop 1
    v_cndmask_b32 v9, v9, v10, vcc
    v_lshrrev_b32 v8, 3, v8
    v_mfma_f32_32x32x16_bf16 v[144:159], v[52:55], a[140:143], v[144:159]
    v_lshl_add_u32 v8, v9, 5, v8
    v_and_b32 v9, 7, v0
    v_lshl_add_u32 v8, v9, 8, v8
    v_lshlrev_b32 v8, 2, v8
    v_min_u32 v9, 3, v0
    v_lshlrev_b32 v9, 6, v9
    v_mfma_f32_32x32x16_bf16 v[160:175], v[56:59], a[136:139], v[160:175]
    s_add_u32 s74, s74, 294912
    s_cmp_ge_u32 s74, 5308416
    s_cselect_b32 s74, 0, s74
    s_add_u32 m0, s56, 20736
    s_nop 0
    buffer_load_dwordx4 v6, s[12:15], s74 offen lds
    s_lshl_b32 s3, s38, 2
    v_mfma_f32_32x32x16_bf16 v[176:191], v[56:59], a[140:143], v[176:191]
    s_add_u32 m0, s56, 20736
    s_nop 0
    buffer_load_dword v7, s[12:15], s74 offen offset:1024 lds
    s_add_u32 s3, s3, s36
    s_lshl_b32 s3, s3, 11
    v_mfma_f32_32x32x16_bf16 v[192:207], v[60:63], a[136:139], v[192:207]
    s_add_u32 m0, s56, 25984
    s_nop 0
    buffer_load_dwordx4 v6, s[20:23], s74 offen lds
    v_add_u32 v11, s3, v4
    v_mfma_f32_32x32x16_bf16 v[208:223], v[60:63], a[140:143], v[208:223]
    s_add_u32 m0, s56, 25984
    s_nop 0
    buffer_load_dword v7, s[20:23], s74 offen offset:1024 lds
    s_waitcnt lgkmcnt(0)
    v_mfma_f32_32x32x16_bf16 v[64:79], v[24:27], a[144:147], v[64:79]
    ds_read_b64_tr_b16 v[44:45], v1 offset:33664
    ds_read_b64_tr_b16 v[46:47], v1 offset:34304
    v_mfma_f32_32x32x16_bf16 v[80:95], v[24:27], a[148:151], v[80:95]
    ds_read_b64_tr_b16 v[48:49], v1 offset:33696
    ds_read_b64_tr_b16 v[50:51], v1 offset:34336
    v_mfma_f32_32x32x16_bf16 v[96:111], v[28:31], a[144:147], v[96:111]
    ds_read_b64_tr_b16 v[52:53], v1 offset:33728
    ds_read_b64_tr_b16 v[54:55], v1 offset:34368
    v_mfma_f32_32x32x16_bf16 v[112:127], v[28:31], a[148:151], v[112:127]
    ds_read_b64_tr_b16 v[56:57], v1 offset:33760
    ds_read_b64_tr_b16 v[58:59], v1 offset:34400
    v_mfma_f32_32x32x16_bf16 v[128:143], v[32:35], a[144:147], v[128:143]
    ds_read_b64_tr_b16 v[60:61], v1 offset:33792
    ds_read_b64_tr_b16 v[62:63], v1 offset:34432
    v_mfma_f32_32x32x16_bf16 v[144:159], v[32:35], a[148:151], v[144:159]
    v_mfma_f32_32x32x16_bf16 v[160:175], v[36:39], a[144:147], v[160:175]
    v_mfma_f32_32x32x16_bf16 v[176:191], v[36:39], a[148:151], v[176:191]
    v_mfma_f32_32x32x16_bf16 v[192:207], v[40:43], a[144:147], v[192:207]
    v_mfma_f32_32x32x16_bf16 v[208:223], v[40:43], a[148:151], v[208:223]
    s_waitcnt vmcnt(17) lgkmcnt(0)
    s_barrier
    v_mfma_f32_32x32x16_bf16 v[64:79], v[44:47], a[152:155], v[64:79]
    ds_read_b64_tr_b16 v[24:25], v1 offset:41472
    ds_read_b64_tr_b16 v[26:27], v1 offset:42112
    v_lshrrev_b32 v16, 5, v0
    v_bfe_u32 v17, v0, 3, 2
    v_mfma_f32_32x32x16_bf16 v[80:95], v[44:47], a[156:159], v[80:95]
    ds_read_b64_tr_b16 v[28:29], v1 offset:41504
    ds_read_b64_tr_b16 v[30:31], v1 offset:42144
    v_xor_b32 v17, v17, v16
    v_lshlrev_b32 v14, 10, v16
    v_mfma_f32_32x32x16_bf16 v[96:111], v[48:51], a[152:155], v[96:111]
    ds_read_b64_tr_b16 v[32:33], v1 offset:41536
    ds_read_b64_tr_b16 v[34:35], v1 offset:42176
    v_lshl_add_u32 v14, v17, 8, v14
    v_and_b32 v17, 7, v0
    v_mfma_f32_32x32x16_bf16 v[112:127], v[48:51], a[156:159], v[112:127]
    ds_read_b64_tr_b16 v[36:37], v1 offset:41568
    ds_read_b64_tr_b16 v[38:39], v1 offset:42208
    v_lshl_add_u32 v14, v17, 4, v14
    v_bfe_u32 v16, v0, 4, 2
    v_mfma_f32_32x32x16_bf16 v[128:143], v[52:55], a[152:155], v[128:143]
    ds_read_b64_tr_b16 v[40:41], v1 offset:41600
    ds_read_b64_tr_b16 v[42:43], v1 offset:42240
    v_and_b32 v17, 3, v0
    v_xor_b32 v16, v16, v17
    v_mfma_f32_32x32x16_bf16 v[144:159], v[52:55], a[156:159], v[144:159]
    v_lshrrev_b32 v15, 2, v0
    v_lshlrev_b32 v15, 6, v15
    v_lshl_add_u32 v15, v16, 4, v15
    v_mfma_f32_32x32x16_bf16 v[160:175], v[56:59], a[152:155], v[160:175]
    s_add_u32 s74, s74, 294912
    s_cmp_ge_u32 s74, 5308416
    s_cselect_b32 s74, 0, s74
    s_add_u32 m0, s56, 31104
    s_nop 0
    buffer_load_dwordx4 v6, s[12:15], s74 offen lds
    v_mfma_f32_32x32x16_bf16 v[176:191], v[56:59], a[156:159], v[176:191]
    s_add_u32 m0, s56, 31104
    s_nop 0
    buffer_load_dword v7, s[12:15], s74 offen offset:1024 lds
    v_mfma_f32_32x32x16_bf16 v[192:207], v[60:63], a[152:155], v[192:207]
    s_add_u32 m0, s56, 36352
    s_nop 0
    buffer_load_dwordx4 v6, s[20:23], s74 offen lds
    v_mfma_f32_32x32x16_bf16 v[208:223], v[60:63], a[156:159], v[208:223]
    s_add_u32 m0, s56, 36352
    s_nop 0
    buffer_load_dword v7, s[20:23], s74 offen offset:1024 lds
    s_waitcnt lgkmcnt(0)
    v_mfma_f32_32x32x16_bf16 v[64:79], v[24:27], a[160:163], v[64:79]
    ds_read_b64_tr_b16 v[44:45], v1 offset:44032
    ds_read_b64_tr_b16 v[46:47], v1 offset:44672
    v_mfma_f32_32x32x16_bf16 v[80:95], v[24:27], a[164:167], v[80:95]
    ds_read_b64_tr_b16 v[48:49], v1 offset:44064
    ds_read_b64_tr_b16 v[50:51], v1 offset:44704
    v_mfma_f32_32x32x16_bf16 v[96:111], v[28:31], a[160:163], v[96:111]
    ds_read_b64_tr_b16 v[52:53], v1 offset:44096
    ds_read_b64_tr_b16 v[54:55], v1 offset:44736
    v_mfma_f32_32x32x16_bf16 v[112:127], v[28:31], a[164:167], v[112:127]
    ds_read_b64_tr_b16 v[56:57], v1 offset:44128
    ds_read_b64_tr_b16 v[58:59], v1 offset:44768
    v_mfma_f32_32x32x16_bf16 v[128:143], v[32:35], a[160:163], v[128:143]
    ds_read_b64_tr_b16 v[60:61], v1 offset:44160
    ds_read_b64_tr_b16 v[62:63], v1 offset:44800
    v_mfma_f32_32x32x16_bf16 v[144:159], v[32:35], a[164:167], v[144:159]
    v_mfma_f32_32x32x16_bf16 v[160:175], v[36:39], a[160:163], v[160:175]
    buffer_load_dword v13, v9, s[32:35], 0 offen sc0 sc1
    v_mfma_f32_32x32x16_bf16 v[176:191], v[36:39], a[164:167], v[176:191]
    v_mfma_f32_32x32x16_bf16 v[192:207], v[40:43], a[160:163], v[192:207]
    v_mfma_f32_32x32x16_bf16 v[208:223], v[40:43], a[164:167], v[208:223]
    s_waitcnt vmcnt(18) lgkmcnt(0)
    s_barrier
    v_mfma_f32_32x32x16_bf16 v[64:79], v[44:47], a[168:171], v[64:79]
    ds_read_b64_tr_b16 v[24:25], v1 offset:51840
    ds_read_b64_tr_b16 v[26:27], v1 offset:52480
    v_mfma_f32_32x32x16_bf16 v[80:95], v[44:47], a[172:175], v[80:95]
    ds_read_b64_tr_b16 v[28:29], v1 offset:51872
    ds_read_b64_tr_b16 v[30:31], v1 offset:52512
    v_mfma_f32_32x32x16_bf16 v[96:111], v[48:51], a[168:171], v[96:111]
    ds_read_b64_tr_b16 v[32:33], v1 offset:51904
    ds_read_b64_tr_b16 v[34:35], v1 offset:52544
    v_mfma_f32_32x32x16_bf16 v[112:127], v[48:51], a[172:175], v[112:127]
    ds_read_b64_tr_b16 v[36:37], v1 offset:51936
    ds_read_b64_tr_b16 v[38:39], v1 offset:52576
    v_mfma_f32_32x32x16_bf16 v[128:143], v[52:55], a[168:171], v[128:143]
    ds_read_b64_tr_b16 v[40:41], v1 offset:51968
    ds_read_b64_tr_b16 v[42:43], v1 offset:52608
    v_mfma_f32_32x32x16_bf16 v[144:159], v[52:55], a[172:175], v[144:159]
    v_mfma_f32_32x32x16_bf16 v[160:175], v[56:59], a[168:171], v[160:175]
    s_add_u32 s74, s74, 294912
    s_cmp_ge_u32 s74, 5308416
    s_cselect_b32 s74, 0, s74
    s_add_u32 m0, s56, 41472
    s_nop 0
    buffer_load_dwordx4 v6, s[12:15], s74 offen lds
    v_mfma_f32_32x32x16_bf16 v[176:191], v[56:59], a[172:175], v[176:191]
    s_add_u32 m0, s56, 41472
    s_nop 0
    buffer_load_dword v7, s[12:15], s74 offen offset:1024 lds
    v_mfma_f32_32x32x16_bf16 v[192:207], v[60:63], a[168:171], v[192:207]
    s_add_u32 m0, s56, 46720
    s_nop 0
    buffer_load_dwordx4 v6, s[20:23], s74 offen lds
    v_mfma_f32_32x32x16_bf16 v[208:223], v[60:63], a[172:175], v[208:223]
    s_add_u32 m0, s56, 46720
    s_nop 0
    buffer_load_dword v7, s[20:23], s74 offen offset:1024 lds
    s_waitcnt lgkmcnt(0)
    v_mfma_f32_32x32x16_bf16 v[64:79], v[24:27], a[176:179], v[64:79]
    ds_read_b64_tr_b16 v[44:45], v1 offset:54400
    ds_read_b64_tr_b16 v[46:47], v1 offset:55040
    v_mfma_f32_32x32x16_bf16 v[80:95], v[24:27], a[180:183], v[80:95]
    ds_read_b64_tr_b16 v[48:49], v1 offset:54432
    ds_read_b64_tr_b16 v[50:51], v1 offset:55072
    v_mfma_f32_32x32x16_bf16 v[96:111], v[28:31], a[176:179], v[96:111]
    ds_read_b64_tr_b16 v[52:53], v1 offset:54464
    ds_read_b64_tr_b16 v[54:55], v1 offset:55104
    v_mfma_f32_32x32x16_bf16 v[112:127], v[28:31], a[180:183], v[112:127]
    ds_read_b64_tr_b16 v[56:57], v1 offset:54496
    ds_read_b64_tr_b16 v[58:59], v1 offset:55136
    v_mfma_f32_32x32x16_bf16 v[128:143], v[32:35], a[176:179], v[128:143]
    ds_read_b64_tr_b16 v[60:61], v1 offset:54528
    ds_read_b64_tr_b16 v[62:63], v1 offset:55168
    v_mfma_f32_32x32x16_bf16 v[144:159], v[32:35], a[180:183], v[144:159]
    v_mfma_f32_32x32x16_bf16 v[160:175], v[36:39], a[176:179], v[160:175]
    v_mfma_f32_32x32x16_bf16 v[176:191], v[36:39], a[180:183], v[176:191]
    v_mfma_f32_32x32x16_bf16 v[192:207], v[40:43], a[176:179], v[192:207]
    v_mfma_f32_32x32x16_bf16 v[208:223], v[40:43], a[180:183], v[208:223]
    s_waitcnt vmcnt(17) lgkmcnt(0)
    s_barrier
    v_mfma_f32_32x32x16_bf16 v[64:79], v[44:47], a[184:187], v[64:79]
    ds_read_b64_tr_b16 v[24:25], v1 offset:0
    ds_read_b64_tr_b16 v[26:27], v1 offset:640
    v_mfma_f32_32x32x16_bf16 v[80:95], v[44:47], a[188:191], v[80:95]
    ds_read_b64_tr_b16 v[28:29], v1 offset:32
    ds_read_b64_tr_b16 v[30:31], v1 offset:672
    v_mfma_f32_32x32x16_bf16 v[96:111], v[48:51], a[184:187], v[96:111]
    ds_read_b64_tr_b16 v[32:33], v1 offset:64
    ds_read_b64_tr_b16 v[34:35], v1 offset:704
    v_mfma_f32_32x32x16_bf16 v[112:127], v[48:51], a[188:191], v[112:127]
    ds_read_b64_tr_b16 v[36:37], v1 offset:96
    ds_read_b64_tr_b16 v[38:39], v1 offset:736
    v_mfma_f32_32x32x16_bf16 v[128:143], v[52:55], a[184:187], v[128:143]
    ds_read_b64_tr_b16 v[40:41], v1 offset:128
    ds_read_b64_tr_b16 v[42:43], v1 offset:768
    v_mfma_f32_32x32x16_bf16 v[144:159], v[52:55], a[188:191], v[144:159]
    v_mfma_f32_32x32x16_bf16 v[160:175], v[56:59], a[184:187], v[160:175]
    s_add_u32 s74, s74, 294912
    s_cmp_ge_u32 s74, 5308416
    s_cselect_b32 s74, 0, s74
    s_add_u32 m0, s56, 51840
    s_nop 0
    buffer_load_dwordx4 v6, s[12:15], s74 offen lds
    v_mfma_f32_32x32x16_bf16 v[176:191], v[56:59], a[188:191], v[176:191]
    s_add_u32 m0, s56, 51840
    s_nop 0
    buffer_load_dword v7, s[12:15], s74 offen offset:1024 lds
    v_mfma_f32_32x32x16_bf16 v[192:207], v[60:63], a[184:187], v[192:207]
    s_add_u32 m0, s56, 57088
    s_nop 0
    buffer_load_dwordx4 v6, s[20:23], s74 offen lds
    v_mfma_f32_32x32x16_bf16 v[208:223], v[60:63], a[188:191], v[208:223]
    s_add_u32 m0, s56, 57088
    s_nop 0
    buffer_load_dword v7, s[20:23], s74 offen offset:1024 lds
    s_waitcnt vmcnt(8)
    s_mov_b32 s62, 0
L_pw9:
    v_cmp_le_u32 vcc, 64, v13
    s_nop 0
    s_and_b32 s3, vcc_lo, 15
    s_cmp_eq_u32 s3, 15
    s_cbranch_scc1 L_pok9
    s_add_u32 s62, s62, 1
    s_cmp_ge_u32 s62, 100000
    s_cbranch_scc1 L_pok9
    s_sleep 4
    buffer_load_dword v13, v9, s[32:35], 0 offen sc0 sc1
    s_waitcnt vmcnt(0)
    s_branch L_pw9
L_pok9:
    s_waitcnt lgkmcnt(0)
    v_mfma_f32_32x32x16_bf16 v[64:79], v[24:27], a[192:195], v[64:79]
    ds_read_b64_tr_b16 v[44:45], v1 offset:2560
    ds_read_b64_tr_b16 v[46:47], v1 offset:3200
    v_mfma_f32_32x32x16_bf16 v[80:95], v[24:27], a[196:199], v[80:95]
    ds_read_b64_tr_b16 v[48:49], v1 offset:2592
    ds_read_b64_tr_b16 v[50:51], v1 offset:3232
    v_mfma_f32_32x32x16_bf16 v[96:111], v[28:31], a[192:195], v[96:111]
    ds_read_b64_tr_b16 v[52:53], v1 offset:2624
    ds_read_b64_tr_b16 v[54:55], v1 offset:3264
    v_mfma_f32_32x32x16_bf16 v[112:127], v[28:31], a[196:199], v[112:127]
    ds_read_b64_tr_b16 v[56:57], v1 offset:2656
    ds_read_b64_tr_b16 v[58:59], v1 offset:3296
    v_mfma_f32_32x32x16_bf16 v[128:143], v[32:35], a[192:195], v[128:143]
    ds_read_b64_tr_b16 v[60:61], v1 offset:2688
    ds_read_b64_tr_b16 v[62:63], v1 offset:3328
    v_mfma_f32_32x32x16_bf16 v[144:159], v[32:35], a[196:199], v[144:159]
    v_mfma_f32_32x32x16_bf16 v[160:175], v[36:39], a[192:195], v[160:175]
    buffer_load_dword v12, v8, s[16:19], s75 offen sc0 sc1
    v_mfma_f32_32x32x16_bf16 v[176:191], v[36:39], a[196:199], v[176:191]
    v_mfma_f32_32x32x16_bf16 v[192:207], v[40:43], a[192:195], v[192:207]
    v_mfma_f32_32x32x16_bf16 v[208:223], v[40:43], a[196:199], v[208:223]
    s_waitcnt lgkmcnt(0)
    s_barrier
    v_mfma_f32_32x32x16_bf16 v[64:79], v[44:47], a[200:203], v[64:79]
    ds_read_b64_tr_b16 v[24:25], v1 offset:10368
    ds_read_b64_tr_b16 v[26:27], v1 offset:11008
    v_mfma_f32_32x32x16_bf16 v[80:95], v[44:47], a[204:207], v[80:95]
    ds_read_b64_tr_b16 v[28:29], v1 offset:10400
    ds_read_b64_tr_b16 v[30:31], v1 offset:11040
    v_mfma_f32_32x32x16_bf16 v[96:111], v[48:51], a[200:203], v[96:111]
    ds_read_b64_tr_b16 v[32:33], v1 offset:10432
    ds_read_b64_tr_b16 v[34:35], v1 offset:11072
    v_mfma_f32_32x32x16_bf16 v[112:127], v[48:51], a[204:207], v[112:127]
    ds_read_b64_tr_b16 v[36:37], v1 offset:10464
    ds_read_b64_tr_b16 v[38:39], v1 offset:11104
    v_mfma_f32_32x32x16_bf16 v[128:143], v[52:55], a[200:203], v[128:143]
    ds_read_b64_tr_b16 v[40:41], v1 offset:10496
    ds_read_b64_tr_b16 v[42:43], v1 offset:11136
    v_mfma_f32_32x32x16_bf16 v[144:159], v[52:55], a[204:207], v[144:159]
    v_mfma_f32_32x32x16_bf16 v[160:175], v[56:59], a[200:203], v[160:175]
    v_mfma_f32_32x32x16_bf16 v[176:191], v[56:59], a[204:207], v[176:191]
    v_mfma_f32_32x32x16_bf16 v[192:207], v[60:63], a[200:203], v[192:207]
    v_mfma_f32_32x32x16_bf16 v[208:223], v[60:63], a[204:207], v[208:223]
    s_waitcnt lgkmcnt(0)
    v_mfma_f32_32x32x16_bf16 v[64:79], v[24:27], a[208:211], v[64:79]
    ds_read_b64_tr_b16 v[44:45], v1 offset:12928
    ds_read_b64_tr_b16 v[46:47], v1 offset:13568
    v_mfma_f32_32x32x16_bf16 v[80:95], v[24:27], a[212:215], v[80:95]
    ds_read_b64_tr_b16 v[48:49], v1 offset:12960
    ds_read_b64_tr_b16 v[50:51], v1 offset:13600
    v_mfma_f32_32x32x16_bf16 v[96:111], v[28:31], a[208:211], v[96:111]
    ds_read_b64_tr_b16 v[52:53], v1 offset:12992
    ds_read_b64_tr_b16 v[54:55], v1 offset:13632
    v_mfma_f32_32x32x16_bf16 v[112:127], v[28:31], a[212:215], v[112:127]
    ds_read_b64_tr_b16 v[56:57], v1 offset:13024
    ds_read_b64_tr_b16 v[58:59], v1 offset:13664
    v_mfma_f32_32x32x16_bf16 v[128:143], v[32:35], a[208:211], v[128:143]
    ds_read_b64_tr_b16 v[60:61], v1 offset:13056
    ds_read_b64_tr_b16 v[62:63], v1 offset:13696
    v_mfma_f32_32x32x16_bf16 v[144:159], v[32:35], a[212:215], v[144:159]
    v_mfma_f32_32x32x16_bf16 v[160:175], v[36:39], a[208:211], v[160:175]
    v_mfma_f32_32x32x16_bf16 v[176:191], v[36:39], a[212:215], v[176:191]
    v_mfma_f32_32x32x16_bf16 v[192:207], v[40:43], a[208:211], v[192:207]
    v_mfma_f32_32x32x16_bf16 v[208:223], v[40:43], a[212:215], v[208:223]
    s_waitcnt vmcnt(0)
    s_mov_b32 s62, 0
L_pw10:
    v_cmp_le_u32 vcc, 1, v12
    s_nop 0
    s_cmp_eq_u64 vcc, -1
    s_cbranch_scc1 L_pok10
    s_add_u32 s62, s62, 1
    s_cmp_ge_u32 s62, 100000
    s_cbranch_scc1 L_pok10
    s_sleep 4
    buffer_load_dword v12, v8, s[16:19], s75 offen sc0 sc1
    s_waitcnt vmcnt(0)
    s_branch L_pw10
L_pok10:
    s_waitcnt lgkmcnt(0)
    s_barrier
    v_mfma_f32_32x32x16_bf16 v[64:79], v[44:47], a[216:219], v[64:79]
    ds_read_b64_tr_b16 v[24:25], v1 offset:20736
    ds_read_b64_tr_b16 v[26:27], v1 offset:21376
    v_mfma_f32_32x32x16_bf16 v[80:95], v[44:47], a[220:223], v[80:95]
    ds_read_b64_tr_b16 v[28:29], v1 offset:20768
    ds_read_b64_tr_b16 v[30:31], v1 offset:21408
    v_mfma_f32_32x32x16_bf16 v[96:111], v[48:51], a[216:219], v[96:111]
    ds_read_b64_tr_b16 v[32:33], v1 offset:20800
    ds_read_b64_tr_b16 v[34:35], v1 offset:21440
    v_mfma_f32_32x32x16_bf16 v[112:127], v[48:51], a[220:223], v[112:127]
    ds_read_b64_tr_b16 v[36:37], v1 offset:20832
    ds_read_b64_tr_b16 v[38:39], v1 offset:21472
    v_mfma_f32_32x32x16_bf16 v[128:143], v[52:55], a[216:219], v[128:143]
    ds_read_b64_tr_b16 v[40:41], v1 offset:20864
    ds_read_b64_tr_b16 v[42:43], v1 offset:21504
    v_mfma_f32_32x32x16_bf16 v[144:159], v[52:55], a[220:223], v[144:159]
    v_mfma_f32_32x32x16_bf16 v[160:175], v[56:59], a[216:219], v[160:175]
    s_add_u32 m0, s71, 0
    s_add_u32 s58, s46, 0
    buffer_load_dwordx4 v14, s[16:19], s58 offen sc1 lds
    v_mfma_f32_32x32x16_bf16 v[176:191], v[56:59], a[220:223], v[176:191]
    s_add_u32 m0, s71, 1040
    s_add_u32 s58, s46, 2048
    buffer_load_dwordx4 v14, s[16:19], s58 offen sc1 lds
    v_mfma_f32_32x32x16_bf16 v[192:207], v[60:63], a[216:219], v[192:207]
    s_add_u32 m0, s71, 2080
    s_add_u32 s58, s46, 4096
    buffer_load_dwordx4 v14, s[16:19], s58 offen sc1 lds
    v_mfma_f32_32x32x16_bf16 v[208:223], v[60:63], a[220:223], v[208:223]
    s_waitcnt lgkmcnt(0)
    v_mfma_f32_32x32x16_bf16 v[64:79], v[24:27], a[224:227], v[64:79]
    ds_read_b64_tr_b16 v[44:45], v1 offset:23296
    ds_read_b64_tr_b16 v[46:47], v1 offset:23936
    v_mfma_f32_32x32x16_bf16 v[80:95], v[24:27], a[228:231], v[80:95]
    ds_read_b64_tr_b16 v[48:49], v1 offset:23328
    ds_read_b64_tr_b16 v[50:51], v1 offset:23968
    v_mfma_f32_32x32x16_bf16 v[96:111], v[28:31], a[224:227], v[96:111]
    ds_read_b64_tr_b16 v[52:53], v1 offset:23360
    ds_read_b64_tr_b16 v[54:55], v1 offset:24000
    v_mfma_f32_32x32x16_bf16 v[112:127], v[28:31], a[228:231], v[112:127]
    ds_read_b64_tr_b16 v[56:57], v1 offset:23392
    ds_read_b64_tr_b16 v[58:59], v1 offset:24032
    v_mfma_f32_32x32x16_bf16 v[128:143], v[32:35], a[224:227], v[128:143]
    ds_read_b64_tr_b16 v[60:61], v1 offset:23424
    ds_read_b64_tr_b16 v[62:63], v1 offset:24064
    v_mfma_f32_32x32x16_bf16 v[144:159], v[32:35], a[228:231], v[144:159]
    v_mfma_f32_32x32x16_bf16 v[160:175], v[36:39], a[224:227], v[160:175]
    s_add_u32 m0, s71, 3120
    s_add_u32 s58, s46, 6144
    buffer_load_dwordx4 v14, s[16:19], s58 offen sc1 lds
    v_mfma_f32_32x32x16_bf16 v[176:191], v[36:39], a[228:231], v[176:191]
    s_add_u32 m0, s71, 16640
    s_add_u32 s58, s46, 1179648
    buffer_load_dwordx4 v14, s[16:19], s58 offen sc1 lds
    v_mfma_f32_32x32x16_bf16 v[192:207], v[40:43], a[224:227], v[192:207]
    s_add_u32 m0, s71, 17680
    s_add_u32 s58, s46, 1181696
    buffer_load_dwordx4 v14, s[16:19], s58 offen sc1 lds
    v_mfma_f32_32x32x16_bf16 v[208:223], v[40:43], a[228:231], v[208:223]
    s_waitcnt lgkmcnt(0)
    s_barrier
    v_mfma_f32_32x32x16_bf16 v[64:79], v[44:47], a[232:235], v[64:79]
    ds_read_b64_tr_b16 v[24:25], v1 offset:31104
    ds_read_b64_tr_b16 v[26:27], v1 offset:31744
    v_mfma_f32_32x32x16_bf16 v[80:95], v[44:47], a[236:239], v[80:95]
    ds_read_b64_tr_b16 v[28:29], v1 offset:31136
    ds_read_b64_tr_b16 v[30:31], v1 offset:31776
    v_mfma_f32_32x32x16_bf16 v[96:111], v[48:51], a[232:235], v[96:111]
    ds_read_b64_tr_b16 v[32:33], v1 offset:31168
    ds_read_b64_tr_b16 v[34:35], v1 offset:31808
    v_mfma_f32_32x32x16_bf16 v[112:127], v[48:51], a[236:239], v[112:127]
    ds_read_b64_tr_b16 v[36:37], v1 offset:31200
    ds_read_b64_tr_b16 v[38:39], v1 offset:31840
    v_mfma_f32_32x32x16_bf16 v[128:143], v[52:55], a[232:235], v[128:143]
    ds_read_b64_tr_b16 v[40:41], v1 offset:31232
    ds_read_b64_tr_b16 v[42:43], v1 offset:31872
    v_mfma_f32_32x32x16_bf16 v[144:159], v[52:55], a[236:239], v[144:159]
    v_mfma_f32_32x32x16_bf16 v[160:175], v[56:59], a[232:235], v[160:175]
    s_add_u32 m0, s71, 18720
    s_add_u32 s58, s46, 1183744
    buffer_load_dwordx4 v14, s[16:19], s58 offen sc1 lds
    v_mfma_f32_32x32x16_bf16 v[176:191], v[56:59], a[236:239], v[176:191]
    s_add_u32 m0, s71, 19760
    s_add_u32 s58, s46, 1185792
    buffer_load_dwordx4 v14, s[16:19], s58 offen sc1 lds
    v_mfma_f32_32x32x16_bf16 v[192:207], v[60:63], a[232:235], v[192:207]
    s_add_u32 m0, s73, 0
    s_add_u32 s58, s64, 0
    buffer_load_dwordx4 v15, s[16:19], s58 offen sc1 lds
    v_mfma_f32_32x32x16_bf16 v[208:223], v[60:63], a[236:239], v[208:223]
    s_waitcnt lgkmcnt(0)
    v_mfma_f32_32x32x16_bf16 v[64:79], v[24:27], a[240:243], v[64:79]
    ds_read_b64_tr_b16 v[44:45], v1 offset:33664
    ds_read_b64_tr_b16 v[46:47], v1 offset:34304
    v_mfma_f32_32x32x16_bf16 v[80:95], v[24:27], a[244:247], v[80:95]
    ds_read_b64_tr_b16 v[48:49], v1 offset:33696
    ds_read_b64_tr_b16 v[50:51], v1 offset:34336
    v_mfma_f32_32x32x16_bf16 v[96:111], v[28:31], a[240:243], v[96:111]
    ds_read_b64_tr_b16 v[52:53], v1 offset:33728
    ds_read_b64_tr_b16 v[54:55], v1 offset:34368
    v_mfma_f32_32x32x16_bf16 v[112:127], v[28:31], a[244:247], v[112:127]
    ds_read_b64_tr_b16 v[56:57], v1 offset:33760
    ds_read_b64_tr_b16 v[58:59], v1 offset:34400
    v_mfma_f32_32x32x16_bf16 v[128:143], v[32:35], a[240:243], v[128:143]
    ds_read_b64_tr_b16 v[60:61], v1 offset:33792
    ds_read_b64_tr_b16 v[62:63], v1 offset:34432
    v_mfma_f32_32x32x16_bf16 v[144:159], v[32:35], a[244:247], v[144:159]
    v_mfma_f32_32x32x16_bf16 v[160:175], v[36:39], a[240:243], v[160:175]
    s_add_u32 m0, s73, 1024
    s_add_u32 s58, s64, 1024
    buffer_load_dwordx4 v15, s[16:19], s58 offen sc1 lds
    v_mfma_f32_32x32x16_bf16 v[176:191], v[36:39], a[244:247], v[176:191]
    s_add_u32 m0, s73, 2048
    s_add_u32 s58, s64, 2048
    buffer_load_dwordx4 v15, s[16:19], s58 offen sc1 lds
    v_mfma_f32_32x32x16_bf16 v[192:207], v[40:43], a[240:243], v[192:207]
    s_add_u32 m0, s73, 3072
    s_add_u32 s58, s64, 3072
    buffer_load_dwordx4 v15, s[16:19], s58 offen sc1 lds
    v_mfma_f32_32x32x16_bf16 v[208:223], v[40:43], a[244:247], v[208:223]
    s_waitcnt lgkmcnt(0)
    s_barrier
    v_mfma_f32_32x32x16_bf16 v[64:79], v[44:47], a[248:251], v[64:79]
    ds_read_b64_tr_b16 v[24:25], v1 offset:41472
    ds_read_b64_tr_b16 v[26:27], v1 offset:42112
    v_mfma_f32_32x32x16_bf16 v[80:95], v[44:47], a[252:255], v[80:95]
    ds_read_b64_tr_b16 v[28:29], v1 offset:41504
    ds_read_b64_tr_b16 v[30:31], v1 offset:42144
    v_mfma_f32_32x32x16_bf16 v[96:111], v[48:51], a[248:251], v[96:111]
    ds_read_b64_tr_b16 v[32:33], v1 offset:41536
    ds_read_b64_tr_b16 v[34:35], v1 offset:42176
    v_mfma_f32_32x32x16_bf16 v[112:127], v[48:51], a[252:255], v[112:127]
    ds_read_b64_tr_b16 v[36:37], v1 offset:41568
    ds_read_b64_tr_b16 v[38:39], v1 offset:42208
    v_mfma_f32_32x32x16_bf16 v[128:143], v[52:55], a[248:251], v[128:143]
    ds_read_b64_tr_b16 v[40:41], v1 offset:41600
    ds_read_b64_tr_b16 v[42:43], v1 offset:42240
    v_mfma_f32_32x32x16_bf16 v[144:159], v[52:55], a[252:255], v[144:159]
    v_mfma_f32_32x32x16_bf16 v[160:175], v[56:59], a[248:251], v[160:175]
    s_add_u32 m0, s73, 4096
    s_add_u32 s58, s64, 4096
    buffer_load_dwordx4 v15, s[16:19], s58 offen sc1 lds
    v_mfma_f32_32x32x16_bf16 v[176:191], v[56:59], a[252:255], v[176:191]
    s_add_u32 m0, s73, 5120
    s_add_u32 s58, s64, 5120
    buffer_load_dwordx4 v15, s[16:19], s58 offen sc1 lds
    v_mfma_f32_32x32x16_bf16 v[192:207], v[60:63], a[248:251], v[192:207]
    s_add_u32 m0, s73, 6144
    s_add_u32 s58, s64, 6144
    buffer_load_dwordx4 v15, s[16:19], s58 offen sc1 lds
    v_mfma_f32_32x32x16_bf16 v[208:223], v[60:63], a[252:255], v[208:223]
    s_waitcnt lgkmcnt(0)
    v_mfma_f32_32x32x16_bf16 v[64:79], v[24:27], v[224:227], v[64:79]
    ds_read_b64_tr_b16 v[44:45], v1 offset:44032
    ds_read_b64_tr_b16 v[46:47], v1 offset:44672
    v_mfma_f32_32x32x16_bf16 v[80:95], v[24:27], v[228:231], v[80:95]
    ds_read_b64_tr_b16 v[48:49], v1 offset:44064
    ds_read_b64_tr_b16 v[50:51], v1 offset:44704
    v_mfma_f32_32x32x16_bf16 v[96:111], v[28:31], v[224:227], v[96:111]
    ds_read_b64_tr_b16 v[52:53], v1 offset:44096
    ds_read_b64_tr_b16 v[54:55], v1 offset:44736
    v_mfma_f32_32x32x16_bf16 v[112:127], v[28:31], v[228:231], v[112:127]
    ds_read_b64_tr_b16 v[56:57], v1 offset:44128
    ds_read_b64_tr_b16 v[58:59], v1 offset:44768
    v_mfma_f32_32x32x16_bf16 v[128:143], v[32:35], v[224:227], v[128:143]
    ds_read_b64_tr_b16 v[60:61], v1 offset:44160
    ds_read_b64_tr_b16 v[62:63], v1 offset:44800
    v_mfma_f32_32x32x16_bf16 v[144:159], v[32:35], v[228:231], v[144:159]
    v_mfma_f32_32x32x16_bf16 v[160:175], v[36:39], v[224:227], v[160:175]
    s_add_u32 m0, s73, 7168
    s_add_u32 s58, s64, 7168
    buffer_load_dwordx4 v15, s[16:19], s58 offen sc1 lds
    v_mfma_f32_32x32x16_bf16 v[176:191], v[36:39], v[228:231], v[176:191]
    v_mfma_f32_32x32x16_bf16 v[192:207], v[40:43], v[224:227], v[192:207]
    v_mfma_f32_32x32x16_bf16 v[208:223], v[40:43], v[228:231], v[208:223]
    s_waitcnt lgkmcnt(0)
    s_barrier
    v_mfma_f32_32x32x16_bf16 v[64:79], v[44:47], v[232:235], v[64:79]
    ds_read_b64_tr_b16 v[24:25], v1 offset:51840
    ds_read_b64_tr_b16 v[26:27], v1 offset:52480
    v_mfma_f32_32x32x16_bf16 v[80:95], v[44:47], v[236:239], v[80:95]
    ds_read_b64_tr_b16 v[28:29], v1 offset:51872
    ds_read_b64_tr_b16 v[30:31], v1 offset:52512
    v_mfma_f32_32x32x16_bf16 v[96:111], v[48:51], v[232:235], v[96:111]
    ds_read_b64_tr_b16 v[32:33], v1 offset:51904
    ds_read_b64_tr_b16 v[34:35], v1 offset:52544
    v_mfma_f32_32x32x16_bf16 v[112:127], v[48:51], v[236:239], v[112:127]
    ds_read_b64_tr_b16 v[36:37], v1 offset:51936
    ds_read_b64_tr_b16 v[38:39], v1 offset:52576
    v_mfma_f32_32x32x16_bf16 v[128:143], v[52:55], v[232:235], v[128:143]
    ds_read_b64_tr_b16 v[40:41], v1 offset:51968
    ds_read_b64_tr_b16 v[42:43], v1 offset:52608
    v_mfma_f32_32x32x16_bf16 v[144:159], v[52:55], v[236:239], v[144:159]
    v_mfma_f32_32x32x16_bf16 v[160:175], v[56:59], v[232:235], v[160:175]
    v_mfma_f32_32x32x16_bf16 v[176:191], v[56:59], v[236:239], v[176:191]
    v_mfma_f32_32x32x16_bf16 v[192:207], v[60:63], v[232:235], v[192:207]
    v_mfma_f32_32x32x16_bf16 v[208:223], v[60:63], v[236:239], v[208:223]
    s_waitcnt lgkmcnt(0)
    v_mfma_f32_32x32x16_bf16 v[64:79], v[24:27], v[240:243], v[64:79]
    ds_read_b64_tr_b16 v[44:45], v1 offset:54400
    ds_read_b64_tr_b16 v[46:47], v1 offset:55040
    v_mfma_f32_32x32x16_bf16 v[80:95], v[24:27], v[244:247], v[80:95]
    ds_read_b64_tr_b16 v[48:49], v1 offset:54432
    ds_read_b64_tr_b16 v[50:51], v1 offset:55072
    v_mfma_f32_32x32x16_bf16 v[96:111], v[28:31], v[240:243], v[96:111]
    ds_read_b64_tr_b16 v[52:53], v1 offset:54464
    ds_read_b64_tr_b16 v[54:55], v1 offset:55104
    v_mfma_f32_32x32x16_bf16 v[112:127], v[28:31], v[244:247], v[112:127]
    ds_read_b64_tr_b16 v[56:57], v1 offset:54496
    ds_read_b64_tr_b16 v[58:59], v1 offset:55136
    v_mfma_f32_32x32x16_bf16 v[128:143], v[32:35], v[240:243], v[128:143]
    ds_read_b64_tr_b16 v[60:61], v1 offset:54528
    ds_read_b64_tr_b16 v[62:63], v1 offset:55168
    v_mfma_f32_32x32x16_bf16 v[144:159], v[32:35], v[244:247], v[144:159]
    v_mfma_f32_32x32x16_bf16 v[160:175], v[36:39], v[240:243], v[160:175]
    v_mfma_f32_32x32x16_bf16 v[176:191], v[36:39], v[244:247], v[176:191]
    v_mfma_f32_32x32x16_bf16 v[192:207], v[40:43], v[240:243], v[192:207]
    v_mfma_f32_32x32x16_bf16 v[208:223], v[40:43], v[244:247], v[208:223]
    s_waitcnt lgkmcnt(0)
    v_mfma_f32_32x32x16_bf16 v[64:79], v[44:47], v[248:251], v[64:79]
    v_mfma_f32_32x32x16_bf16 v[80:95], v[44:47], v[252:255], v[80:95]
    v_mfma_f32_32x32x16_bf16 v[96:111], v[48:51], v[248:251], v[96:111]
    v_mfma_f32_32x32x16_bf16 v[112:127], v[48:51], v[252:255], v[112:127]
    v_mfma_f32_32x32x16_bf16 v[128:143], v[52:55], v[248:251], v[128:143]
    v_mfma_f32_32x32x16_bf16 v[144:159], v[52:55], v[252:255], v[144:159]
    v_mfma_f32_32x32x16_bf16 v[160:175], v[56:59], v[248:251], v[160:175]
    v_mfma_f32_32x32x16_bf16 v[176:191], v[56:59], v[252:255], v[176:191]
    v_mfma_f32_32x32x16_bf16 v[192:207], v[60:63], v[248:251], v[192:207]
    v_mfma_f32_32x32x16_bf16 v[208:223], v[60:63], v[252:255], v[208:223]
    s_lshr_b32 s3, s43, 3
    s_add_u32 s3, s3, 32
    s_and_b32 s4, s43, 7
    s_lshl_b32 s76, s3, 15
    s_lshl_b32 s5, s4, 5
    s_add_u32 s76, s76, s5
    s_add_u32 s76, s76, 21495808
    s_add_u32 s77, s76, 1179648
    s_lshl_b32 s78, s3, 16
    s_lshr_b32 s5, s4, 2
    s_lshl_b32 s5, s5, 15
    s_add_u32 s78, s78, s5
    s_and_b32 s5, s4, 3
    s_lshl_b32 s5, s5, 4
    s_add_u32 s78, s78, s5
    s_add_u32 s78, s78, 23855104
    s_lshl_b32 s79, s3, 3
    s_add_u32 s79, s79, s4
    s_lshl_b32 s79, s79, 13
    s_add_u32 s79, s79, 18874368
    s_cmp_eq_u32 s43, 32
    s_cselect_b32 s77, 0x80000000, s77
    s_cmp_lt_u32 s43, 33
    s_cselect_b32 s80, 1, 0
    s_cmp_eq_u32 s36, 3
    s_cselect_b32 s80, s80, 0
    s_cmp_eq_u32 s80, 1
    s_cselect_b32 s76, s76, 0x80000000
    s_cselect_b32 s77, s77, 0x80000000
    s_cselect_b32 s78, s78, 0x80000000
    v_and_b32 v2, 31, v0
    v_lshrrev_b32 v4, 5, v0
    v_lshlrev_b32 v6, 10, v2
    v_lshl_add_u32 v6, v4, 4, v6
    v_lshlrev_b32 v7, 6, v0
    s_cmp_gt_u32 s48, 0
    s_cselect_b32 s50, 0, 4
    s_add_u32 s50, s50, s49
    s_lshl_b32 s50, s50, 16
    v_max_f32 v64, 0, v64
    v_max_f32 v65, 0, v65
    v_max_f32 v66, 0, v66
    v_max_f32 v67, 0, v67
    v_max_f32 v68, 0, v68
    v_max_f32 v69, 0, v69
    v_max_f32 v70, 0, v70
    v_max_f32 v71, 0, v71
    v_mul_f32 v64, v64, v72
    v_mul_f32 v65, v65, v73
    v_mul_f32 v66, v66, v74
    v_mul_f32 v67, v67, v75
    v_mul_f32 v68, v68, v76
    v_mul_f32 v69, v69, v77
    v_mul_f32 v70, v70, v78
    v_mul_f32 v71, v71, v79
    v_cvt_pk_bf16_f32 v72, v64, v65
    v_cvt_pk_bf16_f32 v73, v66, v67
    v_cvt_pk_bf16_f32 v74, v68, v69
    v_cvt_pk_bf16_f32 v75, v70, v71
    buffer_store_dwordx4 v[72:75], v11, s[16:19], s50 offen offset:0 sc0 sc1
    v_max_f32 v80, 0, v80
    v_max_f32 v81, 0, v81
    v_max_f32 v82, 0, v82
    v_max_f32 v83, 0, v83
    v_max_f32 v84, 0, v84
    v_max_f32 v85, 0, v85
    v_max_f32 v86, 0, v86
    v_max_f32 v87, 0, v87
    v_mul_f32 v80, v80, v88
    v_mul_f32 v81, v81, v89
    v_mul_f32 v82, v82, v90
    v_mul_f32 v83, v83, v91
    v_mul_f32 v84, v84, v92
    v_mul_f32 v85, v85, v93
    v_mul_f32 v86, v86, v94
    v_mul_f32 v87, v87, v95
    v_cvt_pk_bf16_f32 v88, v80, v81
    v_cvt_pk_bf16_f32 v89, v82, v83
    v_cvt_pk_bf16_f32 v90, v84, v85
    v_cvt_pk_bf16_f32 v91, v86, v87
    buffer_store_dwordx4 v[88:91], v11, s[16:19], s50 offen offset:1024 sc0 sc1
    s_cmp_gt_u32 s48, 1
    s_cselect_b32 s50, 1, 5
    s_add_u32 s50, s50, s49
    s_lshl_b32 s50, s50, 16
    v_max_f32 v96, 0, v96
    v_max_f32 v97, 0, v97
    v_max_f32 v98, 0, v98
    v_max_f32 v99, 0, v99
    v_max_f32 v100, 0, v100
    v_max_f32 v101, 0, v101
    v_max_f32 v102, 0, v102
    v_max_f32 v103, 0, v103
    v_mul_f32 v96, v96, v104
    v_mul_f32 v97, v97, v105
    v_mul_f32 v98, v98, v106
    v_mul_f32 v99, v99, v107
    v_mul_f32 v100, v100, v108
    v_mul_f32 v101, v101, v109
    v_mul_f32 v102, v102, v110
    v_mul_f32 v103, v103, v111
    v_cvt_pk_bf16_f32 v104, v96, v97
    v_cvt_pk_bf16_f32 v105, v98, v99
    v_cvt_pk_bf16_f32 v106, v100, v101
    v_cvt_pk_bf16_f32 v107, v102, v103
    buffer_store_dwordx4 v[104:107], v11, s[16:19], s50 offen offset:0 sc0 sc1
    v_max_f32 v112, 0, v112
    v_max_f32 v113, 0, v113
    v_max_f32 v114, 0, v114
    v_max_f32 v115, 0, v115
    v_max_f32 v116, 0, v116
    v_max_f32 v117, 0, v117
    v_max_f32 v118, 0, v118
    v_max_f32 v119, 0, v119
    v_mul_f32 v112, v112, v120
    v_mul_f32 v113, v113, v121
    v_mul_f32 v114, v114, v122
    v_mul_f32 v115, v115, v123
    v_mul_f32 v116, v116, v124
    v_mul_f32 v117, v117, v125
    v_mul_f32 v118, v118, v126
    v_mul_f32 v119, v119, v127
    v_cvt_pk_bf16_f32 v120, v112, v113
    v_cvt_pk_bf16_f32 v121, v114, v115
    v_cvt_pk_bf16_f32 v122, v116, v117
    v_cvt_pk_bf16_f32 v123, v118, v119
    buffer_store_dwordx4 v[120:123], v11, s[16:19], s50 offen offset:1024 sc0 sc1
    s_cmp_gt_u32 s48, 2
    s_cselect_b32 s50, 2, 6
    s_add_u32 s50, s50, s49
    s_lshl_b32 s50, s50, 16
    v_max_f32 v128, 0, v128
    v_max_f32 v129, 0, v129
    v_max_f32 v130, 0, v130
    v_max_f32 v131, 0, v131
    v_max_f32 v132, 0, v132
    v_max_f32 v133, 0, v133
    v_max_f32 v134, 0, v134
    v_max_f32 v135, 0, v135
    v_mul_f32 v128, v128, v136
    v_mul_f32 v129, v129, v137
    v_mul_f32 v130, v130, v138
    v_mul_f32 v131, v131, v139
    v_mul_f32 v132, v132, v140
    v_mul_f32 v133, v133, v141
    v_mul_f32 v134, v134, v142
    v_mul_f32 v135, v135, v143
    v_cvt_pk_bf16_f32 v136, v128, v129
    v_cvt_pk_bf16_f32 v137, v130, v131
    v_cvt_pk_bf16_f32 v138, v132, v133
    v_cvt_pk_bf16_f32 v139, v134, v135
    buffer_store_dwordx4 v[136:139], v11, s[16:19], s50 offen offset:0 sc0 sc1
    v_max_f32 v144, 0, v144
    v_max_f32 v145, 0, v145
    v_max_f32 v146, 0, v146
    v_max_f32 v147, 0, v147
    v_max_f32 v148, 0, v148
    v_max_f32 v149, 0, v149
    v_max_f32 v150, 0, v150
    v_max_f32 v151, 0, v151
    v_mul_f32 v144, v144, v152
    v_mul_f32 v145, v145, v153
    v_mul_f32 v146, v146, v154
    v_mul_f32 v147, v147, v155
    v_mul_f32 v148, v148, v156
    v_mul_f32 v149, v149, v157
    v_mul_f32 v150, v150, v158
    v_mul_f32 v151, v151, v159
    v_cvt_pk_bf16_f32 v152, v144, v145
    v_cvt_pk_bf16_f32 v153, v146, v147
    v_cvt_pk_bf16_f32 v154, v148, v149
    v_cvt_pk_bf16_f32 v155, v150, v151
    buffer_store_dwordx4 v[152:155], v11, s[16:19], s50 offen offset:1024 sc0 sc1
    s_cmp_gt_u32 s48, 3
    s_cselect_b32 s50, 3, 7
    s_add_u32 s50, s50, s49
    s_lshl_b32 s50, s50, 16
    v_max_f32 v160, 0, v160
    v_max_f32 v161, 0, v161
    v_max_f32 v162, 0, v162
    v_max_f32 v163, 0, v163
    v_max_f32 v164, 0, v164
    v_max_f32 v165, 0, v165
    v_max_f32 v166, 0, v166
    v_max_f32 v167, 0, v167
    v_mul_f32 v160, v160, v168
    v_mul_f32 v161, v161, v169
    v_mul_f32 v162, v162, v170
    v_mul_f32 v163, v163, v171
    v_mul_f32 v164, v164, v172
    v_mul_f32 v165, v165, v173
    v_mul_f32 v166, v166, v174
    v_mul_f32 v167, v167, v175
    v_cvt_pk_bf16_f32 v168, v160, v161
    v_cvt_pk_bf16_f32 v169, v162, v163
    v_cvt_pk_bf16_f32 v170, v164, v165
    v_cvt_pk_bf16_f32 v171, v166, v167
    buffer_store_dwordx4 v[168:171], v11, s[16:19], s50 offen offset:0 sc0 sc1
    v_max_f32 v176, 0, v176
    v_max_f32 v177, 0, v177
    v_max_f32 v178, 0, v178
    v_max_f32 v179, 0, v179
    v_max_f32 v180, 0, v180
    v_max_f32 v181, 0, v181
    v_max_f32 v182, 0, v182
    v_max_f32 v183, 0, v183
    v_mul_f32 v176, v176, v184
    v_mul_f32 v177, v177, v185
    v_mul_f32 v178, v178, v186
    v_mul_f32 v179, v179, v187
    v_mul_f32 v180, v180, v188
    v_mul_f32 v181, v181, v189
    v_mul_f32 v182, v182, v190
    v_mul_f32 v183, v183, v191
    v_cvt_pk_bf16_f32 v184, v176, v177
    v_cvt_pk_bf16_f32 v185, v178, v179
    v_cvt_pk_bf16_f32 v186, v180, v181
    v_cvt_pk_bf16_f32 v187, v182, v183
    buffer_store_dwordx4 v[184:187], v11, s[16:19], s50 offen offset:1024 sc0 sc1
    s_cmp_gt_u32 s48, 4
    s_cselect_b32 s50, 4, 8
    s_add_u32 s50, s50, s49
    s_lshl_b32 s50, s50, 16
    v_max_f32 v192, 0, v192
    v_max_f32 v193, 0, v193
    v_max_f32 v194, 0, v194
    v_max_f32 v195, 0, v195
    v_max_f32 v196, 0, v196
    v_max_f32 v197, 0, v197
    v_max_f32 v198, 0, v198
    v_max_f32 v199, 0, v199
    v_mul_f32 v192, v192, v200
    v_mul_f32 v193, v193, v201
    v_mul_f32 v194, v194, v202
    v_mul_f32 v195, v195, v203
    v_mul_f32 v196, v196, v204
    v_mul_f32 v197, v197, v205
    v_mul_f32 v198, v198, v206
    v_mul_f32 v199, v199, v207
    v_cvt_pk_bf16_f32 v200, v192, v193
    v_cvt_pk_bf16_f32 v201, v194, v195
    v_cvt_pk_bf16_f32 v202, v196, v197
    v_cvt_pk_bf16_f32 v203, v198, v199
    buffer_store_dwordx4 v[200:203], v11, s[16:19], s50 offen offset:0 sc0 sc1
    v_max_f32 v208, 0, v208
    v_max_f32 v209, 0, v209
    v_max_f32 v210, 0, v210
    v_max_f32 v211, 0, v211
    v_max_f32 v212, 0, v212
    v_max_f32 v213, 0, v213
    v_max_f32 v214, 0, v214
    v_max_f32 v215, 0, v215
    v_mul_f32 v208, v208, v216
    v_mul_f32 v209, v209, v217
    v_mul_f32 v210, v210, v218
    v_mul_f32 v211, v211, v219
    v_mul_f32 v212, v212, v220
    v_mul_f32 v213, v213, v221
    v_mul_f32 v214, v214, v222
    v_mul_f32 v215, v215, v223
    v_cvt_pk_bf16_f32 v216, v208, v209
    v_cvt_pk_bf16_f32 v217, v210, v211
    v_cvt_pk_bf16_f32 v218, v212, v213
    v_cvt_pk_bf16_f32 v219, v214, v215
    buffer_store_dwordx4 v[216:219], v11, s[16:19], s50 offen offset:1024 sc0 sc1
    buffer_load_dwordx4 a[128:131], v6, s[16:19], s76 offen offset:0 sc1
    buffer_load_dwordx4 a[132:135], v6, s[16:19], s76 offen offset:256 sc1
    buffer_load_dwordx4 a[136:139], v6, s[16:19], s76 offen offset:512 sc1
    buffer_load_dwordx4 a[140:143], v6, s[16:19], s76 offen offset:768 sc1
    buffer_load_dwordx4 a[144:147], v6, s[16:19], s77 offen offset:0 sc1
    buffer_load_dwordx4 a[148:151], v6, s[16:19], s77 offen offset:256 sc1
    buffer_load_dwordx4 a[152:155], v6, s[16:19], s77 offen offset:512 sc1
    buffer_load_dwordx4 a[156:159], v6, s[16:19], s77 offen offset:768 sc1
    s_add_u32 s58, s78, 0
    buffer_load_dwordx4 a[160:163], v7, s[16:19], s58 offen sc1
    s_add_u32 s58, s78, 4096
    buffer_load_dwordx4 a[164:167], v7, s[16:19], s58 offen sc1
    s_add_u32 s58, s78, 8192
    buffer_load_dwordx4 a[168:171], v7, s[16:19], s58 offen sc1
    s_add_u32 s58, s78, 12288
    buffer_load_dwordx4 a[172:175], v7, s[16:19], s58 offen sc1
    s_add_u32 s58, s78, 16384
    buffer_load_dwordx4 a[176:179], v7, s[16:19], s58 offen sc1
    s_add_u32 s58, s78, 20480
    buffer_load_dwordx4 a[180:183], v7, s[16:19], s58 offen sc1
    s_add_u32 s58, s78, 24576
    buffer_load_dwordx4 a[184:187], v7, s[16:19], s58 offen sc1
    s_add_u32 s58, s78, 28672
    buffer_load_dwordx4 a[188:191], v7, s[16:19], s58 offen sc1
    v_lshrrev_b32 v12, 1, v2
    v_mul_u32_u24 v12, 1040, v12
    v_and_b32 v8, 1, v2
    v_mul_u32_u24 v9, 640, v8
    v_add_u32 v12, v12, v9
    v_lshl_add_u32 v12, v4, 4, v12
    s_lshl_b32 s3, s36, 5
    s_add_u32 s3, s3, 62208
    v_add_u32 v12, s3, v12
    v_lshlrev_b32 v8, 8, v8
    v_sub_u32 v13, v12, v8
    v_add_u32 v13, 128, v13
    v_bfe_u32 v14, v0, 2, 2
    v_xor_b32 v14, s36, v14
    v_lshlrev_b32 v14, 4, v14
    v_lshl_add_u32 v14, v0, 6, v14
    v_add_u32 v14, 95488, v14
    v_lshlrev_b32 v15, 4, v0
    s_lshl_b32 s3, s36, 13
    v_add_u32 v7, s3, v15
    v_add_u32 v15, 128256, v15
    v_and_b32 v8, 7, v2
    v_lshlrev_b32 v9, 1, v4
    v_xor_b32 v8, v8, v9
    v_lshlrev_b32 v8, 4, v8
    v_lshl_add_u32 v6, v2, 7, v8
    v_add_u32 v6, s3, v6
    v_lshrrev_b32 v8, 3, v0
    v_and_b32 v9, 7, v0
    v_xor_b32 v9, v9, v8
    v_lshlrev_b32 v1, 7, v8
    v_lshl_add_u32 v1, v9, 4, v1
    v_mov_b32 v10, -2.0
    v_mov_b32 v11, -2.0
    s_mov_b32 s67, 0xffff0000
    s_waitcnt vmcnt(26)
    s_barrier
    ds_read_b128 a[24:27], v15 offset:6144
    ds_read_b128 a[28:31], v15 offset:7168
    ds_read_b128 a[32:35], v15 offset:8192
    ds_read_b128 a[36:39], v15 offset:9216
    ds_read_b128 a[40:43], v15 offset:10240
    ds_read_b128 a[44:47], v15 offset:11264
    ds_read_b128 a[0:3], v15 offset:0
    ds_read_b128 a[4:7], v15 offset:1024
    ds_read_b128 a[8:11], v15 offset:2048
    ds_read_b128 a[12:15], v15 offset:3072
    ds_read_b128 a[16:19], v15 offset:4096
    ds_read_b128 a[20:23], v15 offset:5120
    ds_read_b128 a[48:51], v15 offset:12288
    ds_read_b128 a[52:55], v15 offset:13312
    ds_read_b128 a[56:59], v15 offset:14336
    ds_read_b128 a[60:63], v15 offset:15360
    ds_read_b128 a[64:67], v15 offset:16384
    ds_read_b128 a[68:71], v15 offset:17408
L_col:
    ds_read_b128 v[24:27], v12 offset:256
    ds_read_b128 v[40:43], v12 offset:16896
    ds_read_b128 v[28:31], v13 offset:256
    ds_read_b128 v[44:47], v13 offset:16896
    ds_read_b128 v[16:19], v12 offset:0
    ds_read_b128 v[32:35], v12 offset:16640
    ds_read_b128 v[20:23], v13 offset:0
    ds_read_b128 v[36:39], v13 offset:16640
    ds_read_b128 v[48:51], v14 offset:0
    ds_read_b128 v[52:55], v14 offset:4096
    ds_read_b128 v[56:59], v14 offset:8192
    ds_read_b128 v[60:63], v14 offset:12288
    ds_read_b128 v[64:67], v14 offset:16384
    ds_read_b128 v[68:71], v14 offset:20480
    ds_read_b128 v[72:75], v14 offset:24576
    ds_read_b128 v[76:79], v14 offset:28672
    v_mul_f32 v9, 0x3a000000, v3
    v_mul_f32 v8, 4.0, v5
    v_mul_f32 v8, v8, v9
    v_fmamk_f32 v160, v9, 0x0, v8
    v_fmamk_f32 v161, v9, 0x3f800000, v8
    v_fmamk_f32 v162, v9, 0x40000000, v8
    v_fmamk_f32 v163, v9, 0x40400000, v8
    v_fmamk_f32 v164, v9, 0x41000000, v8
    v_fmamk_f32 v165, v9, 0x41100000, v8
    v_fmamk_f32 v166, v9, 0x41200000, v8
    v_fmamk_f32 v167, v9, 0x41300000, v8
    v_fmamk_f32 v168, v9, 0x41800000, v8
    v_fmamk_f32 v169, v9, 0x41880000, v8
    v_fmamk_f32 v170, v9, 0x41900000, v8
    v_fmamk_f32 v171, v9, 0x41980000, v8
    v_fmamk_f32 v172, v9, 0x41c00000, v8
    v_fmamk_f32 v173, v9, 0x41c80000, v8
    v_fmamk_f32 v174, v9, 0x41d00000, v8
    v_fmamk_f32 v175, v9, 0x41d80000, v8
    v_cos_f32 v144, v160
    s_waitcnt lgkmcnt(8)
    v_and_b32 v32, s70, v32
    v_and_b32 v33, s70, v33
    v_and_b32 v34, s70, v34
    v_and_b32 v35, s70, v35
    v_and_b32 v36, s70, v36
    v_and_b32 v37, s70, v37
    v_and_b32 v38, s70, v38
    v_and_b32 v39, s70, v39
    v_and_b32 v40, s70, v40
    v_and_b32 v41, s70, v41
    v_and_b32 v42, s70, v42
    v_and_b32 v43, s70, v43
    v_and_b32 v44, s70, v44
    v_and_b32 v45, s70, v45
    v_and_b32 v46, s70, v46
    v_and_b32 v47, s70, v47
    v_mfma_f32_32x32x16_bf16 v[112:127], v[24:27], a[24:27], 0
    v_sin_f32 v160, v160
    v_cos_f32 v145, v161
    v_sin_f32 v161, v161
    v_cos_f32 v146, v162
    v_sin_f32 v162, v162
    v_mfma_f32_32x32x16_bf16 v[128:143], v[40:43], a[24:27], 0
    v_cos_f32 v147, v163
    v_sin_f32 v163, v163
    v_cos_f32 v148, v164
    v_sin_f32 v164, v164
    v_cos_f32 v149, v165
    v_mfma_f32_32x32x16_bf16 v[112:127], v[28:31], a[28:31], v[112:127]
    v_sin_f32 v165, v165
    v_cos_f32 v150, v166
    v_sin_f32 v166, v166
    v_cos_f32 v151, v167
    v_sin_f32 v167, v167
    v_mfma_f32_32x32x16_bf16 v[128:143], v[44:47], a[28:31], v[128:143]
    v_cos_f32 v152, v168
    v_sin_f32 v168, v168
    v_cos_f32 v153, v169
    v_sin_f32 v169, v169
    v_cos_f32 v154, v170
    v_mfma_f32_32x32x16_bf16 v[112:127], v[40:43], a[32:35], v[112:127]
    v_sin_f32 v170, v170
    v_cos_f32 v155, v171
    v_sin_f32 v171, v171
    v_cos_f32 v156, v172
    v_sin_f32 v172, v172
    v_mfma_f32_32x32x16_bf16 v[128:143], v[24:27], a[40:43], v[128:143]
    v_cos_f32 v157, v173
    v_sin_f32 v173, v173
    v_cos_f32 v158, v174
    v_sin_f32 v174, v174
    v_cos_f32 v159, v175
    v_mfma_f32_32x32x16_bf16 v[112:127], v[44:47], a[36:39], v[112:127]
    v_sin_f32 v175, v175
    v_mul_f32 v9, 0x3a000000, v3
    v_add_f32 v9, 0x3c800000, v9
    v_mul_f32 v8, 4.0, v5
    v_mul_f32 v8, v8, v9
    v_mfma_f32_32x32x16_bf16 v[128:143], v[28:31], a[44:47], v[128:143]
    v_fmamk_f32 v192, v9, 0x0, v8
    v_fmamk_f32 v193, v9, 0x3f800000, v8
    v_fmamk_f32 v194, v9, 0x40000000, v8
    v_fmamk_f32 v195, v9, 0x40400000, v8
    v_fmamk_f32 v196, v9, 0x41000000, v8
    v_mfma_f32_32x32x16_bf16 v[80:95], v[16:19], a[0:3], 0
    v_fmamk_f32 v197, v9, 0x41100000, v8
    v_fmamk_f32 v198, v9, 0x41200000, v8
    v_fmamk_f32 v199, v9, 0x41300000, v8
    v_fmamk_f32 v200, v9, 0x41800000, v8
    v_fmamk_f32 v201, v9, 0x41880000, v8
    v_mfma_f32_32x32x16_bf16 v[96:111], v[32:35], a[0:3], 0
    v_fmamk_f32 v202, v9, 0x41900000, v8
    v_fmamk_f32 v203, v9, 0x41980000, v8
    v_fmamk_f32 v204, v9, 0x41c00000, v8
    v_fmamk_f32 v205, v9, 0x41c80000, v8
    v_fmamk_f32 v206, v9, 0x41d00000, v8
    v_mfma_f32_32x32x16_bf16 v[80:95], v[20:23], a[4:7], v[80:95]
    v_fmamk_f32 v207, v9, 0x41d80000, v8
    v_cos_f32 v176, v192
    v_sin_f32 v192, v192
    v_cos_f32 v177, v193
    v_sin_f32 v193, v193
    v_mfma_f32_32x32x16_bf16 v[96:111], v[36:39], a[4:7], v[96:111]
    v_cos_f32 v178, v194
    v_sin_f32 v194, v194
    v_cos_f32 v179, v195
    v_sin_f32 v195, v195
    v_cos_f32 v180, v196
    v_mfma_f32_32x32x16_bf16 v[80:95], v[32:35], a[8:11], v[80:95]
    v_sin_f32 v196, v196
    v_cos_f32 v181, v197
    v_sin_f32 v197, v197
    v_cos_f32 v182, v198
    v_sin_f32 v198, v198
    v_mfma_f32_32x32x16_bf16 v[96:111], v[16:19], a[16:19], v[96:111]
    v_cos_f32 v183, v199
    v_sin_f32 v199, v199
    v_cos_f32 v184, v200
    v_sin_f32 v200, v200
    v_cos_f32 v185, v201
    v_mfma_f32_32x32x16_bf16 v[80:95], v[36:39], a[12:15], v[80:95]
    v_sin_f32 v201, v201
    v_cos_f32 v186, v202
    v_sin_f32 v202, v202
    v_cos_f32 v187, v203
    v_sin_f32 v203, v203
    v_mfma_f32_32x32x16_bf16 v[96:111], v[20:23], a[20:23], v[96:111]
    v_cos_f32 v188, v204
    v_sin_f32 v204, v204
    v_cos_f32 v189, v205
    v_sin_f32 v205, v205
    v_cos_f32 v190, v206
    v_sin_f32 v206, v206
    v_cos_f32 v191, v207
    v_sin_f32 v207, v207
    v_pk_add_f32 v[80:81], v[80:81], v[112:113]
    v_pk_fma_f32 v[112:113], v[112:113], v[10:11], v[80:81]
    v_pk_add_f32 v[82:83], v[82:83], v[114:115]
    v_pk_fma_f32 v[114:115], v[114:115], v[10:11], v[82:83]
    v_pk_add_f32 v[84:85], v[84:85], v[116:117]
    v_pk_fma_f32 v[116:117], v[116:117], v[10:11], v[84:85]
    v_pk_add_f32 v[86:87], v[86:87], v[118:119]
    v_pk_fma_f32 v[118:119], v[118:119], v[10:11], v[86:87]
    v_pk_add_f32 v[88:89], v[88:89], v[120:121]
    v_pk_fma_f32 v[120:121], v[120:121], v[10:11], v[88:89]
    v_pk_add_f32 v[90:91], v[90:91], v[122:123]
    v_pk_fma_f32 v[122:123], v[122:123], v[10:11], v[90:91]
    v_pk_add_f32 v[92:93], v[92:93], v[124:125]
    v_pk_fma_f32 v[124:125], v[124:125], v[10:11], v[92:93]
    v_pk_add_f32 v[94:95], v[94:95], v[126:127]
    v_pk_fma_f32 v[126:127], v[126:127], v[10:11], v[94:95]
    v_pk_add_f32 v[96:97], v[96:97], v[128:129]
    v_pk_fma_f32 v[128:129], v[128:129], v[10:11], v[96:97]
    v_pk_add_f32 v[98:99], v[98:99], v[130:131]
    v_pk_fma_f32 v[130:131], v[130:131], v[10:11], v[98:99]
    v_pk_add_f32 v[100:101], v[100:101], v[132:133]
    v_pk_fma_f32 v[132:133], v[132:133], v[10:11], v[100:101]
    v_pk_add_f32 v[102:103], v[102:103], v[134:135]
    v_pk_fma_f32 v[134:135], v[134:135], v[10:11], v[102:103]
    v_pk_add_f32 v[104:105], v[104:105], v[136:137]
    v_pk_fma_f32 v[136:137], v[136:137], v[10:11], v[104:105]
    v_pk_add_f32 v[106:107], v[106:107], v[138:139]
    v_pk_fma_f32 v[138:139], v[138:139], v[10:11], v[106:107]
    v_pk_add_f32 v[108:109], v[108:109], v[140:141]
    v_pk_fma_f32 v[140:141], v[140:141], v[10:11], v[108:109]
    v_pk_add_f32 v[110:111], v[110:111], v[142:143]
    v_pk_fma_f32 v[142:143], v[142:143], v[10:11], v[110:111]
    v_mul_f32 v208, v80, v144
    v_mul_f32 v209, v81, v145
    v_mul_f32 v210, v96, v144
    v_mul_f32 v211, v97, v145
    v_fma_f32 v208, v96, v160, v208
    v_fma_f32 v209, v97, v161, v209
    v_fma_f32 v210, -v80, v160, v210
    v_fma_f32 v211, -v81, v161, v211
    v_cvt_pk_bf16_f32 v16, v208, v209
    v_cvt_pk_bf16_f32 v32, v210, v211
    v_mul_f32 v208, v82, v146
    v_mul_f32 v209, v83, v147
    v_mul_f32 v210, v98, v146
    v_mul_f32 v211, v99, v147
    v_fma_f32 v208, v98, v162, v208
    v_fma_f32 v209, v99, v163, v209
    v_fma_f32 v210, -v82, v162, v210
    v_fma_f32 v211, -v83, v163, v211
    v_cvt_pk_bf16_f32 v17, v208, v209
    v_cvt_pk_bf16_f32 v33, v210, v211
    v_mul_f32 v208, v84, v148
    v_mul_f32 v209, v85, v149
    v_mul_f32 v210, v100, v148
    v_mul_f32 v211, v101, v149
    v_fma_f32 v208, v100, v164, v208
    v_fma_f32 v209, v101, v165, v209
    v_fma_f32 v210, -v84, v164, v210
    v_fma_f32 v211, -v85, v165, v211
    v_cvt_pk_bf16_f32 v18, v208, v209
    v_cvt_pk_bf16_f32 v34, v210, v211
    v_mul_f32 v208, v86, v150
    v_mul_f32 v209, v87, v151
    v_mul_f32 v210, v102, v150
    v_mul_f32 v211, v103, v151
    v_fma_f32 v208, v102, v166, v208
    v_fma_f32 v209, v103, v167, v209
    v_fma_f32 v210, -v86, v166, v210
    v_fma_f32 v211, -v87, v167, v211
    v_cvt_pk_bf16_f32 v19, v208, v209
    v_cvt_pk_bf16_f32 v35, v210, v211
    v_mul_f32 v208, v88, v152
    v_mul_f32 v209, v89, v153
    v_mul_f32 v210, v104, v152
    v_mul_f32 v211, v105, v153
    v_fma_f32 v208, v104, v168, v208
    v_fma_f32 v209, v105, v169, v209
    v_fma_f32 v210, -v88, v168, v210
    v_fma_f32 v211, -v89, v169, v211
    v_cvt_pk_bf16_f32 v20, v208, v209
    v_cvt_pk_bf16_f32 v36, v210, v211
    v_mul_f32 v208, v90, v154
    v_mul_f32 v209, v91, v155
    v_mul_f32 v210, v106, v154
    v_mul_f32 v211, v107, v155
    v_fma_f32 v208, v106, v170, v208
    v_fma_f32 v209, v107, v171, v209
    v_fma_f32 v210, -v90, v170, v210
    v_fma_f32 v211, -v91, v171, v211
    v_cvt_pk_bf16_f32 v21, v208, v209
    v_cvt_pk_bf16_f32 v37, v210, v211
    v_mul_f32 v208, v92, v156
    v_mul_f32 v209, v93, v157
    v_mul_f32 v210, v108, v156
    v_mul_f32 v211, v109, v157
    v_fma_f32 v208, v108, v172, v208
    v_fma_f32 v209, v109, v173, v209
    v_fma_f32 v210, -v92, v172, v210
    v_fma_f32 v211, -v93, v173, v211
    v_cvt_pk_bf16_f32 v22, v208, v209
    v_cvt_pk_bf16_f32 v38, v210, v211
    v_mul_f32 v208, v94, v158
    v_mul_f32 v209, v95, v159
    v_mul_f32 v210, v110, v158
    v_mul_f32 v211, v111, v159
    v_fma_f32 v208, v110, v174, v208
    v_fma_f32 v209, v111, v175, v209
    v_fma_f32 v210, -v94, v174, v210
    v_fma_f32 v211, -v95, v175, v211
    v_cvt_pk_bf16_f32 v23, v208, v209
    v_cvt_pk_bf16_f32 v39, v210, v211
    s_cmp_eq_u32 s80, 2
    s_cbranch_scc1 L_col_nosig
    s_waitcnt vmcnt(16)
    s_barrier
    v_mov_b32 v8, 2
    v_min_u32 v9, 1, v0
    v_lshlrev_b32 v9, 30, v9
    buffer_store_dword v8, v9, s[16:19], s60 offen sc0 sc1
L_col_nosig:
    v_mfma_f32_32x32x16_bf16 v[80:95], a[0:3], v[16:19], 0
    v_mul_f32 v208, v112, v176
    v_mul_f32 v209, v113, v177
    v_mul_f32 v210, v128, v176
    v_mul_f32 v211, v129, v177
    v_fma_f32 v208, v128, v192, v208
    v_fma_f32 v209, v129, v193, v209
    v_mfma_f32_32x32x16_bf16 v[96:111], a[0:3], v[32:35], 0
    v_fma_f32 v210, -v112, v192, v210
    v_fma_f32 v211, -v113, v193, v211
    v_cvt_pk_bf16_f32 v24, v208, v209
    v_cvt_pk_bf16_f32 v40, v210, v211
    v_mul_f32 v208, v114, v178
    v_mul_f32 v209, v115, v179
    v_mfma_f32_32x32x16_bf16 v[80:95], a[4:7], v[20:23], v[80:95]
    v_mul_f32 v210, v130, v178
    v_mul_f32 v211, v131, v179
    v_fma_f32 v208, v130, v194, v208
    v_fma_f32 v209, v131, v195, v209
    v_fma_f32 v210, -v114, v194, v210
    v_fma_f32 v211, -v115, v195, v211
    v_mfma_f32_32x32x16_bf16 v[96:111], a[4:7], v[36:39], v[96:111]
    v_cvt_pk_bf16_f32 v25, v208, v209
    v_cvt_pk_bf16_f32 v41, v210, v211
    v_mul_f32 v208, v116, v180
    v_mul_f32 v209, v117, v181
    v_mul_f32 v210, v132, v180
    v_mul_f32 v211, v133, v181
    v_mfma_f32_32x32x16_bf16 v[80:95], a[8:11], v[32:35], v[80:95]
    v_fma_f32 v208, v132, v196, v208
    v_fma_f32 v209, v133, v197, v209
    v_fma_f32 v210, -v116, v196, v210
    v_fma_f32 v211, -v117, v197, v211
    v_cvt_pk_bf16_f32 v26, v208, v209
    v_cvt_pk_bf16_f32 v42, v210, v211
    v_mfma_f32_32x32x16_bf16 v[96:111], a[16:19], v[16:19], v[96:111]
    v_mul_f32 v208, v118, v182
    v_mul_f32 v209, v119, v183
    v_mul_f32 v210, v134, v182
    v_mul_f32 v211, v135, v183
    v_fma_f32 v208, v134, v198, v208
    v_fma_f32 v209, v135, v199, v209
    v_mfma_f32_32x32x16_bf16 v[80:95], a[12:15], v[36:39], v[80:95]
    v_fma_f32 v210, -v118, v198, v210
    v_fma_f32 v211, -v119, v199, v211
    v_cvt_pk_bf16_f32 v27, v208, v209
    v_cvt_pk_bf16_f32 v43, v210, v211
    v_mul_f32 v208, v120, v184
    v_mul_f32 v209, v121, v185
    v_mfma_f32_32x32x16_bf16 v[96:111], a[20:23], v[20:23], v[96:111]
    v_mul_f32 v210, v136, v184
    v_mul_f32 v211, v137, v185
    v_fma_f32 v208, v136, v200, v208
    v_fma_f32 v209, v137, v201, v209
    v_fma_f32 v210, -v120, v200, v210
    v_fma_f32 v211, -v121, v201, v211
    v_cvt_pk_bf16_f32 v28, v208, v209
    v_cvt_pk_bf16_f32 v44, v210, v211
    v_mul_f32 v208, v122, v186
    v_mul_f32 v209, v123, v187
    v_mul_f32 v210, v138, v186
    v_mul_f32 v211, v139, v187
    v_fma_f32 v208, v138, v202, v208
    v_fma_f32 v209, v139, v203, v209
    v_fma_f32 v210, -v122, v202, v210
    v_fma_f32 v211, -v123, v203, v211
    v_cvt_pk_bf16_f32 v29, v208, v209
    v_cvt_pk_bf16_f32 v45, v210, v211
    v_mul_f32 v208, v124, v188
    v_mul_f32 v209, v125, v189
    v_mul_f32 v210, v140, v188
    v_mul_f32 v211, v141, v189
    v_fma_f32 v208, v140, v204, v208
    v_fma_f32 v209, v141, v205, v209
    v_fma_f32 v210, -v124, v204, v210
    v_fma_f32 v211, -v125, v205, v211
    v_cvt_pk_bf16_f32 v30, v208, v209
    v_cvt_pk_bf16_f32 v46, v210, v211
    v_mul_f32 v208, v126, v190
    v_mul_f32 v209, v127, v191
    v_mul_f32 v210, v142, v190
    v_mul_f32 v211, v143, v191
    v_fma_f32 v208, v142, v206, v208
    v_fma_f32 v209, v143, v207, v209
    v_fma_f32 v210, -v126, v206, v210
    v_fma_f32 v211, -v127, v207, v211
    v_cvt_pk_bf16_f32 v31, v208, v209
    v_cvt_pk_bf16_f32 v47, v210, v211
    s_waitcnt lgkmcnt(0)
    v_mfma_f32_32x32x16_bf16 v[112:127], a[0:3], v[24:27], 0
    v_lshlrev_b32 v212, 16, v48
    v_and_b32 v214, s67, v48
    v_lshlrev_b32 v213, 16, v49
    v_and_b32 v215, s67, v49
    v_mul_f32 v208, v80, v212
    v_mul_f32 v209, v81, v213
    v_mfma_f32_32x32x16_bf16 v[128:143], a[0:3], v[40:43], 0
    v_mul_f32 v210, v96, v212
    v_mul_f32 v211, v97, v213
    v_fma_f32 v208, -v96, v214, v208
    v_fma_f32 v209, -v97, v215, v209
    v_fma_f32 v210, v80, v214, v210
    v_fma_f32 v211, v81, v215, v211
    v_mfma_f32_32x32x16_bf16 v[112:127], a[4:7], v[28:31], v[112:127]
    v_cvt_pk_bf16_f32 v16, v208, v209
    v_cvt_pk_bf16_f32 v32, v210, v211
    v_lshlrev_b32 v212, 16, v50
    v_and_b32 v214, s67, v50
    v_lshlrev_b32 v213, 16, v51
    v_and_b32 v215, s67, v51
    v_mfma_f32_32x32x16_bf16 v[128:143], a[4:7], v[44:47], v[128:143]
    v_mul_f32 v208, v82, v212
    v_mul_f32 v209, v83, v213
    v_mul_f32 v210, v98, v212
    v_mul_f32 v211, v99, v213
    v_fma_f32 v208, -v98, v214, v208
    v_fma_f32 v209, -v99, v215, v209
    v_mfma_f32_32x32x16_bf16 v[112:127], a[8:11], v[40:43], v[112:127]
    v_fma_f32 v210, v82, v214, v210
    v_fma_f32 v211, v83, v215, v211
    v_cvt_pk_bf16_f32 v17, v208, v209
    v_cvt_pk_bf16_f32 v33, v210, v211
    v_lshlrev_b32 v212, 16, v52
    v_and_b32 v214, s67, v52
    v_mfma_f32_32x32x16_bf16 v[128:143], a[16:19], v[24:27], v[128:143]
    v_lshlrev_b32 v213, 16, v53
    v_and_b32 v215, s67, v53
    v_mul_f32 v208, v84, v212
    v_mul_f32 v209, v85, v213
    v_mul_f32 v210, v100, v212
    v_mul_f32 v211, v101, v213
    v_mfma_f32_32x32x16_bf16 v[112:127], a[12:15], v[44:47], v[112:127]
    v_fma_f32 v208, -v100, v214, v208
    v_fma_f32 v209, -v101, v215, v209
    v_fma_f32 v210, v84, v214, v210
    v_fma_f32 v211, v85, v215, v211
    v_cvt_pk_bf16_f32 v18, v208, v209
    v_cvt_pk_bf16_f32 v34, v210, v211
    v_mfma_f32_32x32x16_bf16 v[128:143], a[20:23], v[28:31], v[128:143]
    v_lshlrev_b32 v212, 16, v54
    v_and_b32 v214, s67, v54
    v_lshlrev_b32 v213, 16, v55
    v_and_b32 v215, s67, v55
    v_mul_f32 v208, v86, v212
    v_mul_f32 v209, v87, v213
    v_mul_f32 v210, v102, v212
    v_mul_f32 v211, v103, v213
    v_fma_f32 v208, -v102, v214, v208
    v_fma_f32 v209, -v103, v215, v209
    v_fma_f32 v210, v86, v214, v210
    v_fma_f32 v211, v87, v215, v211
    v_cvt_pk_bf16_f32 v19, v208, v209
    v_cvt_pk_bf16_f32 v35, v210, v211
    v_lshlrev_b32 v212, 16, v56
    v_and_b32 v214, s67, v56
    v_lshlrev_b32 v213, 16, v57
    v_and_b32 v215, s67, v57
    v_mul_f32 v208, v88, v212
    v_mul_f32 v209, v89, v213
    v_mul_f32 v210, v104, v212
    v_mul_f32 v211, v105, v213
    v_fma_f32 v208, -v104, v214, v208
    v_fma_f32 v209, -v105, v215, v209
    v_fma_f32 v210, v88, v214, v210
    v_fma_f32 v211, v89, v215, v211
    v_cvt_pk_bf16_f32 v20, v208, v209
    v_cvt_pk_bf16_f32 v36, v210, v211
    v_lshlrev_b32 v212, 16, v58
    v_and_b32 v214, s67, v58
    v_lshlrev_b32 v213, 16, v59
    v_and_b32 v215, s67, v59
    v_mul_f32 v208, v90, v212
    v_mul_f32 v209, v91, v213
    v_mul_f32 v210, v106, v212
    v_mul_f32 v211, v107, v213
    v_fma_f32 v208, -v106, v214, v208
    v_fma_f32 v209, -v107, v215, v209
    v_fma_f32 v210, v90, v214, v210
    v_fma_f32 v211, v91, v215, v211
    v_cvt_pk_bf16_f32 v21, v208, v209
    v_cvt_pk_bf16_f32 v37, v210, v211
    v_lshlrev_b32 v212, 16, v60
    v_and_b32 v214, s67, v60
    v_lshlrev_b32 v213, 16, v61
    v_and_b32 v215, s67, v61
    v_mul_f32 v208, v92, v212
    v_mul_f32 v209, v93, v213
    v_mul_f32 v210, v108, v212
    v_mul_f32 v211, v109, v213
    v_fma_f32 v208, -v108, v214, v208
    v_fma_f32 v209, -v109, v215, v209
    v_fma_f32 v210, v92, v214, v210
    v_fma_f32 v211, v93, v215, v211
    v_cvt_pk_bf16_f32 v22, v208, v209
    v_cvt_pk_bf16_f32 v38, v210, v211
    v_lshlrev_b32 v212, 16, v62
    v_and_b32 v214, s67, v62
    v_lshlrev_b32 v213, 16, v63
    v_and_b32 v215, s67, v63
    v_mul_f32 v208, v94, v212
    v_mul_f32 v209, v95, v213
    v_mul_f32 v210, v110, v212
    v_mul_f32 v211, v111, v213
    v_fma_f32 v208, -v110, v214, v208
    v_fma_f32 v209, -v111, v215, v209
    v_fma_f32 v210, v94, v214, v210
    v_fma_f32 v211, v95, v215, v211
    v_cvt_pk_bf16_f32 v23, v208, v209
    v_cvt_pk_bf16_f32 v39, v210, v211
    v_mfma_f32_32x32x16_bf16 v[80:95], v[16:19], a[0:3], 0
    v_lshlrev_b32 v212, 16, v64
    v_and_b32 v214, s67, v64
    v_lshlrev_b32 v213, 16, v65
    v_and_b32 v215, s67, v65
    v_mul_f32 v208, v112, v212
    v_mul_f32 v209, v113, v213
    v_mfma_f32_32x32x16_bf16 v[96:111], v[32:35], a[0:3], 0
    v_mul_f32 v210, v128, v212
    v_mul_f32 v211, v129, v213
    v_fma_f32 v208, -v128, v214, v208
    v_fma_f32 v209, -v129, v215, v209
    v_fma_f32 v210, v112, v214, v210
    v_fma_f32 v211, v113, v215, v211
    v_mfma_f32_32x32x16_bf16 v[80:95], v[20:23], a[4:7], v[80:95]
    v_cvt_pk_bf16_f32 v24, v208, v209
    v_cvt_pk_bf16_f32 v40, v210, v211
    v_lshlrev_b32 v212, 16, v66
    v_and_b32 v214, s67, v66
    v_lshlrev_b32 v213, 16, v67
    v_and_b32 v215, s67, v67
    v_mfma_f32_32x32x16_bf16 v[96:111], v[36:39], a[4:7], v[96:111]
    v_mul_f32 v208, v114, v212
    v_mul_f32 v209, v115, v213
    v_mul_f32 v210, v130, v212
    v_mul_f32 v211, v131, v213
    v_fma_f32 v208, -v130, v214, v208
    v_fma_f32 v209, -v131, v215, v209
    v_mfma_f32_32x32x16_bf16 v[80:95], v[32:35], a[16:19], v[80:95]
    v_fma_f32 v210, v114, v214, v210
    v_fma_f32 v211, v115, v215, v211
    v_cvt_pk_bf16_f32 v25, v208, v209
    v_cvt_pk_bf16_f32 v41, v210, v211
    v_lshlrev_b32 v212, 16, v68
    v_and_b32 v214, s67, v68
    v_mfma_f32_32x32x16_bf16 v[96:111], v[16:19], a[8:11], v[96:111]
    v_lshlrev_b32 v213, 16, v69
    v_and_b32 v215, s67, v69
    v_mul_f32 v208, v116, v212
    v_mul_f32 v209, v117, v213
    v_mul_f32 v210, v132, v212
    v_mul_f32 v211, v133, v213
    v_mfma_f32_32x32x16_bf16 v[80:95], v[36:39], a[20:23], v[80:95]
    v_fma_f32 v208, -v132, v214, v208
    v_fma_f32 v209, -v133, v215, v209
    v_fma_f32 v210, v116, v214, v210
    v_fma_f32 v211, v117, v215, v211
    v_cvt_pk_bf16_f32 v26, v208, v209
    v_cvt_pk_bf16_f32 v42, v210, v211
    v_mfma_f32_32x32x16_bf16 v[96:111], v[20:23], a[12:15], v[96:111]
    v_lshlrev_b32 v212, 16, v70
    v_and_b32 v214, s67, v70
    v_lshlrev_b32 v213, 16, v71
    v_and_b32 v215, s67, v71
    v_mul_f32 v208, v118, v212
    v_mul_f32 v209, v119, v213
    v_mul_f32 v210, v134, v212
    v_mul_f32 v211, v135, v213
    v_fma_f32 v208, -v134, v214, v208
    v_fma_f32 v209, -v135, v215, v209
    v_fma_f32 v210, v118, v214, v210
    v_fma_f32 v211, v119, v215, v211
    v_cvt_pk_bf16_f32 v27, v208, v209
    v_cvt_pk_bf16_f32 v43, v210, v211
    v_lshlrev_b32 v212, 16, v72
    v_and_b32 v214, s67, v72
    v_lshlrev_b32 v213, 16, v73
    v_and_b32 v215, s67, v73
    v_mul_f32 v208, v120, v212
    v_mul_f32 v209, v121, v213
    v_mul_f32 v210, v136, v212
    v_mul_f32 v211, v137, v213
    v_fma_f32 v208, -v136, v214, v208
    v_fma_f32 v209, -v137, v215, v209
    v_fma_f32 v210, v120, v214, v210
    v_fma_f32 v211, v121, v215, v211
    v_cvt_pk_bf16_f32 v28, v208, v209
    v_cvt_pk_bf16_f32 v44, v210, v211
    v_lshlrev_b32 v212, 16, v74
    v_and_b32 v214, s67, v74
    v_lshlrev_b32 v213, 16, v75
    v_and_b32 v215, s67, v75
    v_mul_f32 v208, v122, v212
    v_mul_f32 v209, v123, v213
    v_mul_f32 v210, v138, v212
    v_mul_f32 v211, v139, v213
    v_fma_f32 v208, -v138, v214, v208
    v_fma_f32 v209, -v139, v215, v209
    v_fma_f32 v210, v122, v214, v210
    v_fma_f32 v211, v123, v215, v211
    v_cvt_pk_bf16_f32 v29, v208, v209
    v_cvt_pk_bf16_f32 v45, v210, v211
    v_lshlrev_b32 v212, 16, v76
    v_and_b32 v214, s67, v76
    v_lshlrev_b32 v213, 16, v77
    v_and_b32 v215, s67, v77
    v_mul_f32 v208, v124, v212
    v_mul_f32 v209, v125, v213
    v_mul_f32 v210, v140, v212
    v_mul_f32 v211, v141, v213
    v_fma_f32 v208, -v140, v214, v208
    v_fma_f32 v209, -v141, v215, v209
    v_fma_f32 v210, v124, v214, v210
    v_fma_f32 v211, v125, v215, v211
    v_cvt_pk_bf16_f32 v30, v208, v209
    v_cvt_pk_bf16_f32 v46, v210, v211
    v_lshlrev_b32 v212, 16, v78
    v_and_b32 v214, s67, v78
    v_lshlrev_b32 v213, 16, v79
    v_and_b32 v215, s67, v79
    v_mul_f32 v208, v126, v212
    v_mul_f32 v209, v127, v213
    v_mul_f32 v210, v142, v212
    v_mul_f32 v211, v143, v213
    v_fma_f32 v208, -v142, v214, v208
    v_fma_f32 v209, -v143, v215, v209
    v_fma_f32 v210, v126, v214, v210
    v_fma_f32 v211, v127, v215, v211
    v_cvt_pk_bf16_f32 v31, v208, v209
    v_cvt_pk_bf16_f32 v47, v210, v211
    v_mfma_f32_32x32x16_bf16 v[112:127], v[24:27], a[0:3], 0
    v_mul_f32 v48, v80, v144
    v_mul_f32 v49, v81, v145
    v_mul_f32 v64, v96, v144
    v_mul_f32 v65, v97, v145
    v_fma_f32 v48, -v96, v160, v48
    v_fma_f32 v49, -v97, v161, v49
    v_mfma_f32_32x32x16_bf16 v[128:143], v[40:43], a[0:3], 0
    v_fma_f32 v64, v80, v160, v64
    v_fma_f32 v65, v81, v161, v65
    v_mul_f32 v50, v82, v146
    v_mul_f32 v51, v83, v147
    v_mul_f32 v66, v98, v146
    v_mul_f32 v67, v99, v147
    v_mfma_f32_32x32x16_bf16 v[112:127], v[28:31], a[4:7], v[112:127]
    v_fma_f32 v50, -v98, v162, v50
    v_fma_f32 v51, -v99, v163, v51
    v_fma_f32 v66, v82, v162, v66
    v_fma_f32 v67, v83, v163, v67
    v_mul_f32 v52, v84, v148
    v_mul_f32 v53, v85, v149
    v_mfma_f32_32x32x16_bf16 v[128:143], v[44:47], a[4:7], v[128:143]
    v_mul_f32 v68, v100, v148
    v_mul_f32 v69, v101, v149
    v_fma_f32 v52, -v100, v164, v52
    v_fma_f32 v53, -v101, v165, v53
    v_fma_f32 v68, v84, v164, v68
    v_fma_f32 v69, v85, v165, v69
    v_mfma_f32_32x32x16_bf16 v[112:127], v[40:43], a[16:19], v[112:127]
    v_mul_f32 v54, v86, v150
    v_mul_f32 v55, v87, v151
    v_mul_f32 v70, v102, v150
    v_mul_f32 v71, v103, v151
    v_fma_f32 v54, -v102, v166, v54
    v_fma_f32 v55, -v103, v167, v55
    v_mfma_f32_32x32x16_bf16 v[128:143], v[24:27], a[8:11], v[128:143]
    v_fma_f32 v70, v86, v166, v70
    v_fma_f32 v71, v87, v167, v71
    v_mul_f32 v56, v88, v152
    v_mul_f32 v57, v89, v153
    v_mul_f32 v72, v104, v152
    v_mul_f32 v73, v105, v153
    v_mfma_f32_32x32x16_bf16 v[112:127], v[44:47], a[20:23], v[112:127]
    v_fma_f32 v56, -v104, v168, v56
    v_fma_f32 v57, -v105, v169, v57
    v_fma_f32 v72, v88, v168, v72
    v_fma_f32 v73, v89, v169, v73
    v_mul_f32 v58, v90, v154
    v_mul_f32 v59, v91, v155
    v_mfma_f32_32x32x16_bf16 v[128:143], v[28:31], a[12:15], v[128:143]
    v_mul_f32 v74, v106, v154
    v_mul_f32 v75, v107, v155
    v_fma_f32 v58, -v106, v170, v58
    v_fma_f32 v59, -v107, v171, v59
    v_fma_f32 v74, v90, v170, v74
    v_fma_f32 v75, v91, v171, v75
    v_mul_f32 v60, v92, v156
    v_mul_f32 v61, v93, v157
    v_mul_f32 v76, v108, v156
    v_mul_f32 v77, v109, v157
    v_fma_f32 v60, -v108, v172, v60
    v_fma_f32 v61, -v109, v173, v61
    v_fma_f32 v76, v92, v172, v76
    v_fma_f32 v77, v93, v173, v77
    v_mul_f32 v62, v94, v158
    v_mul_f32 v63, v95, v159
    v_mul_f32 v78, v110, v158
    v_mul_f32 v79, v111, v159
    v_fma_f32 v62, -v110, v174, v62
    v_fma_f32 v63, -v111, v175, v63
    v_fma_f32 v78, v94, v174, v78
    v_fma_f32 v79, v95, v175, v79
    v_mul_f32 v9, 0x3a000000, v3
    v_mul_f32 v8, 4.0, v5
    v_mul_f32 v8, v8, v9
    v_fmamk_f32 v192, v9, 0x42000000, v8
    v_fmamk_f32 v193, v9, 0x42040000, v8
    v_fmamk_f32 v194, v9, 0x42080000, v8
    v_fmamk_f32 v195, v9, 0x420c0000, v8
    v_fmamk_f32 v196, v9, 0x42200000, v8
    v_fmamk_f32 v197, v9, 0x42240000, v8
    v_fmamk_f32 v198, v9, 0x42280000, v8
    v_fmamk_f32 v199, v9, 0x422c0000, v8
    v_fmamk_f32 v200, v9, 0x42400000, v8
    v_fmamk_f32 v201, v9, 0x42440000, v8
    v_fmamk_f32 v202, v9, 0x42480000, v8
    v_fmamk_f32 v203, v9, 0x424c0000, v8
    v_fmamk_f32 v204, v9, 0x42600000, v8
    v_fmamk_f32 v205, v9, 0x42640000, v8
    v_fmamk_f32 v206, v9, 0x42680000, v8
    v_fmamk_f32 v207, v9, 0x426c0000, v8
    v_cos_f32 v176, v192
    v_sin_f32 v192, v192
    v_cos_f32 v177, v193
    v_sin_f32 v193, v193
    v_cos_f32 v178, v194
    v_sin_f32 v194, v194
    v_cos_f32 v179, v195
    v_sin_f32 v195, v195
    v_cos_f32 v180, v196
    v_sin_f32 v196, v196
    v_cos_f32 v181, v197
    v_sin_f32 v197, v197
    v_cos_f32 v182, v198
    v_sin_f32 v198, v198
    v_cos_f32 v183, v199
    v_sin_f32 v199, v199
    v_cos_f32 v184, v200
    v_sin_f32 v200, v200
    v_cos_f32 v185, v201
    v_sin_f32 v201, v201
    v_cos_f32 v186, v202
    v_sin_f32 v202, v202
    v_cos_f32 v187, v203
    v_sin_f32 v203, v203
    v_cos_f32 v188, v204
    v_sin_f32 v204, v204
    v_cos_f32 v189, v205
    v_sin_f32 v205, v205
    v_cos_f32 v190, v206
    v_sin_f32 v206, v206
    v_cos_f32 v191, v207
    v_sin_f32 v207, v207
    v_mul_f32 v208, v112, v176
    v_mul_f32 v209, v113, v177
    v_mul_f32 v210, v128, v176
    v_mul_f32 v211, v129, v177
    v_fma_f32 v208, -v128, v192, v208
    v_fma_f32 v209, -v129, v193, v209
    v_fma_f32 v210, v112, v192, v210
    v_fma_f32 v211, v113, v193, v211
    v_pk_add_f32 v[212:213], v[48:49], v[208:209]
    v_pk_add_f32 v[214:215], v[48:49], v[208:209] neg_lo:[0,1] neg_hi:[0,1]
    v_cvt_pk_bf16_f32 v16, v212, v213
    v_cvt_pk_bf16_f32 v24, v214, v215
    v_pk_add_f32 v[212:213], v[64:65], v[210:211]
    v_pk_add_f32 v[214:215], v[64:65], v[210:211] neg_lo:[0,1] neg_hi:[0,1]
    v_cvt_pk_bf16_f32 v32, v212, v213
    v_cvt_pk_bf16_f32 v40, v214, v215
    v_mul_f32 v208, v114, v178
    v_mul_f32 v209, v115, v179
    v_mul_f32 v210, v130, v178
    v_mul_f32 v211, v131, v179
    v_fma_f32 v208, -v130, v194, v208
    v_fma_f32 v209, -v131, v195, v209
    v_fma_f32 v210, v114, v194, v210
    v_fma_f32 v211, v115, v195, v211
    v_pk_add_f32 v[212:213], v[50:51], v[208:209]
    v_pk_add_f32 v[214:215], v[50:51], v[208:209] neg_lo:[0,1] neg_hi:[0,1]
    v_cvt_pk_bf16_f32 v17, v212, v213
    v_cvt_pk_bf16_f32 v25, v214, v215
    v_pk_add_f32 v[212:213], v[66:67], v[210:211]
    v_pk_add_f32 v[214:215], v[66:67], v[210:211] neg_lo:[0,1] neg_hi:[0,1]
    v_cvt_pk_bf16_f32 v33, v212, v213
    v_cvt_pk_bf16_f32 v41, v214, v215
    v_mul_f32 v208, v116, v180
    v_mul_f32 v209, v117, v181
    v_mul_f32 v210, v132, v180
    v_mul_f32 v211, v133, v181
    v_fma_f32 v208, -v132, v196, v208
    v_fma_f32 v209, -v133, v197, v209
    v_fma_f32 v210, v116, v196, v210
    v_fma_f32 v211, v117, v197, v211
    v_pk_add_f32 v[212:213], v[52:53], v[208:209]
    v_pk_add_f32 v[214:215], v[52:53], v[208:209] neg_lo:[0,1] neg_hi:[0,1]
    v_cvt_pk_bf16_f32 v18, v212, v213
    v_cvt_pk_bf16_f32 v26, v214, v215
    v_pk_add_f32 v[212:213], v[68:69], v[210:211]
    v_pk_add_f32 v[214:215], v[68:69], v[210:211] neg_lo:[0,1] neg_hi:[0,1]
    v_cvt_pk_bf16_f32 v34, v212, v213
    v_cvt_pk_bf16_f32 v42, v214, v215
    v_mul_f32 v208, v118, v182
    v_mul_f32 v209, v119, v183
    v_mul_f32 v210, v134, v182
    v_mul_f32 v211, v135, v183
    v_fma_f32 v208, -v134, v198, v208
    v_fma_f32 v209, -v135, v199, v209
    v_fma_f32 v210, v118, v198, v210
    v_fma_f32 v211, v119, v199, v211
    v_pk_add_f32 v[212:213], v[54:55], v[208:209]
    v_pk_add_f32 v[214:215], v[54:55], v[208:209] neg_lo:[0,1] neg_hi:[0,1]
    v_cvt_pk_bf16_f32 v19, v212, v213
    v_cvt_pk_bf16_f32 v27, v214, v215
    v_pk_add_f32 v[212:213], v[70:71], v[210:211]
    v_pk_add_f32 v[214:215], v[70:71], v[210:211] neg_lo:[0,1] neg_hi:[0,1]
    v_cvt_pk_bf16_f32 v35, v212, v213
    v_cvt_pk_bf16_f32 v43, v214, v215
    v_mul_f32 v208, v120, v184
    v_mul_f32 v209, v121, v185
    v_mul_f32 v210, v136, v184
    v_mul_f32 v211, v137, v185
    v_fma_f32 v208, -v136, v200, v208
    v_fma_f32 v209, -v137, v201, v209
    v_fma_f32 v210, v120, v200, v210
    v_fma_f32 v211, v121, v201, v211
    v_pk_add_f32 v[212:213], v[56:57], v[208:209]
    v_pk_add_f32 v[214:215], v[56:57], v[208:209] neg_lo:[0,1] neg_hi:[0,1]
    v_cvt_pk_bf16_f32 v20, v212, v213
    v_cvt_pk_bf16_f32 v28, v214, v215
    v_pk_add_f32 v[212:213], v[72:73], v[210:211]
    v_pk_add_f32 v[214:215], v[72:73], v[210:211] neg_lo:[0,1] neg_hi:[0,1]
    v_cvt_pk_bf16_f32 v36, v212, v213
    v_cvt_pk_bf16_f32 v44, v214, v215
    v_mul_f32 v208, v122, v186
    v_mul_f32 v209, v123, v187
    v_mul_f32 v210, v138, v186
    v_mul_f32 v211, v139, v187
    v_fma_f32 v208, -v138, v202, v208
    v_fma_f32 v209, -v139, v203, v209
    v_fma_f32 v210, v122, v202, v210
    v_fma_f32 v211, v123, v203, v211
    v_pk_add_f32 v[212:213], v[58:59], v[208:209]
    v_pk_add_f32 v[214:215], v[58:59], v[208:209] neg_lo:[0,1] neg_hi:[0,1]
    v_cvt_pk_bf16_f32 v21, v212, v213
    v_cvt_pk_bf16_f32 v29, v214, v215
    v_pk_add_f32 v[212:213], v[74:75], v[210:211]
    v_pk_add_f32 v[214:215], v[74:75], v[210:211] neg_lo:[0,1] neg_hi:[0,1]
    v_cvt_pk_bf16_f32 v37, v212, v213
    v_cvt_pk_bf16_f32 v45, v214, v215
    v_mul_f32 v208, v124, v188
    v_mul_f32 v209, v125, v189
    v_mul_f32 v210, v140, v188
    v_mul_f32 v211, v141, v189
    v_fma_f32 v208, -v140, v204, v208
    v_fma_f32 v209, -v141, v205, v209
    v_fma_f32 v210, v124, v204, v210
    v_fma_f32 v211, v125, v205, v211
    v_pk_add_f32 v[212:213], v[60:61], v[208:209]
    v_pk_add_f32 v[214:215], v[60:61], v[208:209] neg_lo:[0,1] neg_hi:[0,1]
    v_cvt_pk_bf16_f32 v22, v212, v213
    v_cvt_pk_bf16_f32 v30, v214, v215
    v_pk_add_f32 v[212:213], v[76:77], v[210:211]
    v_pk_add_f32 v[214:215], v[76:77], v[210:211] neg_lo:[0,1] neg_hi:[0,1]
    v_cvt_pk_bf16_f32 v38, v212, v213
    v_cvt_pk_bf16_f32 v46, v214, v215
    v_mul_f32 v208, v126, v190
    v_mul_f32 v209, v127, v191
    v_mul_f32 v210, v142, v190
    v_mul_f32 v211, v143, v191
    v_fma_f32 v208, -v142, v206, v208
    v_fma_f32 v209, -v143, v207, v209
    v_fma_f32 v210, v126, v206, v210
    v_fma_f32 v211, v127, v207, v211
    v_pk_add_f32 v[212:213], v[62:63], v[208:209]
    v_pk_add_f32 v[214:215], v[62:63], v[208:209] neg_lo:[0,1] neg_hi:[0,1]
    v_cvt_pk_bf16_f32 v23, v212, v213
    v_cvt_pk_bf16_f32 v31, v214, v215
    v_pk_add_f32 v[212:213], v[78:79], v[210:211]
    v_pk_add_f32 v[214:215], v[78:79], v[210:211] neg_lo:[0,1] neg_hi:[0,1]
    v_cvt_pk_bf16_f32 v39, v212, v213
    v_cvt_pk_bf16_f32 v47, v214, v215
    v_mfma_f32_32x32x16_bf16 v[80:95], a[0:3], v[16:19], 0
    v_xor_b32 v208, 0, v6
    v_mfma_f32_32x32x16_bf16 v[96:111], a[0:3], v[32:35], 0
    v_xor_b32 v209, 16, v6
    v_mfma_f32_32x32x16_bf16 v[80:95], a[4:7], v[20:23], v[80:95]
    v_xor_b32 v210, 64, v6
    v_mfma_f32_32x32x16_bf16 v[96:111], a[4:7], v[36:39], v[96:111]
    v_xor_b32 v211, 80, v6
    v_mfma_f32_32x32x16_bf16 v[80:95], a[16:19], v[32:35], v[80:95]
    v_mfma_f32_32x32x16_bf16 v[96:111], a[8:11], v[16:19], v[96:111]
    v_mfma_f32_32x32x16_bf16 v[80:95], a[20:23], v[36:39], v[80:95]
    v_mfma_f32_32x32x16_bf16 v[96:111], a[12:15], v[20:23], v[96:111]
    v_mfma_f32_32x32x16_bf16 v[112:127], a[48:51], v[24:27], 0
    s_nop 7
    s_nop 1
    v_cvt_pk_bf16_f32 v80, v80, v81
    v_cvt_pk_bf16_f32 v81, v82, v83
    v_mfma_f32_32x32x16_bf16 v[128:143], a[48:51], v[40:43], 0
    v_cvt_pk_bf16_f32 v82, v84, v85
    v_cvt_pk_bf16_f32 v83, v86, v87
    v_cvt_pk_bf16_f32 v84, v88, v89
    v_mfma_f32_32x32x16_bf16 v[112:127], a[52:55], v[28:31], v[112:127]
    v_cvt_pk_bf16_f32 v85, v90, v91
    v_cvt_pk_bf16_f32 v86, v92, v93
    v_cvt_pk_bf16_f32 v87, v94, v95
    v_mfma_f32_32x32x16_bf16 v[128:143], a[52:55], v[44:47], v[128:143]
    ds_write_b128 v208, v[80:83] offset:0
    ds_write_b128 v209, v[84:87] offset:0
    v_cvt_pk_bf16_f32 v96, v96, v97
    v_mfma_f32_32x32x16_bf16 v[112:127], a[64:67], v[40:43], v[112:127]
    v_cvt_pk_bf16_f32 v97, v98, v99
    v_cvt_pk_bf16_f32 v98, v100, v101
    v_cvt_pk_bf16_f32 v99, v102, v103
    v_mfma_f32_32x32x16_bf16 v[128:143], a[56:59], v[24:27], v[128:143]
    v_cvt_pk_bf16_f32 v100, v104, v105
    v_cvt_pk_bf16_f32 v101, v106, v107
    v_cvt_pk_bf16_f32 v102, v108, v109
    v_mfma_f32_32x32x16_bf16 v[112:127], a[68:71], v[44:47], v[112:127]
    v_cvt_pk_bf16_f32 v103, v110, v111
    ds_write_b128 v208, v[96:99] offset:4096
    ds_write_b128 v209, v[100:103] offset:4096
    v_mfma_f32_32x32x16_bf16 v[128:143], a[60:63], v[28:31], v[128:143]
    s_nop 7
    v_cvt_pk_bf16_f32 v112, v112, v113
    v_cvt_pk_bf16_f32 v113, v114, v115
    v_cvt_pk_bf16_f32 v114, v116, v117
    v_cvt_pk_bf16_f32 v115, v118, v119
    v_cvt_pk_bf16_f32 v116, v120, v121
    v_cvt_pk_bf16_f32 v117, v122, v123
    v_cvt_pk_bf16_f32 v118, v124, v125
    v_cvt_pk_bf16_f32 v119, v126, v127
    ds_write_b128 v210, v[112:115] offset:0
    ds_write_b128 v211, v[116:119] offset:0
    v_cvt_pk_bf16_f32 v128, v128, v129
    v_cvt_pk_bf16_f32 v129, v130, v131
    v_cvt_pk_bf16_f32 v130, v132, v133
    v_cvt_pk_bf16_f32 v131, v134, v135
    v_cvt_pk_bf16_f32 v132, v136, v137
    v_cvt_pk_bf16_f32 v133, v138, v139
    v_cvt_pk_bf16_f32 v134, v140, v141
    v_cvt_pk_bf16_f32 v135, v142, v143
    ds_write_b128 v210, v[128:131] offset:4096
    ds_write_b128 v211, v[132:135] offset:4096
    s_waitcnt lgkmcnt(0)
    ds_read_b128 v[48:51], v7 offset:0
    ds_read_b128 v[52:55], v7 offset:1024
    ds_read_b128 v[56:59], v7 offset:2048
    ds_read_b128 v[60:63], v7 offset:3072
    ds_read_b128 v[64:67], v7 offset:4096
    ds_read_b128 v[68:71], v7 offset:5120
    ds_read_b128 v[72:75], v7 offset:6144
    ds_read_b128 v[76:79], v7 offset:7168
    s_waitcnt lgkmcnt(7)
    buffer_store_dwordx4 v[48:51], v1, s[16:19], s66 offen offset:0 sc0 sc1
    s_waitcnt lgkmcnt(6)
    buffer_store_dwordx4 v[52:55], v1, s[16:19], s66 offen offset:1024 sc0 sc1
    s_waitcnt lgkmcnt(5)
    buffer_store_dwordx4 v[56:59], v1, s[16:19], s66 offen offset:2048 sc0 sc1
    s_waitcnt lgkmcnt(4)
    buffer_store_dwordx4 v[60:63], v1, s[16:19], s66 offen offset:3072 sc0 sc1
    s_waitcnt lgkmcnt(3)
    s_add_u32 s66, s66, 4096
    buffer_store_dwordx4 v[64:67], v1, s[16:19], s66 offen offset:0 sc0 sc1
    s_waitcnt lgkmcnt(2)
    buffer_store_dwordx4 v[68:71], v1, s[16:19], s66 offen offset:1024 sc0 sc1
    s_waitcnt lgkmcnt(1)
    buffer_store_dwordx4 v[72:75], v1, s[16:19], s66 offen offset:2048 sc0 sc1
    s_waitcnt lgkmcnt(0)
    buffer_store_dwordx4 v[76:79], v1, s[16:19], s66 offen offset:3072 sc0 sc1
    s_waitcnt vmcnt(0)
    s_cmp_eq_u32 s80, 2
    s_cbranch_scc1 L_col2_done
    s_barrier
    v_mov_b32 v8, 3
    v_lshlrev_b32 v9, 8, v0
    s_mov_b64 exec, 0xff
    buffer_store_dword v8, v9, s[16:19], s84 offen sc0 sc1
    s_mov_b64 exec, -1
    s_cmp_eq_u32 s80, 1
    s_cbranch_scc0 L_side_done
    ds_write_b128 v12, a[128:131] offset:0
    ds_write_b128 v13, a[132:135] offset:0
    ds_write_b128 v12, a[136:139] offset:256
    ds_write_b128 v13, a[140:143] offset:256
    ds_write_b128 v12, a[144:147] offset:16640
    ds_write_b128 v13, a[148:151] offset:16640
    ds_write_b128 v12, a[152:155] offset:16896
    ds_write_b128 v13, a[156:159] offset:16896
    ds_write_b128 v14, a[160:163] offset:0
    ds_write_b128 v14, a[164:167] offset:4096
    ds_write_b128 v14, a[168:171] offset:8192
    ds_write_b128 v14, a[172:175] offset:12288
    ds_write_b128 v14, a[176:179] offset:16384
    ds_write_b128 v14, a[180:183] offset:20480
    ds_write_b128 v14, a[184:187] offset:24576
    ds_write_b128 v14, a[188:191] offset:28672
    s_mov_b32 s80, 2
    s_mov_b32 s70, -1
    s_mov_b32 s66, s79
    s_waitcnt lgkmcnt(0)
    s_branch L_col
L_col2_done:
    v_mov_b32 v8, 1
    v_lshlrev_b32 v9, 8, v0
    s_mov_b64 exec, 0xff
    buffer_store_dword v8, v9, s[16:19], s85 offen sc0 sc1
    s_mov_b64 exec, -1
L_side_done:
L_fin:
L_end:
    s_endpgm
L_code_end:
.section .rodata,"a"
.p2align 6
.amdhsa_kernel gated_mix__spectral_gfnet__glu_gated_reglu__prompt_kernel
  .amdhsa_next_free_vgpr 512
  .amdhsa_next_free_sgpr 102
  .amdhsa_accum_offset 256
  .amdhsa_group_segment_fixed_size 0
  .amdhsa_kernarg_size 88
  .amdhsa_user_sgpr_count 2
  .amdhsa_user_sgpr_kernarg_segment_ptr 1
  .amdhsa_system_sgpr_workgroup_id_x 1
  .amdhsa_float_denorm_mode_32 3
.end_amdhsa_kernel
.text
```
